```python
import torch

def _softmax(x, axis=-1):
    return torch.softmax(x, dim=axis)
def _gelu(x):
    return torch.nn.functional.gelu(x, approximate="tanh")
def _silu(x):
    return torch.nn.functional.silu(x)
def _sigmoid(x):
    return torch.sigmoid(x)
def _layernorm(x, axis=-1, eps=1e-5):
    m = x.mean(dim=axis, keepdim=True)
    v = x.var(dim=axis, keepdim=True, unbiased=False)
    return (x - m) / torch.sqrt(v + eps)
def _scatter_add(tgt, idx, src, axis=0):
    return tgt.clone().index_add_(axis, idx, src)
def _segment_sum(src, seg, n):
    out = torch.zeros((n,) + src.shape[1:], dtype=src.dtype)
    return out.index_add_(0, seg, src)
def _pad(x, pw):
    flat = tuple(v for pair in reversed(pw) for v in pair)
    return torch.nn.functional.pad(x, flat)

kernel_name = 'interleave_layers__mha_block__glu_gated_swiglu__prompt'

def setup_inputs():

    _w = (lambda a: (lambda t: t.to(torch.bfloat16) if t.is_floating_point() else t)(torch.as_tensor(a)))
    def _A_setup():
        B, S, D, H = 1, 2048, 512, 32
        return {
            "x": _w((lambda *s: torch.randn(*s, dtype=torch.bfloat16) * 0.05)(B, S, D)),
            "wqkv": _w((lambda *s: torch.randn(*s, dtype=torch.bfloat16) * 0.05)(D, 3 * D)),
            "wo": _w((lambda *s: torch.randn(*s, dtype=torch.bfloat16) * 0.05)(D, D)),
        }
    _A_in = _A_setup()

    def _B_setup():
        B, S, D, F = 1, 2048, 512, 1792
        return {
            "x": _w((lambda *s: torch.randn(*s, dtype=torch.bfloat16) * 0.05)(B, S, D)),
            "w1": _w((lambda *s: torch.randn(*s, dtype=torch.bfloat16) * 0.4)(D, F) * (2.0 / D) ** 0.5),
            "w3": _w((lambda *s: torch.randn(*s, dtype=torch.bfloat16) * 0.4)(D, F) * (2.0 / D) ** 0.5),
            "w2": _w((lambda *s: torch.randn(*s, dtype=torch.bfloat16) * 0.4)(F, D) * (2.0 / F) ** 0.5),
        }
    _B_in = _B_setup()

    return {
        "A_x": _A_in["x"],
        "A_wqkv": _A_in["wqkv"],
        "A_wo": _A_in["wo"],
        "B_x": _B_in["x"],
        "B_w1": _B_in["w1"],
        "B_w3": _B_in["w3"],
        "B_w2": _B_in["w2"],
    }

def reference(A_x, A_wqkv, A_wo, B_x, B_w1, B_w3, B_w2):
    def _A_ref(x, wqkv, wo):
        B, S, D = x.shape
        H = 32
        Dh = D // H
        qkv = (lambda x, *d: x.permute(*d))((x @ wqkv).reshape(B, S, 3, H, Dh), 2, 0, 3, 1, 4)
        q, k, v = qkv[0], qkv[1], qkv[2]
        scores = torch.einsum("bhqd,bhkd->bhqk", q, k) * (Dh ** -0.5)
        p = _softmax(scores, axis=-1)
        o = torch.einsum("bhqk,bhkd->bhqd", p, v)
        return (lambda x, *d: x.permute(*d))(o, 0, 2, 1, 3).reshape(B, S, D) @ wo

    def _B_ref(x, w1, w3, w2):
        gate = torch.einsum("bsd,df->bsf", x, w1)
        up = torch.einsum("bsd,df->bsf", x, w3)
        h = _silu(gate) * up
        out = torch.einsum("bsf,fd->bsd", h, w2)
        return out

    x = A_x
    x = x + _A_ref(_layernorm(x, axis=-1), A_wqkv, A_wo)
    x = x + _B_ref(_layernorm(x, axis=-1), B_w1, B_w3, B_w2)
    x = x + _A_ref(_layernorm(x, axis=-1), A_wqkv, A_wo)
    x = x + _B_ref(_layernorm(x, axis=-1), B_w1, B_w3, B_w2)
    return x
```

```asm
; @launch grid=(256,1,1) block=(256,1,1) lds=163840
.amdgcn_target "amdgcn-amd-amdhsa--gfx950"
.text
.globl interleave_layers__mha_block__glu_gated_swiglu__prompt_kernel
.p2align 8
.type interleave_layers__mha_block__glu_gated_swiglu__prompt_kernel,@function
interleave_layers__mha_block__glu_gated_swiglu__prompt_kernel:
  s_cmp_ge_u32 s2, 256
  s_cbranch_scc1 L_exit
  s_load_dwordx4 s[52:55], s[0:1], 0
  s_load_dwordx2 s[4:5], s[0:1], 72
  s_load_dwordx4 s[48:51], s[0:1], 56
  s_load_dwordx4 s[56:59], s[0:1], 16
  s_load_dwordx4 s[60:63], s[0:1], 32
  s_load_dwordx2 s[64:65], s[0:1], 48
  v_lshrrev_b32 v22, 6, v0
  v_and_b32 v0, 63, v0
  v_readfirstlane_b32 s16, v22
  s_getpc_b64 s[74:75]
L_pc:
  s_sub_u32 s74, s74, L_pc-interleave_layers__mha_block__glu_gated_swiglu__prompt_kernel
  s_subb_u32 s75, s75, 0
  s_lshr_b32 s18, s2, 3
  s_lshl_b32 s44, s18, 2
  s_add_u32 s44, s44, s16
  s_mul_i32 s44, s44, 640
  s_add_u32 s44, s44, 0
  v_min_u32 v140, 4, v0
  v_lshl_add_u32 v140, v140, 7, s44
  v_min_u32 v140, L_last-interleave_layers__mha_block__glu_gated_swiglu__prompt_kernel, v140
  global_load_dword v140, v140, s[74:75]
  v_lshlrev_b32 v1, 4, v0
  s_mov_b32 s6, 0x10000000
  s_mov_b32 s7, 0x20000
  s_and_b32 s17, s2, 7
  s_lshl_b32 s31, s17, 1
  s_lshr_b32 s32, s18, 4
  s_add_u32 s23, s31, s32
  s_and_b32 s24, s18, 15
  s_lshl_b32 s27, s23, 2
  s_lshr_b32 s31, s24, 2
  s_add_u32 s21, s27, s31
  s_and_b32 s31, s31, 2
  s_add_u32 s33, s27, s31
  s_lshr_b32 s31, s16, 1
  s_add_u32 s26, s33, s31
  s_add_u32 s27, s27, s16
  s_and_b32 s34, s24, 7
  s_lshl_b32 s31, s34, 1
  s_and_b32 s32, s16, 1
  s_add_u32 s25, s31, s32
  v_lshrrev_b32 v29, 2, v0
  v_and_b32 v30, 3, v0
  v_lshlrev_b32 v30, 4, v30
  s_movk_i32 s40, 3072
  v_mad_u32_u24 v170, v29, s40, v30
  s_add_u32 s37, s24, s23
  s_mul_i32 s42, s16, 12288
  s_add_u32 s42, s42, 98304
  s_lshl_b32 s41, s27, 15
  s_mul_i32 s85, s16, 3072
  s_mul_i32 s84, s16, 49152
  s_lshl_b32 s40, s24, 6
  s_add_u32 s84, s84, s40
  v_lshrrev_b32 v32, 3, v0
  v_and_b32 v33, 7, v0
  v_lshrrev_b32 v34, 4, v0
  v_xor_b32 v33, v33, v34
  v_lshlrev_b32 v32, 10, v32
  v_lshl_or_b32 v168, v33, 4, v32
  v_xor_b32 v169, 64, v168
  s_lshl_b32 s40, s16, 8
  s_add_u32 s40, s40, s2
  s_sub_u32 s40, s40, 251
  s_lshl_b32 s66, s40, 14
  s_lshl_b32 s67, s40, 2
  s_cmp_eq_u32 s40, 4
  s_cselect_b32 s66, 0x60000, s66
  s_cselect_b32 s43, 0, 1
  v_lshlrev_b32 v35, 8, v0
  v_lshl_add_u32 v36, v29, 8, v30
  s_cmp_eq_u32 s43, 0
  s_cselect_b64 vcc, -1, 0
  v_cndmask_b32 v35, v35, v36, vcc
  v_mov_b64 v[36:37], 0
  v_mov_b64 v[38:39], 0
  s_cmp_gt_u32 s40, 4
  s_cselect_b32 s66, 0x40000000, s66
  s_cselect_b32 s67, 0x40000000, s67
  s_waitcnt lgkmcnt(0)
  s_mov_b32 s8, s52
  s_mov_b32 s9, s53
  s_mov_b32 s10, 2097152
  s_mov_b32 s11, 0x20000
  s_mov_b32 s12, s54
  s_mov_b32 s13, s55
  s_mov_b32 s14, 1572864
  s_mov_b32 s15, 0x20000
  s_mov_b32 s96, s50
  s_mov_b32 s97, s51
  s_mov_b32 s98, 256
  s_mov_b32 s99, 0x20000
  buffer_store_dwordx4 v[36:39], v35, s[4:7], s66 offen sc1
  s_add_u32 s83, s37, 0
  s_and_b32 s83, s83, 7
  s_mul_i32 s83, s83, 196608
  s_add_u32 m0, s85, 0
  s_add_u32 s83, s83, s84
  buffer_load_dwordx4 v170, s[12:15], s83 offen offset:0  lds
  buffer_load_dwordx4 v170, s[12:15], s83 offen offset:1024  lds
  buffer_load_dwordx4 v170, s[12:15], s83 offen offset:2048  lds
  s_add_u32 s81, s37, 0
  s_and_b32 s81, s81, 7
  s_lshl_b32 s81, s81, 7
  s_add_u32 s81, s81, s41
  s_add_u32 m0, s42, 0
  s_add_u32 s33, s81, 0
  buffer_load_dwordx4 v168, s[8:11], s33 offen  lds
  s_add_u32 m0, s42, 1024
  s_add_u32 s33, s81, 8192
  buffer_load_dwordx4 v169, s[8:11], s33 offen  lds
  s_add_u32 m0, s42, 2048
  s_add_u32 s33, s81, 16384
  buffer_load_dwordx4 v168, s[8:11], s33 offen  lds
  s_add_u32 m0, s42, 3072
  s_add_u32 s33, s81, 24576
  buffer_load_dwordx4 v169, s[8:11], s33 offen  lds
  v_lshlrev_b32 v19, 2, v0
  v_add_u32 v17, 0x10000, v1
  v_add_u32 v18, 0x20000, v1
  v_mov_b32 v3, 0xdddddddd
  s_getreg_b32 s78, hwreg(HW_REG_XCC_ID, 0, 4)
  s_mov_b32 s28, 0xffff
  s_mov_b32 s29, 0xffff
  s_mov_b32 s20, 0x40000
  s_mov_b32 s79, 0
  s_lshl_b32 s30, s2, 8
  s_lshl_b32 s43, s23, 8
  s_lshl_b32 s44, s24, 2
  s_add_u32 s77, s43, s44
  s_add_u32 s77, s77, 0x60000
  s_and_b32 s43, s24, 3
  s_lshl_b32 s43, s43, 2
  s_add_u32 s22, s43, s16
  v_lshrrev_b32 v24, 5, v0
  v_bfe_u32 v25, v0, 2, 2
  v_lshl_or_b32 v27, v24, 3, v25
  v_bfe_u32 v24, v0, 4, 1
  v_and_b32 v25, 1, v0
  v_bfe_u32 v26, v0, 1, 1
  v_lshlrev_b32 v24, 2, v24
  v_lshl_or_b32 v24, v25, 1, v24
  v_or_b32 v28, v24, v26
  v_and_b32 v24, 31, v0
  v_lshrrev_b32 v25, 5, v0
  v_bfe_u32 v26, v0, 1, 3
  v_xor_b32 v25, v25, v26
  v_lshlrev_b32 v25, 4, v25
  v_lshl_or_b32 v25, v24, 7, v25
  v_add_u32 v164, s42, v25
  v_xor_b32 v165, 32, v164
  v_xor_b32 v166, 64, v164
  v_xor_b32 v167, 0x60, v164
  v_lshlrev_b32 v25, 6, v27
  v_lshl_or_b32 v171, v28, 3, v25
  v_add_u32 v172, 0x10000, v171
  s_lshr_b32 s34, s23, 3
  s_lshl_b32 s35, s34, 1
  s_add_u32 s35, s35, s16
  s_add_u32 s34, s34, s16
  s_min_u32 s35, s35, 2
  s_and_b32 s36, s37, 7
  s_lshl_b32 s40, s35, 10
  v_add_u32 v173, s40, v171
  v_min_u32 v174, 4, v0
  s_lshl_b32 s40, s16, 12
  v_lshl_add_u32 v174, v174, 2, s40
  v_lshlrev_b32 v31, 4, v24
  s_mul_i32 s38, s24, 101376
  s_lshl_b32 s40, s35, 10
  s_add_u32 s38, s38, s40
  s_add_u32 s38, s38, 0x200000
  s_cmp_ge_u32 s34, 2
  s_cselect_b32 s38, 0x40000000, s38
  s_lshr_b32 s39, s36, 2
  s_lshl_b32 s39, s39, 9
  s_and_b32 s40, s36, 3
  s_lshl_b32 s40, s40, 2
  s_add_u32 s39, s39, s40
  s_add_u32 s39, s39, s38
  s_add_u32 s39, s39, 98304
  s_mul_i32 s40, s36, 12288
  s_add_u32 s38, s38, s40
  s_cmp_eq_u32 s16, 0
  s_cselect_b32 s34, 1, 0
  v_mov_b32 v152, 0x3f803f80
  v_mov_b32 v153, 0x3f803f80
  v_mov_b32 v154, 0x3f803f80
  v_mov_b32 v155, 0x3f803f80
  s_lshr_b32 s40, s24, 3
  s_lshl_b32 s32, s36, 1
  s_add_u32 s32, s32, s40
  s_lshl_b32 s32, s32, 8
  s_lshl_b32 s40, s40, 6
  v_xor_b32 v156, s40, v164
  v_xor_b32 v157, 32, v156
  s_lshl_b32 s40, s27, 12
  s_add_u32 s32, s32, s40
  s_add_u32 s32, s32, 0x80000
  s_and_b32 s44, s2, 7
  s_lshr_b32 s89, s2, 3
  s_mul_i32 s90, s44, 229376
  s_lshl_b32 s3, s89, 7
  s_add_u32 s90, s90, s3
  s_sub_u32 s19, s89, 28
  s_lshl_b32 s19, s19, 17
  s_lshl_b32 s3, s44, 7
  s_add_u32 s19, s19, s3
  s_lshl_b32 s100, s89, 16
  s_add_u32 s100, s100, s3
  s_add_u32 s58, s56, 0x10000
  s_addc_u32 s59, s57, 0
  s_movk_i32 s91, 1024
  s_cmp_lt_u32 s2, 224
  s_cselect_b32 s90, s90, s19
  s_cselect_b32 s91, 0xe00, s91
  s_cselect_b64 s[60:61], s[60:61], s[56:57]
  s_cselect_b64 s[62:63], s[62:63], s[58:59]
  s_cselect_b32 s100, s100, 0
  s_lshl_b32 s3, s16, 4
  v_lshrrev_b32 v32, 3, v0
  v_add_u32 v32, s3, v32
  v_and_b32 v33, 7, v0
  v_lshlrev_b32 v33, 4, v33
  v_mad_u32_u24 v146, v32, s91, v33
  v_add_u32 v146, s90, v146
  v_lshl_add_u32 v144, v32, 10, v33
  v_add_u32 v144, s100, v144
  s_lshl_b32 s101, s91, 3
  s_lshl_b32 s100, s16, 11
  s_add_u32 s100, s100, 73728
  s_mov_b64 s[68:69], s[60:61]
  s_mov_b64 s[70:71], s[62:63]
  s_mov_b64 s[72:73], s[64:65]
  s_and_b32 s44, s2, 7
  s_lshr_b32 s89, s2, 3
  s_lshl_b32 s43, s89, 2
  s_add_u32 s43, s43, s16
  s_mul_i32 s80, s43, 33792
  s_add_u32 s80, s80, 0x5d0000
  s_lshr_b32 s82, s44, 2
  s_lshl_b32 s82, s82, 9
  s_and_b32 s3, s44, 3
  s_lshl_b32 s3, s3, 2
  s_add_u32 s82, s82, s3
  s_add_u32 s82, s82, s80
  s_add_u32 s82, s82, 32768
  s_lshl_b32 s3, s44, 12
  s_add_u32 s80, s80, s3
  s_lshl_b32 s88, s44, 1
  s_and_b32 s3, s16, 1
  s_add_u32 s88, s88, s3
  s_lshl_b32 s89, s89, 1
  s_lshr_b32 s3, s16, 1
  s_add_u32 s89, s89, s3
  s_mul_i32 s1, s88, 114688
  s_lshl_b32 s91, s89, 11
  s_add_u32 s1, s1, s91
  s_add_u32 s1, s1, 0x410000
  s_sub_u32 s89, s89, 56
  s_lshl_b32 s19, s88, 15
  s_lshl_b32 s91, s89, 12
  s_add_u32 s19, s19, s91
  s_add_u32 s19, s19, 0x390000
  v_lshrrev_b32 v32, 2, v28
  v_and_b32 v33, 3, v28
  v_lshlrev_b32 v32, 13, v32
  v_lshl_or_b32 v32, v33, 3, v32
  s_lshl_b32 s91, s16, 5
  v_add_u32 v32, s91, v32
  s_and_b32 s91, s16, 1
  s_lshl_b32 s91, s91, 6
  v_lshl_add_u32 v33, v28, 3, s91
  v_lshlrev_b32 v34, 7, v27
  v_add_u32 v34, 73728, v34
  s_lshl_b32 s91, s3, 12
  s_add_u32 s91, s91, 16384
  v_add3_u32 v147, v33, v34, s91
  s_lshl_b32 s91, s3, 13
  v_add_u32 v33, s91, v33
  s_cmp_lt_u32 s2, 224
  s_cselect_b32 s80, s80, s19
  s_cselect_b32 s82, s82, 0x40000000
  s_cselect_b32 s1, s1, 0x40000000
  s_cselect_b64 s[92:93], -1, 0
  v_cndmask_b32 v32, v33, v32, s[92:93]
  v_add_u32 v14, v32, v34
  s_mul_i32 s3, s24, 7
  s_lshr_b32 s3, s3, 2
  v_lshrrev_b32 v32, 3, v0
  v_add_u32 v32, s3, v32
  v_min_u32 v32, 27, v32
  v_and_b32 v34, 7, v0
  v_lshl_add_u32 v32, v32, 3, v34
  s_lshr_b32 s3, s22, 1
  s_add_u32 s3, s3, 224
  v_and_b32 v33, 3, v0
  v_cmp_lt_u32 s[92:93], 23, v0
  v_cmp_lt_u32 s[94:95], 31, v0
  v_lshl_add_u32 v33, v33, 3, s3
  v_cndmask_b32 v32, v32, v33, s[92:93]
  s_mul_i32 s3, s16, 56
  s_lshr_b32 s91, s25, 1
  s_add_u32 s3, s3, s91
  v_min_u32 v33, 6, v34
  v_lshl_add_u32 v33, v33, 3, s3
  v_cndmask_b32 v32, v32, v33, s[94:95]
  v_bfe_u32 v33, v0, 1, 3
  v_and_b32 v34, 1, v0
  v_lshl_add_u32 v33, v34, 7, v33
  s_lshl_b32 s3, s24, 3
  v_cmp_lt_u32 s[92:93], 39, v0
  v_add_u32 v33, s3, v33
  s_mov_b32 s3, 0x8
  v_cndmask_b32 v32, v32, v33, s[92:93]
  v_lshl_add_u32 v16, v32, 8, s3
  v_lshrrev_b32 v24, 5, v0
  v_and_b32 v35, 15, v0
  v_lshlrev_b32 v25, 4, v35
  v_lshl_or_b32 v2, v24, 8, v25
  v_bfe_u32 v25, v0, 4, 1
  v_lshl_or_b32 v21, v25, 17, v2
  v_and_b32 v24, 0x33, v0
  v_bfe_u32 v25, v0, 2, 1
  v_bfe_u32 v26, v0, 3, 1
  v_lshl_or_b32 v24, v25, 3, v24
  v_lshl_or_b32 v24, v26, 2, v24
  v_lshlrev_b32 v20, 4, v24
  s_lshl_b32 s43, s23, 8
  s_add_u32 s43, s43, 0x60000
  v_lshl_add_u32 v13, v35, 2, s43
  s_and_b32 s43, s23, 14
  s_add_u32 s43, s43, 2
  v_min_u32 v35, 13, v35
  v_add_u32 v35, s43, v35
  v_bfe_u32 v24, v35, 1, 3
  v_and_b32 v25, 1, v35
  v_lshl_add_u32 v24, v25, 7, v24
  s_lshl_b32 s43, s24, 3
  v_add_u32 v24, s43, v24
  v_lshlrev_b32 v12, 8, v24
  v_and_b32 v24, 15, v0
  s_lshr_b32 s43, s18, 4
  s_lshl_b32 s43, s43, 7
  s_add_u32 s43, s43, s17
  v_lshl_add_u32 v25, v24, 3, s43
  v_lshrrev_b32 v26, 1, v24
  v_and_b32 v24, 1, v24
  v_lshl_add_u32 v24, v24, 7, v26
  s_lshl_b32 s43, s24, 3
  v_add_u32 v24, s43, v24
  v_cmp_gt_u32 s[92:93], 16, v0
  v_cmp_lt_u32 s[94:95], 39, v0
  s_xor_b32 s43, s2, 128
  v_cndmask_b32 v24, v24, v25, s[92:93]
  v_mov_b32 v25, s43
  v_cndmask_b32 v24, v24, v25, s[94:95]
  v_lshlrev_b32 v175, 8, v24
  s_and_b32 s61, s16, 1
  s_lshl_b32 s52, s24, 1
  s_add_u32 s52, s52, s61
  s_lshl_b32 s61, s61, 10
  s_add_u32 s61, s61, 135168
  v_add_u32 v143, s61, v1
  s_and_b32 s62, s16, 2
  s_mul_i32 s54, s62, 6144
  v_add_u32 v163, s54, v143
  s_add_u32 s61, s61, s54
  v_add_u32 v145, s61, v2
  s_sub_u32 s54, 12288, s54
  v_add_u32 v141, s54, v143
  s_lshl_b32 s53, s23, 2
  s_add_u32 s53, s53, s62
  s_lshl_b32 s62, s62, 11
  s_xor_b32 s54, s23, 1
  s_lshl_b32 s54, s54, 13
  s_add_u32 s54, s54, s62
  s_and_b32 s59, s23, 14
  s_add_u32 s59, s59, 2
  s_and_b32 s59, s59, 15
  s_lshl_b32 s59, s59, 13
  s_add_u32 s59, s59, s62
  s_xor_b32 s60, s77, 256
  s_lshl_b32 s61, s52, 17
  s_add_u32 s61, s61, 0x1a00000
  s_mov_b32 s58, 0
  s_mul_i32 s55, s24, 7
  s_add_u32 s57, s55, 4
  s_add_u32 s55, s55, s16
  s_mul_i32 s55, s55, 33792
  s_add_u32 s55, s55, 0x5d0000
  s_mul_i32 s57, s57, 33792
  s_lshl_b32 s62, s16, 13
  s_add_u32 s57, s57, s62
  s_add_u32 s57, s57, 0x5d0000
  s_lshl_b32 s56, s22, 15
  s_add_u32 s56, s56, 0x390000
  s_lshl_b32 s86, s21, 15
  s_lshl_b32 s62, s22, 6
  s_add_u32 s86, s86, s62
  v_and_b32 v176, 27, v0
  v_mov_b32 v177, 0x3f803f80
  v_cmp_eq_u32 s[64:65], 16, v176
  s_nop 1
  v_cndmask_b32 v176, 0, v177, s[64:65]
  v_mov_b32 v177, v176
  v_mov_b64 v[178:179], v[176:177]
  v_mov_b64 v[180:181], v[176:177]
  v_mov_b64 v[182:183], v[176:177]
  v_mov_b64 v[184:185], v[176:177]
  v_mov_b64 v[186:187], v[176:177]
  v_mov_b64 v[188:189], v[176:177]
  v_mov_b64 v[190:191], v[176:177]
  v_mov_b64 v[192:193], 0
  v_mov_b64 v[194:195], 0
  v_mov_b64 v[196:197], 0
  v_mov_b64 v[198:199], 0
  v_mov_b64 v[200:201], 0
  v_mov_b64 v[202:203], 0
  v_mov_b64 v[204:205], 0
  v_mov_b64 v[206:207], 0
  v_mov_b64 v[208:209], 0
  v_mov_b64 v[210:211], 0
  v_mov_b64 v[212:213], 0
  v_mov_b64 v[214:215], 0
  v_mov_b64 v[216:217], 0
  v_mov_b64 v[218:219], 0
  v_mov_b64 v[220:221], 0
  v_mov_b64 v[222:223], 0
  v_mov_b64 v[224:225], 0
  v_mov_b64 v[226:227], 0
  v_mov_b64 v[228:229], 0
  v_mov_b64 v[230:231], 0
  v_mov_b64 v[232:233], 0
  v_mov_b64 v[234:235], 0
  v_mov_b64 v[236:237], 0
  v_mov_b64 v[238:239], 0
  v_mov_b64 v[240:241], 0
  v_mov_b64 v[242:243], 0
  v_mov_b64 v[244:245], 0
  v_mov_b64 v[246:247], 0
  v_mov_b64 v[248:249], 0
  v_mov_b64 v[250:251], 0
  v_mov_b64 v[252:253], 0
  v_mov_b64 v[254:255], 0
  s_waitcnt vmcnt(7)
  s_mov_b64 exec, 1
  buffer_store_dword v152, off, s[96:99], s67 sc1
  s_mov_b64 exec, -1
  s_add_u32 s83, s37, 1
  s_and_b32 s83, s83, 7
  s_mul_i32 s83, s83, 196608
  s_add_u32 m0, s85, 12288
  s_add_u32 s83, s83, s84
  buffer_load_dwordx4 v170, s[12:15], s83 offen offset:0  lds
  buffer_load_dwordx4 v170, s[12:15], s83 offen offset:1024  lds
  buffer_load_dwordx4 v170, s[12:15], s83 offen offset:2048  lds
  s_add_u32 s81, s37, 1
  s_and_b32 s81, s81, 7
  s_lshl_b32 s81, s81, 7
  s_add_u32 s81, s81, s41
  s_add_u32 m0, s42, 4096
  s_add_u32 s33, s81, 0
  buffer_load_dwordx4 v168, s[8:11], s33 offen  lds
  s_add_u32 m0, s42, 5120
  s_add_u32 s33, s81, 8192
  buffer_load_dwordx4 v169, s[8:11], s33 offen  lds
  s_add_u32 m0, s42, 6144
  s_add_u32 s33, s81, 16384
  buffer_load_dwordx4 v168, s[8:11], s33 offen  lds
  s_add_u32 m0, s42, 7168
  s_add_u32 s33, s81, 24576
  buffer_load_dwordx4 v169, s[8:11], s33 offen  lds
  s_mov_b32 s87, s38
  s_waitcnt vmcnt(8)
  s_barrier
  ds_read_b128 a[0:3], v164 offset:0
  ds_read_b128 a[4:7], v165 offset:0
  ds_read_b128 a[8:11], v166 offset:0
  ds_read_b128 a[12:15], v167 offset:0
  ds_read_b64_tr_b16 v[104:105], v171 offset:1024
  ds_read_b64_tr_b16 v[106:107], v171 offset:1280
  ds_read_b64_tr_b16 v[108:109], v171 offset:2048
  ds_read_b64_tr_b16 v[110:111], v171 offset:2304
  ds_read_b64_tr_b16 v[112:113], v171 offset:0
  ds_read_b64_tr_b16 v[114:115], v171 offset:256
  ds_read_b64_tr_b16 v[116:117], v171 offset:4096
  ds_read_b64_tr_b16 v[118:119], v171 offset:4352
  s_waitcnt lgkmcnt(6)
  v_mfma_f32_32x32x16_bf16 v[56:71], v[104:107], a[0:3], 0
  s_add_u32 s83, s37, 2
  s_and_b32 s83, s83, 7
  s_mul_i32 s83, s83, 196608
  s_add_u32 m0, s85, 24576
  s_add_u32 s83, s83, s84
  buffer_load_dwordx4 v170, s[12:15], s83 offen offset:0  lds
  ds_read_b64_tr_b16 v[120:121], v171 offset:5120
  ds_read_b64_tr_b16 v[122:123], v171 offset:5376
  ds_read_b128 v[4:7], v156
  ds_read_b128 v[8:11], v157
  s_waitcnt lgkmcnt(8)
  v_mfma_f32_32x32x16_bf16 v[72:87], a[0:3], v[108:111], 0
  buffer_load_dwordx4 v170, s[12:15], s83 offen offset:1024  lds
  ds_read_b64_tr_b16 v[104:105], v171 offset:3072
  ds_read_b64_tr_b16 v[106:107], v171 offset:3328
  ds_read_b64_tr_b16 a[32:33], v173 offset:0
  ds_read_b64_tr_b16 a[34:35], v173 offset:256
  s_waitcnt lgkmcnt(10)
  v_mfma_f32_32x32x16_bf16 v[40:55], v[112:115], a[0:3], 0
  buffer_load_dwordx4 v170, s[12:15], s83 offen offset:2048  lds
  ds_read_b64_tr_b16 v[108:109], v171 offset:7168
  ds_read_b64_tr_b16 v[110:111], v171 offset:7424
  ds_read_b64_tr_b16 a[36:37], v173 offset:3072
  ds_read_b64_tr_b16 a[38:39], v173 offset:3328
  s_waitcnt lgkmcnt(12)
  v_mfma_f32_32x32x16_bf16 v[56:71], v[116:119], a[4:7], v[56:71]
  s_add_u32 s81, s37, 2
  s_and_b32 s81, s81, 7
  s_lshl_b32 s81, s81, 7
  s_add_u32 s81, s81, s41
  s_add_u32 m0, s42, 8192
  s_add_u32 s33, s81, 0
  buffer_load_dwordx4 v168, s[8:11], s33 offen  lds
  ds_read_b64_tr_b16 v[112:113], v171 offset:8192
  ds_read_b64_tr_b16 v[114:115], v171 offset:8448
  ds_read_b64_tr_b16 a[40:41], v173 offset:6144
  ds_read_b64_tr_b16 a[42:43], v173 offset:6400
  s_waitcnt lgkmcnt(14)
  v_mfma_f32_32x32x16_bf16 v[72:87], a[4:7], v[120:123], v[72:87]
  s_add_u32 m0, s42, 9216
  s_add_u32 s33, s81, 8192
  buffer_load_dwordx4 v169, s[8:11], s33 offen  lds
  ds_read_b64_tr_b16 v[116:117], v171 offset:6144
  ds_read_b64_tr_b16 v[118:119], v171 offset:6400
  ds_read_b64_tr_b16 a[44:45], v173 offset:9216
  ds_read_b64_tr_b16 a[46:47], v173 offset:9472
  s_waitcnt lgkmcnt(0)
  v_lshlrev_b32 v88, 16, v4
  v_and_b32 v89, 0xffff0000, v4
  v_lshlrev_b32 v90, 16, v5
  v_and_b32 v91, 0xffff0000, v5
  v_lshlrev_b32 v92, 16, v6
  v_and_b32 v93, 0xffff0000, v6
  v_lshlrev_b32 v94, 16, v7
  v_and_b32 v95, 0xffff0000, v7
  v_lshlrev_b32 v96, 16, v8
  v_and_b32 v97, 0xffff0000, v8
  v_lshlrev_b32 v98, 16, v9
  v_and_b32 v99, 0xffff0000, v9
  s_waitcnt lgkmcnt(14)
  v_mfma_f32_32x32x16_bf16 v[40:55], v[104:107], a[4:7], v[40:55]
  s_add_u32 m0, s42, 10240
  s_add_u32 s33, s81, 16384
  buffer_load_dwordx4 v168, s[8:11], s33 offen  lds
  ds_read_b64_tr_b16 v[120:121], v171 offset:10240
  ds_read_b64_tr_b16 v[122:123], v171 offset:10496
  v_lshlrev_b32 v100, 16, v10
  v_and_b32 v101, 0xffff0000, v10
  v_lshlrev_b32 v102, 16, v11
  v_and_b32 v103, 0xffff0000, v11
  v_mfma_f32_32x32x16_bf16 a[72:87], v[152:155], a[32:35], 0
  v_mfma_f32_32x32x16_bf16 a[72:87], v[152:155], a[36:39], a[72:87]
  v_mfma_f32_32x32x16_bf16 a[72:87], v[152:155], a[40:43], a[72:87]
  v_mfma_f32_32x32x16_bf16 a[72:87], v[152:155], a[44:47], a[72:87]
  v_pk_add_f32 v[148:149], v[88:89], v[90:91]
  v_pk_mul_f32 v[150:151], v[88:89], v[88:89]
  s_waitcnt lgkmcnt(12)
  v_mfma_f32_32x32x16_bf16 v[56:71], v[108:111], a[8:11], v[56:71]
  s_add_u32 m0, s42, 11264
  s_add_u32 s33, s81, 24576
  buffer_load_dwordx4 v169, s[8:11], s33 offen  lds
  ds_read_b64_tr_b16 v[104:105], v171 offset:11264
  ds_read_b64_tr_b16 v[106:107], v171 offset:11520
  v_pk_fma_f32 v[150:151], v[90:91], v[90:91], v[150:151]
  v_pk_fma_f32 v[150:151], v[92:93], v[92:93], v[150:151]
  v_pk_add_f32 v[148:149], v[148:149], v[92:93]
  v_pk_fma_f32 v[150:151], v[94:95], v[94:95], v[150:151]
  v_pk_add_f32 v[148:149], v[148:149], v[94:95]
  v_pk_fma_f32 v[150:151], v[96:97], v[96:97], v[150:151]
  v_pk_add_f32 v[148:149], v[148:149], v[96:97]
  v_pk_fma_f32 v[150:151], v[98:99], v[98:99], v[150:151]
  s_waitcnt lgkmcnt(10)
  v_mfma_f32_32x32x16_bf16 v[72:87], a[8:11], v[112:115], v[72:87]
  ds_read_b64_tr_b16 v[108:109], v171 offset:9216
  ds_read_b64_tr_b16 v[110:111], v171 offset:9472
  v_pk_add_f32 v[148:149], v[148:149], v[98:99]
  v_pk_fma_f32 v[150:151], v[100:101], v[100:101], v[150:151]
  v_pk_add_f32 v[148:149], v[148:149], v[100:101]
  v_pk_fma_f32 v[150:151], v[102:103], v[102:103], v[150:151]
  v_pk_add_f32 v[148:149], v[148:149], v[102:103]
  v_add_f32 v148, v148, v149
  v_add_f32 v149, v150, v151
  s_nop 1
  v_permlane32_swap_b32 v148, v149
  s_waitcnt lgkmcnt(8)
  v_mfma_f32_32x32x16_bf16 v[40:55], v[116:119], a[8:11], v[40:55]
  s_waitcnt vmcnt(7)
  s_barrier
  ds_read_b128 a[16:19], v164 offset:4096
  ds_read_b128 a[20:23], v165 offset:4096
  ds_read_b128 a[24:27], v166 offset:4096
  ds_read_b128 a[28:31], v167 offset:4096
  ds_read_b64_tr_b16 v[112:113], v171 offset:13312
  ds_read_b64_tr_b16 v[114:115], v171 offset:13568
  v_add_f32 v148, v148, v149
  buffer_store_dword v148, v19, s[4:7], s32 offen sc1
  v_accvgpr_read_b32 v158, a72
  v_and_b32 v156, 0xffff0000, v158
  v_sub_f32 v157, v158, v156
  v_cvt_pk_bf16_f32 v156, v156, v157
  buffer_store_dword v156, v31, s[4:7], s39 offen sc1
  buffer_load_dword v23, v174, s[96:99], 0 offen sc1
  s_waitcnt lgkmcnt(10)
  v_mfma_f32_32x32x16_bf16 v[56:71], v[120:123], a[12:15], v[56:71]
  s_add_u32 m0, s100, 0
  s_nop 0
  global_load_lds_dwordx4 v146, s[68:69] nt
  s_add_u32 m0, s100, 8192
  s_nop 0
  global_load_lds_dwordx4 v146, s[70:71] nt
  v_add_u32 v146, s101, v146
  ds_read_b64_tr_b16 v[116:117], v171 offset:14336
  ds_read_b64_tr_b16 v[118:119], v171 offset:14592
  s_waitcnt lgkmcnt(10)
  v_mfma_f32_32x32x16_bf16 v[72:87], a[12:15], v[104:107], v[72:87]
  s_add_u32 m0, s100, 1024
  s_nop 0
  global_load_lds_dwordx4 v146, s[68:69] nt
  s_add_u32 m0, s100, 9216
  s_nop 0
  global_load_lds_dwordx4 v146, s[70:71] nt
  ds_read_b64_tr_b16 v[120:121], v171 offset:12288
  ds_read_b64_tr_b16 v[122:123], v171 offset:12544
  s_waitcnt lgkmcnt(10)
  v_mfma_f32_32x32x16_bf16 v[40:55], v[108:111], a[12:15], v[40:55]
  s_add_u32 m0, s100, 16384
  s_nop 0
  global_load_lds_dwordx4 v144, s[72:73] nt
  v_add_u32 v144, 8192, v144
  s_add_u32 m0, s100, 17408
  s_nop 0
  global_load_lds_dwordx4 v144, s[72:73] nt
  ds_read_b64_tr_b16 v[104:105], v171 offset:16384
  ds_read_b64_tr_b16 v[106:107], v171 offset:16640
  s_waitcnt lgkmcnt(6)
  v_mfma_f32_32x32x16_bf16 v[56:71], v[112:115], a[16:19], v[56:71]
  s_waitcnt vmcnt(6)
  v_cmp_gt_u32 vcc, s34, v23
  s_cbranch_vccnz L_slow_1
L_back_2:
  s_barrier
  v_mov_b32 v22, 1
  s_cmp_lg_u32 s16, 0
  s_cbranch_scc1 L_sig_3
  s_mov_b64 exec, 1
  v_mov_b32 v23, s78
  buffer_store_dwordx2 v[22:23], off, s[4:7], s30 sc1
  s_mov_b64 exec, -1
L_sig_3:
  s_add_u32 s81, s37, 3
  s_and_b32 s81, s81, 7
  s_lshl_b32 s81, s81, 7
  s_add_u32 s81, s81, s41
  s_add_u32 m0, s42, 0
  s_add_u32 s33, s81, 0
  buffer_load_dwordx4 v168, s[8:11], s33 offen  lds
  s_add_u32 m0, s42, 1024
  s_add_u32 s33, s81, 8192
  buffer_load_dwordx4 v169, s[8:11], s33 offen  lds
  ds_read_b64_tr_b16 v[108:109], v171 offset:17408
  ds_read_b64_tr_b16 v[110:111], v171 offset:17664
  s_waitcnt lgkmcnt(6)
  v_mfma_f32_32x32x16_bf16 v[72:87], a[16:19], v[116:119], v[72:87]
  s_add_u32 m0, s42, 2048
  s_add_u32 s33, s81, 16384
  buffer_load_dwordx4 v168, s[8:11], s33 offen  lds
  s_add_u32 m0, s42, 3072
  s_add_u32 s33, s81, 24576
  buffer_load_dwordx4 v169, s[8:11], s33 offen  lds
  ds_read_b64_tr_b16 v[112:113], v171 offset:15360
  ds_read_b64_tr_b16 v[114:115], v171 offset:15616
  s_waitcnt lgkmcnt(6)
  v_mfma_f32_32x32x16_bf16 v[40:55], v[120:123], a[16:19], v[40:55]
  s_add_u32 s83, s37, 3
  s_and_b32 s83, s83, 7
  s_mul_i32 s83, s83, 196608
  s_add_u32 m0, s85, 36864
  s_add_u32 s83, s83, s84
  buffer_load_dwordx4 v170, s[12:15], s83 offen offset:0  lds
  buffer_load_dwordx4 v170, s[12:15], s83 offen offset:1024  lds
  ds_read_b64_tr_b16 v[116:117], v171 offset:19456
  ds_read_b64_tr_b16 v[118:119], v171 offset:19712
  s_waitcnt lgkmcnt(6)
  v_mfma_f32_32x32x16_bf16 v[56:71], v[104:107], a[20:23], v[56:71]
  buffer_load_dwordx4 v170, s[12:15], s83 offen offset:2048  lds
  ds_read_b64_tr_b16 v[120:121], v171 offset:20480
  ds_read_b64_tr_b16 v[122:123], v171 offset:20736
  s_waitcnt lgkmcnt(6)
  v_mfma_f32_32x32x16_bf16 v[72:87], a[20:23], v[108:111], v[72:87]
  s_add_u32 s81, s37, 4
  s_and_b32 s81, s81, 7
  s_lshl_b32 s81, s81, 7
  s_add_u32 s81, s81, s41
  s_add_u32 m0, s42, 4096
  s_add_u32 s33, s81, 0
  buffer_load_dwordx4 v168, s[8:11], s33 offen  lds
  ds_read_b64_tr_b16 v[104:105], v171 offset:18432
  ds_read_b64_tr_b16 v[106:107], v171 offset:18688
  s_waitcnt lgkmcnt(6)
  v_mfma_f32_32x32x16_bf16 v[40:55], v[112:115], a[20:23], v[40:55]
  s_add_u32 m0, s42, 5120
  s_add_u32 s33, s81, 8192
  buffer_load_dwordx4 v169, s[8:11], s33 offen  lds
  ds_read_b64_tr_b16 v[108:109], v171 offset:22528
  ds_read_b64_tr_b16 v[110:111], v171 offset:22784
  s_waitcnt lgkmcnt(6)
  v_mfma_f32_32x32x16_bf16 v[56:71], v[116:119], a[24:27], v[56:71]
  s_add_u32 m0, s42, 6144
  s_add_u32 s33, s81, 16384
  buffer_load_dwordx4 v168, s[8:11], s33 offen  lds
  ds_read_b64_tr_b16 v[112:113], v171 offset:23552
  ds_read_b64_tr_b16 v[114:115], v171 offset:23808
  s_waitcnt lgkmcnt(6)
  v_mfma_f32_32x32x16_bf16 v[72:87], a[24:27], v[120:123], v[72:87]
  s_add_u32 m0, s42, 7168
  s_add_u32 s33, s81, 24576
  buffer_load_dwordx4 v169, s[8:11], s33 offen  lds
  ds_read_b64_tr_b16 v[116:117], v171 offset:21504
  ds_read_b64_tr_b16 v[118:119], v171 offset:21760
  s_waitcnt lgkmcnt(6)
  v_mfma_f32_32x32x16_bf16 v[40:55], v[104:107], a[24:27], v[40:55]
  s_add_u32 s83, s37, 4
  s_and_b32 s83, s83, 7
  s_mul_i32 s83, s83, 196608
  s_add_u32 m0, s85, 49152
  s_add_u32 s83, s83, s84
  buffer_load_dwordx4 v170, s[12:15], s83 offen offset:0  lds
  s_waitcnt vmcnt(21)
  s_barrier
  ds_read_b128 a[0:3], v164 offset:8192
  ds_read_b128 a[4:7], v165 offset:8192
  ds_read_b128 a[8:11], v166 offset:8192
  ds_read_b128 a[12:15], v167 offset:8192
  ds_read_b64_tr_b16 v[120:121], v171 offset:25600
  ds_read_b64_tr_b16 v[122:123], v171 offset:25856
  s_waitcnt lgkmcnt(10)
  v_mfma_f32_32x32x16_bf16 v[56:71], v[108:111], a[28:31], v[56:71]
  buffer_load_dwordx4 v170, s[12:15], s83 offen offset:1024  lds
  ds_read_b64_tr_b16 v[104:105], v171 offset:26624
  ds_read_b64_tr_b16 v[106:107], v171 offset:26880
  s_waitcnt lgkmcnt(10)
  v_mfma_f32_32x32x16_bf16 v[72:87], a[28:31], v[112:115], v[72:87]
  buffer_load_dwordx4 v170, s[12:15], s83 offen offset:2048  lds
  ds_read_b64_tr_b16 v[108:109], v171 offset:24576
  ds_read_b64_tr_b16 v[110:111], v171 offset:24832
  s_waitcnt lgkmcnt(10)
  v_mfma_f32_32x32x16_bf16 v[40:55], v[116:119], a[28:31], v[40:55]
  ds_read_b64_tr_b16 v[112:113], v171 offset:28672
  ds_read_b64_tr_b16 v[114:115], v171 offset:28928
  s_waitcnt lgkmcnt(6)
  v_mfma_f32_32x32x16_bf16 v[56:71], v[120:123], a[0:3], v[56:71]
  s_add_u32 s81, s37, 5
  s_and_b32 s81, s81, 7
  s_lshl_b32 s81, s81, 7
  s_add_u32 s81, s81, s41
  s_add_u32 m0, s42, 8192
  s_add_u32 s33, s81, 0
  buffer_load_dwordx4 v168, s[8:11], s33 offen  lds
  ds_read_b64_tr_b16 v[116:117], v171 offset:29696
  ds_read_b64_tr_b16 v[118:119], v171 offset:29952
  s_waitcnt lgkmcnt(6)
  v_mfma_f32_32x32x16_bf16 v[72:87], a[0:3], v[104:107], v[72:87]
  s_add_u32 m0, s42, 9216
  s_add_u32 s33, s81, 8192
  buffer_load_dwordx4 v169, s[8:11], s33 offen  lds
  ds_read_b64_tr_b16 v[120:121], v171 offset:27648
  ds_read_b64_tr_b16 v[122:123], v171 offset:27904
  s_waitcnt lgkmcnt(6)
  v_mfma_f32_32x32x16_bf16 v[40:55], v[108:111], a[0:3], v[40:55]
  s_add_u32 m0, s42, 10240
  s_add_u32 s33, s81, 16384
  buffer_load_dwordx4 v168, s[8:11], s33 offen  lds
  ds_read_b64_tr_b16 v[104:105], v171 offset:31744
  ds_read_b64_tr_b16 v[106:107], v171 offset:32000
  s_waitcnt lgkmcnt(6)
  v_mfma_f32_32x32x16_bf16 v[56:71], v[112:115], a[4:7], v[56:71]
  s_add_u32 m0, s42, 11264
  s_add_u32 s33, s81, 24576
  buffer_load_dwordx4 v169, s[8:11], s33 offen  lds
  ds_read_b64_tr_b16 v[108:109], v171 offset:32768
  ds_read_b64_tr_b16 v[110:111], v171 offset:33024
  s_waitcnt lgkmcnt(6)
  v_mfma_f32_32x32x16_bf16 v[72:87], a[4:7], v[116:119], v[72:87]
  s_add_u32 s83, s37, 5
  s_and_b32 s83, s83, 7
  s_mul_i32 s83, s83, 196608
  s_add_u32 m0, s85, 61440
  s_add_u32 s83, s83, s84
  buffer_load_dwordx4 v170, s[12:15], s83 offen offset:0  lds
  ds_read_b64_tr_b16 v[112:113], v171 offset:30720
  ds_read_b64_tr_b16 v[114:115], v171 offset:30976
  s_waitcnt lgkmcnt(6)
  v_mfma_f32_32x32x16_bf16 v[40:55], v[120:123], a[4:7], v[40:55]
  buffer_load_dwordx4 v170, s[12:15], s83 offen offset:1024  lds
  ds_read_b64_tr_b16 v[116:117], v171 offset:34816
  ds_read_b64_tr_b16 v[118:119], v171 offset:35072
  s_waitcnt lgkmcnt(6)
  v_mfma_f32_32x32x16_bf16 v[56:71], v[104:107], a[8:11], v[56:71]
  buffer_load_dwordx4 v170, s[12:15], s83 offen offset:2048  lds
  ds_read_b64_tr_b16 v[120:121], v171 offset:35840
  ds_read_b64_tr_b16 v[122:123], v171 offset:36096
  s_waitcnt lgkmcnt(6)
  v_mfma_f32_32x32x16_bf16 v[72:87], a[8:11], v[108:111], v[72:87]
  ds_read_b64_tr_b16 v[104:105], v171 offset:33792
  ds_read_b64_tr_b16 v[106:107], v171 offset:34048
  s_waitcnt lgkmcnt(6)
  v_mfma_f32_32x32x16_bf16 v[40:55], v[112:115], a[8:11], v[40:55]
  s_waitcnt vmcnt(14)
  s_barrier
  ds_read_b128 a[16:19], v164 offset:0
  ds_read_b128 a[20:23], v165 offset:0
  ds_read_b128 a[24:27], v166 offset:0
  ds_read_b128 a[28:31], v167 offset:0
  ds_read_b64_tr_b16 v[108:109], v171 offset:37888
  ds_read_b64_tr_b16 v[110:111], v171 offset:38144
  s_waitcnt lgkmcnt(10)
  v_mfma_f32_32x32x16_bf16 v[56:71], v[116:119], a[12:15], v[56:71]
  ds_read_b64_tr_b16 v[112:113], v171 offset:38912
  ds_read_b64_tr_b16 v[114:115], v171 offset:39168
  s_waitcnt lgkmcnt(10)
  v_mfma_f32_32x32x16_bf16 v[72:87], a[12:15], v[120:123], v[72:87]
  ds_read_b64_tr_b16 v[116:117], v171 offset:36864
  ds_read_b64_tr_b16 v[118:119], v171 offset:37120
  s_waitcnt lgkmcnt(10)
  v_mfma_f32_32x32x16_bf16 v[40:55], v[104:107], a[12:15], v[40:55]
  ds_read_b64_tr_b16 v[120:121], v171 offset:40960
  ds_read_b64_tr_b16 v[122:123], v171 offset:41216
  s_waitcnt lgkmcnt(6)
  v_mfma_f32_32x32x16_bf16 v[56:71], v[108:111], a[16:19], v[56:71]
  s_add_u32 s81, s37, 6
  s_and_b32 s81, s81, 7
  s_lshl_b32 s81, s81, 7
  s_add_u32 s81, s81, s41
  s_add_u32 m0, s42, 0
  s_add_u32 s33, s81, 0
  buffer_load_dwordx4 v168, s[8:11], s33 offen  lds
  ds_read_b64_tr_b16 a[48:49], v14 offset:0
  ds_read_b64_tr_b16 a[50:51], v14 offset:512
  ds_read_b64_tr_b16 v[104:105], v171 offset:41984
  ds_read_b64_tr_b16 v[106:107], v171 offset:42240
  s_waitcnt lgkmcnt(8)
  v_mfma_f32_32x32x16_bf16 v[72:87], a[16:19], v[112:115], v[72:87]
  s_add_u32 m0, s42, 1024
  s_add_u32 s33, s81, 8192
  buffer_load_dwordx4 v169, s[8:11], s33 offen  lds
  ds_read_b64_tr_b16 a[52:53], v14 offset:2048
  ds_read_b64_tr_b16 a[54:55], v14 offset:2560
  ds_read_b64_tr_b16 v[108:109], v171 offset:39936
  ds_read_b64_tr_b16 v[110:111], v171 offset:40192
  s_waitcnt lgkmcnt(10)
  v_mfma_f32_32x32x16_bf16 v[40:55], v[116:119], a[16:19], v[40:55]
  s_add_u32 m0, s42, 2048
  s_add_u32 s33, s81, 16384
  buffer_load_dwordx4 v168, s[8:11], s33 offen  lds
  ds_read_b64_tr_b16 a[56:57], v14 offset:4096
  ds_read_b64_tr_b16 a[58:59], v14 offset:4608
  ds_read_b64_tr_b16 v[112:113], v171 offset:44032
  ds_read_b64_tr_b16 v[114:115], v171 offset:44288
  s_waitcnt lgkmcnt(12)
  v_mfma_f32_32x32x16_bf16 v[56:71], v[120:123], a[20:23], v[56:71]
  s_add_u32 m0, s42, 3072
  s_add_u32 s33, s81, 24576
  buffer_load_dwordx4 v169, s[8:11], s33 offen  lds
  ds_read_b64_tr_b16 a[60:61], v14 offset:6144
  ds_read_b64_tr_b16 a[62:63], v14 offset:6656
  ds_read_b64_tr_b16 v[116:117], v171 offset:45056
  ds_read_b64_tr_b16 v[118:119], v171 offset:45312
  s_waitcnt lgkmcnt(12)
  v_mfma_f32_32x32x16_bf16 v[72:87], a[20:23], v[104:107], v[72:87]
  ds_read_b64_tr_b16 a[64:65], v147 offset:0
  ds_read_b64_tr_b16 a[66:67], v147 offset:512
  ds_read_b64_tr_b16 v[120:121], v171 offset:43008
  ds_read_b64_tr_b16 v[122:123], v171 offset:43264
  s_waitcnt lgkmcnt(12)
  v_mfma_f32_32x32x16_bf16 v[40:55], v[108:111], a[20:23], v[40:55]
  ds_read_b64_tr_b16 a[68:69], v147 offset:2048
  ds_read_b64_tr_b16 a[70:71], v147 offset:2560
  ds_read_b64_tr_b16 v[104:105], v171 offset:47104
  ds_read_b64_tr_b16 v[106:107], v171 offset:47360
  s_waitcnt lgkmcnt(12)
  v_mfma_f32_32x32x16_bf16 v[56:71], v[112:115], a[24:27], v[56:71]
  ds_read_b64_tr_b16 v[108:109], v171 offset:48128
  ds_read_b64_tr_b16 v[110:111], v171 offset:48384
  s_waitcnt lgkmcnt(10)
  v_mfma_f32_32x32x16_bf16 v[72:87], a[24:27], v[116:119], v[72:87]
  ds_read_b64_tr_b16 v[112:113], v171 offset:46080
  ds_read_b64_tr_b16 v[114:115], v171 offset:46336
  s_waitcnt lgkmcnt(8)
  v_mfma_f32_32x32x16_bf16 v[40:55], v[120:123], a[24:27], v[40:55]
  s_waitcnt vmcnt(11) lgkmcnt(6)
  s_barrier
  ds_read_b128 a[0:3], v164 offset:4096
  ds_read_b128 a[4:7], v165 offset:4096
  ds_read_b128 a[8:11], v166 offset:4096
  ds_read_b128 a[12:15], v167 offset:4096
  ds_read_b64_tr_b16 v[116:117], v171 offset:50176
  ds_read_b64_tr_b16 v[118:119], v171 offset:50432
  v_mfma_f32_32x32x16_bf16 a[72:87], v[152:155], a[48:51], 0
  v_mfma_f32_32x32x16_bf16 a[72:87], v[152:155], a[52:55], a[72:87]
  v_mfma_f32_32x32x16_bf16 a[72:87], v[152:155], a[56:59], a[72:87]
  v_mfma_f32_32x32x16_bf16 a[72:87], v[152:155], a[60:63], a[72:87]
  s_waitcnt lgkmcnt(10)
  v_mfma_f32_32x32x16_bf16 v[56:71], v[104:107], a[28:31], v[56:71]
  ds_read_b64_tr_b16 v[120:121], v171 offset:51200
  ds_read_b64_tr_b16 v[122:123], v171 offset:51456
  s_waitcnt lgkmcnt(10)
  v_mfma_f32_32x32x16_bf16 v[72:87], a[28:31], v[108:111], v[72:87]
  ds_read_b64_tr_b16 v[104:105], v171 offset:49152
  ds_read_b64_tr_b16 v[106:107], v171 offset:49408
  s_waitcnt lgkmcnt(10)
  v_mfma_f32_32x32x16_bf16 v[40:55], v[112:115], a[28:31], v[40:55]
  ds_read_b64_tr_b16 v[108:109], v171 offset:53248
  ds_read_b64_tr_b16 v[110:111], v171 offset:53504
  s_waitcnt lgkmcnt(6)
  v_mfma_f32_32x32x16_bf16 v[56:71], v[116:119], a[0:3], v[56:71]
  buffer_load_dwordx2 v[22:23], v175, s[4:7], 0 offen sc1
  s_add_u32 s83, s37, 6
  s_and_b32 s83, s83, 7
  s_mul_i32 s83, s83, 196608
  s_add_u32 m0, s85, 73728
  s_add_u32 s83, s83, s84
  buffer_load_dwordx4 v170, s[12:15], s83 offen offset:0  lds
  buffer_load_dwordx4 v170, s[12:15], s83 offen offset:1024  lds
  ds_read_b64_tr_b16 v[112:113], v171 offset:54272
  ds_read_b64_tr_b16 v[114:115], v171 offset:54528
  s_waitcnt lgkmcnt(6)
  v_mfma_f32_32x32x16_bf16 v[72:87], a[0:3], v[120:123], v[72:87]
  buffer_load_dwordx4 v170, s[12:15], s83 offen offset:2048  lds
  ds_read_b64_tr_b16 v[116:117], v171 offset:52224
  ds_read_b64_tr_b16 v[118:119], v171 offset:52480
  s_waitcnt lgkmcnt(6)
  v_mfma_f32_32x32x16_bf16 v[40:55], v[104:107], a[0:3], v[40:55]
  s_add_u32 s81, s37, 7
  s_and_b32 s81, s81, 7
  s_lshl_b32 s81, s81, 7
  s_add_u32 s81, s81, s41
  s_add_u32 m0, s42, 4096
  s_add_u32 s33, s81, 0
  buffer_load_dwordx4 v168, s[8:11], s33 offen  lds
  ds_read_b64_tr_b16 v[120:121], v171 offset:56320
  ds_read_b64_tr_b16 v[122:123], v171 offset:56576
  s_waitcnt lgkmcnt(6)
  v_mfma_f32_32x32x16_bf16 v[56:71], v[108:111], a[4:7], v[56:71]
  s_add_u32 m0, s42, 5120
  s_add_u32 s33, s81, 8192
  buffer_load_dwordx4 v169, s[8:11], s33 offen  lds
  ds_read_b64_tr_b16 v[104:105], v171 offset:57344
  ds_read_b64_tr_b16 v[106:107], v171 offset:57600
  s_waitcnt lgkmcnt(6)
  v_mfma_f32_32x32x16_bf16 v[72:87], a[4:7], v[112:115], v[72:87]
  s_add_u32 m0, s42, 6144
  s_add_u32 s33, s81, 16384
  buffer_load_dwordx4 v168, s[8:11], s33 offen  lds
  ds_read_b64_tr_b16 v[108:109], v171 offset:55296
  ds_read_b64_tr_b16 v[110:111], v171 offset:55552
  s_waitcnt lgkmcnt(6)
  v_mfma_f32_32x32x16_bf16 v[40:55], v[116:119], a[4:7], v[40:55]
  s_add_u32 m0, s42, 7168
  s_add_u32 s33, s81, 24576
  buffer_load_dwordx4 v169, s[8:11], s33 offen  lds
  ds_read_b64_tr_b16 v[112:113], v171 offset:59392
  ds_read_b64_tr_b16 v[114:115], v171 offset:59648
  s_waitcnt lgkmcnt(6)
  v_mfma_f32_32x32x16_bf16 v[56:71], v[120:123], a[8:11], v[56:71]
  s_add_u32 s83, s37, 7
  s_and_b32 s83, s83, 7
  s_mul_i32 s83, s83, 196608
  s_add_u32 m0, s85, 86016
  s_add_u32 s83, s83, s84
  buffer_load_dwordx4 v170, s[12:15], s83 offen offset:0  lds
  ds_read_b64_tr_b16 v[116:117], v171 offset:60416
  ds_read_b64_tr_b16 v[118:119], v171 offset:60672
  s_waitcnt lgkmcnt(6)
  v_mfma_f32_32x32x16_bf16 v[72:87], a[8:11], v[104:107], v[72:87]
  buffer_load_dwordx4 v170, s[12:15], s83 offen offset:1024  lds
  ds_read_b64_tr_b16 v[120:121], v171 offset:58368
  ds_read_b64_tr_b16 v[122:123], v171 offset:58624
  s_waitcnt lgkmcnt(6)
  v_mfma_f32_32x32x16_bf16 v[40:55], v[108:111], a[8:11], v[40:55]
  buffer_load_dwordx4 v170, s[12:15], s83 offen offset:2048  lds
  s_waitcnt vmcnt(15)
  s_barrier
  ds_read_b128 a[16:19], v164 offset:8192
  ds_read_b128 a[20:23], v165 offset:8192
  ds_read_b128 a[24:27], v166 offset:8192
  ds_read_b128 a[28:31], v167 offset:8192
  ds_read_b64_tr_b16 v[104:105], v171 offset:62464
  ds_read_b64_tr_b16 v[106:107], v171 offset:62720
  v_accvgpr_read_b32 v158, a72
  v_and_b32 v156, 0xffff0000, v158
  v_sub_f32 v157, v158, v156
  v_cvt_pk_bf16_f32 v156, v156, v157
  v_accvgpr_write_b32 a92, v156
  s_waitcnt lgkmcnt(10)
  v_mfma_f32_32x32x16_bf16 v[56:71], v[112:115], a[12:15], v[56:71]
  ds_read_b64_tr_b16 v[108:109], v171 offset:63488
  ds_read_b64_tr_b16 v[110:111], v171 offset:63744
  s_waitcnt lgkmcnt(10)
  v_mfma_f32_32x32x16_bf16 v[72:87], a[12:15], v[116:119], v[72:87]
  ds_read_b64_tr_b16 v[112:113], v171 offset:61440
  ds_read_b64_tr_b16 v[114:115], v171 offset:61696
  s_mov_b32 s12, s8
  s_mov_b32 s13, s9
  s_mov_b32 s14, s10
  v_and_b32 v173, 31, v0
  v_lshlrev_b32 v169, 4, v173
  v_lshlrev_b32 v173, 10, v173
  v_lshrrev_b32 v147, 5, v0
  v_lshl_or_b32 v173, v147, 4, v173
  s_waitcnt lgkmcnt(10)
  v_mfma_f32_32x32x16_bf16 v[40:55], v[120:123], a[12:15], v[40:55]
  ds_read_b64_tr_b16 v[116:117], v172 offset:0
  ds_read_b64_tr_b16 v[118:119], v172 offset:256
  s_add_u32 s8, s4, s61
  s_addc_u32 s9, s5, 0
  s_mov_b32 s10, 0x20000
  s_mov_b32 s11, 0x20000
  s_mul_i32 s63, s16, 28672
  s_add_u32 s63, s63, 0x410000
  s_xor_b32 s66, s25, 0
  s_mul_i32 s66, s66, 114688
  s_add_u32 s66, s66, s63
  s_waitcnt lgkmcnt(6)
  v_mfma_f32_32x32x16_bf16 v[56:71], v[104:107], a[16:19], v[56:71]
  ds_read_b64_tr_b16 v[120:121], v172 offset:1024
  ds_read_b64_tr_b16 v[122:123], v172 offset:1280
  s_add_u32 s67, s66, 7168
  s_add_u32 s68, s66, 14336
  s_add_u32 s69, s66, 21504
  s_xor_b32 s70, s25, 1
  s_mul_i32 s70, s70, 114688
  s_waitcnt lgkmcnt(6)
  v_mfma_f32_32x32x16_bf16 v[72:87], a[16:19], v[108:111], v[72:87]
  ds_read_b64_tr_b16 v[104:105], v171 offset:64512
  ds_read_b64_tr_b16 v[106:107], v171 offset:64768
  s_add_u32 s70, s70, s63
  s_add_u32 s71, s70, 7168
  s_add_u32 s72, s70, 14336
  s_add_u32 s73, s70, 21504
  s_waitcnt lgkmcnt(6)
  v_mfma_f32_32x32x16_bf16 v[40:55], v[112:115], a[16:19], v[40:55]
  ds_read_b64_tr_b16 v[108:109], v172 offset:3072
  ds_read_b64_tr_b16 v[110:111], v172 offset:3328
  s_waitcnt lgkmcnt(6)
  v_mfma_f32_32x32x16_bf16 v[56:71], v[116:119], a[20:23], v[56:71]
  ds_read_b64_tr_b16 v[112:113], v172 offset:4096
  ds_read_b64_tr_b16 v[114:115], v172 offset:4352
  s_waitcnt lgkmcnt(6)
  v_mfma_f32_32x32x16_bf16 v[72:87], a[20:23], v[120:123], v[72:87]
  ds_read_b64_tr_b16 v[116:117], v172 offset:2048
  ds_read_b64_tr_b16 v[118:119], v172 offset:2304
  s_waitcnt lgkmcnt(6)
  v_mfma_f32_32x32x16_bf16 v[40:55], v[104:107], a[20:23], v[40:55]
  ds_read_b64_tr_b16 v[120:121], v172 offset:6144
  ds_read_b64_tr_b16 v[122:123], v172 offset:6400
  s_waitcnt lgkmcnt(6)
  v_mfma_f32_32x32x16_bf16 v[56:71], v[108:111], a[24:27], v[56:71]
  ds_read_b64_tr_b16 v[104:105], v172 offset:7168
  ds_read_b64_tr_b16 v[106:107], v172 offset:7424
  s_waitcnt lgkmcnt(6)
  v_mfma_f32_32x32x16_bf16 v[72:87], a[24:27], v[112:115], v[72:87]
  ds_read_b64_tr_b16 v[108:109], v172 offset:5120
  ds_read_b64_tr_b16 v[110:111], v172 offset:5376
  s_waitcnt lgkmcnt(6)
  v_mfma_f32_32x32x16_bf16 v[40:55], v[116:119], a[24:27], v[40:55]
  s_waitcnt vmcnt(7)
  s_barrier
  ds_read_b128 a[0:3], v164 offset:0
  ds_read_b128 a[4:7], v165 offset:0
  ds_read_b128 a[8:11], v166 offset:0
  ds_read_b128 a[12:15], v167 offset:0
  ds_read_b64_tr_b16 v[112:113], v172 offset:9216
  ds_read_b64_tr_b16 v[114:115], v172 offset:9472
  s_waitcnt lgkmcnt(10)
  v_mfma_f32_32x32x16_bf16 v[56:71], v[120:123], a[28:31], v[56:71]
  ds_read_b64_tr_b16 v[116:117], v172 offset:10240
  ds_read_b64_tr_b16 v[118:119], v172 offset:10496
  s_waitcnt lgkmcnt(10)
  v_mfma_f32_32x32x16_bf16 v[72:87], a[28:31], v[104:107], v[72:87]
  s_waitcnt vmcnt(10)
  s_waitcnt vmcnt(10)
  v_cmp_gt_u32 vcc, 1, v22
  s_cbranch_vccnz L_slow_4
L_back_5:
  v_cmp_ne_u32 vcc, s78, v23
  s_nop 0
  s_and_b32 s40, vcc_lo, 0xffff
  s_and_b32 s31, vcc_hi, 0x100
  s_or_b32 s40, s40, s31
  s_cselect_b32 s79, 0, 1
  s_mul_i32 s31, s24, 101376
  s_add_u32 s31, s31, 0x218000
  s_lshl_b32 s32, s27, 12
  s_add_u32 s32, s32, 0x80000
  buffer_load_dwordx4 v[24:27], v1, s[4:7], s32 offen offset:0 sc1
  ds_read_b64_tr_b16 v[120:121], v172 offset:8192
  ds_read_b64_tr_b16 v[122:123], v172 offset:8448
  s_waitcnt lgkmcnt(10)
  v_mfma_f32_32x32x16_bf16 v[40:55], v[108:111], a[28:31], v[40:55]
  buffer_load_dwordx4 v[28:31], v1, s[4:7], s32 offen offset:1024 sc1
  ds_read_b64_tr_b16 v[104:105], v172 offset:12288
  ds_read_b64_tr_b16 v[106:107], v172 offset:12544
  s_waitcnt lgkmcnt(6)
  v_mfma_f32_32x32x16_bf16 v[56:71], v[112:115], a[0:3], v[56:71]
  buffer_load_dwordx4 v[32:35], v1, s[4:7], s32 offen offset:2048 sc1
  ds_read_b64_tr_b16 v[108:109], v172 offset:13312
  ds_read_b64_tr_b16 v[110:111], v172 offset:13568
  s_waitcnt lgkmcnt(6)
  v_mfma_f32_32x32x16_bf16 v[72:87], a[0:3], v[116:119], v[72:87]
  buffer_load_dwordx4 v[36:39], v1, s[4:7], s32 offen offset:3072 sc1
  ds_read_b64_tr_b16 v[112:113], v172 offset:11264
  ds_read_b64_tr_b16 v[114:115], v172 offset:11520
  s_waitcnt lgkmcnt(6)
  v_mfma_f32_32x32x16_bf16 v[40:55], v[120:123], a[0:3], v[40:55]
  buffer_load_dwordx4 v[128:131], v1, s[4:7], s31 offen offset:0 sc1
  ds_read_b64_tr_b16 v[116:117], v172 offset:15360
  ds_read_b64_tr_b16 v[118:119], v172 offset:15616
  s_waitcnt lgkmcnt(6)
  v_mfma_f32_32x32x16_bf16 v[56:71], v[104:107], a[4:7], v[56:71]
  buffer_load_dwordx4 v[132:135], v1, s[4:7], s31 offen offset:1024 sc1
  ds_read_b64_tr_b16 v[120:121], v172 offset:16384
  ds_read_b64_tr_b16 v[122:123], v172 offset:16640
  s_waitcnt lgkmcnt(6)
  v_mfma_f32_32x32x16_bf16 v[72:87], a[4:7], v[108:111], v[72:87]
  buffer_load_dwordx4 v[136:139], v1, s[4:7], s31 offen offset:2048 sc1
  ds_read_b64_tr_b16 v[104:105], v172 offset:14336
  ds_read_b64_tr_b16 v[106:107], v172 offset:14592
  s_waitcnt lgkmcnt(6)
  v_mfma_f32_32x32x16_bf16 v[40:55], v[112:115], a[4:7], v[40:55]
  ds_read_b64_tr_b16 v[108:109], v172 offset:18432
  ds_read_b64_tr_b16 v[110:111], v172 offset:18688
  s_waitcnt lgkmcnt(6)
  v_mfma_f32_32x32x16_bf16 v[56:71], v[116:119], a[8:11], v[56:71]
  ds_read_b64_tr_b16 v[112:113], v172 offset:19456
  ds_read_b64_tr_b16 v[114:115], v172 offset:19712
  s_waitcnt lgkmcnt(6)
  v_mfma_f32_32x32x16_bf16 v[72:87], a[8:11], v[120:123], v[72:87]
  ds_read_b64_tr_b16 v[116:117], v172 offset:17408
  ds_read_b64_tr_b16 v[118:119], v172 offset:17664
  s_waitcnt lgkmcnt(6)
  v_mfma_f32_32x32x16_bf16 v[40:55], v[104:107], a[8:11], v[40:55]
  s_waitcnt vmcnt(7)
  s_barrier
  ds_read_b128 a[16:19], v164 offset:4096
  ds_read_b128 a[20:23], v165 offset:4096
  ds_read_b128 a[24:27], v166 offset:4096
  ds_read_b128 a[28:31], v167 offset:4096
  ds_read_b64_tr_b16 v[120:121], v172 offset:21504
  ds_read_b64_tr_b16 v[122:123], v172 offset:21760
  s_waitcnt lgkmcnt(10)
  v_mfma_f32_32x32x16_bf16 v[56:71], v[108:111], a[12:15], v[56:71]
  ds_read_b64_tr_b16 v[104:105], v172 offset:22528
  ds_read_b64_tr_b16 v[106:107], v172 offset:22784
  s_waitcnt lgkmcnt(10)
  v_mfma_f32_32x32x16_bf16 v[72:87], a[12:15], v[112:115], v[72:87]
  ds_read_b64_tr_b16 v[108:109], v172 offset:20480
  ds_read_b64_tr_b16 v[110:111], v172 offset:20736
  s_waitcnt lgkmcnt(10)
  v_mfma_f32_32x32x16_bf16 v[40:55], v[116:119], a[12:15], v[40:55]
  ds_read_b64_tr_b16 v[112:113], v172 offset:24576
  ds_read_b64_tr_b16 v[114:115], v172 offset:24832
  s_waitcnt lgkmcnt(6)
  v_mfma_f32_32x32x16_bf16 v[56:71], v[120:123], a[16:19], v[56:71]
  s_waitcnt vmcnt(3)
  ds_read_b64_tr_b16 v[116:117], v172 offset:25600
  ds_read_b64_tr_b16 v[118:119], v172 offset:25856
  v_add_f32 v24, v24, v32
  v_add_f32 v25, v25, v33
  v_add_f32 v26, v26, v34
  v_add_f32 v27, v27, v35
  v_add_f32 v28, v28, v36
  s_waitcnt lgkmcnt(6)
  v_mfma_f32_32x32x16_bf16 v[72:87], a[16:19], v[104:107], v[72:87]
  ds_read_b64_tr_b16 v[120:121], v172 offset:23552
  ds_read_b64_tr_b16 v[122:123], v172 offset:23808
  v_add_f32 v29, v29, v37
  v_add_f32 v30, v30, v38
  v_add_f32 v31, v31, v39
  v_add_f32 v24, v24, v28
  v_add_f32 v25, v25, v29
  s_waitcnt lgkmcnt(6)
  v_mfma_f32_32x32x16_bf16 v[40:55], v[108:111], a[16:19], v[40:55]
  ds_read_b64_tr_b16 v[104:105], v172 offset:27648
  ds_read_b64_tr_b16 v[106:107], v172 offset:27904
  v_add_f32 v26, v26, v30
  v_add_f32 v27, v27, v31
  v_and_b32 v28, 1, v0
  v_bfe_u32 v29, v0, 1, 1
  v_permlane32_swap_b32 v24, v25
  s_waitcnt lgkmcnt(6)
  v_mfma_f32_32x32x16_bf16 v[56:71], v[112:115], a[20:23], v[56:71]
  ds_read_b64_tr_b16 v[108:109], v172 offset:28672
  ds_read_b64_tr_b16 v[110:111], v172 offset:28928
  v_permlane32_swap_b32 v26, v27
  v_lshl_or_b32 v28, v28, 1, v29
  v_and_b32 v29, 28, v0
  v_add_f32 v24, v24, v25
  v_add_f32 v26, v26, v27
  s_waitcnt lgkmcnt(6)
  v_mfma_f32_32x32x16_bf16 v[72:87], a[20:23], v[116:119], v[72:87]
  ds_read_b64_tr_b16 v[112:113], v172 offset:26624
  ds_read_b64_tr_b16 v[114:115], v172 offset:26880
  v_lshl_or_b32 v28, v28, 6, v29
  v_permlane16_swap_b32 v24, v26
  v_add_f32 v24, v24, v26
  ds_bpermute_b32 v26, v28, v24
  ds_bpermute_b32 v25, v28, v24 offset:32
  s_waitcnt lgkmcnt(8)
  v_mfma_f32_32x32x16_bf16 v[40:55], v[120:123], a[20:23], v[40:55]
  ds_read_b64_tr_b16 v[116:117], v172 offset:30720
  ds_read_b64_tr_b16 v[118:119], v172 offset:30976
  s_waitcnt lgkmcnt(8)
  v_mfma_f32_32x32x16_bf16 v[56:71], v[104:107], a[24:27], v[56:71]
  ds_read_b64_tr_b16 v[120:121], v172 offset:31744
  ds_read_b64_tr_b16 v[122:123], v172 offset:32000
  s_waitcnt lgkmcnt(8)
  v_mfma_f32_32x32x16_bf16 v[72:87], a[24:27], v[108:111], v[72:87]
  ds_read_b64_tr_b16 v[104:105], v172 offset:29696
  ds_read_b64_tr_b16 v[106:107], v172 offset:29952
  s_waitcnt lgkmcnt(6)
  v_mul_f32 v140, 0x3b000000, v26
  v_mul_f32 v25, 0x3b000000, v25
  v_fma_f32 v25, -v140, v140, v25
  v_max_f32 v25, 0, v25
  s_waitcnt lgkmcnt(8)
  v_mfma_f32_32x32x16_bf16 v[40:55], v[112:115], a[24:27], v[40:55]
  v_add_f32 v25, 0x3727c5ac, v25
  v_rsq_f32 v142, v25
  v_cvt_pk_bf16_f32 v148, -v140, -v140
  v_cvt_pk_bf16_f32 v149, -v140, -v140
  v_cvt_pk_bf16_f32 v150, -v140, -v140
  s_waitcnt lgkmcnt(4)
  v_mfma_f32_32x32x16_bf16 v[56:71], v[116:119], a[28:31], v[56:71]
  v_cvt_pk_bf16_f32 v151, -v140, -v140
  v_mul_f32 v144, 0x3eb8aa3b, v142
  v_and_b32 v24, 0xffff0000, v142
  v_sub_f32 v25, v142, v24
  v_and_b32 v26, 0xffff0000, v25
  s_waitcnt lgkmcnt(2)
  v_mfma_f32_32x32x16_bf16 v[72:87], a[28:31], v[120:123], v[72:87]
  v_sub_f32 v25, v25, v26
  v_cvt_pk_bf16_f32 v152, v24, v26
  v_cvt_pk_bf16_f32 v153, v25, 0
  v_mov_b32 v154, 0
  v_mov_b32 v155, 0
  s_waitcnt lgkmcnt(0)
  v_mfma_f32_32x32x16_bf16 v[40:55], v[104:107], a[28:31], v[40:55]
  v_mov_b32 v156, 0x3f003f00
  v_mov_b32 v157, 0x3f003f00
  v_mov_b32 v158, 0
  v_mov_b32 v159, 0
  s_lshl_b32 s33, s24, 7
  s_add_u32 s33, s33, s27
  s_lshl_b32 s33, s33, 11
  s_add_u32 s33, s33, 0x1a00000
  s_add_u32 s35, s33, 0x20000
  s_mul_i32 s34, s16, 6144
  s_add_u32 s34, s34, 135168
  v_add_u32 v160, s34, v20
  v_lshrrev_b32 v161, 7, v21
  v_and_b32 v161, 0x400, v161
  v_add3_u32 v161, v161, v2, s34
  v_add_u32 v162, s34, v1
  v_mfma_f32_32x32x16_bf16 v[88:103], v[152:155], v[156:159], 0
  s_waitcnt vmcnt(0)
  v_mfma_f32_32x32x16_bf16 v[56:71], v[132:135], v[148:151], v[56:71]
  v_mfma_f32_32x32x16_bf16 v[72:87], v[148:151], v[136:139], v[72:87]
  v_mfma_f32_32x32x16_bf16 v[40:55], v[128:131], v[148:151], v[40:55]
  s_barrier
  s_nop 8
  v_pk_mul_f32 v[56:57], v[56:57], v[142:143] op_sel_hi:[1,0]
  v_pk_mul_f32 v[58:59], v[58:59], v[142:143] op_sel_hi:[1,0]
  v_pk_mul_f32 v[60:61], v[60:61], v[142:143] op_sel_hi:[1,0]
  v_pk_mul_f32 v[62:63], v[62:63], v[142:143] op_sel_hi:[1,0]
  v_pk_mul_f32 v[64:65], v[64:65], v[142:143] op_sel_hi:[1,0]
  v_pk_mul_f32 v[66:67], v[66:67], v[142:143] op_sel_hi:[1,0]
  v_pk_mul_f32 v[68:69], v[68:69], v[142:143] op_sel_hi:[1,0]
  v_pk_mul_f32 v[70:71], v[70:71], v[142:143] op_sel_hi:[1,0]
  v_cvt_pk_bf16_f32 v104, v56, v57
  v_cvt_pk_bf16_f32 v105, v58, v59
  v_cvt_pk_bf16_f32 v106, v60, v61
  v_cvt_pk_bf16_f32 v107, v62, v63
  v_cvt_pk_bf16_f32 v108, v64, v65
  v_cvt_pk_bf16_f32 v109, v66, v67
  v_cvt_pk_bf16_f32 v110, v68, v69
  v_cvt_pk_bf16_f32 v111, v70, v71
  buffer_store_dwordx4 v[104:107], v20, s[4:7], s33 offen sc1
  buffer_store_dwordx4 v[108:111], v20, s[4:7], s35 offen sc1
  ds_write_b128 v160, v[104:107]
  ds_write_b128 v160, v[108:111] offset:1024
  v_pk_mul_f32 v[72:73], v[72:73], v[88:89]
  v_pk_mul_f32 v[74:75], v[74:75], v[90:91]
  v_pk_mul_f32 v[76:77], v[76:77], v[92:93]
  v_pk_mul_f32 v[78:79], v[78:79], v[94:95]
  v_pk_mul_f32 v[80:81], v[80:81], v[96:97]
  v_pk_mul_f32 v[82:83], v[82:83], v[98:99]
  v_pk_mul_f32 v[84:85], v[84:85], v[100:101]
  v_pk_mul_f32 v[86:87], v[86:87], v[102:103]
  v_cvt_pk_bf16_f32 v112, v72, v73
  v_cvt_pk_bf16_f32 v113, v74, v75
  v_cvt_pk_bf16_f32 v114, v76, v77
  v_cvt_pk_bf16_f32 v115, v78, v79
  v_cvt_pk_bf16_f32 v116, v80, v81
  v_cvt_pk_bf16_f32 v117, v82, v83
  v_cvt_pk_bf16_f32 v118, v84, v85
  v_cvt_pk_bf16_f32 v119, v86, v87
  buffer_store_dwordx4 v[112:115], v21, s[4:7], s33 offen offset:1024 sc1
  buffer_store_dwordx4 v[116:119], v21, s[4:7], s33 offen offset:1536 sc1
  ds_write_b128 v161, v[112:115] offset:2048
  ds_write_b128 v161, v[116:119] offset:2560
  v_pk_mul_f32 v[40:41], v[40:41], v[144:145] op_sel_hi:[1,0]
  v_pk_mul_f32 v[42:43], v[42:43], v[144:145] op_sel_hi:[1,0]
  v_pk_mul_f32 v[44:45], v[44:45], v[144:145] op_sel_hi:[1,0]
  v_pk_mul_f32 v[46:47], v[46:47], v[144:145] op_sel_hi:[1,0]
  v_pk_mul_f32 v[48:49], v[48:49], v[144:145] op_sel_hi:[1,0]
  v_pk_mul_f32 v[50:51], v[50:51], v[144:145] op_sel_hi:[1,0]
  v_pk_mul_f32 v[52:53], v[52:53], v[144:145] op_sel_hi:[1,0]
  v_pk_mul_f32 v[54:55], v[54:55], v[144:145] op_sel_hi:[1,0]
  v_cvt_pk_bf16_f32 v120, v40, v41
  v_cvt_pk_bf16_f32 v121, v42, v43
  v_cvt_pk_bf16_f32 v122, v44, v45
  v_cvt_pk_bf16_f32 v123, v46, v47
  v_cvt_pk_bf16_f32 v124, v48, v49
  v_cvt_pk_bf16_f32 v125, v50, v51
  v_cvt_pk_bf16_f32 v126, v52, v53
  v_cvt_pk_bf16_f32 v127, v54, v55
  ds_write_b128 v162, v[120:123] offset:4096
  ds_write_b128 v162, v[124:127] offset:5120
  s_waitcnt lgkmcnt(0)
  s_barrier
  ds_read_b128 v[128:131], v143
  ds_read_b128 a[248:251], v141 offset:4096
  ds_read_b128 a[252:255], v141 offset:10240
  ds_read_b128 a[240:243], v163 offset:4096
  ds_read_b128 a[244:247], v163 offset:10240
  ds_read_b128 v[120:123], v163 offset:0
  ds_read_b128 v[124:127], v163 offset:6144
  s_mov_b64 exec, s[28:29]
  ds_read_b128 v[176:179], v145 offset:2048
  ds_read_b128 v[180:183], v145 offset:2560
  ds_read_b128 v[184:187], v145 offset:8192
  ds_read_b128 v[188:191], v145 offset:8704
  s_mov_b64 exec, -1
  s_waitcnt lgkmcnt(9)
  v_mfma_f32_32x32x16_bf16 v[88:103], v[128:131], a[248:251], 0
  s_waitcnt lgkmcnt(8)
  v_mfma_f32_32x32x16_bf16 v[104:119], v[128:131], a[252:255], 0
  s_waitcnt lgkmcnt(7)
  v_mfma_f32_32x32x16_bf16 v[56:71], v[128:131], a[240:243], 0
  s_waitcnt lgkmcnt(6)
  v_mfma_f32_32x32x16_bf16 v[72:87], v[128:131], a[244:247], 0
  s_nop 5
  v_max3_f32 v40, v88, v89, v88
  v_max3_f32 v40, v90, v91, v40
  v_max3_f32 v40, v92, v93, v40
  v_max3_f32 v40, v94, v95, v40
  v_max3_f32 v40, v96, v97, v40
  v_max3_f32 v40, v98, v99, v40
  v_max3_f32 v40, v100, v101, v40
  v_max3_f32 v40, v102, v103, v40
  v_mov_b32 v41, v40
  s_nop 1
  v_permlane32_swap_b32 v40, v41
  v_max_f32 v40, v40, v41
  v_sub_f32 v88, 0, v40
  v_sub_f32 v89, 0, v40
  v_mov_b64 v[90:91], v[88:89]
  v_mov_b64 v[92:93], v[88:89]
  v_mov_b64 v[94:95], v[88:89]
  v_mov_b64 v[96:97], v[88:89]
  v_mov_b64 v[98:99], v[88:89]
  v_mov_b64 v[100:101], v[88:89]
  v_mov_b64 v[102:103], v[88:89]
  s_waitcnt lgkmcnt(0)
  s_nop 0
  v_mfma_f32_32x32x16_bf16 v[24:39], v[120:123], a[248:251], v[88:103]
  v_max3_f32 v40, v104, v105, v104
  v_max3_f32 v40, v106, v107, v40
  v_max3_f32 v40, v108, v109, v40
  v_max3_f32 v40, v110, v111, v40
  v_max3_f32 v40, v112, v113, v40
  v_max3_f32 v40, v114, v115, v40
  v_max3_f32 v40, v116, v117, v40
  v_max3_f32 v40, v118, v119, v40
  v_mov_b32 v41, v40
  s_nop 1
  v_permlane32_swap_b32 v40, v41
  v_max_f32 v40, v40, v41
  v_sub_f32 v104, 0, v40
  v_sub_f32 v105, 0, v40
  v_mov_b64 v[106:107], v[104:105]
  v_mov_b64 v[108:109], v[104:105]
  v_mov_b64 v[110:111], v[104:105]
  v_mov_b64 v[112:113], v[104:105]
  v_mov_b64 v[114:115], v[104:105]
  v_mov_b64 v[116:117], v[104:105]
  v_mov_b64 v[118:119], v[104:105]
  v_max3_f32 v40, v56, v57, v56
  v_max3_f32 v40, v58, v59, v40
  v_max3_f32 v40, v60, v61, v40
  v_max3_f32 v40, v62, v63, v40
  v_max3_f32 v40, v64, v65, v40
  v_max3_f32 v40, v66, v67, v40
  v_max3_f32 v40, v68, v69, v40
  v_max3_f32 v40, v70, v71, v40
  v_mov_b32 v41, v40
  s_nop 1
  v_permlane32_swap_b32 v40, v41
  v_max_f32 v40, v40, v41
  v_sub_f32 v56, 0, v40
  v_sub_f32 v57, 0, v40
  v_mov_b64 v[58:59], v[56:57]
  v_mov_b64 v[60:61], v[56:57]
  v_mov_b64 v[62:63], v[56:57]
  v_mov_b64 v[64:65], v[56:57]
  v_mov_b64 v[66:67], v[56:57]
  v_mov_b64 v[68:69], v[56:57]
  v_mov_b64 v[70:71], v[56:57]
  v_max3_f32 v40, v72, v73, v72
  v_max3_f32 v40, v74, v75, v40
  v_max3_f32 v40, v76, v77, v40
  v_max3_f32 v40, v78, v79, v40
  v_max3_f32 v40, v80, v81, v40
  v_max3_f32 v40, v82, v83, v40
  v_max3_f32 v40, v84, v85, v40
  v_max3_f32 v40, v86, v87, v40
  v_mov_b32 v41, v40
  s_nop 1
  v_permlane32_swap_b32 v40, v41
  v_max_f32 v40, v40, v41
  v_sub_f32 v72, 0, v40
  v_sub_f32 v73, 0, v40
  v_mov_b64 v[74:75], v[72:73]
  v_mov_b64 v[76:77], v[72:73]
  v_mov_b64 v[78:79], v[72:73]
  v_mov_b64 v[80:81], v[72:73]
  v_mov_b64 v[82:83], v[72:73]
  v_mov_b64 v[84:85], v[72:73]
  v_mov_b64 v[86:87], v[72:73]
  v_mov_b32 v175, s60
  s_mul_i32 s38, s16, 33792
  s_mov_b32 m0, s38
  v_exp_f32 v24, v24
  v_exp_f32 v25, v25
  v_exp_f32 v26, v26
  v_exp_f32 v27, v27
  v_exp_f32 v28, v28
  v_exp_f32 v29, v29
  v_exp_f32 v30, v30
  v_exp_f32 v31, v31
  v_mfma_f32_32x32x16_bf16 v[40:55], v[120:123], a[252:255], v[104:119]
  v_mov_b64 v[136:137], v[176:177]
  v_mov_b64 v[138:139], v[176:177]
  v_mov_b64 v[140:141], v[176:177]
  v_mov_b64 v[142:143], v[176:177]
  v_exp_f32 v32, v32
  v_exp_f32 v33, v33
  v_exp_f32 v34, v34
  v_exp_f32 v35, v35
  v_smfmac_f32_32x32x32_bf16 v[224:239], v[176:179], v[24:31], v3
  v_mov_b64 v[144:145], v[176:177]
  v_mov_b64 v[146:147], v[176:177]
  v_mov_b64 v[148:149], v[176:177]
  v_mov_b64 v[150:151], v[176:177]
  v_exp_f32 v36, v36
  v_exp_f32 v37, v37
  v_exp_f32 v38, v38
  v_exp_f32 v39, v39
  v_exp_f32 v40, v40
  v_exp_f32 v41, v41
  v_exp_f32 v42, v42
  v_smfmac_f32_32x32x32_bf16 v[224:239], v[180:183], v[32:39], v3
  v_exp_f32 v43, v43
  v_exp_f32 v44, v44
  v_exp_f32 v45, v45
  v_exp_f32 v46, v46
  v_exp_f32 v47, v47
  v_mfma_f32_32x32x16_bf16 v[24:39], v[120:123], a[240:243], v[56:71]
  buffer_store_dwordx4 a[48:51], v1, s[4:7], s80 offen offset:0 sc1
  v_exp_f32 v48, v48
  v_exp_f32 v49, v49
  v_exp_f32 v50, v50
  v_exp_f32 v51, v51
  v_smfmac_f32_32x32x32_bf16 v[240:255], v[176:179], v[40:47], v3
  buffer_store_dwordx4 a[52:55], v1, s[4:7], s80 offen offset:1024 sc1
  v_exp_f32 v52, v52
  v_exp_f32 v53, v53
  v_exp_f32 v54, v54
  v_exp_f32 v55, v55
  s_waitcnt vmcnt(2)
  s_barrier
  v_mov_b32 v22, 2
  s_cmp_lg_u32 s16, 0
  s_cbranch_scc1 L_sig_6
  s_mov_b64 exec, 1
  v_mov_b32 v23, s78
  buffer_store_dwordx2 v[22:23], off, s[4:7], s30 sc1
  s_mov_b64 exec, -1
L_sig_6:
  v_mov_b32 v22, 1
  s_cmp_lg_u32 s16, 0
  s_cbranch_scc1 L_sig_7
  s_mov_b64 exec, 1
  s_cmp_eq_u32 s79, 0
  s_cbranch_scc1 L_far_8
  buffer_store_dword v22, off, s[4:7], s77
  s_mov_b64 exec, -1
L_sig_7:
  v_exp_f32 v24, v24
  v_exp_f32 v25, v25
  v_exp_f32 v26, v26
  v_smfmac_f32_32x32x32_bf16 v[240:255], v[180:183], v[48:55], v3
  v_exp_f32 v27, v27
  v_exp_f32 v28, v28
  v_exp_f32 v29, v29
  v_exp_f32 v30, v30
  v_exp_f32 v31, v31
  v_mfma_f32_32x32x16_bf16 v[40:55], v[120:123], a[244:247], v[72:87]
  buffer_store_dwordx4 a[56:59], v1, s[4:7], s80 offen offset:2048 sc1
  v_exp_f32 v32, v32
  v_exp_f32 v33, v33
  v_exp_f32 v34, v34
  v_exp_f32 v35, v35
  v_smfmac_f32_32x32x32_bf16 v[192:207], v[176:179], v[24:31], v3
  buffer_store_dwordx4 a[60:63], v1, s[4:7], s80 offen offset:3072 sc1
  v_exp_f32 v36, v36
  v_exp_f32 v37, v37
  v_exp_f32 v38, v38
  v_exp_f32 v39, v39
  v_exp_f32 v40, v40
  v_exp_f32 v41, v41
  v_exp_f32 v42, v42
  v_smfmac_f32_32x32x32_bf16 v[192:207], v[180:183], v[32:39], v3
  v_exp_f32 v43, v43
  v_exp_f32 v44, v44
  v_exp_f32 v45, v45
  v_exp_f32 v46, v46
  v_exp_f32 v47, v47
  v_mfma_f32_32x32x16_bf16 v[24:39], v[124:127], a[248:251], v[88:103]
  buffer_store_dword a92, v169, s[4:7], s82 offen sc1
  v_exp_f32 v48, v48
  v_exp_f32 v49, v49
  v_exp_f32 v50, v50
  v_exp_f32 v51, v51
  v_smfmac_f32_32x32x32_bf16 v[208:223], v[176:179], v[40:47], v3
  buffer_store_dwordx4 a[64:67], v1, s[4:7], s1 offen offset:0 sc1
  v_exp_f32 v52, v52
  v_exp_f32 v53, v53
  v_exp_f32 v54, v54
  v_exp_f32 v55, v55
  v_exp_f32 v24, v24
  v_exp_f32 v25, v25
  v_exp_f32 v26, v26
  v_smfmac_f32_32x32x32_bf16 v[208:223], v[180:183], v[48:55], v3
  v_exp_f32 v27, v27
  v_exp_f32 v28, v28
  v_exp_f32 v29, v29
  v_exp_f32 v30, v30
  v_exp_f32 v31, v31
  v_mfma_f32_32x32x16_bf16 v[40:55], v[124:127], a[252:255], v[104:119]
  buffer_store_dwordx4 a[68:71], v1, s[4:7], s1 offen offset:1024 sc1
  v_exp_f32 v32, v32
  v_exp_f32 v33, v33
  v_exp_f32 v34, v34
  v_exp_f32 v35, v35
  v_smfmac_f32_32x32x32_bf16 v[224:239], v[184:187], v[24:31], v3
  buffer_store_dwordx4 a[32:35], v1, s[4:7], s87 offen sc1
  s_add_u32 s87, s87, 3072
  v_exp_f32 v36, v36
  v_exp_f32 v37, v37
  v_exp_f32 v38, v38
  v_exp_f32 v39, v39
  v_exp_f32 v40, v40
  v_exp_f32 v41, v41
  v_exp_f32 v42, v42
  v_smfmac_f32_32x32x32_bf16 v[224:239], v[188:191], v[32:39], v3
  buffer_store_dwordx4 a[36:39], v1, s[4:7], s87 offen sc1
  s_add_u32 s87, s87, 3072
  v_exp_f32 v43, v43
  v_exp_f32 v44, v44
  v_exp_f32 v45, v45
  v_exp_f32 v46, v46
  v_exp_f32 v47, v47
  v_mfma_f32_32x32x16_bf16 v[24:39], v[124:127], a[240:243], v[56:71]
  buffer_store_dwordx4 a[40:43], v1, s[4:7], s87 offen sc1
  s_add_u32 s87, s87, 3072
  v_exp_f32 v48, v48
  v_exp_f32 v49, v49
  v_exp_f32 v50, v50
  v_exp_f32 v51, v51
  v_smfmac_f32_32x32x32_bf16 v[240:255], v[184:187], v[40:47], v3
  buffer_load_dword v23, v175, s[4:7], 0 offen sc1
  v_exp_f32 v52, v52
  v_exp_f32 v53, v53
  v_exp_f32 v54, v54
  v_exp_f32 v55, v55
  s_waitcnt vmcnt(0)
  v_cmp_gt_u32 vcc, 1, v23
  s_cbranch_vccnz L_slow_9
L_back_10:
  s_mov_b64 exec, s[28:29]
  buffer_load_dwordx4 v[136:139], v2, s[8:11], s54 offen offset:1024
  buffer_load_dwordx4 v[140:143], v2, s[8:11], s54 offen offset:1536
  s_mov_b64 exec, -1
  buffer_load_dwordx4 v[128:131], v1, s[8:11], s54 offen offset:0
  s_mov_b64 exec, s[28:29]
  buffer_load_dwordx4 v[144:147], v2, s[8:11], s54 offen offset:3072
  buffer_load_dwordx4 v[148:151], v2, s[8:11], s54 offen offset:3584
  s_mov_b64 exec, -1
  buffer_load_dwordx4 v[132:135], v1, s[8:11], s54 offen offset:2048
  s_mov_b32 s54, s59
  v_exp_f32 v24, v24
  v_exp_f32 v25, v25
  v_exp_f32 v26, v26
  v_smfmac_f32_32x32x32_bf16 v[240:255], v[188:191], v[48:55], v3
  v_exp_f32 v27, v27
  v_exp_f32 v28, v28
  v_exp_f32 v29, v29
  v_exp_f32 v30, v30
  v_exp_f32 v31, v31
  v_mfma_f32_32x32x16_bf16 v[40:55], v[124:127], a[244:247], v[72:87]
  v_exp_f32 v32, v32
  v_exp_f32 v33, v33
  v_exp_f32 v34, v34
  v_exp_f32 v35, v35
  v_smfmac_f32_32x32x32_bf16 v[192:207], v[184:187], v[24:31], v3
  buffer_store_dwordx4 a[44:47], v1, s[4:7], s87 offen sc1
  v_exp_f32 v36, v36
  v_exp_f32 v37, v37
  v_exp_f32 v38, v38
  v_exp_f32 v39, v39
  v_exp_f32 v40, v40
  v_exp_f32 v41, v41
  v_exp_f32 v42, v42
  v_smfmac_f32_32x32x32_bf16 v[192:207], v[188:191], v[32:39], v3
  s_waitcnt vmcnt(4)
  v_exp_f32 v43, v43
  v_exp_f32 v44, v44
  v_exp_f32 v45, v45
  v_exp_f32 v46, v46
  v_exp_f32 v47, v47
  v_mfma_f32_32x32x16_bf16 v[24:39], v[128:131], a[248:251], v[88:103]
  v_exp_f32 v48, v48
  v_exp_f32 v49, v49
  v_exp_f32 v50, v50
  v_exp_f32 v51, v51
  v_smfmac_f32_32x32x32_bf16 v[208:223], v[184:187], v[40:47], v3
  v_exp_f32 v52, v52
  v_exp_f32 v53, v53
  v_exp_f32 v54, v54
  v_exp_f32 v55, v55
  v_exp_f32 v24, v24
  v_exp_f32 v25, v25
  v_exp_f32 v26, v26
  v_smfmac_f32_32x32x32_bf16 v[208:223], v[188:191], v[48:55], v3
  v_exp_f32 v27, v27
  v_exp_f32 v28, v28
  v_exp_f32 v29, v29
  v_exp_f32 v30, v30
  v_exp_f32 v31, v31
  v_mfma_f32_32x32x16_bf16 v[40:55], v[128:131], a[252:255], v[104:119]
  v_exp_f32 v32, v32
  v_exp_f32 v33, v33
  v_exp_f32 v34, v34
  v_exp_f32 v35, v35
  v_smfmac_f32_32x32x32_bf16 v[224:239], v[136:139], v[24:31], v3
  v_exp_f32 v36, v36
  v_exp_f32 v37, v37
  v_exp_f32 v38, v38
  v_exp_f32 v39, v39
  v_exp_f32 v40, v40
  v_exp_f32 v41, v41
  v_exp_f32 v42, v42
  v_smfmac_f32_32x32x32_bf16 v[224:239], v[140:143], v[32:39], v3
  v_exp_f32 v43, v43
  v_exp_f32 v44, v44
  v_exp_f32 v45, v45
  v_exp_f32 v46, v46
  v_exp_f32 v47, v47
  v_mfma_f32_32x32x16_bf16 v[24:39], v[128:131], a[240:243], v[56:71]
  v_exp_f32 v48, v48
  v_exp_f32 v49, v49
  v_exp_f32 v50, v50
  v_exp_f32 v51, v51
  v_smfmac_f32_32x32x32_bf16 v[240:255], v[136:139], v[40:47], v3
  buffer_load_dword v23, v12, s[4:7], 0 offen sc1
  v_exp_f32 v52, v52
  v_exp_f32 v53, v53
  v_exp_f32 v54, v54
  v_exp_f32 v55, v55
  s_waitcnt vmcnt(0)
  v_cmp_gt_u32 vcc, 2, v23
  s_cbranch_vccnz L_slow_11
L_back_12:
  s_mov_b64 exec, s[28:29]
  buffer_load_dwordx4 v[176:179], v2, s[8:11], s54 offen offset:1024
  buffer_load_dwordx4 v[180:183], v2, s[8:11], s54 offen offset:1536
  s_mov_b64 exec, -1
  buffer_load_dwordx4 v[120:123], v1, s[8:11], s54 offen offset:0
  s_mov_b64 exec, s[28:29]
  buffer_load_dwordx4 v[184:187], v2, s[8:11], s54 offen offset:3072
  buffer_load_dwordx4 v[188:191], v2, s[8:11], s54 offen offset:3584
  s_mov_b64 exec, -1
  buffer_load_dwordx4 v[124:127], v1, s[8:11], s54 offen offset:2048
  s_add_u32 s54, s54, 8192
  s_and_b32 s54, s54, 0x1ffff
  v_exp_f32 v24, v24
  v_exp_f32 v25, v25
  v_exp_f32 v26, v26
  v_smfmac_f32_32x32x32_bf16 v[240:255], v[140:143], v[48:55], v3
  v_exp_f32 v27, v27
  v_exp_f32 v28, v28
  v_exp_f32 v29, v29
  v_exp_f32 v30, v30
  v_exp_f32 v31, v31
  v_mfma_f32_32x32x16_bf16 v[40:55], v[128:131], a[244:247], v[72:87]
  v_exp_f32 v32, v32
  v_exp_f32 v33, v33
  v_exp_f32 v34, v34
  v_exp_f32 v35, v35
  v_smfmac_f32_32x32x32_bf16 v[192:207], v[136:139], v[24:31], v3
  v_exp_f32 v36, v36
  v_exp_f32 v37, v37
  v_exp_f32 v38, v38
  v_exp_f32 v39, v39
  v_exp_f32 v40, v40
  v_exp_f32 v41, v41
  v_exp_f32 v42, v42
  v_smfmac_f32_32x32x32_bf16 v[192:207], v[140:143], v[32:39], v3
  s_waitcnt vmcnt(8)
  v_exp_f32 v43, v43
  v_exp_f32 v44, v44
  v_exp_f32 v45, v45
  v_exp_f32 v46, v46
  v_exp_f32 v47, v47
  v_mfma_f32_32x32x16_bf16 v[24:39], v[132:135], a[248:251], v[88:103]
  v_exp_f32 v48, v48
  v_exp_f32 v49, v49
  v_exp_f32 v50, v50
  v_exp_f32 v51, v51
  v_smfmac_f32_32x32x32_bf16 v[208:223], v[136:139], v[40:47], v3
  v_exp_f32 v52, v52
  v_exp_f32 v53, v53
  v_exp_f32 v54, v54
  v_exp_f32 v55, v55
  v_exp_f32 v24, v24
  v_exp_f32 v25, v25
  v_exp_f32 v26, v26
  v_smfmac_f32_32x32x32_bf16 v[208:223], v[140:143], v[48:55], v3
  s_mov_b64 exec, s[28:29]
  buffer_load_dwordx4 v[136:139], v2, s[8:11], s54 offen offset:1024
  buffer_load_dwordx4 v[140:143], v2, s[8:11], s54 offen offset:1536
  s_mov_b64 exec, -1
  v_exp_f32 v27, v27
  v_exp_f32 v28, v28
  v_exp_f32 v29, v29
  v_exp_f32 v30, v30
  v_exp_f32 v31, v31
  v_mfma_f32_32x32x16_bf16 v[40:55], v[132:135], a[252:255], v[104:119]
  buffer_load_dwordx4 v[128:131], v1, s[8:11], s54 offen offset:0
  v_exp_f32 v32, v32
  v_exp_f32 v33, v33
  v_exp_f32 v34, v34
  v_exp_f32 v35, v35
  v_smfmac_f32_32x32x32_bf16 v[224:239], v[144:147], v[24:31], v3
  v_exp_f32 v36, v36
  v_exp_f32 v37, v37
  v_exp_f32 v38, v38
  v_exp_f32 v39, v39
  s_waitcnt vmcnt(10)
  s_barrier
  s_cmp_lg_u32 s16, 0
  s_cbranch_scc1 L_nosigw_13
  s_add_u32 s38, s30, 0x8
  v_mov_b32 v22, 1
  s_mov_b64 exec, 1
  buffer_store_dword v22, off, s[4:7], s38 sc1
  s_mov_b64 exec, -1
L_nosigw_13:
  v_exp_f32 v40, v40
  v_exp_f32 v41, v41
  v_exp_f32 v42, v42
  v_smfmac_f32_32x32x32_bf16 v[224:239], v[148:151], v[32:39], v3
  v_exp_f32 v43, v43
  v_exp_f32 v44, v44
  v_exp_f32 v45, v45
  v_exp_f32 v46, v46
  v_exp_f32 v47, v47
  v_mfma_f32_32x32x16_bf16 v[24:39], v[132:135], a[240:243], v[56:71]
  v_exp_f32 v48, v48
  v_exp_f32 v49, v49
  v_exp_f32 v50, v50
  v_exp_f32 v51, v51
  v_smfmac_f32_32x32x32_bf16 v[240:255], v[144:147], v[40:47], v3
  v_exp_f32 v52, v52
  v_exp_f32 v53, v53
  v_exp_f32 v54, v54
  v_exp_f32 v55, v55
  v_exp_f32 v24, v24
  v_exp_f32 v25, v25
  v_exp_f32 v26, v26
  v_smfmac_f32_32x32x32_bf16 v[240:255], v[148:151], v[48:55], v3
  v_exp_f32 v27, v27
  v_exp_f32 v28, v28
  v_exp_f32 v29, v29
  v_exp_f32 v30, v30
  v_exp_f32 v31, v31
  v_mfma_f32_32x32x16_bf16 v[40:55], v[132:135], a[244:247], v[72:87]
  v_exp_f32 v32, v32
  v_exp_f32 v33, v33
  v_exp_f32 v34, v34
  v_exp_f32 v35, v35
  v_smfmac_f32_32x32x32_bf16 v[192:207], v[144:147], v[24:31], v3
  v_exp_f32 v36, v36
  v_exp_f32 v37, v37
  v_exp_f32 v38, v38
  v_exp_f32 v39, v39
  v_exp_f32 v40, v40
  v_exp_f32 v41, v41
  v_exp_f32 v42, v42
  v_smfmac_f32_32x32x32_bf16 v[192:207], v[148:151], v[32:39], v3
  s_waitcnt vmcnt(6)
  v_exp_f32 v43, v43
  v_exp_f32 v44, v44
  v_exp_f32 v45, v45
  v_exp_f32 v46, v46
  v_exp_f32 v47, v47
  v_mfma_f32_32x32x16_bf16 v[24:39], v[120:123], a[248:251], v[88:103]
  v_exp_f32 v48, v48
  v_exp_f32 v49, v49
  v_exp_f32 v50, v50
  v_exp_f32 v51, v51
  v_smfmac_f32_32x32x32_bf16 v[208:223], v[144:147], v[40:47], v3
  v_exp_f32 v52, v52
  v_exp_f32 v53, v53
  v_exp_f32 v54, v54
  v_exp_f32 v55, v55
  v_exp_f32 v24, v24
  v_exp_f32 v25, v25
  v_exp_f32 v26, v26
  v_smfmac_f32_32x32x32_bf16 v[208:223], v[148:151], v[48:55], v3
  s_mov_b64 exec, s[28:29]
  buffer_load_dwordx4 v[144:147], v2, s[8:11], s54 offen offset:3072
  buffer_load_dwordx4 v[148:151], v2, s[8:11], s54 offen offset:3584
  s_mov_b64 exec, -1
  v_exp_f32 v27, v27
  v_exp_f32 v28, v28
  v_exp_f32 v29, v29
  v_exp_f32 v30, v30
  v_exp_f32 v31, v31
  v_mfma_f32_32x32x16_bf16 v[40:55], v[120:123], a[252:255], v[104:119]
  buffer_load_dwordx4 v[132:135], v1, s[8:11], s54 offen offset:2048
  v_exp_f32 v32, v32
  v_exp_f32 v33, v33
  v_exp_f32 v34, v34
  v_exp_f32 v35, v35
  v_smfmac_f32_32x32x32_bf16 v[224:239], v[176:179], v[24:31], v3
  s_add_u32 s54, s54, 8192
  s_and_b32 s54, s54, 0x1ffff
  v_exp_f32 v36, v36
  v_exp_f32 v37, v37
  v_exp_f32 v38, v38
  v_exp_f32 v39, v39
  v_exp_f32 v40, v40
  v_exp_f32 v41, v41
  v_exp_f32 v42, v42
  v_smfmac_f32_32x32x32_bf16 v[224:239], v[180:183], v[32:39], v3
  v_exp_f32 v43, v43
  v_exp_f32 v44, v44
  v_exp_f32 v45, v45
  v_exp_f32 v46, v46
  v_exp_f32 v47, v47
  v_mfma_f32_32x32x16_bf16 v[24:39], v[120:123], a[240:243], v[56:71]
  v_exp_f32 v48, v48
  v_exp_f32 v49, v49
  v_exp_f32 v50, v50
  v_exp_f32 v51, v51
  v_smfmac_f32_32x32x32_bf16 v[240:255], v[176:179], v[40:47], v3
  v_exp_f32 v52, v52
  v_exp_f32 v53, v53
  v_exp_f32 v54, v54
  v_exp_f32 v55, v55
  v_exp_f32 v24, v24
  v_exp_f32 v25, v25
  v_exp_f32 v26, v26
  v_smfmac_f32_32x32x32_bf16 v[240:255], v[180:183], v[48:55], v3
  v_exp_f32 v27, v27
  v_exp_f32 v28, v28
  v_exp_f32 v29, v29
  v_exp_f32 v30, v30
  v_exp_f32 v31, v31
  v_mfma_f32_32x32x16_bf16 v[40:55], v[120:123], a[244:247], v[72:87]
  v_exp_f32 v32, v32
  v_exp_f32 v33, v33
  v_exp_f32 v34, v34
  v_exp_f32 v35, v35
  v_smfmac_f32_32x32x32_bf16 v[192:207], v[176:179], v[24:31], v3
  v_exp_f32 v36, v36
  v_exp_f32 v37, v37
  v_exp_f32 v38, v38
  v_exp_f32 v39, v39
  v_exp_f32 v40, v40
  v_exp_f32 v41, v41
  v_exp_f32 v42, v42
  v_smfmac_f32_32x32x32_bf16 v[192:207], v[180:183], v[32:39], v3
  s_waitcnt vmcnt(6)
  v_exp_f32 v43, v43
  v_exp_f32 v44, v44
  v_exp_f32 v45, v45
  v_exp_f32 v46, v46
  v_exp_f32 v47, v47
  v_mfma_f32_32x32x16_bf16 v[24:39], v[124:127], a[248:251], v[88:103]
  v_exp_f32 v48, v48
  v_exp_f32 v49, v49
  v_exp_f32 v50, v50
  v_exp_f32 v51, v51
  v_smfmac_f32_32x32x32_bf16 v[208:223], v[176:179], v[40:47], v3
  v_exp_f32 v52, v52
  v_exp_f32 v53, v53
  v_exp_f32 v54, v54
  v_exp_f32 v55, v55
  v_exp_f32 v24, v24
  v_exp_f32 v25, v25
  v_exp_f32 v26, v26
  v_smfmac_f32_32x32x32_bf16 v[208:223], v[180:183], v[48:55], v3
  s_mov_b64 exec, s[28:29]
  buffer_load_dwordx4 v[176:179], v2, s[8:11], s54 offen offset:1024
  buffer_load_dwordx4 v[180:183], v2, s[8:11], s54 offen offset:1536
  s_mov_b64 exec, -1
  v_exp_f32 v27, v27
  v_exp_f32 v28, v28
  v_exp_f32 v29, v29
  v_exp_f32 v30, v30
  v_exp_f32 v31, v31
  v_mfma_f32_32x32x16_bf16 v[40:55], v[124:127], a[252:255], v[104:119]
  buffer_load_dwordx4 v[120:123], v1, s[8:11], s54 offen offset:0
  v_exp_f32 v32, v32
  v_exp_f32 v33, v33
  v_exp_f32 v34, v34
  v_exp_f32 v35, v35
  v_smfmac_f32_32x32x32_bf16 v[224:239], v[184:187], v[24:31], v3
  v_exp_f32 v36, v36
  v_exp_f32 v37, v37
  v_exp_f32 v38, v38
  v_exp_f32 v39, v39
  v_exp_f32 v40, v40
  v_exp_f32 v41, v41
  v_exp_f32 v42, v42
  v_smfmac_f32_32x32x32_bf16 v[224:239], v[188:191], v[32:39], v3
  v_exp_f32 v43, v43
  v_exp_f32 v44, v44
  v_exp_f32 v45, v45
  v_exp_f32 v46, v46
  v_exp_f32 v47, v47
  v_mfma_f32_32x32x16_bf16 v[24:39], v[124:127], a[240:243], v[56:71]
  v_exp_f32 v48, v48
  v_exp_f32 v49, v49
  v_exp_f32 v50, v50
  v_exp_f32 v51, v51
  v_smfmac_f32_32x32x32_bf16 v[240:255], v[184:187], v[40:47], v3
  v_exp_f32 v52, v52
  v_exp_f32 v53, v53
  v_exp_f32 v54, v54
  v_exp_f32 v55, v55
  v_exp_f32 v24, v24
  v_exp_f32 v25, v25
  v_exp_f32 v26, v26
  v_smfmac_f32_32x32x32_bf16 v[240:255], v[188:191], v[48:55], v3
  v_exp_f32 v27, v27
  v_exp_f32 v28, v28
  v_exp_f32 v29, v29
  v_exp_f32 v30, v30
  v_exp_f32 v31, v31
  v_mfma_f32_32x32x16_bf16 v[40:55], v[124:127], a[244:247], v[72:87]
  v_exp_f32 v32, v32
  v_exp_f32 v33, v33
  v_exp_f32 v34, v34
  v_exp_f32 v35, v35
  v_smfmac_f32_32x32x32_bf16 v[192:207], v[184:187], v[24:31], v3
  v_exp_f32 v36, v36
  v_exp_f32 v37, v37
  v_exp_f32 v38, v38
  v_exp_f32 v39, v39
  v_exp_f32 v40, v40
  v_exp_f32 v41, v41
  v_exp_f32 v42, v42
  v_smfmac_f32_32x32x32_bf16 v[192:207], v[188:191], v[32:39], v3
  s_waitcnt vmcnt(6)
  v_exp_f32 v43, v43
  v_exp_f32 v44, v44
  v_exp_f32 v45, v45
  v_exp_f32 v46, v46
  v_exp_f32 v47, v47
  v_mfma_f32_32x32x16_bf16 v[24:39], v[128:131], a[248:251], v[88:103]
  v_exp_f32 v48, v48
  v_exp_f32 v49, v49
  v_exp_f32 v50, v50
  v_exp_f32 v51, v51
  v_smfmac_f32_32x32x32_bf16 v[208:223], v[184:187], v[40:47], v3
  v_exp_f32 v52, v52
  v_exp_f32 v53, v53
  v_exp_f32 v54, v54
  v_exp_f32 v55, v55
  v_exp_f32 v24, v24
  v_exp_f32 v25, v25
  v_exp_f32 v26, v26
  v_smfmac_f32_32x32x32_bf16 v[208:223], v[188:191], v[48:55], v3
  s_mov_b64 exec, s[28:29]
  buffer_load_dwordx4 v[184:187], v2, s[8:11], s54 offen offset:3072
  buffer_load_dwordx4 v[188:191], v2, s[8:11], s54 offen offset:3584
  s_mov_b64 exec, -1
  v_exp_f32 v27, v27
  v_exp_f32 v28, v28
  v_exp_f32 v29, v29
  v_exp_f32 v30, v30
  v_exp_f32 v31, v31
  v_mfma_f32_32x32x16_bf16 v[40:55], v[128:131], a[252:255], v[104:119]
  buffer_load_dwordx4 v[124:127], v1, s[8:11], s54 offen offset:2048
  v_exp_f32 v32, v32
  v_exp_f32 v33, v33
  v_exp_f32 v34, v34
  v_exp_f32 v35, v35
  v_smfmac_f32_32x32x32_bf16 v[224:239], v[136:139], v[24:31], v3
  s_add_u32 s54, s54, 8192
  s_and_b32 s54, s54, 0x1ffff
  v_exp_f32 v36, v36
  v_exp_f32 v37, v37
  v_exp_f32 v38, v38
  v_exp_f32 v39, v39
  v_exp_f32 v40, v40
  v_exp_f32 v41, v41
  v_exp_f32 v42, v42
  v_smfmac_f32_32x32x32_bf16 v[224:239], v[140:143], v[32:39], v3
  v_exp_f32 v43, v43
  v_exp_f32 v44, v44
  v_exp_f32 v45, v45
  v_exp_f32 v46, v46
  v_exp_f32 v47, v47
  v_mfma_f32_32x32x16_bf16 v[24:39], v[128:131], a[240:243], v[56:71]
  v_exp_f32 v48, v48
  v_exp_f32 v49, v49
  v_exp_f32 v50, v50
  v_exp_f32 v51, v51
  v_smfmac_f32_32x32x32_bf16 v[240:255], v[136:139], v[40:47], v3
  v_exp_f32 v52, v52
  v_exp_f32 v53, v53
  v_exp_f32 v54, v54
  v_exp_f32 v55, v55
  v_exp_f32 v24, v24
  v_exp_f32 v25, v25
  v_exp_f32 v26, v26
  v_smfmac_f32_32x32x32_bf16 v[240:255], v[140:143], v[48:55], v3
  v_exp_f32 v27, v27
  v_exp_f32 v28, v28
  v_exp_f32 v29, v29
  v_exp_f32 v30, v30
  v_exp_f32 v31, v31
  v_mfma_f32_32x32x16_bf16 v[40:55], v[128:131], a[244:247], v[72:87]
  v_exp_f32 v32, v32
  v_exp_f32 v33, v33
  v_exp_f32 v34, v34
  v_exp_f32 v35, v35
  v_smfmac_f32_32x32x32_bf16 v[192:207], v[136:139], v[24:31], v3
  v_exp_f32 v36, v36
  v_exp_f32 v37, v37
  v_exp_f32 v38, v38
  v_exp_f32 v39, v39
  v_exp_f32 v40, v40
  v_exp_f32 v41, v41
  v_exp_f32 v42, v42
  v_smfmac_f32_32x32x32_bf16 v[192:207], v[140:143], v[32:39], v3
  s_waitcnt vmcnt(6)
  v_exp_f32 v43, v43
  v_exp_f32 v44, v44
  v_exp_f32 v45, v45
  v_exp_f32 v46, v46
  v_exp_f32 v47, v47
  v_mfma_f32_32x32x16_bf16 v[24:39], v[132:135], a[248:251], v[88:103]
  v_exp_f32 v48, v48
  v_exp_f32 v49, v49
  v_exp_f32 v50, v50
  v_exp_f32 v51, v51
  v_smfmac_f32_32x32x32_bf16 v[208:223], v[136:139], v[40:47], v3
  v_exp_f32 v52, v52
  v_exp_f32 v53, v53
  v_exp_f32 v54, v54
  v_exp_f32 v55, v55
  v_exp_f32 v24, v24
  v_exp_f32 v25, v25
  v_exp_f32 v26, v26
  v_smfmac_f32_32x32x32_bf16 v[208:223], v[140:143], v[48:55], v3
  s_mov_b64 exec, s[28:29]
  buffer_load_dwordx4 v[136:139], v2, s[8:11], s54 offen offset:1024
  buffer_load_dwordx4 v[140:143], v2, s[8:11], s54 offen offset:1536
  s_mov_b64 exec, -1
  v_exp_f32 v27, v27
  v_exp_f32 v28, v28
  v_exp_f32 v29, v29
  v_exp_f32 v30, v30
  v_exp_f32 v31, v31
  v_mfma_f32_32x32x16_bf16 v[40:55], v[132:135], a[252:255], v[104:119]
  buffer_load_dwordx4 v[128:131], v1, s[8:11], s54 offen offset:0
  v_exp_f32 v32, v32
  v_exp_f32 v33, v33
  v_exp_f32 v34, v34
  v_exp_f32 v35, v35
  v_smfmac_f32_32x32x32_bf16 v[224:239], v[144:147], v[24:31], v3
  buffer_load_dword v22, v16, s[4:7], 0 offen sc1
  v_exp_f32 v36, v36
  v_exp_f32 v37, v37
  v_exp_f32 v38, v38
  v_exp_f32 v39, v39
  v_exp_f32 v40, v40
  v_exp_f32 v41, v41
  v_exp_f32 v42, v42
  v_smfmac_f32_32x32x32_bf16 v[224:239], v[148:151], v[32:39], v3
  v_exp_f32 v43, v43
  v_exp_f32 v44, v44
  v_exp_f32 v45, v45
  v_exp_f32 v46, v46
  v_exp_f32 v47, v47
  v_mfma_f32_32x32x16_bf16 v[24:39], v[132:135], a[240:243], v[56:71]
  v_exp_f32 v48, v48
  v_exp_f32 v49, v49
  v_exp_f32 v50, v50
  v_exp_f32 v51, v51
  v_smfmac_f32_32x32x32_bf16 v[240:255], v[144:147], v[40:47], v3
  v_exp_f32 v52, v52
  v_exp_f32 v53, v53
  v_exp_f32 v54, v54
  v_exp_f32 v55, v55
  v_exp_f32 v24, v24
  v_exp_f32 v25, v25
  v_exp_f32 v26, v26
  v_smfmac_f32_32x32x32_bf16 v[240:255], v[148:151], v[48:55], v3
  v_exp_f32 v27, v27
  v_exp_f32 v28, v28
  v_exp_f32 v29, v29
  v_exp_f32 v30, v30
  v_exp_f32 v31, v31
  v_mfma_f32_32x32x16_bf16 v[40:55], v[132:135], a[244:247], v[72:87]
  v_exp_f32 v32, v32
  v_exp_f32 v33, v33
  v_exp_f32 v34, v34
  v_exp_f32 v35, v35
  v_smfmac_f32_32x32x32_bf16 v[192:207], v[144:147], v[24:31], v3
  v_exp_f32 v36, v36
  v_exp_f32 v37, v37
  v_exp_f32 v38, v38
  v_exp_f32 v39, v39
  v_exp_f32 v40, v40
  v_exp_f32 v41, v41
  v_exp_f32 v42, v42
  v_smfmac_f32_32x32x32_bf16 v[192:207], v[148:151], v[32:39], v3
  s_waitcnt vmcnt(7)
  v_exp_f32 v43, v43
  v_exp_f32 v44, v44
  v_exp_f32 v45, v45
  v_exp_f32 v46, v46
  v_exp_f32 v47, v47
  v_mfma_f32_32x32x16_bf16 v[24:39], v[120:123], a[248:251], v[88:103]
  v_exp_f32 v48, v48
  v_exp_f32 v49, v49
  v_exp_f32 v50, v50
  v_exp_f32 v51, v51
  v_smfmac_f32_32x32x32_bf16 v[208:223], v[144:147], v[40:47], v3
  v_exp_f32 v52, v52
  v_exp_f32 v53, v53
  v_exp_f32 v54, v54
  v_exp_f32 v55, v55
  v_exp_f32 v24, v24
  v_exp_f32 v25, v25
  v_exp_f32 v26, v26
  v_smfmac_f32_32x32x32_bf16 v[208:223], v[148:151], v[48:55], v3
  s_mov_b64 exec, s[28:29]
  buffer_load_dwordx4 v[144:147], v2, s[8:11], s54 offen offset:3072
  buffer_load_dwordx4 v[148:151], v2, s[8:11], s54 offen offset:3584
  s_mov_b64 exec, -1
  v_exp_f32 v27, v27
  v_exp_f32 v28, v28
  v_exp_f32 v29, v29
  v_exp_f32 v30, v30
  v_exp_f32 v31, v31
  v_mfma_f32_32x32x16_bf16 v[40:55], v[120:123], a[252:255], v[104:119]
  buffer_load_dwordx4 v[132:135], v1, s[8:11], s54 offen offset:2048
  v_exp_f32 v32, v32
  v_exp_f32 v33, v33
  v_exp_f32 v34, v34
  v_exp_f32 v35, v35
  v_smfmac_f32_32x32x32_bf16 v[224:239], v[176:179], v[24:31], v3
  s_add_u32 s54, s54, 8192
  s_and_b32 s54, s54, 0x1ffff
  v_exp_f32 v36, v36
  v_exp_f32 v37, v37
  v_exp_f32 v38, v38
  v_exp_f32 v39, v39
  v_exp_f32 v40, v40
  v_exp_f32 v41, v41
  v_exp_f32 v42, v42
  v_smfmac_f32_32x32x32_bf16 v[224:239], v[180:183], v[32:39], v3
  v_exp_f32 v43, v43
  v_exp_f32 v44, v44
  v_exp_f32 v45, v45
  v_exp_f32 v46, v46
  v_exp_f32 v47, v47
  v_mfma_f32_32x32x16_bf16 v[24:39], v[120:123], a[240:243], v[56:71]
  v_exp_f32 v48, v48
  v_exp_f32 v49, v49
  v_exp_f32 v50, v50
  v_exp_f32 v51, v51
  v_smfmac_f32_32x32x32_bf16 v[240:255], v[176:179], v[40:47], v3
  v_exp_f32 v52, v52
  v_exp_f32 v53, v53
  v_exp_f32 v54, v54
  v_exp_f32 v55, v55
  s_waitcnt vmcnt(3)
  v_cmp_gt_u32 vcc, 1, v22
  s_cbranch_vccnz L_slow_14
L_back_15:
  v_exp_f32 v24, v24
  v_exp_f32 v25, v25
  v_exp_f32 v26, v26
  v_smfmac_f32_32x32x32_bf16 v[240:255], v[180:183], v[48:55], v3
  v_exp_f32 v27, v27
  v_exp_f32 v28, v28
  v_exp_f32 v29, v29
  v_exp_f32 v30, v30
  v_exp_f32 v31, v31
  v_mfma_f32_32x32x16_bf16 v[40:55], v[120:123], a[244:247], v[72:87]
  v_exp_f32 v32, v32
  v_exp_f32 v33, v33
  v_exp_f32 v34, v34
  v_exp_f32 v35, v35
  v_smfmac_f32_32x32x32_bf16 v[192:207], v[176:179], v[24:31], v3
  buffer_load_dwordx4 a[0:3], v1, s[4:7], s56 offen offset:0
  v_exp_f32 v36, v36
  v_exp_f32 v37, v37
  v_exp_f32 v38, v38
  v_exp_f32 v39, v39
  v_exp_f32 v40, v40
  v_exp_f32 v41, v41
  v_exp_f32 v42, v42
  v_smfmac_f32_32x32x32_bf16 v[192:207], v[180:183], v[32:39], v3
  s_waitcnt vmcnt(8)
  v_exp_f32 v43, v43
  v_exp_f32 v44, v44
  v_exp_f32 v45, v45
  v_exp_f32 v46, v46
  v_exp_f32 v47, v47
  v_mfma_f32_32x32x16_bf16 v[24:39], v[124:127], a[248:251], v[88:103]
  v_exp_f32 v48, v48
  v_exp_f32 v49, v49
  v_exp_f32 v50, v50
  v_exp_f32 v51, v51
  v_smfmac_f32_32x32x32_bf16 v[208:223], v[176:179], v[40:47], v3
  buffer_load_dwordx4 v1, s[4:7], s55 offen offset:0 lds
  v_exp_f32 v52, v52
  v_exp_f32 v53, v53
  v_exp_f32 v54, v54
  v_exp_f32 v55, v55
  v_exp_f32 v24, v24
  v_exp_f32 v25, v25
  v_exp_f32 v26, v26
  v_smfmac_f32_32x32x32_bf16 v[208:223], v[180:183], v[48:55], v3
  s_mov_b64 exec, s[28:29]
  buffer_load_dwordx4 v[176:179], v2, s[8:11], s54 offen offset:1024
  buffer_load_dwordx4 v[180:183], v2, s[8:11], s54 offen offset:1536
  s_mov_b64 exec, -1
  v_exp_f32 v27, v27
  v_exp_f32 v28, v28
  v_exp_f32 v29, v29
  v_exp_f32 v30, v30
  v_exp_f32 v31, v31
  v_mfma_f32_32x32x16_bf16 v[40:55], v[124:127], a[252:255], v[104:119]
  buffer_load_dwordx4 v[120:123], v1, s[8:11], s54 offen offset:0
  v_exp_f32 v32, v32
  v_exp_f32 v33, v33
  v_exp_f32 v34, v34
  v_exp_f32 v35, v35
  v_smfmac_f32_32x32x32_bf16 v[224:239], v[184:187], v[24:31], v3
  v_exp_f32 v36, v36
  v_exp_f32 v37, v37
  v_exp_f32 v38, v38
  v_exp_f32 v39, v39
  v_exp_f32 v40, v40
  v_exp_f32 v41, v41
  v_exp_f32 v42, v42
  v_smfmac_f32_32x32x32_bf16 v[224:239], v[188:191], v[32:39], v3
  v_exp_f32 v43, v43
  v_exp_f32 v44, v44
  v_exp_f32 v45, v45
  v_exp_f32 v46, v46
  v_exp_f32 v47, v47
  v_mfma_f32_32x32x16_bf16 v[24:39], v[124:127], a[240:243], v[56:71]
  buffer_load_dwordx4 a[128:131], v1, s[4:7], s57 offen offset:0
  v_exp_f32 v48, v48
  v_exp_f32 v49, v49
  v_exp_f32 v50, v50
  v_exp_f32 v51, v51
  v_smfmac_f32_32x32x32_bf16 v[240:255], v[184:187], v[40:47], v3
  buffer_load_dwordx4 a[4:7], v1, s[4:7], s56 offen offset:1024
  v_exp_f32 v52, v52
  v_exp_f32 v53, v53
  v_exp_f32 v54, v54
  v_exp_f32 v55, v55
  v_exp_f32 v24, v24
  v_exp_f32 v25, v25
  v_exp_f32 v26, v26
  v_smfmac_f32_32x32x32_bf16 v[240:255], v[188:191], v[48:55], v3
  v_exp_f32 v27, v27
  v_exp_f32 v28, v28
  v_exp_f32 v29, v29
  v_exp_f32 v30, v30
  v_exp_f32 v31, v31
  v_mfma_f32_32x32x16_bf16 v[40:55], v[124:127], a[244:247], v[72:87]
  v_exp_f32 v32, v32
  v_exp_f32 v33, v33
  v_exp_f32 v34, v34
  v_exp_f32 v35, v35
  v_smfmac_f32_32x32x32_bf16 v[192:207], v[184:187], v[24:31], v3
  buffer_load_dwordx4 v1, s[4:7], s55 offen offset:1024 lds
  v_exp_f32 v36, v36
  v_exp_f32 v37, v37
  v_exp_f32 v38, v38
  v_exp_f32 v39, v39
  v_exp_f32 v40, v40
  v_exp_f32 v41, v41
  v_exp_f32 v42, v42
  v_smfmac_f32_32x32x32_bf16 v[192:207], v[188:191], v[32:39], v3
  s_waitcnt vmcnt(12)
  v_exp_f32 v43, v43
  v_exp_f32 v44, v44
  v_exp_f32 v45, v45
  v_exp_f32 v46, v46
  v_exp_f32 v47, v47
  v_mfma_f32_32x32x16_bf16 v[24:39], v[128:131], a[248:251], v[88:103]
  v_exp_f32 v48, v48
  v_exp_f32 v49, v49
  v_exp_f32 v50, v50
  v_exp_f32 v51, v51
  v_smfmac_f32_32x32x32_bf16 v[208:223], v[184:187], v[40:47], v3
  buffer_load_dwordx4 a[132:135], v1, s[4:7], s57 offen offset:1024
  v_exp_f32 v52, v52
  v_exp_f32 v53, v53
  v_exp_f32 v54, v54
  v_exp_f32 v55, v55
  v_exp_f32 v24, v24
  v_exp_f32 v25, v25
  v_exp_f32 v26, v26
  v_smfmac_f32_32x32x32_bf16 v[208:223], v[188:191], v[48:55], v3
  s_mov_b64 exec, s[28:29]
  buffer_load_dwordx4 v[184:187], v2, s[8:11], s54 offen offset:3072
  buffer_load_dwordx4 v[188:191], v2, s[8:11], s54 offen offset:3584
  s_mov_b64 exec, -1
  v_exp_f32 v27, v27
  v_exp_f32 v28, v28
  v_exp_f32 v29, v29
  v_exp_f32 v30, v30
  v_exp_f32 v31, v31
  v_mfma_f32_32x32x16_bf16 v[40:55], v[128:131], a[252:255], v[104:119]
  buffer_load_dwordx4 v[124:127], v1, s[8:11], s54 offen offset:2048
  v_exp_f32 v32, v32
  v_exp_f32 v33, v33
  v_exp_f32 v34, v34
  v_exp_f32 v35, v35
  v_smfmac_f32_32x32x32_bf16 v[224:239], v[136:139], v[24:31], v3
  s_add_u32 s54, s54, 8192
  s_and_b32 s54, s54, 0x1ffff
  v_exp_f32 v36, v36
  v_exp_f32 v37, v37
  v_exp_f32 v38, v38
  v_exp_f32 v39, v39
  v_exp_f32 v40, v40
  v_exp_f32 v41, v41
  v_exp_f32 v42, v42
  v_smfmac_f32_32x32x32_bf16 v[224:239], v[140:143], v[32:39], v3
  buffer_load_dwordx4 a[8:11], v1, s[4:7], s56 offen offset:2048
  v_exp_f32 v43, v43
  v_exp_f32 v44, v44
  v_exp_f32 v45, v45
  v_exp_f32 v46, v46
  v_exp_f32 v47, v47
  v_mfma_f32_32x32x16_bf16 v[24:39], v[128:131], a[240:243], v[56:71]
  buffer_load_dwordx4 v1, s[4:7], s55 offen offset:2048 lds
  v_exp_f32 v48, v48
  v_exp_f32 v49, v49
  v_exp_f32 v50, v50
  v_exp_f32 v51, v51
  v_smfmac_f32_32x32x32_bf16 v[240:255], v[136:139], v[40:47], v3
  buffer_load_dwordx4 a[136:139], v1, s[4:7], s57 offen offset:2048
  v_exp_f32 v52, v52
  v_exp_f32 v53, v53
  v_exp_f32 v54, v54
  v_exp_f32 v55, v55
  v_exp_f32 v24, v24
  v_exp_f32 v25, v25
  v_exp_f32 v26, v26
  v_smfmac_f32_32x32x32_bf16 v[240:255], v[140:143], v[48:55], v3
  v_exp_f32 v27, v27
  v_exp_f32 v28, v28
  v_exp_f32 v29, v29
  v_exp_f32 v30, v30
  v_exp_f32 v31, v31
  v_mfma_f32_32x32x16_bf16 v[40:55], v[128:131], a[244:247], v[72:87]
  v_exp_f32 v32, v32
  v_exp_f32 v33, v33
  v_exp_f32 v34, v34
  v_exp_f32 v35, v35
  v_smfmac_f32_32x32x32_bf16 v[192:207], v[136:139], v[24:31], v3
  buffer_load_dwordx4 a[12:15], v1, s[4:7], s56 offen offset:3072
  s_add_u32 s56, s56, 4096
  v_exp_f32 v36, v36
  v_exp_f32 v37, v37
  v_exp_f32 v38, v38
  v_exp_f32 v39, v39
  v_exp_f32 v40, v40
  v_exp_f32 v41, v41
  v_exp_f32 v42, v42
  v_smfmac_f32_32x32x32_bf16 v[192:207], v[140:143], v[32:39], v3
  s_waitcnt vmcnt(16)
  v_exp_f32 v43, v43
  v_exp_f32 v44, v44
  v_exp_f32 v45, v45
  v_exp_f32 v46, v46
  v_exp_f32 v47, v47
  v_mfma_f32_32x32x16_bf16 v[24:39], v[132:135], a[248:251], v[88:103]
  v_exp_f32 v48, v48
  v_exp_f32 v49, v49
  v_exp_f32 v50, v50
  v_exp_f32 v51, v51
  v_smfmac_f32_32x32x32_bf16 v[208:223], v[136:139], v[40:47], v3
  buffer_load_dwordx4 v1, s[4:7], s55 offen offset:3072 lds
  s_add_u32 m0, m0, 4096
  s_add_u32 s55, s55, 4096
  v_exp_f32 v52, v52
  v_exp_f32 v53, v53
  v_exp_f32 v54, v54
  v_exp_f32 v55, v55
  v_exp_f32 v24, v24
  v_exp_f32 v25, v25
  v_exp_f32 v26, v26
  v_smfmac_f32_32x32x32_bf16 v[208:223], v[140:143], v[48:55], v3
  s_mov_b64 exec, s[28:29]
  buffer_load_dwordx4 v[136:139], v2, s[8:11], s54 offen offset:1024
  buffer_load_dwordx4 v[140:143], v2, s[8:11], s54 offen offset:1536
  s_mov_b64 exec, -1
  v_exp_f32 v27, v27
  v_exp_f32 v28, v28
  v_exp_f32 v29, v29
  v_exp_f32 v30, v30
  v_exp_f32 v31, v31
  v_mfma_f32_32x32x16_bf16 v[40:55], v[132:135], a[252:255], v[104:119]
  buffer_load_dwordx4 v[128:131], v1, s[8:11], s54 offen offset:0
  v_exp_f32 v32, v32
  v_exp_f32 v33, v33
  v_exp_f32 v34, v34
  v_exp_f32 v35, v35
  v_smfmac_f32_32x32x32_bf16 v[224:239], v[144:147], v[24:31], v3
  v_exp_f32 v36, v36
  v_exp_f32 v37, v37
  v_exp_f32 v38, v38
  v_exp_f32 v39, v39
  v_exp_f32 v40, v40
  v_exp_f32 v41, v41
  v_exp_f32 v42, v42
  v_smfmac_f32_32x32x32_bf16 v[224:239], v[148:151], v[32:39], v3
  v_exp_f32 v43, v43
  v_exp_f32 v44, v44
  v_exp_f32 v45, v45
  v_exp_f32 v46, v46
  v_exp_f32 v47, v47
  v_mfma_f32_32x32x16_bf16 v[24:39], v[132:135], a[240:243], v[56:71]
  buffer_load_dwordx4 a[140:143], v1, s[4:7], s57 offen offset:3072
  s_add_u32 s57, s57, 4096
  v_exp_f32 v48, v48
  v_exp_f32 v49, v49
  v_exp_f32 v50, v50
  v_exp_f32 v51, v51
  v_smfmac_f32_32x32x32_bf16 v[240:255], v[144:147], v[40:47], v3
  buffer_load_dwordx4 a[16:19], v1, s[4:7], s56 offen offset:0
  v_exp_f32 v52, v52
  v_exp_f32 v53, v53
  v_exp_f32 v54, v54
  v_exp_f32 v55, v55
  v_exp_f32 v24, v24
  v_exp_f32 v25, v25
  v_exp_f32 v26, v26
  v_smfmac_f32_32x32x32_bf16 v[240:255], v[148:151], v[48:55], v3
  v_exp_f32 v27, v27
  v_exp_f32 v28, v28
  v_exp_f32 v29, v29
  v_exp_f32 v30, v30
  v_exp_f32 v31, v31
  v_mfma_f32_32x32x16_bf16 v[40:55], v[132:135], a[244:247], v[72:87]
  v_exp_f32 v32, v32
  v_exp_f32 v33, v33
  v_exp_f32 v34, v34
  v_exp_f32 v35, v35
  v_smfmac_f32_32x32x32_bf16 v[192:207], v[144:147], v[24:31], v3
  buffer_load_dwordx4 v1, s[4:7], s55 offen offset:0 lds
  v_exp_f32 v36, v36
  v_exp_f32 v37, v37
  v_exp_f32 v38, v38
  v_exp_f32 v39, v39
  v_exp_f32 v40, v40
  v_exp_f32 v41, v41
  v_exp_f32 v42, v42
  v_smfmac_f32_32x32x32_bf16 v[192:207], v[148:151], v[32:39], v3
  s_waitcnt vmcnt(18)
  v_exp_f32 v43, v43
  v_exp_f32 v44, v44
  v_exp_f32 v45, v45
  v_exp_f32 v46, v46
  v_exp_f32 v47, v47
  v_mfma_f32_32x32x16_bf16 v[24:39], v[120:123], a[248:251], v[88:103]
  v_exp_f32 v48, v48
  v_exp_f32 v49, v49
  v_exp_f32 v50, v50
  v_exp_f32 v51, v51
  v_smfmac_f32_32x32x32_bf16 v[208:223], v[144:147], v[40:47], v3
  buffer_load_dwordx4 a[20:23], v1, s[4:7], s56 offen offset:1024
  v_exp_f32 v52, v52
  v_exp_f32 v53, v53
  v_exp_f32 v54, v54
  v_exp_f32 v55, v55
  v_exp_f32 v24, v24
  v_exp_f32 v25, v25
  v_exp_f32 v26, v26
  v_smfmac_f32_32x32x32_bf16 v[208:223], v[148:151], v[48:55], v3
  s_mov_b64 exec, s[28:29]
  buffer_load_dwordx4 v[144:147], v2, s[8:11], s54 offen offset:3072
  buffer_load_dwordx4 v[148:151], v2, s[8:11], s54 offen offset:3584
  s_mov_b64 exec, -1
  v_exp_f32 v27, v27
  v_exp_f32 v28, v28
  v_exp_f32 v29, v29
  v_exp_f32 v30, v30
  v_exp_f32 v31, v31
  v_mfma_f32_32x32x16_bf16 v[40:55], v[120:123], a[252:255], v[104:119]
  buffer_load_dwordx4 v[132:135], v1, s[8:11], s54 offen offset:2048
  v_exp_f32 v32, v32
  v_exp_f32 v33, v33
  v_exp_f32 v34, v34
  v_exp_f32 v35, v35
  v_smfmac_f32_32x32x32_bf16 v[224:239], v[176:179], v[24:31], v3
  s_add_u32 s54, s54, 8192
  s_and_b32 s54, s54, 0x1ffff
  v_exp_f32 v36, v36
  v_exp_f32 v37, v37
  v_exp_f32 v38, v38
  v_exp_f32 v39, v39
  v_exp_f32 v40, v40
  v_exp_f32 v41, v41
  v_exp_f32 v42, v42
  v_smfmac_f32_32x32x32_bf16 v[224:239], v[180:183], v[32:39], v3
  v_exp_f32 v43, v43
  v_exp_f32 v44, v44
  v_exp_f32 v45, v45
  v_exp_f32 v46, v46
  v_exp_f32 v47, v47
  v_mfma_f32_32x32x16_bf16 v[24:39], v[120:123], a[240:243], v[56:71]
  buffer_load_dwordx4 v1, s[4:7], s55 offen offset:1024 lds
  v_exp_f32 v48, v48
  v_exp_f32 v49, v49
  v_exp_f32 v50, v50
  v_exp_f32 v51, v51
  v_smfmac_f32_32x32x32_bf16 v[240:255], v[176:179], v[40:47], v3
  buffer_load_dwordx4 a[144:147], v1, s[4:7], s57 offen offset:0
  v_exp_f32 v52, v52
  v_exp_f32 v53, v53
  v_exp_f32 v54, v54
  v_exp_f32 v55, v55
  v_exp_f32 v24, v24
  v_exp_f32 v25, v25
  v_exp_f32 v26, v26
  v_smfmac_f32_32x32x32_bf16 v[240:255], v[180:183], v[48:55], v3
  v_exp_f32 v27, v27
  v_exp_f32 v28, v28
  v_exp_f32 v29, v29
  v_exp_f32 v30, v30
  v_exp_f32 v31, v31
  v_mfma_f32_32x32x16_bf16 v[40:55], v[120:123], a[244:247], v[72:87]
  v_exp_f32 v32, v32
  v_exp_f32 v33, v33
  v_exp_f32 v34, v34
  v_exp_f32 v35, v35
  v_smfmac_f32_32x32x32_bf16 v[192:207], v[176:179], v[24:31], v3
  buffer_load_dwordx4 a[24:27], v1, s[4:7], s56 offen offset:2048
  v_exp_f32 v36, v36
  v_exp_f32 v37, v37
  v_exp_f32 v38, v38
  v_exp_f32 v39, v39
  v_exp_f32 v40, v40
  v_exp_f32 v41, v41
  v_exp_f32 v42, v42
  v_smfmac_f32_32x32x32_bf16 v[192:207], v[180:183], v[32:39], v3
  s_waitcnt vmcnt(18)
  v_exp_f32 v43, v43
  v_exp_f32 v44, v44
  v_exp_f32 v45, v45
  v_exp_f32 v46, v46
  v_exp_f32 v47, v47
  v_mfma_f32_32x32x16_bf16 v[24:39], v[124:127], a[248:251], v[88:103]
  v_exp_f32 v48, v48
  v_exp_f32 v49, v49
  v_exp_f32 v50, v50
  v_exp_f32 v51, v51
  v_smfmac_f32_32x32x32_bf16 v[208:223], v[176:179], v[40:47], v3
  buffer_load_dwordx4 v1, s[4:7], s55 offen offset:2048 lds
  v_exp_f32 v52, v52
  v_exp_f32 v53, v53
  v_exp_f32 v54, v54
  v_exp_f32 v55, v55
  v_exp_f32 v24, v24
  v_exp_f32 v25, v25
  v_exp_f32 v26, v26
  v_smfmac_f32_32x32x32_bf16 v[208:223], v[180:183], v[48:55], v3
  s_mov_b64 exec, s[28:29]
  buffer_load_dwordx4 v[176:179], v2, s[8:11], s54 offen offset:1024
  buffer_load_dwordx4 v[180:183], v2, s[8:11], s54 offen offset:1536
  s_mov_b64 exec, -1
  v_exp_f32 v27, v27
  v_exp_f32 v28, v28
  v_exp_f32 v29, v29
  v_exp_f32 v30, v30
  v_exp_f32 v31, v31
  v_mfma_f32_32x32x16_bf16 v[40:55], v[124:127], a[252:255], v[104:119]
  buffer_load_dwordx4 v[120:123], v1, s[8:11], s54 offen offset:0
  v_exp_f32 v32, v32
  v_exp_f32 v33, v33
  v_exp_f32 v34, v34
  v_exp_f32 v35, v35
  v_smfmac_f32_32x32x32_bf16 v[224:239], v[184:187], v[24:31], v3
  v_exp_f32 v36, v36
  v_exp_f32 v37, v37
  v_exp_f32 v38, v38
  v_exp_f32 v39, v39
  v_exp_f32 v40, v40
  v_exp_f32 v41, v41
  v_exp_f32 v42, v42
  v_smfmac_f32_32x32x32_bf16 v[224:239], v[188:191], v[32:39], v3
  buffer_load_dwordx4 a[148:151], v1, s[4:7], s57 offen offset:1024
  v_exp_f32 v43, v43
  v_exp_f32 v44, v44
  v_exp_f32 v45, v45
  v_exp_f32 v46, v46
  v_exp_f32 v47, v47
  v_mfma_f32_32x32x16_bf16 v[24:39], v[124:127], a[240:243], v[56:71]
  buffer_load_dwordx4 a[28:31], v1, s[4:7], s56 offen offset:3072
  s_add_u32 s56, s56, 4096
  v_exp_f32 v48, v48
  v_exp_f32 v49, v49
  v_exp_f32 v50, v50
  v_exp_f32 v51, v51
  v_smfmac_f32_32x32x32_bf16 v[240:255], v[184:187], v[40:47], v3
  buffer_load_dwordx4 v1, s[4:7], s55 offen offset:3072 lds
  s_add_u32 m0, m0, 4096
  s_add_u32 s55, s55, 4096
  v_exp_f32 v52, v52
  v_exp_f32 v53, v53
  v_exp_f32 v54, v54
  v_exp_f32 v55, v55
  v_exp_f32 v24, v24
  v_exp_f32 v25, v25
  v_exp_f32 v26, v26
  v_smfmac_f32_32x32x32_bf16 v[240:255], v[188:191], v[48:55], v3
  v_exp_f32 v27, v27
  v_exp_f32 v28, v28
  v_exp_f32 v29, v29
  v_exp_f32 v30, v30
  v_exp_f32 v31, v31
  v_mfma_f32_32x32x16_bf16 v[40:55], v[124:127], a[244:247], v[72:87]
  v_exp_f32 v32, v32
  v_exp_f32 v33, v33
  v_exp_f32 v34, v34
  v_exp_f32 v35, v35
  v_smfmac_f32_32x32x32_bf16 v[192:207], v[184:187], v[24:31], v3
  buffer_load_dwordx4 a[152:155], v1, s[4:7], s57 offen offset:2048
  v_exp_f32 v36, v36
  v_exp_f32 v37, v37
  v_exp_f32 v38, v38
  v_exp_f32 v39, v39
  v_exp_f32 v40, v40
  v_exp_f32 v41, v41
  v_exp_f32 v42, v42
  v_smfmac_f32_32x32x32_bf16 v[192:207], v[188:191], v[32:39], v3
  s_waitcnt vmcnt(18)
  v_exp_f32 v43, v43
  v_exp_f32 v44, v44
  v_exp_f32 v45, v45
  v_exp_f32 v46, v46
  v_exp_f32 v47, v47
  v_mfma_f32_32x32x16_bf16 v[24:39], v[128:131], a[248:251], v[88:103]
  v_exp_f32 v48, v48
  v_exp_f32 v49, v49
  v_exp_f32 v50, v50
  v_exp_f32 v51, v51
  v_smfmac_f32_32x32x32_bf16 v[208:223], v[184:187], v[40:47], v3
  buffer_load_dwordx4 a[32:35], v1, s[4:7], s56 offen offset:0
  v_exp_f32 v52, v52
  v_exp_f32 v53, v53
  v_exp_f32 v54, v54
  v_exp_f32 v55, v55
  v_exp_f32 v24, v24
  v_exp_f32 v25, v25
  v_exp_f32 v26, v26
  v_smfmac_f32_32x32x32_bf16 v[208:223], v[188:191], v[48:55], v3
  s_mov_b64 exec, s[28:29]
  buffer_load_dwordx4 v[184:187], v2, s[8:11], s54 offen offset:3072
  buffer_load_dwordx4 v[188:191], v2, s[8:11], s54 offen offset:3584
  s_mov_b64 exec, -1
  v_exp_f32 v27, v27
  v_exp_f32 v28, v28
  v_exp_f32 v29, v29
  v_exp_f32 v30, v30
  v_exp_f32 v31, v31
  v_mfma_f32_32x32x16_bf16 v[40:55], v[128:131], a[252:255], v[104:119]
  buffer_load_dwordx4 v[124:127], v1, s[8:11], s54 offen offset:2048
  v_exp_f32 v32, v32
  v_exp_f32 v33, v33
  v_exp_f32 v34, v34
  v_exp_f32 v35, v35
  v_smfmac_f32_32x32x32_bf16 v[224:239], v[136:139], v[24:31], v3
  s_add_u32 s54, s54, 8192
  s_and_b32 s54, s54, 0x1ffff
  v_exp_f32 v36, v36
  v_exp_f32 v37, v37
  v_exp_f32 v38, v38
  v_exp_f32 v39, v39
  v_exp_f32 v40, v40
  v_exp_f32 v41, v41
  v_exp_f32 v42, v42
  v_smfmac_f32_32x32x32_bf16 v[224:239], v[140:143], v[32:39], v3
  v_exp_f32 v43, v43
  v_exp_f32 v44, v44
  v_exp_f32 v45, v45
  v_exp_f32 v46, v46
  v_exp_f32 v47, v47
  v_mfma_f32_32x32x16_bf16 v[24:39], v[128:131], a[240:243], v[56:71]
  buffer_load_dwordx4 v1, s[4:7], s55 offen offset:0 lds
  v_exp_f32 v48, v48
  v_exp_f32 v49, v49
  v_exp_f32 v50, v50
  v_exp_f32 v51, v51
  v_smfmac_f32_32x32x32_bf16 v[240:255], v[136:139], v[40:47], v3
  buffer_load_dwordx4 a[156:159], v1, s[4:7], s57 offen offset:3072
  s_add_u32 s57, s57, 4096
  v_exp_f32 v52, v52
  v_exp_f32 v53, v53
  v_exp_f32 v54, v54
  v_exp_f32 v55, v55
  v_exp_f32 v24, v24
  v_exp_f32 v25, v25
  v_exp_f32 v26, v26
  v_smfmac_f32_32x32x32_bf16 v[240:255], v[140:143], v[48:55], v3
  v_exp_f32 v27, v27
  v_exp_f32 v28, v28
  v_exp_f32 v29, v29
  v_exp_f32 v30, v30
  v_exp_f32 v31, v31
  v_mfma_f32_32x32x16_bf16 v[40:55], v[128:131], a[244:247], v[72:87]
  v_exp_f32 v32, v32
  v_exp_f32 v33, v33
  v_exp_f32 v34, v34
  v_exp_f32 v35, v35
  v_smfmac_f32_32x32x32_bf16 v[192:207], v[136:139], v[24:31], v3
  buffer_load_dwordx4 a[36:39], v1, s[4:7], s56 offen offset:1024
  v_exp_f32 v36, v36
  v_exp_f32 v37, v37
  v_exp_f32 v38, v38
  v_exp_f32 v39, v39
  v_exp_f32 v40, v40
  v_exp_f32 v41, v41
  v_exp_f32 v42, v42
  v_smfmac_f32_32x32x32_bf16 v[192:207], v[140:143], v[32:39], v3
  s_waitcnt vmcnt(18)
  v_exp_f32 v43, v43
  v_exp_f32 v44, v44
  v_exp_f32 v45, v45
  v_exp_f32 v46, v46
  v_exp_f32 v47, v47
  v_mfma_f32_32x32x16_bf16 v[24:39], v[132:135], a[248:251], v[88:103]
  v_exp_f32 v48, v48
  v_exp_f32 v49, v49
  v_exp_f32 v50, v50
  v_exp_f32 v51, v51
  v_smfmac_f32_32x32x32_bf16 v[208:223], v[136:139], v[40:47], v3
  buffer_load_dwordx4 v1, s[4:7], s55 offen offset:1024 lds
  v_exp_f32 v52, v52
  v_exp_f32 v53, v53
  v_exp_f32 v54, v54
  v_exp_f32 v55, v55
  v_exp_f32 v24, v24
  v_exp_f32 v25, v25
  v_exp_f32 v26, v26
  v_smfmac_f32_32x32x32_bf16 v[208:223], v[140:143], v[48:55], v3
  s_mov_b64 exec, s[28:29]
  buffer_load_dwordx4 v[136:139], v2, s[8:11], s54 offen offset:1024
  buffer_load_dwordx4 v[140:143], v2, s[8:11], s54 offen offset:1536
  s_mov_b64 exec, -1
  v_exp_f32 v27, v27
  v_exp_f32 v28, v28
  v_exp_f32 v29, v29
  v_exp_f32 v30, v30
  v_exp_f32 v31, v31
  v_mfma_f32_32x32x16_bf16 v[40:55], v[132:135], a[252:255], v[104:119]
  buffer_load_dwordx4 v[128:131], v1, s[8:11], s54 offen offset:0
  v_exp_f32 v32, v32
  v_exp_f32 v33, v33
  v_exp_f32 v34, v34
  v_exp_f32 v35, v35
  v_smfmac_f32_32x32x32_bf16 v[224:239], v[144:147], v[24:31], v3
  v_exp_f32 v36, v36
  v_exp_f32 v37, v37
  v_exp_f32 v38, v38
  v_exp_f32 v39, v39
  v_exp_f32 v40, v40
  v_exp_f32 v41, v41
  v_exp_f32 v42, v42
  v_smfmac_f32_32x32x32_bf16 v[224:239], v[148:151], v[32:39], v3
  v_exp_f32 v43, v43
  v_exp_f32 v44, v44
  v_exp_f32 v45, v45
  v_exp_f32 v46, v46
  v_exp_f32 v47, v47
  v_mfma_f32_32x32x16_bf16 v[24:39], v[132:135], a[240:243], v[56:71]
  buffer_load_dwordx4 a[40:43], v1, s[4:7], s56 offen offset:2048
  v_exp_f32 v48, v48
  v_exp_f32 v49, v49
  v_exp_f32 v50, v50
  v_exp_f32 v51, v51
  v_smfmac_f32_32x32x32_bf16 v[240:255], v[144:147], v[40:47], v3
  buffer_load_dwordx4 a[160:163], v1, s[4:7], s57 offen offset:0
  s_add_u32 s57, s57, 25600
  v_exp_f32 v52, v52
  v_exp_f32 v53, v53
  v_exp_f32 v54, v54
  v_exp_f32 v55, v55
  v_exp_f32 v24, v24
  v_exp_f32 v25, v25
  v_exp_f32 v26, v26
  v_smfmac_f32_32x32x32_bf16 v[240:255], v[148:151], v[48:55], v3
  v_exp_f32 v27, v27
  v_exp_f32 v28, v28
  v_exp_f32 v29, v29
  v_exp_f32 v30, v30
  v_exp_f32 v31, v31
  v_mfma_f32_32x32x16_bf16 v[40:55], v[132:135], a[244:247], v[72:87]
  v_exp_f32 v32, v32
  v_exp_f32 v33, v33
  v_exp_f32 v34, v34
  v_exp_f32 v35, v35
  v_smfmac_f32_32x32x32_bf16 v[192:207], v[144:147], v[24:31], v3
  buffer_load_dwordx4 v1, s[4:7], s55 offen offset:2048 lds
  v_exp_f32 v36, v36
  v_exp_f32 v37, v37
  v_exp_f32 v38, v38
  v_exp_f32 v39, v39
  v_exp_f32 v40, v40
  v_exp_f32 v41, v41
  v_exp_f32 v42, v42
  v_smfmac_f32_32x32x32_bf16 v[192:207], v[148:151], v[32:39], v3
  s_waitcnt vmcnt(18)
  v_exp_f32 v43, v43
  v_exp_f32 v44, v44
  v_exp_f32 v45, v45
  v_exp_f32 v46, v46
  v_exp_f32 v47, v47
  v_mfma_f32_32x32x16_bf16 v[24:39], v[120:123], a[248:251], v[88:103]
  v_exp_f32 v48, v48
  v_exp_f32 v49, v49
  v_exp_f32 v50, v50
  v_exp_f32 v51, v51
  v_smfmac_f32_32x32x32_bf16 v[208:223], v[144:147], v[40:47], v3
  buffer_load_dwordx4 a[44:47], v1, s[4:7], s56 offen offset:3072
  s_add_u32 s56, s56, 4096
  v_exp_f32 v52, v52
  v_exp_f32 v53, v53
  v_exp_f32 v54, v54
  v_exp_f32 v55, v55
  v_exp_f32 v24, v24
  v_exp_f32 v25, v25
  v_exp_f32 v26, v26
  v_smfmac_f32_32x32x32_bf16 v[208:223], v[148:151], v[48:55], v3
  s_mov_b64 exec, s[28:29]
  buffer_load_dwordx4 v[144:147], v2, s[8:11], s54 offen offset:3072
  buffer_load_dwordx4 v[148:151], v2, s[8:11], s54 offen offset:3584
  s_mov_b64 exec, -1
  v_exp_f32 v27, v27
  v_exp_f32 v28, v28
  v_exp_f32 v29, v29
  v_exp_f32 v30, v30
  v_exp_f32 v31, v31
  v_mfma_f32_32x32x16_bf16 v[40:55], v[120:123], a[252:255], v[104:119]
  buffer_load_dwordx4 v[132:135], v1, s[8:11], s54 offen offset:2048
  v_exp_f32 v32, v32
  v_exp_f32 v33, v33
  v_exp_f32 v34, v34
  v_exp_f32 v35, v35
  v_smfmac_f32_32x32x32_bf16 v[224:239], v[176:179], v[24:31], v3
  s_add_u32 s54, s54, 8192
  s_and_b32 s54, s54, 0x1ffff
  v_exp_f32 v36, v36
  v_exp_f32 v37, v37
  v_exp_f32 v38, v38
  v_exp_f32 v39, v39
  v_exp_f32 v40, v40
  v_exp_f32 v41, v41
  v_exp_f32 v42, v42
  v_smfmac_f32_32x32x32_bf16 v[224:239], v[180:183], v[32:39], v3
  buffer_load_dwordx4 v1, s[4:7], s55 offen offset:3072 lds
  s_add_u32 m0, m0, 4096
  s_add_u32 s55, s55, 4096
  v_exp_f32 v43, v43
  v_exp_f32 v44, v44
  v_exp_f32 v45, v45
  v_exp_f32 v46, v46
  v_exp_f32 v47, v47
  v_mfma_f32_32x32x16_bf16 v[24:39], v[120:123], a[240:243], v[56:71]
  buffer_load_dwordx4 a[164:167], v1, s[4:7], s57 offen offset:0
  v_exp_f32 v48, v48
  v_exp_f32 v49, v49
  v_exp_f32 v50, v50
  v_exp_f32 v51, v51
  v_smfmac_f32_32x32x32_bf16 v[240:255], v[176:179], v[40:47], v3
  buffer_load_dwordx4 a[48:51], v1, s[4:7], s56 offen offset:0
  v_exp_f32 v52, v52
  v_exp_f32 v53, v53
  v_exp_f32 v54, v54
  v_exp_f32 v55, v55
  v_exp_f32 v24, v24
  v_exp_f32 v25, v25
  v_exp_f32 v26, v26
  v_smfmac_f32_32x32x32_bf16 v[240:255], v[180:183], v[48:55], v3
  v_exp_f32 v27, v27
  v_exp_f32 v28, v28
  v_exp_f32 v29, v29
  v_exp_f32 v30, v30
  v_exp_f32 v31, v31
  v_mfma_f32_32x32x16_bf16 v[40:55], v[120:123], a[244:247], v[72:87]
  v_exp_f32 v32, v32
  v_exp_f32 v33, v33
  v_exp_f32 v34, v34
  v_exp_f32 v35, v35
  v_smfmac_f32_32x32x32_bf16 v[192:207], v[176:179], v[24:31], v3
  buffer_load_dwordx4 v1, s[4:7], s55 offen offset:0 lds
  v_exp_f32 v36, v36
  v_exp_f32 v37, v37
  v_exp_f32 v38, v38
  v_exp_f32 v39, v39
  v_exp_f32 v40, v40
  v_exp_f32 v41, v41
  v_exp_f32 v42, v42
  v_smfmac_f32_32x32x32_bf16 v[192:207], v[180:183], v[32:39], v3
  s_waitcnt vmcnt(18)
  v_exp_f32 v43, v43
  v_exp_f32 v44, v44
  v_exp_f32 v45, v45
  v_exp_f32 v46, v46
  v_exp_f32 v47, v47
  v_mfma_f32_32x32x16_bf16 v[24:39], v[124:127], a[248:251], v[88:103]
  v_exp_f32 v48, v48
  v_exp_f32 v49, v49
  v_exp_f32 v50, v50
  v_exp_f32 v51, v51
  v_smfmac_f32_32x32x32_bf16 v[208:223], v[176:179], v[40:47], v3
  buffer_load_dwordx4 a[168:171], v1, s[4:7], s57 offen offset:1024
  v_exp_f32 v52, v52
  v_exp_f32 v53, v53
  v_exp_f32 v54, v54
  v_exp_f32 v55, v55
  v_exp_f32 v24, v24
  v_exp_f32 v25, v25
  v_exp_f32 v26, v26
  v_smfmac_f32_32x32x32_bf16 v[208:223], v[180:183], v[48:55], v3
  s_mov_b64 exec, s[28:29]
  buffer_load_dwordx4 v[176:179], v2, s[8:11], s54 offen offset:1024
  buffer_load_dwordx4 v[180:183], v2, s[8:11], s54 offen offset:1536
  s_mov_b64 exec, -1
  v_exp_f32 v27, v27
  v_exp_f32 v28, v28
  v_exp_f32 v29, v29
  v_exp_f32 v30, v30
  v_exp_f32 v31, v31
  v_mfma_f32_32x32x16_bf16 v[40:55], v[124:127], a[252:255], v[104:119]
  buffer_load_dwordx4 v[120:123], v1, s[8:11], s54 offen offset:0
  v_exp_f32 v32, v32
  v_exp_f32 v33, v33
  v_exp_f32 v34, v34
  v_exp_f32 v35, v35
  v_smfmac_f32_32x32x32_bf16 v[224:239], v[184:187], v[24:31], v3
  v_exp_f32 v36, v36
  v_exp_f32 v37, v37
  v_exp_f32 v38, v38
  v_exp_f32 v39, v39
  v_exp_f32 v40, v40
  v_exp_f32 v41, v41
  v_exp_f32 v42, v42
  v_smfmac_f32_32x32x32_bf16 v[224:239], v[188:191], v[32:39], v3
  v_exp_f32 v43, v43
  v_exp_f32 v44, v44
  v_exp_f32 v45, v45
  v_exp_f32 v46, v46
  v_exp_f32 v47, v47
  v_mfma_f32_32x32x16_bf16 v[24:39], v[124:127], a[240:243], v[56:71]
  buffer_load_dwordx4 a[52:55], v1, s[4:7], s56 offen offset:1024
  v_exp_f32 v48, v48
  v_exp_f32 v49, v49
  v_exp_f32 v50, v50
  v_exp_f32 v51, v51
  v_smfmac_f32_32x32x32_bf16 v[240:255], v[184:187], v[40:47], v3
  buffer_load_dwordx4 v1, s[4:7], s55 offen offset:1024 lds
  v_exp_f32 v52, v52
  v_exp_f32 v53, v53
  v_exp_f32 v54, v54
  v_exp_f32 v55, v55
  v_exp_f32 v24, v24
  v_exp_f32 v25, v25
  v_exp_f32 v26, v26
  v_smfmac_f32_32x32x32_bf16 v[240:255], v[188:191], v[48:55], v3
  v_exp_f32 v27, v27
  v_exp_f32 v28, v28
  v_exp_f32 v29, v29
  v_exp_f32 v30, v30
  v_exp_f32 v31, v31
  v_mfma_f32_32x32x16_bf16 v[40:55], v[124:127], a[244:247], v[72:87]
  v_exp_f32 v32, v32
  v_exp_f32 v33, v33
  v_exp_f32 v34, v34
  v_exp_f32 v35, v35
  v_smfmac_f32_32x32x32_bf16 v[192:207], v[184:187], v[24:31], v3
  buffer_load_dwordx4 a[172:175], v1, s[4:7], s57 offen offset:2048
  v_exp_f32 v36, v36
  v_exp_f32 v37, v37
  v_exp_f32 v38, v38
  v_exp_f32 v39, v39
  v_exp_f32 v40, v40
  v_exp_f32 v41, v41
  v_exp_f32 v42, v42
  v_smfmac_f32_32x32x32_bf16 v[192:207], v[188:191], v[32:39], v3
  s_waitcnt vmcnt(18)
  v_exp_f32 v43, v43
  v_exp_f32 v44, v44
  v_exp_f32 v45, v45
  v_exp_f32 v46, v46
  v_exp_f32 v47, v47
  v_mfma_f32_32x32x16_bf16 v[24:39], v[128:131], a[248:251], v[88:103]
  v_exp_f32 v48, v48
  v_exp_f32 v49, v49
  v_exp_f32 v50, v50
  v_exp_f32 v51, v51
  v_smfmac_f32_32x32x32_bf16 v[208:223], v[184:187], v[40:47], v3
  buffer_load_dwordx4 a[56:59], v1, s[4:7], s56 offen offset:2048
  v_exp_f32 v52, v52
  v_exp_f32 v53, v53
  v_exp_f32 v54, v54
  v_exp_f32 v55, v55
  v_exp_f32 v24, v24
  v_exp_f32 v25, v25
  v_exp_f32 v26, v26
  v_smfmac_f32_32x32x32_bf16 v[208:223], v[188:191], v[48:55], v3
  s_mov_b64 exec, s[28:29]
  buffer_load_dwordx4 v[184:187], v2, s[8:11], s54 offen offset:3072
  buffer_load_dwordx4 v[188:191], v2, s[8:11], s54 offen offset:3584
  s_mov_b64 exec, -1
  v_exp_f32 v27, v27
  v_exp_f32 v28, v28
  v_exp_f32 v29, v29
  v_exp_f32 v30, v30
  v_exp_f32 v31, v31
  v_mfma_f32_32x32x16_bf16 v[40:55], v[128:131], a[252:255], v[104:119]
  buffer_load_dwordx4 v[124:127], v1, s[8:11], s54 offen offset:2048
  v_exp_f32 v32, v32
  v_exp_f32 v33, v33
  v_exp_f32 v34, v34
  v_exp_f32 v35, v35
  v_smfmac_f32_32x32x32_bf16 v[224:239], v[136:139], v[24:31], v3
  s_add_u32 s54, s54, 8192
  s_and_b32 s54, s54, 0x1ffff
  v_exp_f32 v36, v36
  v_exp_f32 v37, v37
  v_exp_f32 v38, v38
  v_exp_f32 v39, v39
  v_exp_f32 v40, v40
  v_exp_f32 v41, v41
  v_exp_f32 v42, v42
  v_smfmac_f32_32x32x32_bf16 v[224:239], v[140:143], v[32:39], v3
  v_exp_f32 v43, v43
  v_exp_f32 v44, v44
  v_exp_f32 v45, v45
  v_exp_f32 v46, v46
  v_exp_f32 v47, v47
  v_mfma_f32_32x32x16_bf16 v[24:39], v[128:131], a[240:243], v[56:71]
  buffer_load_dwordx4 v1, s[4:7], s55 offen offset:2048 lds
  v_exp_f32 v48, v48
  v_exp_f32 v49, v49
  v_exp_f32 v50, v50
  v_exp_f32 v51, v51
  v_smfmac_f32_32x32x32_bf16 v[240:255], v[136:139], v[40:47], v3
  buffer_load_dwordx4 a[60:63], v1, s[4:7], s56 offen offset:3072
  s_add_u32 s56, s56, 4096
  v_exp_f32 v52, v52
  v_exp_f32 v53, v53
  v_exp_f32 v54, v54
  v_exp_f32 v55, v55
  v_exp_f32 v24, v24
  v_exp_f32 v25, v25
  v_exp_f32 v26, v26
  v_smfmac_f32_32x32x32_bf16 v[240:255], v[140:143], v[48:55], v3
  v_exp_f32 v27, v27
  v_exp_f32 v28, v28
  v_exp_f32 v29, v29
  v_exp_f32 v30, v30
  v_exp_f32 v31, v31
  v_mfma_f32_32x32x16_bf16 v[40:55], v[128:131], a[244:247], v[72:87]
  v_exp_f32 v32, v32
  v_exp_f32 v33, v33
  v_exp_f32 v34, v34
  v_exp_f32 v35, v35
  v_smfmac_f32_32x32x32_bf16 v[192:207], v[136:139], v[24:31], v3
  buffer_load_dwordx4 a[176:179], v1, s[4:7], s57 offen offset:3072
  s_add_u32 s57, s57, 4096
  v_exp_f32 v36, v36
  v_exp_f32 v37, v37
  v_exp_f32 v38, v38
  v_exp_f32 v39, v39
  v_exp_f32 v40, v40
  v_exp_f32 v41, v41
  v_exp_f32 v42, v42
  v_smfmac_f32_32x32x32_bf16 v[192:207], v[140:143], v[32:39], v3
  s_waitcnt vmcnt(18)
  v_exp_f32 v43, v43
  v_exp_f32 v44, v44
  v_exp_f32 v45, v45
  v_exp_f32 v46, v46
  v_exp_f32 v47, v47
  v_mfma_f32_32x32x16_bf16 v[24:39], v[132:135], a[248:251], v[88:103]
  v_exp_f32 v48, v48
  v_exp_f32 v49, v49
  v_exp_f32 v50, v50
  v_exp_f32 v51, v51
  v_smfmac_f32_32x32x32_bf16 v[208:223], v[136:139], v[40:47], v3
  buffer_load_dwordx4 v1, s[4:7], s55 offen offset:3072 lds
  s_add_u32 m0, m0, 4096
  s_add_u32 s55, s55, 4096
  v_exp_f32 v52, v52
  v_exp_f32 v53, v53
  v_exp_f32 v54, v54
  v_exp_f32 v55, v55
  v_exp_f32 v24, v24
  v_exp_f32 v25, v25
  v_exp_f32 v26, v26
  v_smfmac_f32_32x32x32_bf16 v[208:223], v[140:143], v[48:55], v3
  s_mov_b64 exec, s[28:29]
  buffer_load_dwordx4 v[136:139], v2, s[8:11], s54 offen offset:1024
  buffer_load_dwordx4 v[140:143], v2, s[8:11], s54 offen offset:1536
  s_mov_b64 exec, -1
  v_exp_f32 v27, v27
  v_exp_f32 v28, v28
  v_exp_f32 v29, v29
  v_exp_f32 v30, v30
  v_exp_f32 v31, v31
  v_mfma_f32_32x32x16_bf16 v[40:55], v[132:135], a[252:255], v[104:119]
  buffer_load_dwordx4 v[128:131], v1, s[8:11], s54 offen offset:0
  v_exp_f32 v32, v32
  v_exp_f32 v33, v33
  v_exp_f32 v34, v34
  v_exp_f32 v35, v35
  v_smfmac_f32_32x32x32_bf16 v[224:239], v[144:147], v[24:31], v3
  v_exp_f32 v36, v36
  v_exp_f32 v37, v37
  v_exp_f32 v38, v38
  v_exp_f32 v39, v39
  v_exp_f32 v40, v40
  v_exp_f32 v41, v41
  v_exp_f32 v42, v42
  v_smfmac_f32_32x32x32_bf16 v[224:239], v[148:151], v[32:39], v3
  buffer_load_dwordx4 a[64:67], v1, s[4:7], s56 offen offset:0
  v_exp_f32 v43, v43
  v_exp_f32 v44, v44
  v_exp_f32 v45, v45
  v_exp_f32 v46, v46
  v_exp_f32 v47, v47
  v_mfma_f32_32x32x16_bf16 v[24:39], v[132:135], a[240:243], v[56:71]
  buffer_load_dwordx4 v1, s[4:7], s55 offen offset:0 lds
  v_exp_f32 v48, v48
  v_exp_f32 v49, v49
  v_exp_f32 v50, v50
  v_exp_f32 v51, v51
  v_smfmac_f32_32x32x32_bf16 v[240:255], v[144:147], v[40:47], v3
  buffer_load_dwordx4 a[180:183], v1, s[4:7], s57 offen offset:0
  v_exp_f32 v52, v52
  v_exp_f32 v53, v53
  v_exp_f32 v54, v54
  v_exp_f32 v55, v55
  v_exp_f32 v24, v24
  v_exp_f32 v25, v25
  v_exp_f32 v26, v26
  v_smfmac_f32_32x32x32_bf16 v[240:255], v[148:151], v[48:55], v3
  v_exp_f32 v27, v27
  v_exp_f32 v28, v28
  v_exp_f32 v29, v29
  v_exp_f32 v30, v30
  v_exp_f32 v31, v31
  v_mfma_f32_32x32x16_bf16 v[40:55], v[132:135], a[244:247], v[72:87]
  v_exp_f32 v32, v32
  v_exp_f32 v33, v33
  v_exp_f32 v34, v34
  v_exp_f32 v35, v35
  v_smfmac_f32_32x32x32_bf16 v[192:207], v[144:147], v[24:31], v3
  buffer_load_dwordx4 a[68:71], v1, s[4:7], s56 offen offset:1024
  v_exp_f32 v36, v36
  v_exp_f32 v37, v37
  v_exp_f32 v38, v38
  v_exp_f32 v39, v39
  v_exp_f32 v40, v40
  v_exp_f32 v41, v41
  v_exp_f32 v42, v42
  v_smfmac_f32_32x32x32_bf16 v[192:207], v[148:151], v[32:39], v3
  s_waitcnt vmcnt(18)
  v_exp_f32 v43, v43
  v_exp_f32 v44, v44
  v_exp_f32 v45, v45
  v_exp_f32 v46, v46
  v_exp_f32 v47, v47
  v_mfma_f32_32x32x16_bf16 v[24:39], v[120:123], a[248:251], v[88:103]
  v_exp_f32 v48, v48
  v_exp_f32 v49, v49
  v_exp_f32 v50, v50
  v_exp_f32 v51, v51
  v_smfmac_f32_32x32x32_bf16 v[208:223], v[144:147], v[40:47], v3
  buffer_load_dwordx4 v1, s[4:7], s55 offen offset:1024 lds
  v_exp_f32 v52, v52
  v_exp_f32 v53, v53
  v_exp_f32 v54, v54
  v_exp_f32 v55, v55
  v_exp_f32 v24, v24
  v_exp_f32 v25, v25
  v_exp_f32 v26, v26
  v_smfmac_f32_32x32x32_bf16 v[208:223], v[148:151], v[48:55], v3
  s_mov_b64 exec, s[28:29]
  buffer_load_dwordx4 v[144:147], v2, s[8:11], s54 offen offset:3072
  buffer_load_dwordx4 v[148:151], v2, s[8:11], s54 offen offset:3584
  s_mov_b64 exec, -1
  v_exp_f32 v27, v27
  v_exp_f32 v28, v28
  v_exp_f32 v29, v29
  v_exp_f32 v30, v30
  v_exp_f32 v31, v31
  v_mfma_f32_32x32x16_bf16 v[40:55], v[120:123], a[252:255], v[104:119]
  buffer_load_dwordx4 v[132:135], v1, s[8:11], s54 offen offset:2048
  v_exp_f32 v32, v32
  v_exp_f32 v33, v33
  v_exp_f32 v34, v34
  v_exp_f32 v35, v35
  v_smfmac_f32_32x32x32_bf16 v[224:239], v[176:179], v[24:31], v3
  s_add_u32 s54, s54, 8192
  s_and_b32 s54, s54, 0x1ffff
  v_exp_f32 v36, v36
  v_exp_f32 v37, v37
  v_exp_f32 v38, v38
  v_exp_f32 v39, v39
  v_exp_f32 v40, v40
  v_exp_f32 v41, v41
  v_exp_f32 v42, v42
  v_smfmac_f32_32x32x32_bf16 v[224:239], v[180:183], v[32:39], v3
  v_exp_f32 v43, v43
  v_exp_f32 v44, v44
  v_exp_f32 v45, v45
  v_exp_f32 v46, v46
  v_exp_f32 v47, v47
  v_mfma_f32_32x32x16_bf16 v[24:39], v[120:123], a[240:243], v[56:71]
  buffer_load_dwordx4 a[184:187], v1, s[4:7], s57 offen offset:1024
  v_exp_f32 v48, v48
  v_exp_f32 v49, v49
  v_exp_f32 v50, v50
  v_exp_f32 v51, v51
  v_smfmac_f32_32x32x32_bf16 v[240:255], v[176:179], v[40:47], v3
  buffer_load_dwordx4 a[72:75], v1, s[4:7], s56 offen offset:2048
  v_exp_f32 v52, v52
  v_exp_f32 v53, v53
  v_exp_f32 v54, v54
  v_exp_f32 v55, v55
  v_exp_f32 v24, v24
  v_exp_f32 v25, v25
  v_exp_f32 v26, v26
  v_smfmac_f32_32x32x32_bf16 v[240:255], v[180:183], v[48:55], v3
  v_exp_f32 v27, v27
  v_exp_f32 v28, v28
  v_exp_f32 v29, v29
  v_exp_f32 v30, v30
  v_exp_f32 v31, v31
  v_mfma_f32_32x32x16_bf16 v[40:55], v[120:123], a[244:247], v[72:87]
  v_exp_f32 v32, v32
  v_exp_f32 v33, v33
  v_exp_f32 v34, v34
  v_exp_f32 v35, v35
  v_smfmac_f32_32x32x32_bf16 v[192:207], v[176:179], v[24:31], v3
  buffer_load_dwordx4 v1, s[4:7], s55 offen offset:2048 lds
  v_exp_f32 v36, v36
  v_exp_f32 v37, v37
  v_exp_f32 v38, v38
  v_exp_f32 v39, v39
  v_exp_f32 v40, v40
  v_exp_f32 v41, v41
  v_exp_f32 v42, v42
  v_smfmac_f32_32x32x32_bf16 v[192:207], v[180:183], v[32:39], v3
  s_waitcnt vmcnt(18)
  v_exp_f32 v43, v43
  v_exp_f32 v44, v44
  v_exp_f32 v45, v45
  v_exp_f32 v46, v46
  v_exp_f32 v47, v47
  v_mfma_f32_32x32x16_bf16 v[24:39], v[124:127], a[248:251], v[88:103]
  v_exp_f32 v48, v48
  v_exp_f32 v49, v49
  v_exp_f32 v50, v50
  v_exp_f32 v51, v51
  v_smfmac_f32_32x32x32_bf16 v[208:223], v[176:179], v[40:47], v3
  buffer_load_dwordx4 a[76:79], v1, s[4:7], s56 offen offset:3072
  s_add_u32 s56, s56, 4096
  v_exp_f32 v52, v52
  v_exp_f32 v53, v53
  v_exp_f32 v54, v54
  v_exp_f32 v55, v55
  v_exp_f32 v24, v24
  v_exp_f32 v25, v25
  v_exp_f32 v26, v26
  v_smfmac_f32_32x32x32_bf16 v[208:223], v[180:183], v[48:55], v3
  s_mov_b64 exec, s[28:29]
  buffer_load_dwordx4 v[176:179], v2, s[8:11], s54 offen offset:1024
  buffer_load_dwordx4 v[180:183], v2, s[8:11], s54 offen offset:1536
  s_mov_b64 exec, -1
  v_exp_f32 v27, v27
  v_exp_f32 v28, v28
  v_exp_f32 v29, v29
  v_exp_f32 v30, v30
  v_exp_f32 v31, v31
  v_mfma_f32_32x32x16_bf16 v[40:55], v[124:127], a[252:255], v[104:119]
  buffer_load_dwordx4 v[120:123], v1, s[8:11], s54 offen offset:0
  v_exp_f32 v32, v32
  v_exp_f32 v33, v33
  v_exp_f32 v34, v34
  v_exp_f32 v35, v35
  v_smfmac_f32_32x32x32_bf16 v[224:239], v[184:187], v[24:31], v3
  v_exp_f32 v36, v36
  v_exp_f32 v37, v37
  v_exp_f32 v38, v38
  v_exp_f32 v39, v39
  v_exp_f32 v40, v40
  v_exp_f32 v41, v41
  v_exp_f32 v42, v42
  v_smfmac_f32_32x32x32_bf16 v[224:239], v[188:191], v[32:39], v3
  v_exp_f32 v43, v43
  v_exp_f32 v44, v44
  v_exp_f32 v45, v45
  v_exp_f32 v46, v46
  v_exp_f32 v47, v47
  v_mfma_f32_32x32x16_bf16 v[24:39], v[124:127], a[240:243], v[56:71]
  buffer_load_dwordx4 a[188:191], v1, s[4:7], s57 offen offset:2048
  v_exp_f32 v48, v48
  v_exp_f32 v49, v49
  v_exp_f32 v50, v50
  v_exp_f32 v51, v51
  v_smfmac_f32_32x32x32_bf16 v[240:255], v[184:187], v[40:47], v3
  buffer_load_dwordx4 v1, s[4:7], s55 offen offset:3072 lds
  s_add_u32 m0, m0, 4096
  s_add_u32 s55, s55, 4096
  v_exp_f32 v52, v52
  v_exp_f32 v53, v53
  v_exp_f32 v54, v54
  v_exp_f32 v55, v55
  v_exp_f32 v24, v24
  v_exp_f32 v25, v25
  v_exp_f32 v26, v26
  v_smfmac_f32_32x32x32_bf16 v[240:255], v[188:191], v[48:55], v3
  v_exp_f32 v27, v27
  v_exp_f32 v28, v28
  v_exp_f32 v29, v29
  v_exp_f32 v30, v30
  v_exp_f32 v31, v31
  v_mfma_f32_32x32x16_bf16 v[40:55], v[124:127], a[244:247], v[72:87]
  v_exp_f32 v32, v32
  v_exp_f32 v33, v33
  v_exp_f32 v34, v34
  v_exp_f32 v35, v35
  v_smfmac_f32_32x32x32_bf16 v[192:207], v[184:187], v[24:31], v3
  buffer_load_dwordx4 a[80:83], v1, s[4:7], s56 offen offset:0
  v_exp_f32 v36, v36
  v_exp_f32 v37, v37
  v_exp_f32 v38, v38
  v_exp_f32 v39, v39
  v_exp_f32 v40, v40
  v_exp_f32 v41, v41
  v_exp_f32 v42, v42
  v_smfmac_f32_32x32x32_bf16 v[192:207], v[188:191], v[32:39], v3
  s_waitcnt vmcnt(18)
  v_exp_f32 v43, v43
  v_exp_f32 v44, v44
  v_exp_f32 v45, v45
  v_exp_f32 v46, v46
  v_exp_f32 v47, v47
  v_mfma_f32_32x32x16_bf16 v[24:39], v[128:131], a[248:251], v[88:103]
  v_exp_f32 v48, v48
  v_exp_f32 v49, v49
  v_exp_f32 v50, v50
  v_exp_f32 v51, v51
  v_smfmac_f32_32x32x32_bf16 v[208:223], v[184:187], v[40:47], v3
  buffer_load_dwordx4 a[192:195], v1, s[4:7], s57 offen offset:3072
  s_add_u32 s57, s57, 4096
  v_exp_f32 v52, v52
  v_exp_f32 v53, v53
  v_exp_f32 v54, v54
  v_exp_f32 v55, v55
  v_exp_f32 v24, v24
  v_exp_f32 v25, v25
  v_exp_f32 v26, v26
  v_smfmac_f32_32x32x32_bf16 v[208:223], v[188:191], v[48:55], v3
  s_mov_b64 exec, s[28:29]
  buffer_load_dwordx4 v[184:187], v2, s[8:11], s54 offen offset:3072
  buffer_load_dwordx4 v[188:191], v2, s[8:11], s54 offen offset:3584
  s_mov_b64 exec, -1
  v_exp_f32 v27, v27
  v_exp_f32 v28, v28
  v_exp_f32 v29, v29
  v_exp_f32 v30, v30
  v_exp_f32 v31, v31
  v_mfma_f32_32x32x16_bf16 v[40:55], v[128:131], a[252:255], v[104:119]
  buffer_load_dwordx4 v[124:127], v1, s[8:11], s54 offen offset:2048
  v_exp_f32 v32, v32
  v_exp_f32 v33, v33
  v_exp_f32 v34, v34
  v_exp_f32 v35, v35
  v_smfmac_f32_32x32x32_bf16 v[224:239], v[136:139], v[24:31], v3
  s_add_u32 s54, s54, 8192
  s_and_b32 s54, s54, 0x1ffff
  v_exp_f32 v36, v36
  v_exp_f32 v37, v37
  v_exp_f32 v38, v38
  v_exp_f32 v39, v39
  v_exp_f32 v40, v40
  v_exp_f32 v41, v41
  v_exp_f32 v42, v42
  v_smfmac_f32_32x32x32_bf16 v[224:239], v[140:143], v[32:39], v3
  v_exp_f32 v43, v43
  v_exp_f32 v44, v44
  v_exp_f32 v45, v45
  v_exp_f32 v46, v46
  v_exp_f32 v47, v47
  v_mfma_f32_32x32x16_bf16 v[24:39], v[128:131], a[240:243], v[56:71]
  buffer_load_dwordx4 v1, s[4:7], s55 offen offset:0 lds
  v_exp_f32 v48, v48
  v_exp_f32 v49, v49
  v_exp_f32 v50, v50
  v_exp_f32 v51, v51
  v_smfmac_f32_32x32x32_bf16 v[240:255], v[136:139], v[40:47], v3
  buffer_load_dwordx4 a[84:87], v1, s[4:7], s56 offen offset:1024
  v_exp_f32 v52, v52
  v_exp_f32 v53, v53
  v_exp_f32 v54, v54
  v_exp_f32 v55, v55
  v_exp_f32 v24, v24
  v_exp_f32 v25, v25
  v_exp_f32 v26, v26
  v_smfmac_f32_32x32x32_bf16 v[240:255], v[140:143], v[48:55], v3
  v_exp_f32 v27, v27
  v_exp_f32 v28, v28
  v_exp_f32 v29, v29
  v_exp_f32 v30, v30
  v_exp_f32 v31, v31
  v_mfma_f32_32x32x16_bf16 v[40:55], v[128:131], a[244:247], v[72:87]
  buffer_load_dwordx4 a[196:199], v1, s[4:7], s57 offen offset:0
  s_add_u32 s57, s57, 25600
  v_exp_f32 v32, v32
  v_exp_f32 v33, v33
  v_exp_f32 v34, v34
  v_exp_f32 v35, v35
  v_smfmac_f32_32x32x32_bf16 v[192:207], v[136:139], v[24:31], v3
  buffer_load_dwordx4 v1, s[4:7], s55 offen offset:1024 lds
  v_exp_f32 v36, v36
  v_exp_f32 v37, v37
  v_exp_f32 v38, v38
  v_exp_f32 v39, v39
  v_exp_f32 v40, v40
  v_exp_f32 v41, v41
  v_exp_f32 v42, v42
  v_smfmac_f32_32x32x32_bf16 v[192:207], v[140:143], v[32:39], v3
  s_waitcnt vmcnt(18)
  v_exp_f32 v43, v43
  v_exp_f32 v44, v44
  v_exp_f32 v45, v45
  v_exp_f32 v46, v46
  v_exp_f32 v47, v47
  v_mfma_f32_32x32x16_bf16 v[24:39], v[132:135], a[248:251], v[88:103]
  v_exp_f32 v48, v48
  v_exp_f32 v49, v49
  v_exp_f32 v50, v50
  v_exp_f32 v51, v51
  v_smfmac_f32_32x32x32_bf16 v[208:223], v[136:139], v[40:47], v3
  buffer_load_dwordx4 a[88:91], v1, s[4:7], s56 offen offset:2048
  v_exp_f32 v52, v52
  v_exp_f32 v53, v53
  v_exp_f32 v54, v54
  v_exp_f32 v55, v55
  v_exp_f32 v24, v24
  v_exp_f32 v25, v25
  v_exp_f32 v26, v26
  v_smfmac_f32_32x32x32_bf16 v[208:223], v[140:143], v[48:55], v3
  s_mov_b64 exec, s[28:29]
  buffer_load_dwordx4 v[136:139], v2, s[8:11], s54 offen offset:1024
  buffer_load_dwordx4 v[140:143], v2, s[8:11], s54 offen offset:1536
  s_mov_b64 exec, -1
  v_exp_f32 v27, v27
  v_exp_f32 v28, v28
  v_exp_f32 v29, v29
  v_exp_f32 v30, v30
  v_exp_f32 v31, v31
  v_mfma_f32_32x32x16_bf16 v[40:55], v[132:135], a[252:255], v[104:119]
  buffer_load_dwordx4 v[128:131], v1, s[8:11], s54 offen offset:0
  v_exp_f32 v32, v32
  v_exp_f32 v33, v33
  v_exp_f32 v34, v34
  v_exp_f32 v35, v35
  v_smfmac_f32_32x32x32_bf16 v[224:239], v[144:147], v[24:31], v3
  v_exp_f32 v36, v36
  v_exp_f32 v37, v37
  v_exp_f32 v38, v38
  v_exp_f32 v39, v39
  v_exp_f32 v40, v40
  v_exp_f32 v41, v41
  v_exp_f32 v42, v42
  v_smfmac_f32_32x32x32_bf16 v[224:239], v[148:151], v[32:39], v3
  v_exp_f32 v43, v43
  v_exp_f32 v44, v44
  v_exp_f32 v45, v45
  v_exp_f32 v46, v46
  v_exp_f32 v47, v47
  v_mfma_f32_32x32x16_bf16 v[24:39], v[132:135], a[240:243], v[56:71]
  buffer_load_dwordx4 v1, s[4:7], s55 offen offset:2048 lds
  v_exp_f32 v48, v48
  v_exp_f32 v49, v49
  v_exp_f32 v50, v50
  v_exp_f32 v51, v51
  v_smfmac_f32_32x32x32_bf16 v[240:255], v[144:147], v[40:47], v3
  buffer_load_dwordx4 a[200:203], v1, s[4:7], s57 offen offset:0
  v_exp_f32 v52, v52
  v_exp_f32 v53, v53
  v_exp_f32 v54, v54
  v_exp_f32 v55, v55
  v_exp_f32 v24, v24
  v_exp_f32 v25, v25
  v_exp_f32 v26, v26
  v_smfmac_f32_32x32x32_bf16 v[240:255], v[148:151], v[48:55], v3
  v_exp_f32 v27, v27
  v_exp_f32 v28, v28
  v_exp_f32 v29, v29
  v_exp_f32 v30, v30
  v_exp_f32 v31, v31
  v_mfma_f32_32x32x16_bf16 v[40:55], v[132:135], a[244:247], v[72:87]
  v_exp_f32 v32, v32
  v_exp_f32 v33, v33
  v_exp_f32 v34, v34
  v_exp_f32 v35, v35
  v_smfmac_f32_32x32x32_bf16 v[192:207], v[144:147], v[24:31], v3
  buffer_load_dwordx4 a[92:95], v1, s[4:7], s56 offen offset:3072
  s_add_u32 s56, s56, 4096
  v_exp_f32 v36, v36
  v_exp_f32 v37, v37
  v_exp_f32 v38, v38
  v_exp_f32 v39, v39
  v_exp_f32 v40, v40
  v_exp_f32 v41, v41
  v_exp_f32 v42, v42
  v_smfmac_f32_32x32x32_bf16 v[192:207], v[148:151], v[32:39], v3
  s_waitcnt vmcnt(18)
  v_exp_f32 v43, v43
  v_exp_f32 v44, v44
  v_exp_f32 v45, v45
  v_exp_f32 v46, v46
  v_exp_f32 v47, v47
  v_mfma_f32_32x32x16_bf16 v[24:39], v[120:123], a[248:251], v[88:103]
  v_exp_f32 v48, v48
  v_exp_f32 v49, v49
  v_exp_f32 v50, v50
  v_exp_f32 v51, v51
  v_smfmac_f32_32x32x32_bf16 v[208:223], v[144:147], v[40:47], v3
  buffer_load_dwordx4 v1, s[4:7], s55 offen offset:3072 lds
  s_add_u32 m0, m0, 4096
  s_add_u32 s55, s55, 4096
  v_exp_f32 v52, v52
  v_exp_f32 v53, v53
  v_exp_f32 v54, v54
  v_exp_f32 v55, v55
  v_exp_f32 v24, v24
  v_exp_f32 v25, v25
  v_exp_f32 v26, v26
  v_smfmac_f32_32x32x32_bf16 v[208:223], v[148:151], v[48:55], v3
  s_mov_b64 exec, s[28:29]
  buffer_load_dwordx4 v[144:147], v2, s[8:11], s54 offen offset:3072
  buffer_load_dwordx4 v[148:151], v2, s[8:11], s54 offen offset:3584
  s_mov_b64 exec, -1
  v_exp_f32 v27, v27
  v_exp_f32 v28, v28
  v_exp_f32 v29, v29
  v_exp_f32 v30, v30
  v_exp_f32 v31, v31
  v_mfma_f32_32x32x16_bf16 v[40:55], v[120:123], a[252:255], v[104:119]
  buffer_load_dwordx4 v[132:135], v1, s[8:11], s54 offen offset:2048
  v_exp_f32 v32, v32
  v_exp_f32 v33, v33
  v_exp_f32 v34, v34
  v_exp_f32 v35, v35
  v_smfmac_f32_32x32x32_bf16 v[224:239], v[176:179], v[24:31], v3
  s_add_u32 s54, s54, 8192
  s_and_b32 s54, s54, 0x1ffff
  v_exp_f32 v36, v36
  v_exp_f32 v37, v37
  v_exp_f32 v38, v38
  v_exp_f32 v39, v39
  v_exp_f32 v40, v40
  v_exp_f32 v41, v41
  v_exp_f32 v42, v42
  v_smfmac_f32_32x32x32_bf16 v[224:239], v[180:183], v[32:39], v3
  v_exp_f32 v43, v43
  v_exp_f32 v44, v44
  v_exp_f32 v45, v45
  v_exp_f32 v46, v46
  v_exp_f32 v47, v47
  v_mfma_f32_32x32x16_bf16 v[24:39], v[120:123], a[240:243], v[56:71]
  buffer_load_dwordx4 a[96:99], v1, s[4:7], s56 offen offset:0
  v_exp_f32 v48, v48
  v_exp_f32 v49, v49
  v_exp_f32 v50, v50
  v_exp_f32 v51, v51
  v_smfmac_f32_32x32x32_bf16 v[240:255], v[176:179], v[40:47], v3
  buffer_load_dwordx4 a[204:207], v1, s[4:7], s57 offen offset:1024
  v_exp_f32 v52, v52
  v_exp_f32 v53, v53
  v_exp_f32 v54, v54
  v_exp_f32 v55, v55
  v_exp_f32 v24, v24
  v_exp_f32 v25, v25
  v_exp_f32 v26, v26
  v_smfmac_f32_32x32x32_bf16 v[240:255], v[180:183], v[48:55], v3
  v_exp_f32 v27, v27
  v_exp_f32 v28, v28
  v_exp_f32 v29, v29
  v_exp_f32 v30, v30
  v_exp_f32 v31, v31
  v_mfma_f32_32x32x16_bf16 v[40:55], v[120:123], a[244:247], v[72:87]
  v_exp_f32 v32, v32
  v_exp_f32 v33, v33
  v_exp_f32 v34, v34
  v_exp_f32 v35, v35
  v_smfmac_f32_32x32x32_bf16 v[192:207], v[176:179], v[24:31], v3
  buffer_load_dwordx4 v1, s[4:7], s55 offen offset:0 lds
  v_exp_f32 v36, v36
  v_exp_f32 v37, v37
  v_exp_f32 v38, v38
  v_exp_f32 v39, v39
  v_exp_f32 v40, v40
  v_exp_f32 v41, v41
  v_exp_f32 v42, v42
  v_smfmac_f32_32x32x32_bf16 v[192:207], v[180:183], v[32:39], v3
  s_waitcnt vmcnt(18)
  v_exp_f32 v43, v43
  v_exp_f32 v44, v44
  v_exp_f32 v45, v45
  v_exp_f32 v46, v46
  v_exp_f32 v47, v47
  v_mfma_f32_32x32x16_bf16 v[24:39], v[124:127], a[248:251], v[88:103]
  v_exp_f32 v48, v48
  v_exp_f32 v49, v49
  v_exp_f32 v50, v50
  v_exp_f32 v51, v51
  v_smfmac_f32_32x32x32_bf16 v[208:223], v[176:179], v[40:47], v3
  buffer_load_dwordx4 a[100:103], v1, s[4:7], s56 offen offset:1024
  v_exp_f32 v52, v52
  v_exp_f32 v53, v53
  v_exp_f32 v54, v54
  v_exp_f32 v55, v55
  v_exp_f32 v24, v24
  v_exp_f32 v25, v25
  v_exp_f32 v26, v26
  v_smfmac_f32_32x32x32_bf16 v[208:223], v[180:183], v[48:55], v3
  s_mov_b64 exec, s[28:29]
  buffer_load_dwordx4 v[176:179], v2, s[8:11], s54 offen offset:1024
  buffer_load_dwordx4 v[180:183], v2, s[8:11], s54 offen offset:1536
  s_mov_b64 exec, -1
  v_exp_f32 v27, v27
  v_exp_f32 v28, v28
  v_exp_f32 v29, v29
  v_exp_f32 v30, v30
  v_exp_f32 v31, v31
  v_mfma_f32_32x32x16_bf16 v[40:55], v[124:127], a[252:255], v[104:119]
  buffer_load_dwordx4 v[120:123], v1, s[8:11], s54 offen offset:0
  v_exp_f32 v32, v32
  v_exp_f32 v33, v33
  v_exp_f32 v34, v34
  v_exp_f32 v35, v35
  v_smfmac_f32_32x32x32_bf16 v[224:239], v[184:187], v[24:31], v3
  v_exp_f32 v36, v36
  v_exp_f32 v37, v37
  v_exp_f32 v38, v38
  v_exp_f32 v39, v39
  v_exp_f32 v40, v40
  v_exp_f32 v41, v41
  v_exp_f32 v42, v42
  v_smfmac_f32_32x32x32_bf16 v[224:239], v[188:191], v[32:39], v3
  v_exp_f32 v43, v43
  v_exp_f32 v44, v44
  v_exp_f32 v45, v45
  v_exp_f32 v46, v46
  v_exp_f32 v47, v47
  v_mfma_f32_32x32x16_bf16 v[24:39], v[124:127], a[240:243], v[56:71]
  buffer_load_dwordx4 a[208:211], v1, s[4:7], s57 offen offset:2048
  v_exp_f32 v48, v48
  v_exp_f32 v49, v49
  v_exp_f32 v50, v50
  v_exp_f32 v51, v51
  v_smfmac_f32_32x32x32_bf16 v[240:255], v[184:187], v[40:47], v3
  buffer_load_dwordx4 v1, s[4:7], s55 offen offset:1024 lds
  v_exp_f32 v52, v52
  v_exp_f32 v53, v53
  v_exp_f32 v54, v54
  v_exp_f32 v55, v55
  v_exp_f32 v24, v24
  v_exp_f32 v25, v25
  v_exp_f32 v26, v26
  v_smfmac_f32_32x32x32_bf16 v[240:255], v[188:191], v[48:55], v3
  v_exp_f32 v27, v27
  v_exp_f32 v28, v28
  v_exp_f32 v29, v29
  v_exp_f32 v30, v30
  v_exp_f32 v31, v31
  v_mfma_f32_32x32x16_bf16 v[40:55], v[124:127], a[244:247], v[72:87]
  v_exp_f32 v32, v32
  v_exp_f32 v33, v33
  v_exp_f32 v34, v34
  v_exp_f32 v35, v35
  v_smfmac_f32_32x32x32_bf16 v[192:207], v[184:187], v[24:31], v3
  buffer_load_dwordx4 a[104:107], v1, s[4:7], s56 offen offset:2048
  v_exp_f32 v36, v36
  v_exp_f32 v37, v37
  v_exp_f32 v38, v38
  v_exp_f32 v39, v39
  v_exp_f32 v40, v40
  v_exp_f32 v41, v41
  v_exp_f32 v42, v42
  v_smfmac_f32_32x32x32_bf16 v[192:207], v[188:191], v[32:39], v3
  s_waitcnt vmcnt(17)
  v_exp_f32 v43, v43
  v_exp_f32 v44, v44
  v_exp_f32 v45, v45
  v_exp_f32 v46, v46
  v_exp_f32 v47, v47
  v_mfma_f32_32x32x16_bf16 v[24:39], v[128:131], a[248:251], v[88:103]
  buffer_load_dwordx4 a[212:215], v1, s[4:7], s57 offen offset:3072
  s_add_u32 s57, s57, 4096
  v_exp_f32 v48, v48
  v_exp_f32 v49, v49
  v_exp_f32 v50, v50
  v_exp_f32 v51, v51
  v_smfmac_f32_32x32x32_bf16 v[208:223], v[184:187], v[40:47], v3
  s_lshl_b32 s44, s18, 2
  s_add_u32 s44, s44, s16
  s_mul_i32 s44, s44, 512
  s_add_u32 s44, s44, L_p3_0-interleave_layers__mha_block__glu_gated_swiglu__prompt_kernel
  v_min_u32 v174, 3, v0
  v_lshl_add_u32 v174, v174, 7, s44
  v_min_u32 v174, L_last-interleave_layers__mha_block__glu_gated_swiglu__prompt_kernel, v174
  global_load_dword v174, v174, s[74:75]
  v_exp_f32 v52, v52
  v_exp_f32 v53, v53
  v_exp_f32 v54, v54
  v_exp_f32 v55, v55
  v_exp_f32 v24, v24
  v_exp_f32 v25, v25
  v_exp_f32 v26, v26
  v_smfmac_f32_32x32x32_bf16 v[208:223], v[188:191], v[48:55], v3
  s_mov_b64 exec, s[28:29]
  buffer_load_dwordx4 v[184:187], v2, s[8:11], s54 offen offset:3072
  buffer_load_dwordx4 v[188:191], v2, s[8:11], s54 offen offset:3584
  s_mov_b64 exec, -1
  v_exp_f32 v27, v27
  v_exp_f32 v28, v28
  v_exp_f32 v29, v29
  v_exp_f32 v30, v30
  v_exp_f32 v31, v31
  v_mfma_f32_32x32x16_bf16 v[40:55], v[128:131], a[252:255], v[104:119]
  buffer_load_dwordx4 v[124:127], v1, s[8:11], s54 offen offset:2048
  v_exp_f32 v32, v32
  v_exp_f32 v33, v33
  v_exp_f32 v34, v34
  v_exp_f32 v35, v35
  v_smfmac_f32_32x32x32_bf16 v[224:239], v[136:139], v[24:31], v3
  s_add_u32 s54, s54, 8192
  s_and_b32 s54, s54, 0x1ffff
  v_exp_f32 v36, v36
  v_exp_f32 v37, v37
  v_exp_f32 v38, v38
  v_exp_f32 v39, v39
  v_exp_f32 v40, v40
  v_exp_f32 v41, v41
  v_exp_f32 v42, v42
  v_smfmac_f32_32x32x32_bf16 v[224:239], v[140:143], v[32:39], v3
  v_exp_f32 v43, v43
  v_exp_f32 v44, v44
  v_exp_f32 v45, v45
  v_exp_f32 v46, v46
  v_exp_f32 v47, v47
  v_mfma_f32_32x32x16_bf16 v[24:39], v[128:131], a[240:243], v[56:71]
  buffer_load_dwordx4 v1, s[4:7], s55 offen offset:2048 lds
  v_exp_f32 v48, v48
  v_exp_f32 v49, v49
  v_exp_f32 v50, v50
  v_exp_f32 v51, v51
  v_smfmac_f32_32x32x32_bf16 v[240:255], v[136:139], v[40:47], v3
  buffer_load_dwordx4 a[108:111], v1, s[4:7], s56 offen offset:3072
  s_add_u32 s56, s56, 4096
  v_exp_f32 v52, v52
  v_exp_f32 v53, v53
  v_exp_f32 v54, v54
  v_exp_f32 v55, v55
  v_exp_f32 v24, v24
  v_exp_f32 v25, v25
  v_exp_f32 v26, v26
  v_smfmac_f32_32x32x32_bf16 v[240:255], v[140:143], v[48:55], v3
  v_exp_f32 v27, v27
  v_exp_f32 v28, v28
  v_exp_f32 v29, v29
  v_exp_f32 v30, v30
  v_exp_f32 v31, v31
  v_mfma_f32_32x32x16_bf16 v[40:55], v[128:131], a[244:247], v[72:87]
  v_exp_f32 v32, v32
  v_exp_f32 v33, v33
  v_exp_f32 v34, v34
  v_exp_f32 v35, v35
  v_smfmac_f32_32x32x32_bf16 v[192:207], v[136:139], v[24:31], v3
  buffer_load_dwordx4 v1, s[4:7], s55 offen offset:3072 lds
  s_add_u32 m0, m0, 4096
  s_add_u32 s55, s55, 4096
  v_exp_f32 v36, v36
  v_exp_f32 v37, v37
  v_exp_f32 v38, v38
  v_exp_f32 v39, v39
  v_exp_f32 v40, v40
  v_exp_f32 v41, v41
  v_exp_f32 v42, v42
  v_smfmac_f32_32x32x32_bf16 v[192:207], v[140:143], v[32:39], v3
  s_waitcnt vmcnt(18)
  v_exp_f32 v43, v43
  v_exp_f32 v44, v44
  v_exp_f32 v45, v45
  v_exp_f32 v46, v46
  v_exp_f32 v47, v47
  v_mfma_f32_32x32x16_bf16 v[24:39], v[132:135], a[248:251], v[88:103]
  v_exp_f32 v48, v48
  v_exp_f32 v49, v49
  v_exp_f32 v50, v50
  v_exp_f32 v51, v51
  v_smfmac_f32_32x32x32_bf16 v[208:223], v[136:139], v[40:47], v3
  buffer_load_dwordx4 a[216:219], v1, s[4:7], s57 offen offset:0
  v_exp_f32 v52, v52
  v_exp_f32 v53, v53
  v_exp_f32 v54, v54
  v_exp_f32 v55, v55
  v_exp_f32 v24, v24
  v_exp_f32 v25, v25
  v_exp_f32 v26, v26
  v_smfmac_f32_32x32x32_bf16 v[208:223], v[140:143], v[48:55], v3
  s_mov_b64 exec, s[28:29]
  buffer_load_dwordx4 v[136:139], v2, s[8:11], s54 offen offset:1024
  buffer_load_dwordx4 v[140:143], v2, s[8:11], s54 offen offset:1536
  s_mov_b64 exec, -1
  v_exp_f32 v27, v27
  v_exp_f32 v28, v28
  v_exp_f32 v29, v29
  v_exp_f32 v30, v30
  v_exp_f32 v31, v31
  v_mfma_f32_32x32x16_bf16 v[40:55], v[132:135], a[252:255], v[104:119]
  buffer_load_dwordx4 v[128:131], v1, s[8:11], s54 offen offset:0
  v_exp_f32 v32, v32
  v_exp_f32 v33, v33
  v_exp_f32 v34, v34
  v_exp_f32 v35, v35
  v_smfmac_f32_32x32x32_bf16 v[224:239], v[144:147], v[24:31], v3
  v_exp_f32 v36, v36
  v_exp_f32 v37, v37
  v_exp_f32 v38, v38
  v_exp_f32 v39, v39
  v_exp_f32 v40, v40
  v_exp_f32 v41, v41
  v_exp_f32 v42, v42
  v_smfmac_f32_32x32x32_bf16 v[224:239], v[148:151], v[32:39], v3
  v_exp_f32 v43, v43
  v_exp_f32 v44, v44
  v_exp_f32 v45, v45
  v_exp_f32 v46, v46
  v_exp_f32 v47, v47
  v_mfma_f32_32x32x16_bf16 v[24:39], v[132:135], a[240:243], v[56:71]
  buffer_load_dwordx4 a[112:115], v1, s[4:7], s56 offen offset:0
  v_exp_f32 v48, v48
  v_exp_f32 v49, v49
  v_exp_f32 v50, v50
  v_exp_f32 v51, v51
  v_smfmac_f32_32x32x32_bf16 v[240:255], v[144:147], v[40:47], v3
  buffer_load_dwordx4 v1, s[4:7], s55 offen offset:0 lds
  v_exp_f32 v52, v52
  v_exp_f32 v53, v53
  v_exp_f32 v54, v54
  v_exp_f32 v55, v55
  v_exp_f32 v24, v24
  v_exp_f32 v25, v25
  v_exp_f32 v26, v26
  v_smfmac_f32_32x32x32_bf16 v[240:255], v[148:151], v[48:55], v3
  v_exp_f32 v27, v27
  v_exp_f32 v28, v28
  v_exp_f32 v29, v29
  v_exp_f32 v30, v30
  v_exp_f32 v31, v31
  v_mfma_f32_32x32x16_bf16 v[40:55], v[132:135], a[244:247], v[72:87]
  v_exp_f32 v32, v32
  v_exp_f32 v33, v33
  v_exp_f32 v34, v34
  v_exp_f32 v35, v35
  v_smfmac_f32_32x32x32_bf16 v[192:207], v[144:147], v[24:31], v3
  buffer_load_dwordx4 a[116:119], v1, s[4:7], s56 offen offset:1024
  v_exp_f32 v36, v36
  v_exp_f32 v37, v37
  v_exp_f32 v38, v38
  v_exp_f32 v39, v39
  v_exp_f32 v40, v40
  v_exp_f32 v41, v41
  v_exp_f32 v42, v42
  v_smfmac_f32_32x32x32_bf16 v[192:207], v[148:151], v[32:39], v3
  s_waitcnt vmcnt(18)
  v_exp_f32 v43, v43
  v_exp_f32 v44, v44
  v_exp_f32 v45, v45
  v_exp_f32 v46, v46
  v_exp_f32 v47, v47
  v_mfma_f32_32x32x16_bf16 v[24:39], v[120:123], a[248:251], v[88:103]
  v_exp_f32 v48, v48
  v_exp_f32 v49, v49
  v_exp_f32 v50, v50
  v_exp_f32 v51, v51
  v_smfmac_f32_32x32x32_bf16 v[208:223], v[144:147], v[40:47], v3
  buffer_load_dwordx4 a[220:223], v1, s[4:7], s57 offen offset:1024
  v_exp_f32 v52, v52
  v_exp_f32 v53, v53
  v_exp_f32 v54, v54
  v_exp_f32 v55, v55
  v_exp_f32 v24, v24
  v_exp_f32 v25, v25
  v_exp_f32 v26, v26
  v_smfmac_f32_32x32x32_bf16 v[208:223], v[148:151], v[48:55], v3
  s_mov_b64 exec, s[28:29]
  buffer_load_dwordx4 v[144:147], v2, s[8:11], s54 offen offset:3072
  buffer_load_dwordx4 v[148:151], v2, s[8:11], s54 offen offset:3584
  s_mov_b64 exec, -1
  v_exp_f32 v27, v27
  v_exp_f32 v28, v28
  v_exp_f32 v29, v29
  v_exp_f32 v30, v30
  v_exp_f32 v31, v31
  v_mfma_f32_32x32x16_bf16 v[40:55], v[120:123], a[252:255], v[104:119]
  buffer_load_dwordx4 v[132:135], v1, s[8:11], s54 offen offset:2048
  v_exp_f32 v32, v32
  v_exp_f32 v33, v33
  v_exp_f32 v34, v34
  v_exp_f32 v35, v35
  v_smfmac_f32_32x32x32_bf16 v[224:239], v[176:179], v[24:31], v3
  v_exp_f32 v36, v36
  v_exp_f32 v37, v37
  v_exp_f32 v38, v38
  v_exp_f32 v39, v39
  v_exp_f32 v40, v40
  v_exp_f32 v41, v41
  v_exp_f32 v42, v42
  v_smfmac_f32_32x32x32_bf16 v[224:239], v[180:183], v[32:39], v3
  v_exp_f32 v43, v43
  v_exp_f32 v44, v44
  v_exp_f32 v45, v45
  v_exp_f32 v46, v46
  v_exp_f32 v47, v47
  v_mfma_f32_32x32x16_bf16 v[24:39], v[120:123], a[240:243], v[56:71]
  buffer_load_dwordx4 v1, s[4:7], s55 offen offset:1024 lds
  v_exp_f32 v48, v48
  v_exp_f32 v49, v49
  v_exp_f32 v50, v50
  v_exp_f32 v51, v51
  v_smfmac_f32_32x32x32_bf16 v[240:255], v[176:179], v[40:47], v3
  buffer_load_dwordx4 a[120:123], v1, s[4:7], s56 offen offset:2048
  v_exp_f32 v52, v52
  v_exp_f32 v53, v53
  v_exp_f32 v54, v54
  v_exp_f32 v55, v55
  v_exp_f32 v24, v24
  v_exp_f32 v25, v25
  v_exp_f32 v26, v26
  v_smfmac_f32_32x32x32_bf16 v[240:255], v[180:183], v[48:55], v3
  v_exp_f32 v27, v27
  v_exp_f32 v28, v28
  v_exp_f32 v29, v29
  v_exp_f32 v30, v30
  v_exp_f32 v31, v31
  v_mfma_f32_32x32x16_bf16 v[40:55], v[120:123], a[244:247], v[72:87]
  v_exp_f32 v32, v32
  v_exp_f32 v33, v33
  v_exp_f32 v34, v34
  v_exp_f32 v35, v35
  v_smfmac_f32_32x32x32_bf16 v[192:207], v[176:179], v[24:31], v3
  buffer_load_dwordx4 a[224:227], v1, s[4:7], s57 offen offset:2048
  v_exp_f32 v36, v36
  v_exp_f32 v37, v37
  v_exp_f32 v38, v38
  v_exp_f32 v39, v39
  v_exp_f32 v40, v40
  v_exp_f32 v41, v41
  v_exp_f32 v42, v42
  v_smfmac_f32_32x32x32_bf16 v[192:207], v[180:183], v[32:39], v3
  s_waitcnt vmcnt(17)
  v_exp_f32 v43, v43
  v_exp_f32 v44, v44
  v_exp_f32 v45, v45
  v_exp_f32 v46, v46
  v_exp_f32 v47, v47
  v_mfma_f32_32x32x16_bf16 v[24:39], v[124:127], a[248:251], v[88:103]
  buffer_load_dwordx4 v1, s[4:7], s55 offen offset:2048 lds
  v_exp_f32 v48, v48
  v_exp_f32 v49, v49
  v_exp_f32 v50, v50
  v_exp_f32 v51, v51
  v_smfmac_f32_32x32x32_bf16 v[208:223], v[176:179], v[40:47], v3
  buffer_load_dwordx4 a[124:127], v1, s[4:7], s56 offen offset:3072
  v_exp_f32 v52, v52
  v_exp_f32 v53, v53
  v_exp_f32 v54, v54
  v_exp_f32 v55, v55
  v_exp_f32 v24, v24
  v_exp_f32 v25, v25
  v_exp_f32 v26, v26
  v_smfmac_f32_32x32x32_bf16 v[208:223], v[180:183], v[48:55], v3
  v_exp_f32 v27, v27
  v_exp_f32 v28, v28
  v_exp_f32 v29, v29
  v_exp_f32 v30, v30
  v_exp_f32 v31, v31
  v_mfma_f32_32x32x16_bf16 v[40:55], v[124:127], a[252:255], v[104:119]
  v_exp_f32 v32, v32
  v_exp_f32 v33, v33
  v_exp_f32 v34, v34
  v_exp_f32 v35, v35
  v_smfmac_f32_32x32x32_bf16 v[224:239], v[184:187], v[24:31], v3
  v_exp_f32 v36, v36
  v_exp_f32 v37, v37
  v_exp_f32 v38, v38
  v_exp_f32 v39, v39
  v_exp_f32 v40, v40
  v_exp_f32 v41, v41
  v_exp_f32 v42, v42
  v_smfmac_f32_32x32x32_bf16 v[224:239], v[188:191], v[32:39], v3
  v_exp_f32 v43, v43
  v_exp_f32 v44, v44
  v_exp_f32 v45, v45
  v_exp_f32 v46, v46
  v_exp_f32 v47, v47
  v_mfma_f32_32x32x16_bf16 v[24:39], v[124:127], a[240:243], v[56:71]
  buffer_load_dwordx4 a[228:231], v1, s[4:7], s57 offen offset:3072
  s_add_u32 s57, s57, 4096
  v_exp_f32 v48, v48
  v_exp_f32 v49, v49
  v_exp_f32 v50, v50
  v_exp_f32 v51, v51
  v_smfmac_f32_32x32x32_bf16 v[240:255], v[184:187], v[40:47], v3
  buffer_load_dwordx4 v1, s[4:7], s55 offen offset:3072 lds
  s_add_u32 m0, m0, 4096
  s_add_u32 s55, s55, 4096
  v_exp_f32 v52, v52
  v_exp_f32 v53, v53
  v_exp_f32 v54, v54
  v_exp_f32 v55, v55
  v_exp_f32 v24, v24
  v_exp_f32 v25, v25
  v_exp_f32 v26, v26
  v_smfmac_f32_32x32x32_bf16 v[240:255], v[188:191], v[48:55], v3
  v_exp_f32 v27, v27
  v_exp_f32 v28, v28
  v_exp_f32 v29, v29
  v_exp_f32 v30, v30
  v_exp_f32 v31, v31
  v_mfma_f32_32x32x16_bf16 v[40:55], v[124:127], a[244:247], v[72:87]
  v_exp_f32 v32, v32
  v_exp_f32 v33, v33
  v_exp_f32 v34, v34
  v_exp_f32 v35, v35
  v_smfmac_f32_32x32x32_bf16 v[192:207], v[184:187], v[24:31], v3
  buffer_load_dwordx4 v[4:7], v173, s[12:15], s86 offen offset:0
  v_exp_f32 v36, v36
  v_exp_f32 v37, v37
  v_exp_f32 v38, v38
  v_exp_f32 v39, v39
  v_exp_f32 v40, v40
  v_exp_f32 v41, v41
  v_exp_f32 v42, v42
  v_smfmac_f32_32x32x32_bf16 v[192:207], v[188:191], v[32:39], v3
  s_waitcnt vmcnt(15)
  v_exp_f32 v43, v43
  v_exp_f32 v44, v44
  v_exp_f32 v45, v45
  v_exp_f32 v46, v46
  v_exp_f32 v47, v47
  v_mfma_f32_32x32x16_bf16 v[24:39], v[128:131], a[248:251], v[88:103]
  v_exp_f32 v48, v48
  v_exp_f32 v49, v49
  v_exp_f32 v50, v50
  v_exp_f32 v51, v51
  v_smfmac_f32_32x32x32_bf16 v[208:223], v[184:187], v[40:47], v3
  buffer_load_dwordx4 a[232:235], v1, s[4:7], s57 offen offset:0
  v_exp_f32 v52, v52
  v_exp_f32 v53, v53
  v_exp_f32 v54, v54
  v_exp_f32 v55, v55
  v_exp_f32 v24, v24
  v_exp_f32 v25, v25
  v_exp_f32 v26, v26
  v_smfmac_f32_32x32x32_bf16 v[208:223], v[188:191], v[48:55], v3
  v_exp_f32 v27, v27
  v_exp_f32 v28, v28
  v_exp_f32 v29, v29
  v_exp_f32 v30, v30
  v_exp_f32 v31, v31
  v_mfma_f32_32x32x16_bf16 v[40:55], v[128:131], a[252:255], v[104:119]
  s_xor_b32 s38, s16, 2
  s_mul_i32 s38, s38, 6144
  s_add_u32 s38, s38, 135168
  v_add_u32 v164, s38, v1
  v_exp_f32 v32, v32
  v_exp_f32 v33, v33
  v_exp_f32 v34, v34
  v_exp_f32 v35, v35
  v_smfmac_f32_32x32x32_bf16 v[224:239], v[136:139], v[24:31], v3
  s_mul_i32 s38, s16, 6144
  s_add_u32 s38, s38, 135168
  v_add_u32 v165, s38, v1
  v_exp_f32 v36, v36
  v_exp_f32 v37, v37
  v_exp_f32 v38, v38
  v_exp_f32 v39, v39
  v_exp_f32 v40, v40
  v_exp_f32 v41, v41
  v_exp_f32 v42, v42
  v_smfmac_f32_32x32x32_bf16 v[224:239], v[140:143], v[32:39], v3
  v_exp_f32 v43, v43
  v_exp_f32 v44, v44
  v_exp_f32 v45, v45
  v_exp_f32 v46, v46
  v_exp_f32 v47, v47
  v_mfma_f32_32x32x16_bf16 v[24:39], v[128:131], a[240:243], v[56:71]
  buffer_load_dwordx4 v1, s[4:7], s55 offen offset:0 lds
  v_exp_f32 v48, v48
  v_exp_f32 v49, v49
  v_exp_f32 v50, v50
  v_exp_f32 v51, v51
  v_smfmac_f32_32x32x32_bf16 v[240:255], v[136:139], v[40:47], v3
  buffer_load_dwordx4 v[8:11], v173, s[12:15], s86 offen offset:32
  v_exp_f32 v52, v52
  v_exp_f32 v53, v53
  v_exp_f32 v54, v54
  v_exp_f32 v55, v55
  v_exp_f32 v24, v24
  v_exp_f32 v25, v25
  v_exp_f32 v26, v26
  v_smfmac_f32_32x32x32_bf16 v[240:255], v[140:143], v[48:55], v3
  v_exp_f32 v27, v27
  v_exp_f32 v28, v28
  v_exp_f32 v29, v29
  v_exp_f32 v30, v30
  v_exp_f32 v31, v31
  v_mfma_f32_32x32x16_bf16 v[40:55], v[128:131], a[244:247], v[72:87]
  v_exp_f32 v32, v32
  v_exp_f32 v33, v33
  v_exp_f32 v34, v34
  v_exp_f32 v35, v35
  v_smfmac_f32_32x32x32_bf16 v[192:207], v[136:139], v[24:31], v3
  v_exp_f32 v36, v36
  v_exp_f32 v37, v37
  v_exp_f32 v38, v38
  v_exp_f32 v39, v39
  v_exp_f32 v40, v40
  v_exp_f32 v41, v41
  v_exp_f32 v42, v42
  v_smfmac_f32_32x32x32_bf16 v[192:207], v[140:143], v[32:39], v3
  s_waitcnt vmcnt(11)
  v_exp_f32 v43, v43
  v_exp_f32 v44, v44
  v_exp_f32 v45, v45
  v_exp_f32 v46, v46
  v_exp_f32 v47, v47
  v_mfma_f32_32x32x16_bf16 v[24:39], v[132:135], a[248:251], v[88:103]
  v_exp_f32 v48, v48
  v_exp_f32 v49, v49
  v_exp_f32 v50, v50
  v_exp_f32 v51, v51
  v_smfmac_f32_32x32x32_bf16 v[208:223], v[136:139], v[40:47], v3
  v_exp_f32 v52, v52
  v_exp_f32 v53, v53
  v_exp_f32 v54, v54
  v_exp_f32 v55, v55
  v_exp_f32 v24, v24
  v_exp_f32 v25, v25
  v_exp_f32 v26, v26
  v_smfmac_f32_32x32x32_bf16 v[208:223], v[140:143], v[48:55], v3
  v_exp_f32 v27, v27
  v_exp_f32 v28, v28
  v_exp_f32 v29, v29
  v_exp_f32 v30, v30
  v_exp_f32 v31, v31
  v_mfma_f32_32x32x16_bf16 v[40:55], v[132:135], a[252:255], v[104:119]
  v_exp_f32 v32, v32
  v_exp_f32 v33, v33
  v_exp_f32 v34, v34
  v_exp_f32 v35, v35
  v_smfmac_f32_32x32x32_bf16 v[224:239], v[144:147], v[24:31], v3
  v_exp_f32 v36, v36
  v_exp_f32 v37, v37
  v_exp_f32 v38, v38
  v_exp_f32 v39, v39
  v_exp_f32 v40, v40
  v_exp_f32 v41, v41
  v_exp_f32 v42, v42
  v_smfmac_f32_32x32x32_bf16 v[224:239], v[148:151], v[32:39], v3
  v_exp_f32 v43, v43
  v_exp_f32 v44, v44
  v_exp_f32 v45, v45
  v_exp_f32 v46, v46
  v_exp_f32 v47, v47
  v_mfma_f32_32x32x16_bf16 v[24:39], v[132:135], a[240:243], v[56:71]
  v_exp_f32 v48, v48
  v_exp_f32 v49, v49
  v_exp_f32 v50, v50
  v_exp_f32 v51, v51
  v_smfmac_f32_32x32x32_bf16 v[240:255], v[144:147], v[40:47], v3
  v_exp_f32 v52, v52
  v_exp_f32 v53, v53
  v_exp_f32 v54, v54
  v_exp_f32 v55, v55
  v_exp_f32 v24, v24
  v_exp_f32 v25, v25
  v_exp_f32 v26, v26
  v_smfmac_f32_32x32x32_bf16 v[240:255], v[148:151], v[48:55], v3
  ds_write_b128 v164, v[224:227] offset:0
  v_exp_f32 v27, v27
  v_exp_f32 v28, v28
  v_exp_f32 v29, v29
  v_exp_f32 v30, v30
  v_exp_f32 v31, v31
  v_mfma_f32_32x32x16_bf16 v[40:55], v[132:135], a[244:247], v[72:87]
  ds_write_b128 v164, v[228:231] offset:1024
  v_exp_f32 v32, v32
  v_exp_f32 v33, v33
  v_exp_f32 v34, v34
  v_exp_f32 v35, v35
  v_smfmac_f32_32x32x32_bf16 v[192:207], v[144:147], v[24:31], v3
  ds_write_b128 v164, v[232:235] offset:2048
  v_exp_f32 v36, v36
  v_exp_f32 v37, v37
  v_exp_f32 v38, v38
  v_exp_f32 v39, v39
  v_exp_f32 v40, v40
  v_exp_f32 v41, v41
  v_exp_f32 v42, v42
  v_smfmac_f32_32x32x32_bf16 v[192:207], v[148:151], v[32:39], v3
  ds_write_b128 v164, v[240:243] offset:3072
  ds_write_b128 v164, v[244:247] offset:4096
  v_exp_f32 v43, v43
  v_exp_f32 v44, v44
  v_exp_f32 v45, v45
  v_exp_f32 v46, v46
  v_exp_f32 v47, v47
  ds_write_b128 v164, v[248:251] offset:5120
  v_exp_f32 v48, v48
  v_exp_f32 v49, v49
  v_exp_f32 v50, v50
  v_exp_f32 v51, v51
  v_smfmac_f32_32x32x32_bf16 v[208:223], v[144:147], v[40:47], v3
  s_waitcnt lgkmcnt(0)
  s_barrier
  ds_read_b128 v[224:227], v165 offset:0
  ds_read_b128 v[228:231], v165 offset:1024
  ds_read_b128 v[232:235], v165 offset:2048
  ds_read_b128 v[240:243], v165 offset:3072
  ds_read_b128 v[244:247], v165 offset:4096
  ds_read_b128 v[248:251], v165 offset:5120
  v_exp_f32 v52, v52
  v_exp_f32 v53, v53
  v_exp_f32 v54, v54
  v_exp_f32 v55, v55
  s_nop 1
  v_smfmac_f32_32x32x32_bf16 v[208:223], v[148:151], v[48:55], v3
  s_lshl_b32 s38, s53, 5
  s_add_u32 s38, s38, s52
  s_lshl_b32 s38, s38, 10
  s_add_u32 s38, s38, 0x1600000
  s_add_u32 s39, s38, 0x8000
  s_mov_b32 s40, 0x4e800000
  s_waitcnt lgkmcnt(0)
  v_pk_add_f32 v[192:193], v[192:193], v[224:225]
  v_pk_add_f32 v[194:195], v[194:195], v[226:227]
  v_pk_add_f32 v[196:197], v[196:197], v[228:229]
  v_pk_add_f32 v[198:199], v[198:199], v[230:231]
  v_pk_add_f32 v[200:201], v[200:201], v[232:233]
  v_pk_add_f32 v[208:209], v[208:209], v[240:241]
  v_pk_add_f32 v[210:211], v[210:211], v[242:243]
  v_pk_add_f32 v[212:213], v[212:213], v[244:245]
  v_pk_add_f32 v[214:215], v[214:215], v[246:247]
  v_pk_add_f32 v[216:217], v[216:217], v[248:249]
L_attepi_16:
  v_rcp_f32 v202, v200
  v_add_f32 v28, v200, v216
  v_rcp_f32 v218, v216
  v_cmp_nge_f32 vcc, s40, v28
  s_cbranch_vccnz L_attfb_18
L_attok_17:
  v_pk_mul_f32 v[192:193], v[192:193], v[202:203] op_sel_hi:[1,0]
  v_pk_mul_f32 v[194:195], v[194:195], v[202:203] op_sel_hi:[1,0]
  v_pk_mul_f32 v[196:197], v[196:197], v[202:203] op_sel_hi:[1,0]
  v_pk_mul_f32 v[198:199], v[198:199], v[202:203] op_sel_hi:[1,0]
  v_cvt_pk_bf16_f32 v24, v192, v193
  v_cvt_pk_bf16_f32 v25, v194, v195
  v_cvt_pk_bf16_f32 v26, v196, v197
  v_cvt_pk_bf16_f32 v27, v198, v199
  buffer_store_dwordx4 v[24:27], v1, s[4:7], s38 offen sc1
  v_pk_mul_f32 v[208:209], v[208:209], v[218:219] op_sel_hi:[1,0]
  v_pk_mul_f32 v[210:211], v[210:211], v[218:219] op_sel_hi:[1,0]
  v_pk_mul_f32 v[212:213], v[212:213], v[218:219] op_sel_hi:[1,0]
  v_pk_mul_f32 v[214:215], v[214:215], v[218:219] op_sel_hi:[1,0]
  v_cvt_pk_bf16_f32 v40, v208, v209
  v_cvt_pk_bf16_f32 v41, v210, v211
  v_cvt_pk_bf16_f32 v42, v212, v213
  v_cvt_pk_bf16_f32 v43, v214, v215
  buffer_store_dwordx4 v[40:43], v1, s[4:7], s39 offen sc1
  s_waitcnt vmcnt(0)
  s_waitcnt lgkmcnt(0)
  s_barrier
  v_mov_b32 v22, 2
  s_cmp_lg_u32 s16, 0
  s_cbranch_scc1 L_sig_19
  s_mov_b64 exec, 1
  s_cmp_eq_u32 s79, 0
  s_cbranch_scc1 L_far_20
  buffer_store_dword v22, off, s[4:7], s77
  s_mov_b64 exec, -1
L_sig_19:
L_p3_0:
  s_lshl_b32 s31, s21, 15
  s_add_u32 s31, s31, 0x1600000
  v_lshlrev_b32 v24, 16, v4
  v_and_b32 v25, 0xffff0000, v4
  v_lshlrev_b32 v26, 16, v5
  v_and_b32 v27, 0xffff0000, v5
  v_lshlrev_b32 v28, 16, v6
  v_and_b32 v29, 0xffff0000, v6
  v_lshlrev_b32 v30, 16, v7
  v_and_b32 v31, 0xffff0000, v7
  v_lshlrev_b32 v32, 16, v8
  v_and_b32 v33, 0xffff0000, v8
  v_lshlrev_b32 v34, 16, v9
  v_and_b32 v35, 0xffff0000, v9
  v_lshlrev_b32 v36, 16, v10
  v_and_b32 v37, 0xffff0000, v10
  v_lshlrev_b32 v38, 16, v11
  v_and_b32 v39, 0xffff0000, v11
  s_lshl_b32 s52, s21, 15
  s_lshl_b32 s54, s22, 11
  s_add_u32 s52, s52, s54
  s_add_u32 s52, s52, 0xa00000
  s_lshl_b32 s53, s21, 12
  s_lshl_b32 s54, s22, 8
  s_add_u32 s53, s53, s54
  s_add_u32 s53, s53, 0xc0000
  s_add_u32 s32, s31, 28672
  s_mul_i32 s33, s16, 7168
  s_add_u32 s31, s31, s33
  s_add_u32 m0, s33, 135168
L_poll_21:
  buffer_load_dword v22, v13, s[4:7], 0 offen sc1
  s_waitcnt vmcnt(0)
  v_cmp_gt_u32 vcc, 2, v22
  s_cbranch_vccz L_pdone_22
  s_sub_u32 s20, s20, 1
  s_cbranch_scc0 L_poll_21
  s_mov_b32 s20, 0
L_pdone_22:
  buffer_load_dwordx4 v1, s[4:7], s31 offen offset:0 sc1 lds
  buffer_load_dwordx4 v1, s[4:7], s31 offen offset:1024 sc1 lds
  buffer_load_dwordx4 v1, s[4:7], s31 offen offset:2048 sc1 lds
  buffer_load_dwordx4 v1, s[4:7], s31 offen offset:3072 sc1 lds
  s_add_u32 m0, m0, 4096
  s_add_u32 s31, s31, 4096
  buffer_load_dwordx4 v1, s[4:7], s31 offen offset:0 sc1 lds
  buffer_load_dwordx4 v1, s[4:7], s31 offen offset:1024 sc1 lds
  buffer_load_dwordx4 v1, s[4:7], s31 offen offset:2048 sc1 lds
  s_waitcnt vmcnt(3)
  s_barrier
  ds_read_b128 v[72:75], v18 offset:4096
  ds_read_b128 v[76:79], v18 offset:11264
  ds_read_b128 v[80:83], v18 offset:18432
  ds_read_b128 v[84:87], v18 offset:25600
  ds_read_b128 v[88:91], v18 offset:5120
  ds_read_b128 v[92:95], v18 offset:12288
  ds_read_b128 v[96:99], v18 offset:19456
  s_waitcnt lgkmcnt(6)
  v_mfma_f32_32x32x16_bf16 v[24:39], a[0:3], v[72:75], v[24:39]
  buffer_load_dwordx4 v[56:59], v1, s[4:7], s32 offen offset:0 sc1
  ds_read_b128 v[100:103], v18 offset:26624
  s_waitcnt lgkmcnt(6)
  v_mfma_f32_32x32x16_bf16 v[24:39], a[28:31], v[76:79], v[24:39]
  buffer_load_dwordx4 v[60:63], v1, s[4:7], s32 offen offset:1024 sc1
  ds_read_b128 v[72:75], v18 offset:6144
  s_waitcnt lgkmcnt(6)
  v_mfma_f32_32x32x16_bf16 v[24:39], a[56:59], v[80:83], v[24:39]
  buffer_load_dwordx4 v[64:67], v1, s[4:7], s32 offen offset:2048 sc1
  ds_read_b128 v[76:79], v18 offset:13312
  s_waitcnt lgkmcnt(6)
  v_mfma_f32_32x32x16_bf16 v[24:39], a[84:87], v[84:87], v[24:39]
  buffer_load_dwordx4 v[68:71], v1, s[4:7], s32 offen offset:3072 sc1
  ds_read_b128 v[80:83], v18 offset:20480
  s_waitcnt lgkmcnt(6)
  v_mfma_f32_32x32x16_bf16 v[24:39], a[4:7], v[88:91], v[24:39]
  ds_read_b128 v[84:87], v18 offset:27648
  s_waitcnt lgkmcnt(6)
  v_mfma_f32_32x32x16_bf16 v[24:39], a[32:35], v[92:95], v[24:39]
  ds_read_b128 v[88:91], v18 offset:7168
  s_waitcnt lgkmcnt(6)
  v_mfma_f32_32x32x16_bf16 v[24:39], a[60:63], v[96:99], v[24:39]
  ds_read_b128 v[92:95], v18 offset:14336
  s_waitcnt lgkmcnt(6)
  v_mfma_f32_32x32x16_bf16 v[24:39], a[88:91], v[100:103], v[24:39]
  ds_read_b128 v[96:99], v18 offset:21504
  s_waitcnt lgkmcnt(6)
  v_mfma_f32_32x32x16_bf16 v[24:39], a[8:11], v[72:75], v[24:39]
  ds_read_b128 v[100:103], v18 offset:28672
  s_waitcnt lgkmcnt(6)
  v_mfma_f32_32x32x16_bf16 v[24:39], a[36:39], v[76:79], v[24:39]
  s_waitcnt vmcnt(4)
  s_barrier
  ds_read_b128 v[72:75], v18 offset:8192
  s_waitcnt lgkmcnt(6)
  v_mfma_f32_32x32x16_bf16 v[24:39], a[64:67], v[80:83], v[24:39]
  ds_read_b128 v[76:79], v18 offset:15360
  buffer_load_dwordx4 a[236:239], v1, s[4:7], s66 offen offset:0
  s_waitcnt lgkmcnt(6)
  v_mfma_f32_32x32x16_bf16 v[24:39], a[92:95], v[84:87], v[24:39]
  ds_read_b128 v[80:83], v18 offset:22528
  s_waitcnt lgkmcnt(6)
  v_mfma_f32_32x32x16_bf16 v[24:39], a[12:15], v[88:91], v[24:39]
  ds_read_b128 v[84:87], v18 offset:29696
  buffer_load_dwordx4 a[240:243], v1, s[4:7], s70 offen offset:0
  s_waitcnt lgkmcnt(6)
  v_mfma_f32_32x32x16_bf16 v[24:39], a[40:43], v[92:95], v[24:39]
  ds_read_b128 v[88:91], v18 offset:9216
  s_waitcnt lgkmcnt(6)
  v_mfma_f32_32x32x16_bf16 v[24:39], a[68:71], v[96:99], v[24:39]
  ds_read_b128 v[92:95], v18 offset:16384
  buffer_load_dwordx4 a[244:247], v1, s[4:7], s67 offen offset:0
  s_waitcnt lgkmcnt(6)
  v_mfma_f32_32x32x16_bf16 v[24:39], a[96:99], v[100:103], v[24:39]
  ds_read_b128 v[96:99], v18 offset:23552
  s_waitcnt lgkmcnt(6)
  v_mfma_f32_32x32x16_bf16 v[24:39], a[16:19], v[72:75], v[24:39]
  ds_read_b128 v[100:103], v18 offset:30720
  buffer_load_dwordx4 a[248:251], v1, s[4:7], s71 offen offset:0
  s_waitcnt lgkmcnt(6)
  v_mfma_f32_32x32x16_bf16 v[24:39], a[44:47], v[76:79], v[24:39]
  ds_read_b128 v[72:75], v18 offset:10240
  s_waitcnt lgkmcnt(6)
  v_mfma_f32_32x32x16_bf16 v[24:39], a[72:75], v[80:83], v[24:39]
  ds_read_b128 v[76:79], v18 offset:17408
  buffer_load_dwordx4 a[252:255], v1, s[4:7], s68 offen offset:0
  s_waitcnt lgkmcnt(6)
  v_mfma_f32_32x32x16_bf16 v[24:39], a[100:103], v[84:87], v[24:39]
  ds_read_b128 v[80:83], v18 offset:24576
  s_waitcnt lgkmcnt(6)
  v_mfma_f32_32x32x16_bf16 v[24:39], a[20:23], v[88:91], v[24:39]
  ds_read_b128 v[84:87], v18 offset:31744
  buffer_load_dwordx4 v[160:163], v1, s[4:7], s72 offen offset:0
  s_waitcnt lgkmcnt(6)
  v_mfma_f32_32x32x16_bf16 v[24:39], a[48:51], v[92:95], v[24:39]
  s_waitcnt lgkmcnt(5)
  v_mfma_f32_32x32x16_bf16 v[24:39], a[76:79], v[96:99], v[24:39]
  buffer_load_dwordx4 v[164:167], v1, s[4:7], s69 offen offset:0
  s_waitcnt lgkmcnt(4)
  v_mfma_f32_32x32x16_bf16 v[24:39], a[104:107], v[100:103], v[24:39]
  s_waitcnt lgkmcnt(3)
  v_mfma_f32_32x32x16_bf16 v[24:39], a[24:27], v[72:75], v[24:39]
  buffer_load_dwordx4 v[168:171], v1, s[4:7], s73 offen offset:0
  s_waitcnt lgkmcnt(2)
  v_mfma_f32_32x32x16_bf16 v[24:39], a[52:55], v[76:79], v[24:39]
  s_waitcnt lgkmcnt(1)
  v_mfma_f32_32x32x16_bf16 v[24:39], a[80:83], v[80:83], v[24:39]
  buffer_load_dwordx4 v[172:175], v1, s[4:7], s66 offen offset:1024
  s_waitcnt lgkmcnt(0)
  v_mfma_f32_32x32x16_bf16 v[24:39], a[108:111], v[84:87], v[24:39]
  s_waitcnt vmcnt(12)
  v_mfma_f32_32x32x16_bf16 v[24:39], a[112:115], v[56:59], v[24:39]
  s_waitcnt vmcnt(11)
  v_mfma_f32_32x32x16_bf16 v[24:39], a[116:119], v[60:63], v[24:39]
  s_waitcnt vmcnt(10)
  v_mfma_f32_32x32x16_bf16 v[24:39], a[120:123], v[64:67], v[24:39]
  s_waitcnt vmcnt(9)
  v_mfma_f32_32x32x16_bf16 v[24:39], a[124:127], v[68:71], v[24:39]
  s_nop 11
  v_cvt_pk_bf16_f32 v44, v24, v25
  v_cvt_pk_bf16_f32 v45, v26, v27
  v_cvt_pk_bf16_f32 v46, v28, v29
  v_cvt_pk_bf16_f32 v47, v30, v31
  buffer_store_dwordx4 v[44:47], v1, s[4:7], s52 offen offset:0 sc1
  v_cvt_pk_bf16_f32 v48, v32, v33
  v_cvt_pk_bf16_f32 v49, v34, v35
  v_cvt_pk_bf16_f32 v50, v36, v37
  v_cvt_pk_bf16_f32 v51, v38, v39
  buffer_store_dwordx4 v[48:51], v1, s[4:7], s52 offen offset:1024 sc1
  v_pk_add_f32 v[40:41], v[24:25], v[26:27]
  v_pk_mul_f32 v[42:43], v[24:25], v[24:25]
  v_pk_fma_f32 v[42:43], v[26:27], v[26:27], v[42:43]
  v_pk_fma_f32 v[42:43], v[28:29], v[28:29], v[42:43]
  v_pk_add_f32 v[40:41], v[40:41], v[28:29]
  v_pk_fma_f32 v[42:43], v[30:31], v[30:31], v[42:43]
  v_pk_add_f32 v[40:41], v[40:41], v[30:31]
  v_pk_fma_f32 v[42:43], v[32:33], v[32:33], v[42:43]
  v_pk_add_f32 v[40:41], v[40:41], v[32:33]
  v_pk_fma_f32 v[42:43], v[34:35], v[34:35], v[42:43]
  v_pk_add_f32 v[40:41], v[40:41], v[34:35]
  v_pk_fma_f32 v[42:43], v[36:37], v[36:37], v[42:43]
  v_pk_add_f32 v[40:41], v[40:41], v[36:37]
  v_pk_fma_f32 v[42:43], v[38:39], v[38:39], v[42:43]
  v_pk_add_f32 v[40:41], v[40:41], v[38:39]
  v_add_f32 v40, v40, v41
  v_add_f32 v41, v42, v43
  s_nop 1
  v_permlane32_swap_b32 v40, v41
  v_add_f32 v40, v40, v41
  buffer_store_dword v40, v19, s[4:7], s53 offen offset:0 sc1
  s_waitcnt vmcnt(0)
  s_waitcnt lgkmcnt(0)
  s_barrier
  v_mov_b32 v22, 3
  s_cmp_lg_u32 s16, 0
  s_cbranch_scc1 L_sig_23
  s_mov_b64 exec, 1
  s_cmp_eq_u32 s79, 0
  s_cbranch_scc1 L_far_24
  buffer_store_dword v22, off, s[4:7], s77
  s_mov_b64 exec, -1
L_sig_23:
  s_lshl_b32 s31, s27, 15
  s_add_u32 s31, s31, 0xa00000
  s_mul_i32 s34, s27, 112
  s_mul_i32 s33, s24, 7
  s_add_u32 s34, s34, s33
  s_lshl_b32 s34, s34, 10
  s_add_u32 s34, s34, 0x2200000
  s_lshl_b32 s38, s16, 13
  v_add_u32 v158, s38, v1
  v_add_u32 v159, s38, v17
  s_mul_i32 s44, s16, 28672
  s_add_u32 s44, s44, 0x2200000
  s_xor_b32 s88, s26, 0
  s_mul_i32 s88, s88, 114688
  s_add_u32 s88, s88, s44
  s_add_u32 s89, s88, 7168
  s_add_u32 s90, s88, 14336
  s_add_u32 s91, s88, 21504
  s_xor_b32 s92, s26, 1
  s_mul_i32 s92, s92, 114688
  s_add_u32 s92, s92, s44
  s_add_u32 s93, s92, 7168
  s_add_u32 s94, s92, 14336
  s_add_u32 s95, s92, 21504
  s_lshl_b32 s86, s26, 15
  s_lshl_b32 s39, s25, 11
  s_add_u32 s86, s86, s39
  s_add_u32 s86, s86, 0xa00000
  s_mul_i32 s84, s24, 101376
  s_lshl_b32 s85, s16, 13
  s_add_u32 s84, s84, s85
  s_add_u32 s84, s84, 0x200000
  s_lshl_b32 s32, s27, 12
  s_add_u32 s32, s32, 0xc0000
  ds_read_b128 v[88:91], v1 offset:0
  ds_read_b128 v[92:95], v1 offset:33792
  ds_read_b128 v[96:99], v17 offset:2048
  ds_read_b128 v[100:103], v1 offset:1024
  ds_read_b128 v[104:107], v1 offset:34816
  ds_read_b128 v[108:111], v17 offset:3072
  ds_read_b128 v[112:115], v1 offset:2048
L_poll_25:
  buffer_load_dword v22, v13, s[4:7], 0 offen sc1
  s_waitcnt vmcnt(0)
  v_cmp_gt_u32 vcc, 3, v22
  s_cbranch_vccz L_pdone_26
  s_sub_u32 s20, s20, 1
  s_cbranch_scc0 L_poll_25
  s_mov_b32 s20, 0
L_pdone_26:
  buffer_load_dwordx4 a[0:3], v1, s[4:7], s31 offen offset:0 sc1
  buffer_load_dwordx4 a[4:7], v1, s[4:7], s31 offen offset:1024 sc1
  buffer_load_dwordx4 a[8:11], v1, s[4:7], s31 offen offset:2048 sc1
  buffer_load_dwordx4 a[12:15], v1, s[4:7], s31 offen offset:3072 sc1
  s_add_u32 s31, s31, 4096
  buffer_load_dwordx4 a[16:19], v1, s[4:7], s31 offen offset:0 sc1
  buffer_load_dwordx4 a[20:23], v1, s[4:7], s31 offen offset:1024 sc1
  buffer_load_dwordx4 a[24:27], v1, s[4:7], s31 offen offset:2048 sc1
  buffer_load_dwordx4 a[28:31], v1, s[4:7], s31 offen offset:3072 sc1
  s_add_u32 s31, s31, 4096
  buffer_load_dwordx4 a[32:35], v1, s[4:7], s31 offen offset:0 sc1
  buffer_load_dwordx4 a[36:39], v1, s[4:7], s31 offen offset:1024 sc1
  s_waitcnt vmcnt(9) lgkmcnt(5)
  v_mfma_f32_32x32x16_bf16 v[24:39], v[88:91], a[0:3], 0
  ds_read_b128 v[116:119], v1 offset:35840
  buffer_load_dwordx4 a[40:43], v1, s[4:7], s31 offen offset:2048 sc1
  v_mfma_f32_32x32x16_bf16 v[40:55], v[92:95], a[0:3], 0
  ds_read_b128 v[88:91], v17 offset:4096
  s_waitcnt lgkmcnt(5)
  v_mfma_f32_32x32x16_bf16 v[56:71], v[96:99], a[0:3], 0
  ds_read_b128 v[92:95], v1 offset:3072
  buffer_load_dwordx4 a[44:47], v1, s[4:7], s31 offen offset:3072 sc1
  s_add_u32 s31, s31, 4096
  s_waitcnt vmcnt(10)
  v_mfma_f32_32x32x16_bf16 v[24:39], v[100:103], a[4:7], v[24:39]
  ds_read_b128 v[96:99], v1 offset:36864
  s_waitcnt lgkmcnt(5)
  v_mfma_f32_32x32x16_bf16 v[40:55], v[104:107], a[4:7], v[40:55]
  ds_read_b128 v[100:103], v17 offset:5120
  buffer_load_dwordx4 a[48:51], v1, s[4:7], s31 offen offset:0 sc1
  v_mfma_f32_32x32x16_bf16 v[56:71], v[108:111], a[4:7], v[56:71]
  ds_read_b128 v[104:107], v1 offset:4096
  s_waitcnt vmcnt(10) lgkmcnt(5)
  v_mfma_f32_32x32x16_bf16 v[24:39], v[112:115], a[8:11], v[24:39]
  ds_read_b128 v[108:111], v1 offset:37888
  buffer_load_dwordx4 a[52:55], v1, s[4:7], s31 offen offset:1024 sc1
  v_mfma_f32_32x32x16_bf16 v[40:55], v[116:119], a[8:11], v[40:55]
  ds_read_b128 v[112:115], v17 offset:6144
  s_waitcnt lgkmcnt(5)
  v_mfma_f32_32x32x16_bf16 v[56:71], v[88:91], a[8:11], v[56:71]
  ds_read_b128 v[116:119], v1 offset:5120
  buffer_load_dwordx4 v[120:123], v1, s[4:7], s32 offen offset:0 sc1
  s_waitcnt vmcnt(11)
  v_mfma_f32_32x32x16_bf16 v[24:39], v[92:95], a[12:15], v[24:39]
  ds_read_b128 v[88:91], v1 offset:38912
  s_waitcnt lgkmcnt(5)
  v_mfma_f32_32x32x16_bf16 v[40:55], v[96:99], a[12:15], v[40:55]
  ds_read_b128 v[92:95], v17 offset:7168
  buffer_load_dwordx4 v[124:127], v1, s[4:7], s32 offen offset:1024 sc1
  v_mfma_f32_32x32x16_bf16 v[56:71], v[100:103], a[12:15], v[56:71]
  ds_read_b128 v[96:99], v1 offset:6144
  s_waitcnt vmcnt(11) lgkmcnt(5)
  v_mfma_f32_32x32x16_bf16 v[24:39], v[104:107], a[16:19], v[24:39]
  ds_read_b128 v[100:103], v1 offset:39936
  buffer_load_dwordx4 v[128:131], v1, s[4:7], s32 offen offset:2048 sc1
  v_mfma_f32_32x32x16_bf16 v[40:55], v[108:111], a[16:19], v[40:55]
  ds_read_b128 v[104:107], v17 offset:8192
  s_waitcnt lgkmcnt(5)
  v_mfma_f32_32x32x16_bf16 v[56:71], v[112:115], a[16:19], v[56:71]
  ds_read_b128 v[108:111], v1 offset:7168
  buffer_load_dwordx4 v[132:135], v1, s[4:7], s32 offen offset:3072 sc1
  s_waitcnt vmcnt(12)
  v_mfma_f32_32x32x16_bf16 v[24:39], v[116:119], a[20:23], v[24:39]
  ds_read_b128 v[112:115], v1 offset:40960
  s_waitcnt lgkmcnt(5)
  v_mfma_f32_32x32x16_bf16 v[40:55], v[88:91], a[20:23], v[40:55]
  ds_read_b128 v[116:119], v17 offset:9216
  buffer_load_dwordx4 a[56:59], v1, s[4:7], s31 offen offset:2048 sc1
  v_mfma_f32_32x32x16_bf16 v[56:71], v[92:95], a[20:23], v[56:71]
  ds_read_b128 v[88:91], v1 offset:8192
  s_waitcnt vmcnt(12) lgkmcnt(5)
  v_mfma_f32_32x32x16_bf16 v[24:39], v[96:99], a[24:27], v[24:39]
  ds_read_b128 v[92:95], v1 offset:41984
  buffer_load_dwordx4 a[60:63], v1, s[4:7], s31 offen offset:3072 sc1
  s_add_u32 s31, s31, 4096
  v_mfma_f32_32x32x16_bf16 v[40:55], v[100:103], a[24:27], v[40:55]
  ds_read_b128 v[96:99], v17 offset:10240
  s_waitcnt lgkmcnt(5)
  v_mfma_f32_32x32x16_bf16 v[56:71], v[104:107], a[24:27], v[56:71]
  ds_read_b128 v[100:103], v1 offset:9216
  buffer_load_dwordx4 a[64:67], v1, s[4:7], s31 offen offset:0 sc1
  s_waitcnt vmcnt(13)
  v_mfma_f32_32x32x16_bf16 v[24:39], v[108:111], a[28:31], v[24:39]
  ds_read_b128 v[104:107], v1 offset:43008
  s_waitcnt lgkmcnt(5)
  v_mfma_f32_32x32x16_bf16 v[40:55], v[112:115], a[28:31], v[40:55]
  ds_read_b128 v[108:111], v17 offset:11264
  buffer_load_dwordx4 a[68:71], v1, s[4:7], s31 offen offset:1024 sc1
  v_mfma_f32_32x32x16_bf16 v[56:71], v[116:119], a[28:31], v[56:71]
  ds_read_b128 v[112:115], v1 offset:10240
  s_waitcnt vmcnt(13) lgkmcnt(5)
  v_mfma_f32_32x32x16_bf16 v[24:39], v[88:91], a[32:35], v[24:39]
  ds_read_b128 v[116:119], v1 offset:44032
  buffer_load_dwordx4 a[72:75], v1, s[4:7], s31 offen offset:2048 sc1
  v_mfma_f32_32x32x16_bf16 v[40:55], v[92:95], a[32:35], v[40:55]
  ds_read_b128 v[88:91], v17 offset:12288
  s_waitcnt lgkmcnt(5)
  v_mfma_f32_32x32x16_bf16 v[56:71], v[96:99], a[32:35], v[56:71]
  ds_read_b128 v[92:95], v1 offset:11264
  buffer_load_dwordx4 a[76:79], v1, s[4:7], s31 offen offset:3072 sc1
  s_add_u32 s31, s31, 4096
  s_waitcnt vmcnt(14)
  v_mfma_f32_32x32x16_bf16 v[24:39], v[100:103], a[36:39], v[24:39]
  ds_read_b128 v[96:99], v1 offset:45056
  s_waitcnt lgkmcnt(5)
  v_mfma_f32_32x32x16_bf16 v[40:55], v[104:107], a[36:39], v[40:55]
  ds_read_b128 v[100:103], v17 offset:13312
  buffer_load_dwordx4 a[80:83], v1, s[4:7], s31 offen offset:0 sc1
  v_mfma_f32_32x32x16_bf16 v[56:71], v[108:111], a[36:39], v[56:71]
  ds_read_b128 v[104:107], v1 offset:12288
  s_waitcnt vmcnt(14) lgkmcnt(5)
  v_mfma_f32_32x32x16_bf16 v[24:39], v[112:115], a[40:43], v[24:39]
  ds_read_b128 v[108:111], v1 offset:46080
  buffer_load_dwordx4 a[84:87], v1, s[4:7], s31 offen offset:1024 sc1
  v_mfma_f32_32x32x16_bf16 v[40:55], v[116:119], a[40:43], v[40:55]
  ds_read_b128 v[112:115], v17 offset:14336
  s_waitcnt lgkmcnt(5)
  v_mfma_f32_32x32x16_bf16 v[56:71], v[88:91], a[40:43], v[56:71]
  ds_read_b128 v[116:119], v1 offset:13312
  buffer_load_dwordx4 a[88:91], v1, s[4:7], s31 offen offset:2048 sc1
  s_waitcnt vmcnt(15)
  v_mfma_f32_32x32x16_bf16 v[24:39], v[92:95], a[44:47], v[24:39]
  ds_read_b128 v[88:91], v1 offset:47104
  s_waitcnt lgkmcnt(5)
  v_mfma_f32_32x32x16_bf16 v[40:55], v[96:99], a[44:47], v[40:55]
  ds_read_b128 v[92:95], v17 offset:15360
  buffer_load_dwordx4 a[92:95], v1, s[4:7], s31 offen offset:3072 sc1
  s_add_u32 s31, s31, 4096
  v_mfma_f32_32x32x16_bf16 v[56:71], v[100:103], a[44:47], v[56:71]
  ds_read_b128 v[96:99], v1 offset:14336
  s_waitcnt vmcnt(15) lgkmcnt(5)
  v_mfma_f32_32x32x16_bf16 v[24:39], v[104:107], a[48:51], v[24:39]
  ds_read_b128 v[100:103], v1 offset:48128
  buffer_load_dwordx4 a[96:99], v1, s[4:7], s31 offen offset:0 sc1
  v_mfma_f32_32x32x16_bf16 v[40:55], v[108:111], a[48:51], v[40:55]
  ds_read_b128 v[104:107], v17 offset:16384
  s_waitcnt lgkmcnt(5)
  v_mfma_f32_32x32x16_bf16 v[56:71], v[112:115], a[48:51], v[56:71]
  ds_read_b128 v[108:111], v1 offset:15360
  buffer_load_dwordx4 a[100:103], v1, s[4:7], s31 offen offset:1024 sc1
  s_waitcnt vmcnt(16)
  v_mfma_f32_32x32x16_bf16 v[24:39], v[116:119], a[52:55], v[24:39]
  ds_read_b128 v[112:115], v1 offset:49152
  s_waitcnt lgkmcnt(5)
  v_mfma_f32_32x32x16_bf16 v[40:55], v[88:91], a[52:55], v[40:55]
  ds_read_b128 v[116:119], v17 offset:17408
  buffer_load_dwordx4 a[104:107], v1, s[4:7], s31 offen offset:2048 sc1
  v_mfma_f32_32x32x16_bf16 v[56:71], v[92:95], a[52:55], v[56:71]
  ds_read_b128 v[88:91], v1 offset:16384
  s_waitcnt vmcnt(12) lgkmcnt(5)
  v_mfma_f32_32x32x16_bf16 v[24:39], v[96:99], a[56:59], v[24:39]
  ds_read_b128 v[92:95], v1 offset:50176
  buffer_load_dwordx4 a[108:111], v1, s[4:7], s31 offen offset:3072 sc1
  s_add_u32 s31, s31, 4096
  v_mfma_f32_32x32x16_bf16 v[40:55], v[100:103], a[56:59], v[40:55]
  ds_read_b128 v[96:99], v17 offset:18432
  s_waitcnt lgkmcnt(5)
  v_mfma_f32_32x32x16_bf16 v[56:71], v[104:107], a[56:59], v[56:71]
  ds_read_b128 v[100:103], v1 offset:17408
  buffer_load_dwordx4 a[112:115], v1, s[4:7], s31 offen offset:0 sc1
  s_waitcnt vmcnt(13)
  v_mfma_f32_32x32x16_bf16 v[24:39], v[108:111], a[60:63], v[24:39]
  ds_read_b128 v[104:107], v1 offset:51200
  s_waitcnt lgkmcnt(5)
  v_mfma_f32_32x32x16_bf16 v[40:55], v[112:115], a[60:63], v[40:55]
  ds_read_b128 v[108:111], v17 offset:19456
  buffer_load_dwordx4 a[116:119], v1, s[4:7], s31 offen offset:1024 sc1
  v_mfma_f32_32x32x16_bf16 v[56:71], v[116:119], a[60:63], v[56:71]
  ds_read_b128 v[112:115], v1 offset:18432
  s_waitcnt vmcnt(13) lgkmcnt(5)
  v_mfma_f32_32x32x16_bf16 v[24:39], v[88:91], a[64:67], v[24:39]
  ds_read_b128 v[116:119], v1 offset:52224
  buffer_load_dwordx4 a[120:123], v1, s[4:7], s31 offen offset:2048 sc1
  v_mfma_f32_32x32x16_bf16 v[40:55], v[92:95], a[64:67], v[40:55]
  ds_read_b128 v[88:91], v17 offset:20480
  s_waitcnt lgkmcnt(5)
  v_mfma_f32_32x32x16_bf16 v[56:71], v[96:99], a[64:67], v[56:71]
  ds_read_b128 v[92:95], v1 offset:19456
  buffer_load_dwordx4 a[124:127], v1, s[4:7], s31 offen offset:3072 sc1
  s_waitcnt vmcnt(14)
  v_mfma_f32_32x32x16_bf16 v[24:39], v[100:103], a[68:71], v[24:39]
  ds_read_b128 v[96:99], v1 offset:53248
  s_waitcnt lgkmcnt(5)
  v_mfma_f32_32x32x16_bf16 v[40:55], v[104:107], a[68:71], v[40:55]
  ds_read_b128 v[100:103], v17 offset:21504
  buffer_load_dwordx4 v[4:7], v1, s[4:7], s86 offen offset:0 sc1
  v_mfma_f32_32x32x16_bf16 v[56:71], v[108:111], a[68:71], v[56:71]
  ds_read_b128 v[104:107], v1 offset:20480
  s_waitcnt vmcnt(19)
  s_waitcnt vmcnt(14) lgkmcnt(5)
  v_mfma_f32_32x32x16_bf16 v[24:39], v[112:115], a[72:75], v[24:39]
  ds_read_b128 v[108:111], v1 offset:54272
  buffer_load_dwordx4 v[8:11], v1, s[4:7], s86 offen offset:1024 sc1
  v_add_f32 v120, v120, v128
  v_add_f32 v121, v121, v129
  v_add_f32 v122, v122, v130
  v_add_f32 v123, v123, v131
  v_add_f32 v124, v124, v132
  v_add_f32 v125, v125, v133
  v_mfma_f32_32x32x16_bf16 v[40:55], v[116:119], a[72:75], v[40:55]
  ds_read_b128 v[112:115], v17 offset:22528
  v_add_f32 v126, v126, v134
  v_add_f32 v127, v127, v135
  v_add_f32 v120, v120, v124
  v_add_f32 v121, v121, v125
  v_add_f32 v122, v122, v126
  v_add_f32 v123, v123, v127
  v_and_b32 v124, 1, v0
  v_bfe_u32 v125, v0, 1, 1
  s_waitcnt lgkmcnt(5)
  v_mfma_f32_32x32x16_bf16 v[56:71], v[88:91], a[72:75], v[56:71]
  ds_read_b128 v[116:119], v1 offset:21504
  s_lshl_b32 s43, s26, 15
  s_lshl_b32 s44, s25, 11
  s_add_u32 s43, s43, s44
  s_add_u32 s43, s43, 0x1600000
  v_subrev_u32 v157, 0, v0
  v_min_u32 v157, 15, v157
  v_lshl_add_u32 v156, v157, 7, s43
  s_lshl_b32 s43, s26, 12
  s_lshl_b32 s44, s25, 8
  s_add_u32 s43, s43, s44
  s_add_u32 s43, s43, 0x80000
  v_subrev_u32 v157, 16, v0
  v_min_u32 v157, 1, v157
  v_lshl_add_u32 v157, v157, 7, s43
  v_cmp_le_u32 vcc, 16, v0
  s_nop 1
  v_cndmask_b32 v156, v156, v157, vcc
  buffer_load_dword v157, v156, s[4:7], 0 offen sc1
  s_waitcnt vmcnt(15)
  v_mfma_f32_32x32x16_bf16 v[24:39], v[92:95], a[76:79], v[24:39]
  ds_read_b128 v[88:91], v1 offset:55296
  s_waitcnt lgkmcnt(5)
  v_mfma_f32_32x32x16_bf16 v[40:55], v[96:99], a[76:79], v[40:55]
  ds_read_b128 v[92:95], v17 offset:23552
  buffer_load_dwordx4 v[176:179], v1, s[4:7], s70 offen offset:1024
  v_permlane32_swap_b32 v120, v121
  v_mfma_f32_32x32x16_bf16 v[56:71], v[100:103], a[76:79], v[56:71]
  ds_read_b128 v[96:99], v1 offset:22528
  v_permlane32_swap_b32 v122, v123
  v_lshl_or_b32 v124, v124, 1, v125
  v_and_b32 v125, 28, v0
  v_add_f32 v120, v120, v121
  v_add_f32 v122, v122, v123
  v_lshl_or_b32 v124, v124, 6, v125
  s_waitcnt vmcnt(15) lgkmcnt(5)
  v_mfma_f32_32x32x16_bf16 v[24:39], v[104:107], a[80:83], v[24:39]
  ds_read_b128 v[100:103], v1 offset:56320
  buffer_load_dwordx4 v[180:183], v1, s[4:7], s67 offen offset:1024
  v_permlane16_swap_b32 v120, v122
  v_add_f32 v120, v120, v122
  ds_bpermute_b32 v122, v124, v120
  ds_bpermute_b32 v121, v124, v120 offset:32
  v_mfma_f32_32x32x16_bf16 v[40:55], v[108:111], a[80:83], v[40:55]
  ds_read_b128 v[104:107], v17 offset:24576
  s_waitcnt lgkmcnt(7)
  v_mfma_f32_32x32x16_bf16 v[56:71], v[112:115], a[80:83], v[56:71]
  ds_read_b128 v[108:111], v1 offset:23552
  buffer_load_dwordx4 v[184:187], v1, s[4:7], s71 offen offset:1024
  s_waitcnt lgkmcnt(2)
  v_mul_f32 v136, 0x3b000000, v122
  v_mul_f32 v121, 0x3b000000, v121
  v_fma_f32 v121, -v136, v136, v121
  v_max_f32 v121, 0, v121
  v_add_f32 v121, 0x3727c5ac, v121
  s_waitcnt vmcnt(16)
  v_mfma_f32_32x32x16_bf16 v[24:39], v[116:119], a[84:87], v[24:39]
  ds_read_b128 v[112:115], v1 offset:57344
  v_rsq_f32 v137, v121
  v_cvt_pk_bf16_f32 v140, -v136, -v136
  v_cvt_pk_bf16_f32 v141, -v136, -v136
  v_cvt_pk_bf16_f32 v142, -v136, -v136
  v_cvt_pk_bf16_f32 v143, -v136, -v136
  v_mul_f32 v138, 0xbfb8aa3b, v137
  s_waitcnt lgkmcnt(7)
  v_mfma_f32_32x32x16_bf16 v[40:55], v[88:91], a[84:87], v[40:55]
  ds_read_b128 v[116:119], v17 offset:25600
  buffer_load_dwordx4 v[188:191], v1, s[4:7], s68 offen offset:1024
  v_rcp_f32 v139, v137
  s_nop 0
  v_mul_f32 v139, 0xbfb8aa3b, v139
  v_mfma_f32_32x32x16_bf16 v[56:71], v[92:95], a[84:87], v[56:71]
  ds_read_b128 v[88:91], v1 offset:24576
  s_waitcnt vmcnt(16) lgkmcnt(7)
  v_mfma_f32_32x32x16_bf16 v[24:39], v[96:99], a[88:91], v[24:39]
  ds_read_b128 v[92:95], v1 offset:58368
  buffer_load_dwordx4 v[192:195], v1, s[4:7], s72 offen offset:1024
  v_mfma_f32_32x32x16_bf16 v[40:55], v[100:103], a[88:91], v[40:55]
  ds_read_b128 v[96:99], v17 offset:26624
  s_waitcnt lgkmcnt(5)
  v_mfma_f32_32x32x16_bf16 v[56:71], v[104:107], a[88:91], v[56:71]
  ds_read_b128 v[100:103], v1 offset:25600
  buffer_load_dwordx4 v[196:199], v1, s[4:7], s69 offen offset:1024
  s_waitcnt vmcnt(17)
  v_mfma_f32_32x32x16_bf16 v[24:39], v[108:111], a[92:95], v[24:39]
  ds_read_b128 v[104:107], v1 offset:59392
  s_waitcnt lgkmcnt(5)
  v_mfma_f32_32x32x16_bf16 v[40:55], v[112:115], a[92:95], v[40:55]
  ds_read_b128 v[108:111], v17 offset:27648
  buffer_load_dwordx4 v[200:203], v1, s[4:7], s73 offen offset:1024
  v_mfma_f32_32x32x16_bf16 v[56:71], v[116:119], a[92:95], v[56:71]
  ds_read_b128 v[112:115], v1 offset:26624
  s_waitcnt vmcnt(17) lgkmcnt(5)
  v_mfma_f32_32x32x16_bf16 v[24:39], v[88:91], a[96:99], v[24:39]
  ds_read_b128 v[116:119], v1 offset:60416
  buffer_load_dwordx4 v[204:207], v1, s[4:7], s66 offen offset:2048
  v_mfma_f32_32x32x16_bf16 v[40:55], v[92:95], a[96:99], v[40:55]
  ds_read_b128 v[88:91], v17 offset:28672
  s_waitcnt lgkmcnt(5)
  v_mfma_f32_32x32x16_bf16 v[56:71], v[96:99], a[96:99], v[56:71]
  ds_read_b128 v[92:95], v1 offset:27648
  buffer_load_dwordx4 v[208:211], v1, s[4:7], s70 offen offset:2048
  s_waitcnt vmcnt(18)
  v_mfma_f32_32x32x16_bf16 v[24:39], v[100:103], a[100:103], v[24:39]
  ds_read_b128 v[96:99], v1 offset:61440
  s_waitcnt lgkmcnt(5)
  v_mfma_f32_32x32x16_bf16 v[40:55], v[104:107], a[100:103], v[40:55]
  ds_read_b128 v[100:103], v17 offset:29696
  buffer_load_dwordx4 v[212:215], v1, s[4:7], s67 offen offset:2048
  v_mfma_f32_32x32x16_bf16 v[56:71], v[108:111], a[100:103], v[56:71]
  ds_read_b128 v[104:107], v1 offset:28672
  s_waitcnt vmcnt(18) lgkmcnt(5)
  v_mfma_f32_32x32x16_bf16 v[24:39], v[112:115], a[104:107], v[24:39]
  ds_read_b128 v[108:111], v1 offset:62464
  buffer_load_dwordx4 v[216:219], v1, s[4:7], s71 offen offset:2048
  v_mfma_f32_32x32x16_bf16 v[40:55], v[116:119], a[104:107], v[40:55]
  ds_read_b128 v[112:115], v17 offset:30720
  s_waitcnt lgkmcnt(5)
  v_mfma_f32_32x32x16_bf16 v[56:71], v[88:91], a[104:107], v[56:71]
  ds_read_b128 v[116:119], v1 offset:29696
  buffer_load_dwordx4 v[220:223], v1, s[4:7], s68 offen offset:2048
  s_waitcnt vmcnt(19)
  v_mfma_f32_32x32x16_bf16 v[24:39], v[92:95], a[108:111], v[24:39]
  ds_read_b128 v[88:91], v1 offset:63488
  s_waitcnt lgkmcnt(5)
  v_mfma_f32_32x32x16_bf16 v[40:55], v[96:99], a[108:111], v[40:55]
  ds_read_b128 v[92:95], v17 offset:31744
  buffer_load_dwordx4 v[224:227], v1, s[4:7], s72 offen offset:2048
  v_mfma_f32_32x32x16_bf16 v[56:71], v[100:103], a[108:111], v[56:71]
  ds_read_b128 v[96:99], v1 offset:30720
  s_waitcnt vmcnt(19) lgkmcnt(5)
  v_mfma_f32_32x32x16_bf16 v[24:39], v[104:107], a[112:115], v[24:39]
  ds_read_b128 v[100:103], v1 offset:64512
  buffer_load_dwordx4 v[228:231], v1, s[4:7], s69 offen offset:2048
  v_mfma_f32_32x32x16_bf16 v[40:55], v[108:111], a[112:115], v[40:55]
  ds_read_b128 v[104:107], v17 offset:32768
  s_waitcnt lgkmcnt(5)
  v_mfma_f32_32x32x16_bf16 v[56:71], v[112:115], a[112:115], v[56:71]
  ds_read_b128 v[108:111], v1 offset:31744
  buffer_load_dwordx4 v[232:235], v1, s[4:7], s73 offen offset:2048
  s_waitcnt vmcnt(20)
  v_mfma_f32_32x32x16_bf16 v[24:39], v[116:119], a[116:119], v[24:39]
  ds_read_b128 v[112:115], v17 offset:0
  s_waitcnt lgkmcnt(5)
  v_mfma_f32_32x32x16_bf16 v[40:55], v[88:91], a[116:119], v[40:55]
  ds_read_b128 v[116:119], v17 offset:33792
  buffer_load_dwordx4 v[236:239], v1, s[4:7], s66 offen offset:3072
  s_add_u32 s66, s66, 4096
  v_mfma_f32_32x32x16_bf16 v[56:71], v[92:95], a[116:119], v[56:71]
  ds_read_b128 v[88:91], v1 offset:32768
  s_waitcnt vmcnt(20) lgkmcnt(5)
  v_mfma_f32_32x32x16_bf16 v[24:39], v[96:99], a[120:123], v[24:39]
  ds_read_b128 v[92:95], v17 offset:1024
  buffer_load_dwordx4 v[240:243], v1, s[4:7], s70 offen offset:3072
  s_add_u32 s70, s70, 4096
  v_mfma_f32_32x32x16_bf16 v[40:55], v[100:103], a[120:123], v[40:55]
  ds_read_b128 v[96:99], v17 offset:34816
  s_waitcnt lgkmcnt(5)
  v_mfma_f32_32x32x16_bf16 v[56:71], v[104:107], a[120:123], v[56:71]
  ds_read_b128 v[100:103], v17 offset:35840
  buffer_load_dwordx4 v[244:247], v1, s[4:7], s67 offen offset:3072
  s_add_u32 s67, s67, 4096
  s_waitcnt vmcnt(21)
  v_mfma_f32_32x32x16_bf16 v[24:39], v[108:111], a[124:127], v[24:39]
  ds_read_b128 v[104:107], v17 offset:36864
  s_waitcnt lgkmcnt(5)
  v_mfma_f32_32x32x16_bf16 v[40:55], v[112:115], a[124:127], v[40:55]
  ds_read_b128 v[108:111], v17 offset:37888
  buffer_load_dwordx4 v[248:251], v1, s[4:7], s71 offen offset:3072
  s_add_u32 s71, s71, 4096
  v_mfma_f32_32x32x16_bf16 v[56:71], v[116:119], a[124:127], v[56:71]
  ds_read_b128 v[112:115], v17 offset:38912
  s_waitcnt lgkmcnt(5)
  v_mfma_f32_32x32x16_bf16 v[24:39], v[88:91], v[140:143], v[24:39]
  ds_read_b128 v[116:119], v17 offset:39936
  buffer_load_dwordx4 v[252:255], v1, s[4:7], s68 offen offset:3072
  s_add_u32 s68, s68, 4096
  v_mfma_f32_32x32x16_bf16 v[40:55], v[92:95], v[140:143], v[40:55]
  ds_read_b128 v[88:91], v17 offset:40960
  s_waitcnt lgkmcnt(5)
  v_mfma_f32_32x32x16_bf16 v[56:71], v[96:99], v[140:143], v[56:71]
  s_barrier
  ds_read_b128 v[92:95], v17 offset:41984
  ds_write_b128 v158, a[128:131] offset:0
  v_mfma_f32_32x32x16_bf16 v[72:87], v[100:103], a[0:3], 0
  ds_read_b128 v[96:99], v17 offset:43008
  v_mul_f32 v24, v138, v24
  v_mul_f32 v25, v138, v25
  v_mul_f32 v26, v138, v26
  v_mul_f32 v27, v138, v27
  v_mul_f32 v28, v138, v28
  v_mul_f32 v29, v138, v29
  v_mul_f32 v30, v138, v30
  v_mul_f32 v31, v138, v31
  s_waitcnt lgkmcnt(6)
  v_mfma_f32_32x32x16_bf16 v[72:87], v[104:107], a[4:7], v[72:87]
  ds_read_b128 v[100:103], v17 offset:44032
  v_exp_f32 v144, v24
  v_mul_f32 v32, v24, v32
  v_exp_f32 v145, v25
  v_mul_f32 v33, v25, v33
  v_mfma_f32_32x32x16_bf16 v[72:87], v[108:111], a[8:11], v[72:87]
  ds_read_b128 v[104:107], v17 offset:45056
  ds_write_b128 v158, a[132:135] offset:1024
  s_waitcnt lgkmcnt(7)
  v_mfma_f32_32x32x16_bf16 v[72:87], v[112:115], a[12:15], v[72:87]
  ds_read_b128 v[108:111], v17 offset:46080
  v_exp_f32 v146, v26
  v_mul_f32 v34, v26, v34
  v_exp_f32 v147, v27
  v_mul_f32 v35, v27, v35
  v_mfma_f32_32x32x16_bf16 v[72:87], v[116:119], a[16:19], v[72:87]
  ds_read_b128 v[112:115], v17 offset:47104
  v_exp_f32 v148, v28
  v_mul_f32 v36, v28, v36
  v_exp_f32 v149, v29
  v_mul_f32 v37, v29, v37
  v_exp_f32 v150, v30
  s_waitcnt lgkmcnt(7)
  v_mfma_f32_32x32x16_bf16 v[72:87], v[88:91], a[20:23], v[72:87]
  ds_read_b128 v[116:119], v17 offset:48128
  ds_write_b128 v158, a[136:139] offset:2048
  v_mfma_f32_32x32x16_bf16 v[72:87], v[92:95], a[24:27], v[72:87]
  ds_read_b128 v[88:91], v17 offset:49152
  v_mul_f32 v38, v30, v38
  v_exp_f32 v151, v31
  v_mul_f32 v39, v31, v39
  v_fma_f32 v144, v144, v139, v139
  v_fma_f32 v145, v145, v139, v139
  v_fma_f32 v146, v146, v139, v139
  v_fma_f32 v147, v147, v139, v139
  s_waitcnt lgkmcnt(7)
  v_mfma_f32_32x32x16_bf16 v[72:87], v[96:99], a[28:31], v[72:87]
  ds_read_b128 v[92:95], v17 offset:50176
  v_fma_f32 v148, v148, v139, v139
  v_fma_f32 v149, v149, v139, v139
  v_fma_f32 v150, v150, v139, v139
  v_fma_f32 v151, v151, v139, v139
  v_rcp_f32 v144, v144
  v_mfma_f32_32x32x16_bf16 v[72:87], v[100:103], a[32:35], v[72:87]
  ds_read_b128 v[96:99], v17 offset:51200
  ds_write_b128 v158, a[140:143] offset:3072
  s_waitcnt lgkmcnt(7)
  v_mfma_f32_32x32x16_bf16 v[72:87], v[104:107], a[36:39], v[72:87]
  ds_read_b128 v[100:103], v17 offset:52224
  v_rcp_f32 v145, v145
  v_rcp_f32 v146, v146
  v_rcp_f32 v147, v147
  v_mfma_f32_32x32x16_bf16 v[72:87], v[108:111], a[40:43], v[72:87]
  ds_read_b128 v[104:107], v17 offset:53248
  v_rcp_f32 v148, v148
  v_rcp_f32 v149, v149
  v_rcp_f32 v150, v150
  v_rcp_f32 v151, v151
  s_waitcnt lgkmcnt(7)
  v_mfma_f32_32x32x16_bf16 v[72:87], v[112:115], a[44:47], v[72:87]
  ds_read_b128 v[108:111], v17 offset:54272
  ds_write_b128 v158, a[144:147] offset:4096
  v_mfma_f32_32x32x16_bf16 v[72:87], v[116:119], a[48:51], v[72:87]
  ds_read_b128 v[112:115], v17 offset:55296
  v_mul_f32 v32, v32, v144
  v_mul_f32 v33, v33, v145
  v_mul_f32 v34, v34, v146
  v_mul_f32 v35, v35, v147
  v_mul_f32 v36, v36, v148
  v_mul_f32 v37, v37, v149
  v_mul_f32 v38, v38, v150
  v_mul_f32 v39, v39, v151
  s_waitcnt lgkmcnt(7)
  v_mfma_f32_32x32x16_bf16 v[72:87], v[88:91], a[52:55], v[72:87]
  ds_read_b128 v[116:119], v17 offset:56320
  v_cvt_pk_bf16_f32 v152, v32, v33
  v_cvt_pk_bf16_f32 v153, v34, v35
  v_cvt_pk_bf16_f32 v154, v36, v37
  v_cvt_pk_bf16_f32 v155, v38, v39
  buffer_store_dwordx4 v[152:155], v1, s[4:7], s34 offen offset:0 sc1
  v_mul_f32 v40, v138, v40
  v_mul_f32 v41, v138, v41
  v_mfma_f32_32x32x16_bf16 v[72:87], v[92:95], a[56:59], v[72:87]
  ds_read_b128 v[88:91], v17 offset:57344
  ds_write_b128 v158, a[148:151] offset:5120
  v_mul_f32 v42, v138, v42
  s_waitcnt lgkmcnt(7)
  v_mfma_f32_32x32x16_bf16 v[72:87], v[96:99], a[60:63], v[72:87]
  ds_read_b128 v[92:95], v17 offset:58368
  v_mul_f32 v43, v138, v43
  v_mul_f32 v44, v138, v44
  v_mul_f32 v45, v138, v45
  v_mul_f32 v46, v138, v46
  v_mul_f32 v47, v138, v47
  v_exp_f32 v144, v40
  v_mfma_f32_32x32x16_bf16 v[72:87], v[100:103], a[64:67], v[72:87]
  ds_read_b128 v[96:99], v17 offset:59392
  v_mul_f32 v48, v40, v48
  v_exp_f32 v145, v41
  v_mul_f32 v49, v41, v49
  v_exp_f32 v146, v42
  v_mul_f32 v50, v42, v50
  s_waitcnt lgkmcnt(7)
  v_mfma_f32_32x32x16_bf16 v[72:87], v[104:107], a[68:71], v[72:87]
  ds_read_b128 v[100:103], v17 offset:60416
  ds_write_b128 v158, a[152:155] offset:6144
  v_mfma_f32_32x32x16_bf16 v[72:87], v[108:111], a[72:75], v[72:87]
  ds_read_b128 v[104:107], v17 offset:61440
  v_exp_f32 v147, v43
  v_mul_f32 v51, v43, v51
  v_exp_f32 v148, v44
  v_mul_f32 v52, v44, v52
  v_exp_f32 v149, v45
  s_waitcnt lgkmcnt(7)
  v_mfma_f32_32x32x16_bf16 v[72:87], v[112:115], a[76:79], v[72:87]
  ds_read_b128 v[108:111], v17 offset:62464
  v_mul_f32 v53, v45, v53
  v_exp_f32 v150, v46
  v_mul_f32 v54, v46, v54
  v_exp_f32 v151, v47
  v_mul_f32 v55, v47, v55
  v_mfma_f32_32x32x16_bf16 v[72:87], v[116:119], a[80:83], v[72:87]
  ds_read_b128 v[112:115], v17 offset:63488
  ds_write_b128 v158, a[156:159] offset:7168
  v_fma_f32 v144, v144, v139, v139
  s_waitcnt lgkmcnt(7)
  v_mfma_f32_32x32x16_bf16 v[72:87], v[88:91], a[84:87], v[72:87]
  ds_read_b128 v[116:119], v17 offset:64512
  v_fma_f32 v145, v145, v139, v139
  v_fma_f32 v146, v146, v139, v139
  v_fma_f32 v147, v147, v139, v139
  v_fma_f32 v148, v148, v139, v139
  v_fma_f32 v149, v149, v139, v139
  v_fma_f32 v150, v150, v139, v139
  v_fma_f32 v151, v151, v139, v139
  v_mfma_f32_32x32x16_bf16 v[72:87], v[92:95], a[88:91], v[72:87]
  ds_read_b128 v[88:91], v18 offset:0
  v_rcp_f32 v144, v144
  v_rcp_f32 v145, v145
  v_rcp_f32 v146, v146
  v_rcp_f32 v147, v147
  s_waitcnt lgkmcnt(7)
  v_mfma_f32_32x32x16_bf16 v[72:87], v[96:99], a[92:95], v[72:87]
  ds_read_b128 v[92:95], v18 offset:1024
  ds_write_b128 v158, a[160:163] offset:8192
  v_mfma_f32_32x32x16_bf16 v[72:87], v[100:103], a[96:99], v[72:87]
  ds_read_b128 v[96:99], v18 offset:2048
  v_rcp_f32 v148, v148
  v_rcp_f32 v149, v149
  v_rcp_f32 v150, v150
  v_rcp_f32 v151, v151
  s_waitcnt lgkmcnt(7)
  v_mfma_f32_32x32x16_bf16 v[72:87], v[104:107], a[100:103], v[72:87]
  ds_read_b128 v[100:103], v18 offset:3072
  v_mul_f32 v48, v48, v144
  v_mul_f32 v49, v49, v145
  v_mul_f32 v50, v50, v146
  v_mul_f32 v51, v51, v147
  v_mul_f32 v52, v52, v148
  v_mul_f32 v53, v53, v149
  v_mul_f32 v54, v54, v150
  v_mfma_f32_32x32x16_bf16 v[72:87], v[108:111], a[104:107], v[72:87]
  s_waitcnt lgkmcnt(2)
  s_barrier
  ds_read_b128 v[104:107], v1 offset:0
  ds_write_b128 v158, a[164:167] offset:33792
  v_mul_f32 v55, v55, v151
  s_waitcnt lgkmcnt(7)
  v_mfma_f32_32x32x16_bf16 v[72:87], v[112:115], a[108:111], v[72:87]
  ds_read_b128 v[108:111], v1 offset:1024
  v_cvt_pk_bf16_f32 v152, v48, v49
  v_cvt_pk_bf16_f32 v153, v50, v51
  v_cvt_pk_bf16_f32 v154, v52, v53
  v_cvt_pk_bf16_f32 v155, v54, v55
  buffer_store_dwordx4 v[152:155], v1, s[4:7], s34 offen offset:1024 sc1
  v_mul_f32 v56, v138, v56
  v_mul_f32 v57, v138, v57
  v_mfma_f32_32x32x16_bf16 v[72:87], v[116:119], a[112:115], v[72:87]
  ds_read_b128 v[112:115], v1 offset:2048
  v_mul_f32 v58, v138, v58
  v_mul_f32 v59, v138, v59
  v_mul_f32 v60, v138, v60
  v_mul_f32 v61, v138, v61
  v_mul_f32 v62, v138, v62
  v_mul_f32 v63, v138, v63
  v_exp_f32 v144, v56
  s_waitcnt lgkmcnt(7)
  v_mfma_f32_32x32x16_bf16 v[72:87], v[88:91], a[116:119], v[72:87]
  ds_read_b128 v[116:119], v1 offset:3072
  ds_write_b128 v158, a[168:171] offset:34816
  v_mfma_f32_32x32x16_bf16 v[72:87], v[92:95], a[120:123], v[72:87]
  ds_read_b128 v[88:91], v1 offset:4096
  v_mul_f32 v64, v56, v64
  v_exp_f32 v145, v57
  v_mul_f32 v65, v57, v65
  v_exp_f32 v146, v58
  v_mul_f32 v66, v58, v66
  s_waitcnt lgkmcnt(7)
  v_mfma_f32_32x32x16_bf16 v[72:87], v[96:99], a[124:127], v[72:87]
  ds_read_b128 v[92:95], v1 offset:5120
  v_exp_f32 v147, v59
  v_mul_f32 v67, v59, v67
  v_exp_f32 v148, v60
  v_mul_f32 v68, v60, v68
  v_mfma_f32_32x32x16_bf16 v[72:87], v[100:103], v[140:143], v[72:87]
  ds_read_b128 v[96:99], v1 offset:6144
  buffer_load_dwordx4 a[128:131], v1, s[4:7], s72 offen offset:3072
  s_add_u32 s72, s72, 4096
  v_exp_f32 v149, v61
  v_mul_f32 v69, v61, v69
  v_exp_f32 v150, v62
  v_mul_f32 v70, v62, v70
  s_waitcnt lgkmcnt(6)
  v_mfma_f32_32x32x16_bf16 v[24:39], v[104:107], a[0:3], 0
  ds_read_b128 v[100:103], v1 offset:7168
  ds_write_b128 v158, a[172:175] offset:35840
  v_mfma_f32_32x32x16_bf16 v[24:39], v[108:111], a[4:7], v[24:39]
  ds_read_b128 v[104:107], v1 offset:8192
  buffer_load_dwordx4 a[132:135], v1, s[4:7], s69 offen offset:3072
  s_add_u32 s69, s69, 4096
  v_exp_f32 v151, v63
  v_mul_f32 v71, v63, v71
  v_fma_f32 v144, v144, v139, v139
  v_fma_f32 v145, v145, v139, v139
  v_fma_f32 v146, v146, v139, v139
  s_waitcnt lgkmcnt(7)
  v_mfma_f32_32x32x16_bf16 v[24:39], v[112:115], a[8:11], v[24:39]
  ds_read_b128 v[108:111], v1 offset:9216
  v_fma_f32 v147, v147, v139, v139
  v_fma_f32 v148, v148, v139, v139
  v_fma_f32 v149, v149, v139, v139
  v_fma_f32 v150, v150, v139, v139
  v_fma_f32 v151, v151, v139, v139
  v_rcp_f32 v144, v144
  v_mfma_f32_32x32x16_bf16 v[24:39], v[116:119], a[12:15], v[24:39]
  ds_read_b128 v[112:115], v1 offset:10240
  buffer_load_dwordx4 a[136:139], v1, s[4:7], s73 offen offset:3072
  s_add_u32 s73, s73, 4096
  v_rcp_f32 v145, v145
  v_rcp_f32 v146, v146
  v_rcp_f32 v147, v147
  s_waitcnt lgkmcnt(6)
  v_mfma_f32_32x32x16_bf16 v[24:39], v[88:91], a[16:19], v[24:39]
  ds_read_b128 v[116:119], v1 offset:11264
  ds_write_b128 v158, a[176:179] offset:36864
  v_mfma_f32_32x32x16_bf16 v[24:39], v[92:95], a[20:23], v[24:39]
  ds_read_b128 v[88:91], v1 offset:12288
  buffer_load_dwordx4 a[140:143], v1, s[4:7], s66 offen offset:0
  v_rcp_f32 v148, v148
  v_rcp_f32 v149, v149
  v_rcp_f32 v150, v150
  s_waitcnt lgkmcnt(7)
  v_mfma_f32_32x32x16_bf16 v[24:39], v[96:99], a[24:27], v[24:39]
  ds_read_b128 v[92:95], v1 offset:13312
  v_rcp_f32 v151, v151
  v_mul_f32 v64, v64, v144
  v_mul_f32 v65, v65, v145
  v_mul_f32 v66, v66, v146
  v_mul_f32 v67, v67, v147
  v_mul_f32 v68, v68, v148
  v_mfma_f32_32x32x16_bf16 v[24:39], v[100:103], a[28:31], v[24:39]
  ds_read_b128 v[96:99], v1 offset:14336
  buffer_load_dwordx4 a[144:147], v1, s[4:7], s70 offen offset:0
  v_mul_f32 v69, v69, v149
  v_mul_f32 v70, v70, v150
  v_mul_f32 v71, v71, v151
  v_cvt_pk_bf16_f32 v152, v64, v65
  v_cvt_pk_bf16_f32 v153, v66, v67
  v_cvt_pk_bf16_f32 v154, v68, v69
  v_cvt_pk_bf16_f32 v155, v70, v71
  s_waitcnt lgkmcnt(6)
  v_mfma_f32_32x32x16_bf16 v[24:39], v[104:107], a[32:35], v[24:39]
  ds_read_b128 v[100:103], v1 offset:15360
  ds_write_b128 v158, a[180:183] offset:37888
  v_mfma_f32_32x32x16_bf16 v[24:39], v[108:111], a[36:39], v[24:39]
  ds_read_b128 v[104:107], v1 offset:16384
  buffer_load_dwordx4 a[148:151], v1, s[4:7], s67 offen offset:0
  buffer_store_dwordx4 v[152:155], v1, s[4:7], s34 offen offset:2048 sc1
  v_mul_f32 v72, v138, v72
  v_mul_f32 v73, v138, v73
  v_mul_f32 v74, v138, v74
  v_mul_f32 v75, v138, v75
  v_mul_f32 v76, v138, v76
  v_mul_f32 v77, v138, v77
  s_waitcnt lgkmcnt(7)
  v_mfma_f32_32x32x16_bf16 v[24:39], v[112:115], a[40:43], v[24:39]
  ds_read_b128 v[108:111], v1 offset:17408
  v_mul_f32 v78, v138, v78
  v_mul_f32 v79, v138, v79
  v_exp_f32 v144, v72
  v_mul_f32 v80, v72, v80
  v_exp_f32 v145, v73
  v_mfma_f32_32x32x16_bf16 v[24:39], v[116:119], a[44:47], v[24:39]
  ds_read_b128 v[112:115], v1 offset:18432
  buffer_load_dwordx4 a[152:155], v1, s[4:7], s71 offen offset:0
  v_mul_f32 v81, v73, v81
  v_exp_f32 v146, v74
  v_mul_f32 v82, v74, v82
  v_exp_f32 v147, v75
  v_mul_f32 v83, v75, v83
  s_waitcnt lgkmcnt(6)
  v_mfma_f32_32x32x16_bf16 v[24:39], v[88:91], a[48:51], v[24:39]
  ds_read_b128 v[116:119], v1 offset:19456
  ds_write_b128 v158, a[184:187] offset:38912
  v_mfma_f32_32x32x16_bf16 v[24:39], v[92:95], a[52:55], v[24:39]
  ds_read_b128 v[88:91], v1 offset:20480
  buffer_load_dwordx4 a[156:159], v1, s[4:7], s68 offen offset:0
  v_exp_f32 v148, v76
  v_mul_f32 v84, v76, v84
  v_exp_f32 v149, v77
  v_mul_f32 v85, v77, v85
  s_waitcnt lgkmcnt(7)
  v_mfma_f32_32x32x16_bf16 v[24:39], v[96:99], a[56:59], v[24:39]
  ds_read_b128 v[92:95], v1 offset:21504
  v_exp_f32 v150, v78
  v_mul_f32 v86, v78, v86
  v_exp_f32 v151, v79
  v_mul_f32 v87, v79, v87
  v_fma_f32 v144, v144, v139, v139
  v_mfma_f32_32x32x16_bf16 v[24:39], v[100:103], a[60:63], v[24:39]
  ds_read_b128 v[96:99], v1 offset:22528
  buffer_load_dwordx4 a[160:163], v1, s[4:7], s72 offen offset:0
  v_fma_f32 v145, v145, v139, v139
  v_fma_f32 v146, v146, v139, v139
  v_fma_f32 v147, v147, v139, v139
  v_fma_f32 v148, v148, v139, v139
  v_fma_f32 v149, v149, v139, v139
  v_fma_f32 v150, v150, v139, v139
  v_fma_f32 v151, v151, v139, v139
  s_waitcnt lgkmcnt(6)
  v_mfma_f32_32x32x16_bf16 v[24:39], v[104:107], a[64:67], v[24:39]
  ds_read_b128 v[100:103], v1 offset:23552
  ds_write_b128 v158, a[188:191] offset:39936
  v_mfma_f32_32x32x16_bf16 v[24:39], v[108:111], a[68:71], v[24:39]
  ds_read_b128 v[104:107], v1 offset:24576
  v_rcp_f32 v144, v144
  v_rcp_f32 v145, v145
  v_rcp_f32 v146, v146
  v_rcp_f32 v147, v147
  s_waitcnt lgkmcnt(7)
  v_mfma_f32_32x32x16_bf16 v[24:39], v[112:115], a[72:75], v[24:39]
  ds_read_b128 v[108:111], v1 offset:25600
  v_rcp_f32 v148, v148
  v_rcp_f32 v149, v149
  v_rcp_f32 v150, v150
  v_mfma_f32_32x32x16_bf16 v[24:39], v[116:119], a[76:79], v[24:39]
  ds_read_b128 v[112:115], v1 offset:26624
  ds_write_b128 v158, a[192:195] offset:40960
  s_waitcnt lgkmcnt(7)
  v_mfma_f32_32x32x16_bf16 v[24:39], v[88:91], a[80:83], v[24:39]
  ds_read_b128 v[116:119], v1 offset:27648
  v_rcp_f32 v151, v151
  v_mul_f32 v80, v80, v144
  v_mul_f32 v81, v81, v145
  v_mul_f32 v82, v82, v146
  v_mul_f32 v83, v83, v147
  v_mul_f32 v84, v84, v148
  v_mfma_f32_32x32x16_bf16 v[24:39], v[92:95], a[84:87], v[24:39]
  ds_read_b128 v[88:91], v1 offset:28672
  v_mul_f32 v85, v85, v149
  v_mul_f32 v86, v86, v150
  v_mul_f32 v87, v87, v151
  v_cvt_pk_bf16_f32 v152, v80, v81
  v_cvt_pk_bf16_f32 v153, v82, v83
  v_cvt_pk_bf16_f32 v154, v84, v85
  v_cvt_pk_bf16_f32 v155, v86, v87
  buffer_store_dwordx4 v[152:155], v1, s[4:7], s34 offen offset:3072 sc1
  s_waitcnt lgkmcnt(7)
  v_mfma_f32_32x32x16_bf16 v[24:39], v[96:99], a[88:91], v[24:39]
  ds_read_b128 v[92:95], v1 offset:29696
  ds_write_b128 v158, a[196:199] offset:41984
  v_mfma_f32_32x32x16_bf16 v[24:39], v[100:103], a[92:95], v[24:39]
  ds_read_b128 v[96:99], v1 offset:30720
  s_waitcnt lgkmcnt(7)
  v_mfma_f32_32x32x16_bf16 v[24:39], v[104:107], a[96:99], v[24:39]
  ds_read_b128 v[100:103], v1 offset:31744
  v_mfma_f32_32x32x16_bf16 v[24:39], v[108:111], a[100:103], v[24:39]
  ds_read_b128 v[104:107], v1 offset:32768
  ds_write_b128 v159, a[200:203] offset:2048
  s_waitcnt lgkmcnt(7)
  v_mfma_f32_32x32x16_bf16 v[24:39], v[112:115], a[104:107], v[24:39]
  s_waitcnt lgkmcnt(4)
  s_barrier
  ds_read_b128 v[108:111], v1 offset:33792
  v_mfma_f32_32x32x16_bf16 v[24:39], v[116:119], a[108:111], v[24:39]
  ds_read_b128 v[112:115], v1 offset:34816
  s_waitcnt lgkmcnt(7)
  v_mfma_f32_32x32x16_bf16 v[24:39], v[88:91], a[112:115], v[24:39]
  ds_read_b128 v[116:119], v1 offset:35840
  ds_write_b128 v159, a[204:207] offset:3072
  v_mfma_f32_32x32x16_bf16 v[24:39], v[92:95], a[116:119], v[24:39]
  ds_read_b128 v[88:91], v1 offset:36864
  s_waitcnt lgkmcnt(7)
  v_mfma_f32_32x32x16_bf16 v[24:39], v[96:99], a[120:123], v[24:39]
  ds_read_b128 v[92:95], v1 offset:37888
  v_mfma_f32_32x32x16_bf16 v[24:39], v[100:103], a[124:127], v[24:39]
  ds_read_b128 v[96:99], v1 offset:38912
  buffer_load_dwordx4 a[164:167], v1, s[4:7], s69 offen offset:0
  s_waitcnt lgkmcnt(6)
  v_mfma_f32_32x32x16_bf16 v[24:39], v[104:107], v[140:143], v[24:39]
  ds_read_b128 v[100:103], v1 offset:39936
  ds_write_b128 v159, a[208:211] offset:4096
  v_mfma_f32_32x32x16_bf16 v[40:55], v[108:111], a[0:3], 0
  ds_read_b128 v[104:107], v1 offset:40960
  buffer_load_dwordx4 a[168:171], v1, s[4:7], s73 offen offset:0
  s_waitcnt lgkmcnt(7)
  v_mfma_f32_32x32x16_bf16 v[40:55], v[112:115], a[4:7], v[40:55]
  ds_read_b128 v[108:111], v1 offset:41984
  v_mfma_f32_32x32x16_bf16 v[40:55], v[116:119], a[8:11], v[40:55]
  ds_read_b128 v[112:115], v1 offset:43008
  buffer_load_dwordx4 a[172:175], v1, s[4:7], s66 offen offset:1024
  s_nop 0
  v_mul_f32 v24, v138, v24
  v_mul_f32 v25, v138, v25
  v_mul_f32 v26, v138, v26
  v_mul_f32 v27, v138, v27
  v_mul_f32 v28, v138, v28
  v_mul_f32 v29, v138, v29
  v_mul_f32 v30, v138, v30
  s_waitcnt lgkmcnt(6)
  v_mfma_f32_32x32x16_bf16 v[40:55], v[88:91], a[12:15], v[40:55]
  ds_read_b128 v[116:119], v1 offset:44032
  ds_write_b128 v159, a[212:215] offset:5120
  v_mfma_f32_32x32x16_bf16 v[40:55], v[92:95], a[16:19], v[40:55]
  ds_read_b128 v[88:91], v1 offset:45056
  buffer_load_dwordx4 a[176:179], v1, s[4:7], s70 offen offset:1024
  v_mul_f32 v31, v138, v31
  v_exp_f32 v144, v24
  v_mul_f32 v32, v24, v32
  v_exp_f32 v145, v25
  v_mul_f32 v33, v25, v33
  s_waitcnt lgkmcnt(7)
  v_mfma_f32_32x32x16_bf16 v[40:55], v[96:99], a[20:23], v[40:55]
  ds_read_b128 v[92:95], v1 offset:46080
  v_exp_f32 v146, v26
  v_mul_f32 v34, v26, v34
  v_exp_f32 v147, v27
  v_mul_f32 v35, v27, v35
  v_mfma_f32_32x32x16_bf16 v[40:55], v[100:103], a[24:27], v[40:55]
  ds_read_b128 v[96:99], v1 offset:47104
  buffer_load_dwordx4 a[180:183], v1, s[4:7], s67 offen offset:1024
  v_exp_f32 v148, v28
  v_mul_f32 v36, v28, v36
  v_exp_f32 v149, v29
  v_mul_f32 v37, v29, v37
  s_waitcnt lgkmcnt(6)
  v_mfma_f32_32x32x16_bf16 v[40:55], v[104:107], a[28:31], v[40:55]
  ds_read_b128 v[100:103], v1 offset:48128
  ds_write_b128 v159, a[216:219] offset:6144
  v_mfma_f32_32x32x16_bf16 v[40:55], v[108:111], a[32:35], v[40:55]
  ds_read_b128 v[104:107], v1 offset:49152
  buffer_load_dwordx4 a[184:187], v1, s[4:7], s71 offen offset:1024
  v_exp_f32 v150, v30
  v_mul_f32 v38, v30, v38
  v_exp_f32 v151, v31
  v_mul_f32 v39, v31, v39
  v_fma_f32 v144, v144, v139, v139
  s_waitcnt lgkmcnt(7)
  v_mfma_f32_32x32x16_bf16 v[40:55], v[112:115], a[36:39], v[40:55]
  ds_read_b128 v[108:111], v1 offset:50176
  v_fma_f32 v145, v145, v139, v139
  v_fma_f32 v146, v146, v139, v139
  v_fma_f32 v147, v147, v139, v139
  v_fma_f32 v148, v148, v139, v139
  v_fma_f32 v149, v149, v139, v139
  v_fma_f32 v150, v150, v139, v139
  v_fma_f32 v151, v151, v139, v139
  v_mfma_f32_32x32x16_bf16 v[40:55], v[116:119], a[40:43], v[40:55]
  ds_read_b128 v[112:115], v1 offset:51200
  buffer_load_dwordx4 a[188:191], v1, s[4:7], s68 offen offset:1024
  v_rcp_f32 v144, v144
  v_rcp_f32 v145, v145
  v_rcp_f32 v146, v146
  s_waitcnt lgkmcnt(6)
  v_mfma_f32_32x32x16_bf16 v[40:55], v[88:91], a[44:47], v[40:55]
  ds_read_b128 v[116:119], v1 offset:52224
  ds_write_b128 v159, a[220:223] offset:7168
  v_mfma_f32_32x32x16_bf16 v[40:55], v[92:95], a[48:51], v[40:55]
  ds_read_b128 v[88:91], v1 offset:53248
  buffer_load_dwordx4 a[192:195], v1, s[4:7], s72 offen offset:1024
  v_rcp_f32 v147, v147
  v_rcp_f32 v148, v148
  v_rcp_f32 v149, v149
  s_waitcnt lgkmcnt(7)
  v_mfma_f32_32x32x16_bf16 v[40:55], v[96:99], a[52:55], v[40:55]
  s_waitcnt vmcnt(8)
  s_barrier
  v_mov_b32 v22, 4
  s_cmp_lg_u32 s16, 0
  s_cbranch_scc1 L_sig_27
  s_mov_b64 exec, 1
  s_cmp_eq_u32 s79, 0
  s_cbranch_scc1 L_far_28
  buffer_store_dword v22, off, s[4:7], s77
  s_mov_b64 exec, -1
L_sig_27:
  ds_read_b128 v[92:95], v1 offset:54272
  v_rcp_f32 v150, v150
  v_rcp_f32 v151, v151
  v_mul_f32 v32, v32, v144
  v_mul_f32 v33, v33, v145
  v_mul_f32 v34, v34, v146
  v_mfma_f32_32x32x16_bf16 v[40:55], v[100:103], a[56:59], v[40:55]
  ds_read_b128 v[96:99], v1 offset:55296
  buffer_load_dwordx4 a[196:199], v1, s[4:7], s69 offen offset:1024
  v_mul_f32 v35, v35, v147
  v_mul_f32 v36, v36, v148
  v_mul_f32 v37, v37, v149
  v_mul_f32 v38, v38, v150
  v_mul_f32 v39, v39, v151
  v_cvt_pk_bf16_f32 v152, v32, v33
  v_cvt_pk_bf16_f32 v153, v34, v35
  s_waitcnt lgkmcnt(6)
  v_mfma_f32_32x32x16_bf16 v[40:55], v[104:107], a[60:63], v[40:55]
  ds_read_b128 v[100:103], v1 offset:56320
  ds_write_b128 v159, a[224:227] offset:8192
  v_mfma_f32_32x32x16_bf16 v[40:55], v[108:111], a[64:67], v[40:55]
  ds_read_b128 v[104:107], v1 offset:57344
  v_cvt_pk_bf16_f32 v154, v36, v37
  v_cvt_pk_bf16_f32 v155, v38, v39
  s_add_u32 s34, s34, 4096
  buffer_store_dwordx4 v[152:155], v1, s[4:7], s34 offen offset:0 sc1
  s_waitcnt lgkmcnt(7)
  v_mfma_f32_32x32x16_bf16 v[40:55], v[112:115], a[68:71], v[40:55]
  ds_read_b128 v[108:111], v1 offset:58368
  v_mfma_f32_32x32x16_bf16 v[40:55], v[116:119], a[72:75], v[40:55]
  ds_read_b128 v[112:115], v1 offset:59392
  ds_write_b128 v159, a[228:231] offset:9216
  s_waitcnt lgkmcnt(7)
  v_mfma_f32_32x32x16_bf16 v[40:55], v[88:91], a[76:79], v[40:55]
  ds_read_b128 v[116:119], v1 offset:60416
  v_mfma_f32_32x32x16_bf16 v[40:55], v[92:95], a[80:83], v[40:55]
  ds_read_b128 v[88:91], v1 offset:61440
  s_waitcnt lgkmcnt(7)
  v_mfma_f32_32x32x16_bf16 v[40:55], v[96:99], a[84:87], v[40:55]
  ds_read_b128 v[92:95], v1 offset:62464
  ds_write_b128 v159, a[232:235] offset:10240
  v_mfma_f32_32x32x16_bf16 v[40:55], v[100:103], a[88:91], v[40:55]
  ds_read_b128 v[96:99], v1 offset:63488
  s_waitcnt lgkmcnt(7)
  v_mfma_f32_32x32x16_bf16 v[40:55], v[104:107], a[92:95], v[40:55]
  ds_read_b128 v[100:103], v1 offset:64512
  v_mfma_f32_32x32x16_bf16 v[40:55], v[108:111], a[96:99], v[40:55]
  ds_read_b128 v[104:107], v17 offset:0
  s_waitcnt lgkmcnt(6)
  v_mfma_f32_32x32x16_bf16 v[40:55], v[112:115], a[100:103], v[40:55]
  buffer_load_dword v23, v13, s[4:7], 0 offen sc1
  ds_read_b128 v[108:111], v17 offset:1024
  v_mfma_f32_32x32x16_bf16 v[40:55], v[116:119], a[104:107], v[40:55]
  s_waitcnt lgkmcnt(4)
  s_barrier
  ds_read_b128 v[112:115], v17 offset:2048
  s_waitcnt lgkmcnt(6)
  v_mfma_f32_32x32x16_bf16 v[40:55], v[88:91], a[108:111], v[40:55]
  ds_read_b128 v[116:119], v17 offset:3072
  v_mfma_f32_32x32x16_bf16 v[40:55], v[92:95], a[112:115], v[40:55]
  ds_read_b128 v[88:91], v17 offset:4096
  s_waitcnt lgkmcnt(5)
  v_mfma_f32_32x32x16_bf16 v[40:55], v[96:99], a[116:119], v[40:55]
  ds_read_b128 v[92:95], v17 offset:5120
  v_mfma_f32_32x32x16_bf16 v[40:55], v[100:103], a[120:123], v[40:55]
  ds_read_b128 v[96:99], v17 offset:6144
  buffer_load_dwordx4 a[200:203], v1, s[4:7], s73 offen offset:1024
  s_waitcnt lgkmcnt(5)
  v_mfma_f32_32x32x16_bf16 v[40:55], v[104:107], a[124:127], v[40:55]
  ds_read_b128 v[100:103], v17 offset:7168
  v_mfma_f32_32x32x16_bf16 v[40:55], v[108:111], v[140:143], v[40:55]
  ds_read_b128 v[104:107], v17 offset:8192
  buffer_load_dwordx4 a[204:207], v1, s[4:7], s66 offen offset:2048
  s_waitcnt lgkmcnt(5)
  v_mfma_f32_32x32x16_bf16 v[56:71], v[112:115], a[0:3], 0
  ds_read_b128 v[108:111], v17 offset:9216
  v_mfma_f32_32x32x16_bf16 v[56:71], v[116:119], a[4:7], v[56:71]
  ds_read_b128 v[112:115], v17 offset:10240
  buffer_load_dwordx4 a[208:211], v1, s[4:7], s70 offen offset:2048
  s_waitcnt lgkmcnt(5)
  v_mfma_f32_32x32x16_bf16 v[56:71], v[88:91], a[8:11], v[56:71]
  s_waitcnt vmcnt(3)
  v_cmp_gt_u32 vcc, 4, v23
  s_cbranch_vccnz L_slow_29
L_back_30:
  ds_read_b128 v[116:119], v17 offset:11264
  v_mul_f32 v40, v138, v40
  v_mul_f32 v41, v138, v41
  v_mul_f32 v42, v138, v42
  v_mul_f32 v43, v138, v43
  v_mul_f32 v44, v138, v44
  v_mul_f32 v45, v138, v45
  v_mul_f32 v46, v138, v46
  v_mfma_f32_32x32x16_bf16 v[56:71], v[92:95], a[12:15], v[56:71]
  ds_read_b128 v[88:91], v17 offset:12288
  buffer_load_dwordx4 a[212:215], v1, s[4:7], s67 offen offset:2048
  v_mul_f32 v47, v138, v47
  v_exp_f32 v144, v40
  v_mul_f32 v48, v40, v48
  v_exp_f32 v145, v41
  v_mul_f32 v49, v41, v49
  s_waitcnt lgkmcnt(5)
  v_mfma_f32_32x32x16_bf16 v[56:71], v[96:99], a[16:19], v[56:71]
  ds_read_b128 v[92:95], v17 offset:13312
  v_exp_f32 v146, v42
  v_mul_f32 v50, v42, v50
  v_exp_f32 v147, v43
  v_mul_f32 v51, v43, v51
  v_mfma_f32_32x32x16_bf16 v[56:71], v[100:103], a[20:23], v[56:71]
  ds_read_b128 v[96:99], v17 offset:14336
  buffer_load_dwordx4 a[216:219], v1, s[4:7], s71 offen offset:2048
  v_exp_f32 v148, v44
  v_mul_f32 v52, v44, v52
  v_exp_f32 v149, v45
  v_mul_f32 v53, v45, v53
  s_waitcnt lgkmcnt(5)
  v_mfma_f32_32x32x16_bf16 v[56:71], v[104:107], a[24:27], v[56:71]
  ds_read_b128 v[100:103], v17 offset:15360
  v_exp_f32 v150, v46
  v_mul_f32 v54, v46, v54
  v_exp_f32 v151, v47
  v_mul_f32 v55, v47, v55
  v_fma_f32 v144, v144, v139, v139
  v_mfma_f32_32x32x16_bf16 v[56:71], v[108:111], a[28:31], v[56:71]
  ds_read_b128 v[104:107], v17 offset:16384
  buffer_load_dwordx4 a[220:223], v1, s[4:7], s68 offen offset:2048
  v_fma_f32 v145, v145, v139, v139
  v_fma_f32 v146, v146, v139, v139
  v_fma_f32 v147, v147, v139, v139
  v_fma_f32 v148, v148, v139, v139
  v_fma_f32 v149, v149, v139, v139
  v_fma_f32 v150, v150, v139, v139
  v_fma_f32 v151, v151, v139, v139
  s_waitcnt lgkmcnt(5)
  v_mfma_f32_32x32x16_bf16 v[56:71], v[112:115], a[32:35], v[56:71]
  ds_read_b128 v[108:111], v17 offset:17408
  v_rcp_f32 v144, v144
  v_rcp_f32 v145, v145
  v_rcp_f32 v146, v146
  v_mfma_f32_32x32x16_bf16 v[56:71], v[116:119], a[36:39], v[56:71]
  ds_read_b128 v[112:115], v17 offset:18432
  buffer_load_dwordx4 a[224:227], v1, s[4:7], s72 offen offset:2048
  v_rcp_f32 v147, v147
  v_rcp_f32 v148, v148
  v_rcp_f32 v149, v149
  s_waitcnt lgkmcnt(5)
  v_mfma_f32_32x32x16_bf16 v[56:71], v[88:91], a[40:43], v[56:71]
  ds_read_b128 v[116:119], v17 offset:19456
  v_rcp_f32 v150, v150
  v_rcp_f32 v151, v151
  v_mul_f32 v48, v48, v144
  v_mul_f32 v49, v49, v145
  v_mul_f32 v50, v50, v146
  v_mfma_f32_32x32x16_bf16 v[56:71], v[92:95], a[44:47], v[56:71]
  ds_read_b128 v[88:91], v17 offset:20480
  buffer_load_dwordx4 a[228:231], v1, s[4:7], s69 offen offset:2048
  v_mul_f32 v51, v51, v147
  v_mul_f32 v52, v52, v148
  v_mul_f32 v53, v53, v149
  v_mul_f32 v54, v54, v150
  v_mul_f32 v55, v55, v151
  v_cvt_pk_bf16_f32 v152, v48, v49
  v_cvt_pk_bf16_f32 v153, v50, v51
  s_waitcnt lgkmcnt(5)
  v_mfma_f32_32x32x16_bf16 v[56:71], v[96:99], a[48:51], v[56:71]
  ds_read_b128 v[92:95], v17 offset:21504
  v_cvt_pk_bf16_f32 v154, v52, v53
  v_cvt_pk_bf16_f32 v155, v54, v55
  buffer_store_dwordx4 v[152:155], v1, s[4:7], s34 offen offset:1024 sc1
  v_mfma_f32_32x32x16_bf16 v[56:71], v[100:103], a[52:55], v[56:71]
  ds_read_b128 v[96:99], v17 offset:22528
  s_waitcnt lgkmcnt(5)
  v_mfma_f32_32x32x16_bf16 v[56:71], v[104:107], a[56:59], v[56:71]
  ds_read_b128 v[100:103], v17 offset:23552
  buffer_load_dwordx4 a[232:235], v1, s[4:7], s73 offen offset:2048
  v_mfma_f32_32x32x16_bf16 v[56:71], v[108:111], a[60:63], v[56:71]
  ds_read_b128 v[104:107], v17 offset:24576
  s_waitcnt lgkmcnt(5)
  v_mfma_f32_32x32x16_bf16 v[56:71], v[112:115], a[64:67], v[56:71]
  ds_read_b128 v[108:111], v17 offset:25600
  buffer_load_dwordx4 a[0:3], v1, s[4:7], s92 offen offset:0 sc1
  v_mfma_f32_32x32x16_bf16 v[56:71], v[116:119], a[68:71], v[56:71]
  ds_read_b128 v[112:115], v17 offset:26624
  s_waitcnt lgkmcnt(5)
  v_mfma_f32_32x32x16_bf16 v[56:71], v[88:91], a[72:75], v[56:71]
  ds_read_b128 v[116:119], v17 offset:27648
  buffer_load_dwordx4 a[4:7], v1, s[4:7], s93 offen offset:0 sc1
  v_mfma_f32_32x32x16_bf16 v[56:71], v[92:95], a[76:79], v[56:71]
  ds_read_b128 v[88:91], v17 offset:28672
  s_waitcnt lgkmcnt(5)
  v_mfma_f32_32x32x16_bf16 v[56:71], v[96:99], a[80:83], v[56:71]
  ds_read_b128 v[92:95], v17 offset:29696
  buffer_load_dwordx4 a[8:11], v1, s[4:7], s94 offen offset:0 sc1
  v_mfma_f32_32x32x16_bf16 v[56:71], v[100:103], a[84:87], v[56:71]
  ds_read_b128 v[96:99], v17 offset:30720
  s_waitcnt lgkmcnt(5)
  v_mfma_f32_32x32x16_bf16 v[56:71], v[104:107], a[88:91], v[56:71]
  ds_read_b128 v[100:103], v17 offset:31744
  buffer_load_dwordx4 a[12:15], v1, s[4:7], s95 offen offset:0 sc1
  v_mfma_f32_32x32x16_bf16 v[56:71], v[108:111], a[92:95], v[56:71]
  ds_read_b128 v[104:107], v17 offset:32768
  s_waitcnt lgkmcnt(5)
  v_mfma_f32_32x32x16_bf16 v[56:71], v[112:115], a[96:99], v[56:71]
  ds_read_b128 v[108:111], v17 offset:33792
  buffer_load_dwordx4 a[16:19], v1, s[4:7], s92 offen offset:1024 sc1
  v_mfma_f32_32x32x16_bf16 v[56:71], v[116:119], a[100:103], v[56:71]
  ds_read_b128 v[112:115], v17 offset:34816
  s_waitcnt lgkmcnt(5)
  v_mfma_f32_32x32x16_bf16 v[56:71], v[88:91], a[104:107], v[56:71]
  buffer_load_dwordx4 a[20:23], v1, s[4:7], s93 offen offset:1024 sc1
  v_mfma_f32_32x32x16_bf16 v[56:71], v[92:95], a[108:111], v[56:71]
  s_waitcnt lgkmcnt(3)
  v_mfma_f32_32x32x16_bf16 v[56:71], v[96:99], a[112:115], v[56:71]
  buffer_load_dwordx4 a[24:27], v1, s[4:7], s94 offen offset:1024 sc1
  v_mfma_f32_32x32x16_bf16 v[56:71], v[100:103], a[116:119], v[56:71]
  s_waitcnt lgkmcnt(1)
  v_mfma_f32_32x32x16_bf16 v[56:71], v[104:107], a[120:123], v[56:71]
  buffer_load_dwordx4 a[28:31], v1, s[4:7], s95 offen offset:1024 sc1
  v_mfma_f32_32x32x16_bf16 v[56:71], v[108:111], a[124:127], v[56:71]
  s_waitcnt lgkmcnt(0)
  v_mfma_f32_32x32x16_bf16 v[56:71], v[112:115], v[140:143], v[56:71]
  buffer_load_dwordx4 a[32:35], v1, s[4:7], s92 offen offset:2048 sc1
  s_nop 10
  v_mul_f32 v56, v138, v56
  v_mul_f32 v57, v138, v57
  v_mul_f32 v58, v138, v58
  v_mul_f32 v59, v138, v59
  v_mul_f32 v60, v138, v60
  v_mul_f32 v61, v138, v61
  buffer_load_dwordx4 a[36:39], v1, s[4:7], s93 offen offset:2048 sc1
  v_mul_f32 v62, v138, v62
  v_mul_f32 v63, v138, v63
  v_exp_f32 v144, v56
  v_mul_f32 v64, v56, v64
  v_exp_f32 v145, v57
  v_mul_f32 v65, v57, v65
  v_exp_f32 v146, v58
  v_mul_f32 v66, v58, v66
  v_exp_f32 v147, v59
  v_mul_f32 v67, v59, v67
  v_exp_f32 v148, v60
  v_mul_f32 v68, v60, v68
  buffer_load_dwordx4 a[40:43], v1, s[4:7], s94 offen offset:2048 sc1
  v_exp_f32 v149, v61
  v_mul_f32 v69, v61, v69
  v_exp_f32 v150, v62
  v_mul_f32 v70, v62, v70
  v_exp_f32 v151, v63
  v_mul_f32 v71, v63, v71
  v_fma_f32 v144, v144, v139, v139
  v_fma_f32 v145, v145, v139, v139
  v_fma_f32 v146, v146, v139, v139
  v_fma_f32 v147, v147, v139, v139
  v_fma_f32 v148, v148, v139, v139
  v_fma_f32 v149, v149, v139, v139
  buffer_load_dwordx4 a[44:47], v1, s[4:7], s95 offen offset:2048 sc1
  v_fma_f32 v150, v150, v139, v139
  v_fma_f32 v151, v151, v139, v139
  v_rcp_f32 v144, v144
  v_rcp_f32 v145, v145
  v_rcp_f32 v146, v146
  v_rcp_f32 v147, v147
  v_rcp_f32 v148, v148
  v_rcp_f32 v149, v149
  v_rcp_f32 v150, v150
  v_rcp_f32 v151, v151
  v_mul_f32 v64, v64, v144
  v_mul_f32 v65, v65, v145
  buffer_load_dwordx4 a[48:51], v1, s[4:7], s92 offen offset:3072 sc1
  s_add_u32 s92, s92, 4096
  v_mul_f32 v66, v66, v146
  v_mul_f32 v67, v67, v147
  v_mul_f32 v68, v68, v148
  v_mul_f32 v69, v69, v149
  v_mul_f32 v70, v70, v150
  v_mul_f32 v71, v71, v151
  v_cvt_pk_bf16_f32 v152, v64, v65
  v_cvt_pk_bf16_f32 v153, v66, v67
  v_cvt_pk_bf16_f32 v154, v68, v69
  v_cvt_pk_bf16_f32 v155, v70, v71
  s_waitcnt vmcnt(14)
  s_barrier
  v_mov_b32 v22, 5
  s_cmp_lg_u32 s16, 0
  s_cbranch_scc1 L_sig_31
  s_mov_b64 exec, 1
  s_cmp_eq_u32 s79, 0
  s_cbranch_scc1 L_far_32
  buffer_store_dword v22, off, s[4:7], s77
  s_mov_b64 exec, -1
L_sig_31:
  buffer_store_dwordx4 v[152:155], v1, s[4:7], s34 offen offset:2048 sc1
  s_waitcnt vmcnt(13)
  v_mfma_f32_32x32x16_bf16 v[56:71], a[236:239], a[0:3], 0
  v_lshlrev_b32 v24, 16, v4
  v_and_b32 v25, 0xffff0000, v4
  v_mfma_f32_32x32x16_bf16 v[72:87], a[240:243], a[0:3], 0
  buffer_load_dwordx4 a[52:55], v1, s[4:7], s93 offen offset:3072 sc1
  s_add_u32 s93, s93, 4096
  v_lshlrev_b32 v26, 16, v5
  v_and_b32 v27, 0xffff0000, v5
  s_waitcnt vmcnt(13)
  v_mfma_f32_32x32x16_bf16 v[56:71], a[244:247], a[4:7], v[56:71]
  v_lshlrev_b32 v28, 16, v6
  v_and_b32 v29, 0xffff0000, v6
  v_mfma_f32_32x32x16_bf16 v[72:87], a[248:251], a[4:7], v[72:87]
  buffer_load_dwordx4 a[56:59], v1, s[4:7], s94 offen offset:3072 sc1
  s_add_u32 s94, s94, 4096
  v_lshlrev_b32 v30, 16, v7
  v_and_b32 v31, 0xffff0000, v7
  s_waitcnt vmcnt(13)
  v_mfma_f32_32x32x16_bf16 v[56:71], a[252:255], a[8:11], v[56:71]
  v_lshlrev_b32 v32, 16, v8
  v_and_b32 v33, 0xffff0000, v8
  v_mfma_f32_32x32x16_bf16 v[72:87], v[160:163], a[8:11], v[72:87]
  buffer_load_dwordx4 a[60:63], v1, s[4:7], s95 offen offset:3072 sc1
  s_add_u32 s95, s95, 4096
  v_lshlrev_b32 v34, 16, v9
  v_and_b32 v35, 0xffff0000, v9
  s_waitcnt vmcnt(13)
  v_mfma_f32_32x32x16_bf16 v[56:71], v[164:167], a[12:15], v[56:71]
  v_lshlrev_b32 v36, 16, v10
  v_and_b32 v37, 0xffff0000, v10
  v_mfma_f32_32x32x16_bf16 v[72:87], v[168:171], a[12:15], v[72:87]
  buffer_load_dwordx4 a[64:67], v1, s[4:7], s88 offen offset:0 sc1
  v_lshlrev_b32 v38, 16, v11
  v_and_b32 v39, 0xffff0000, v11
  s_waitcnt vmcnt(13)
  v_mfma_f32_32x32x16_bf16 v[56:71], v[172:175], a[16:19], v[56:71]
  s_xor_b32 s34, s16, 2
  s_lshl_b32 s34, s34, 13
  s_add_u32 s34, s34, 67584
  v_add_u32 v90, s34, v1
  v_mfma_f32_32x32x16_bf16 v[72:87], v[176:179], a[16:19], v[72:87]
  buffer_load_dwordx4 a[68:71], v1, s[4:7], s89 offen offset:0 sc1
  s_xor_b32 s34, s16, 3
  s_lshl_b32 s34, s34, 13
  s_add_u32 s34, s34, 71680
  v_add_u32 v91, s34, v1
  s_waitcnt vmcnt(13)
  v_mfma_f32_32x32x16_bf16 v[56:71], v[180:183], a[20:23], v[56:71]
  s_xor_b32 s34, s16, 1
  s_lshl_b32 s34, s34, 12
  s_add_u32 s34, s34, 135168
  v_add_u32 v89, s34, v1
  v_mfma_f32_32x32x16_bf16 v[72:87], v[184:187], a[20:23], v[72:87]
  buffer_load_dwordx4 a[72:75], v1, s[4:7], s90 offen offset:0 sc1
  s_lshl_b32 s34, s16, 12
  s_add_u32 s34, s34, 135168
  v_add_u32 v88, s34, v1
  s_waitcnt vmcnt(13)
  v_mfma_f32_32x32x16_bf16 v[56:71], v[188:191], a[24:27], v[56:71]
  s_lshl_b32 s34, s16, 13
  s_add_u32 s34, s34, 67584
  v_add_u32 v92, s34, v1
  v_mfma_f32_32x32x16_bf16 v[72:87], v[192:195], a[24:27], v[72:87]
  buffer_load_dwordx4 a[76:79], v1, s[4:7], s91 offen offset:0 sc1
  s_lshl_b32 s52, s26, 15
  s_waitcnt vmcnt(13)
  v_mfma_f32_32x32x16_bf16 v[56:71], v[196:199], a[28:31], v[56:71]
  s_lshl_b32 s54, s25, 11
  v_mfma_f32_32x32x16_bf16 v[72:87], v[200:203], a[28:31], v[72:87]
  buffer_load_dwordx4 a[80:83], v1, s[4:7], s88 offen offset:1024 sc1
  s_add_u32 s52, s52, s54
  s_waitcnt vmcnt(13)
  v_mfma_f32_32x32x16_bf16 v[56:71], v[204:207], a[32:35], v[56:71]
  s_add_u32 s52, s52, 0x1600000
  v_mfma_f32_32x32x16_bf16 v[72:87], v[208:211], a[32:35], v[72:87]
  buffer_load_dwordx4 a[84:87], v1, s[4:7], s89 offen offset:1024 sc1
  s_lshl_b32 s53, s26, 12
  s_waitcnt vmcnt(13)
  v_mfma_f32_32x32x16_bf16 v[56:71], v[212:215], a[36:39], v[56:71]
  s_lshl_b32 s54, s25, 8
  v_mfma_f32_32x32x16_bf16 v[72:87], v[216:219], a[36:39], v[72:87]
  buffer_load_dwordx4 a[88:91], v1, s[4:7], s90 offen offset:1024 sc1
  s_add_u32 s53, s53, s54
  s_waitcnt vmcnt(13)
  s_waitcnt vmcnt(10)
  s_barrier
  v_mov_b32 v22, 6
  s_cmp_lg_u32 s16, 0
  s_cbranch_scc1 L_sig_33
  s_mov_b64 exec, 1
  s_cmp_eq_u32 s79, 0
  s_cbranch_scc1 L_far_34
  buffer_store_dword v22, off, s[4:7], s77
  s_mov_b64 exec, -1
L_sig_33:
  v_mfma_f32_32x32x16_bf16 v[56:71], v[220:223], a[40:43], v[56:71]
  s_add_u32 s53, s53, 0x80000
  v_mfma_f32_32x32x16_bf16 v[72:87], v[224:227], a[40:43], v[72:87]
  buffer_load_dwordx4 a[92:95], v1, s[4:7], s91 offen offset:1024 sc1
  s_waitcnt vmcnt(13)
  v_mfma_f32_32x32x16_bf16 v[56:71], v[228:231], a[44:47], v[56:71]
  v_mfma_f32_32x32x16_bf16 v[72:87], v[232:235], a[44:47], v[72:87]
  buffer_load_dwordx4 a[96:99], v1, s[4:7], s88 offen offset:2048 sc1
  s_waitcnt vmcnt(13)
  v_mfma_f32_32x32x16_bf16 v[56:71], v[236:239], a[48:51], v[56:71]
  v_mfma_f32_32x32x16_bf16 v[72:87], v[240:243], a[48:51], v[72:87]
  buffer_load_dwordx4 a[100:103], v1, s[4:7], s89 offen offset:2048 sc1
  s_waitcnt vmcnt(12)
  v_mfma_f32_32x32x16_bf16 v[56:71], v[244:247], a[52:55], v[56:71]
  v_mfma_f32_32x32x16_bf16 v[72:87], v[248:251], a[52:55], v[72:87]
  buffer_load_dword v23, v13, s[4:7], 0 offen sc1
  buffer_load_dwordx4 a[104:107], v1, s[4:7], s90 offen offset:2048 sc1
  s_waitcnt vmcnt(13)
  v_mfma_f32_32x32x16_bf16 v[56:71], v[252:255], a[56:59], v[56:71]
  v_mfma_f32_32x32x16_bf16 v[72:87], a[128:131], a[56:59], v[72:87]
  buffer_load_dwordx4 a[108:111], v1, s[4:7], s91 offen offset:2048 sc1
  s_waitcnt vmcnt(13)
  v_mfma_f32_32x32x16_bf16 v[56:71], a[132:135], a[60:63], v[56:71]
  v_mfma_f32_32x32x16_bf16 v[72:87], a[136:139], a[60:63], v[72:87]
  buffer_load_dwordx4 a[112:115], v1, s[4:7], s88 offen offset:3072 sc1
  s_add_u32 s88, s88, 4096
  s_waitcnt vmcnt(13)
  v_mfma_f32_32x32x16_bf16 v[40:55], a[240:243], a[64:67], 0
  v_mfma_f32_32x32x16_bf16 v[24:39], a[236:239], a[64:67], v[24:39]
  buffer_load_dwordx4 a[116:119], v1, s[4:7], s89 offen offset:3072 sc1
  s_add_u32 s89, s89, 4096
  s_waitcnt vmcnt(13)
  v_mfma_f32_32x32x16_bf16 v[40:55], a[248:251], a[68:71], v[40:55]
  v_mfma_f32_32x32x16_bf16 v[24:39], a[244:247], a[68:71], v[24:39]
  buffer_load_dwordx4 a[120:123], v1, s[4:7], s90 offen offset:3072 sc1
  s_add_u32 s90, s90, 4096
  s_waitcnt vmcnt(13)
  v_mfma_f32_32x32x16_bf16 v[40:55], v[160:163], a[72:75], v[40:55]
  v_mfma_f32_32x32x16_bf16 v[24:39], a[252:255], a[72:75], v[24:39]
  buffer_load_dwordx4 a[124:127], v1, s[4:7], s91 offen offset:3072 sc1
  s_add_u32 s91, s91, 4096
  s_waitcnt vmcnt(13)
  v_mfma_f32_32x32x16_bf16 v[40:55], v[168:171], a[76:79], v[40:55]
  v_mfma_f32_32x32x16_bf16 v[24:39], v[164:167], a[76:79], v[24:39]
  s_waitcnt vmcnt(6)
  v_cmp_gt_u32 vcc, 5, v23
  s_cbranch_vccnz L_slow_35
L_back_36:
  buffer_load_dwordx4 a[0:3], v1, s[4:7], s92 offen offset:0 sc1
  s_waitcnt vmcnt(13)
  v_mfma_f32_32x32x16_bf16 v[40:55], v[176:179], a[80:83], v[40:55]
  v_mfma_f32_32x32x16_bf16 v[24:39], v[172:175], a[80:83], v[24:39]
  buffer_load_dwordx4 a[4:7], v1, s[4:7], s93 offen offset:0 sc1
  s_waitcnt vmcnt(13)
  v_mfma_f32_32x32x16_bf16 v[40:55], v[184:187], a[84:87], v[40:55]
  v_mfma_f32_32x32x16_bf16 v[24:39], v[180:183], a[84:87], v[24:39]
  buffer_load_dwordx4 a[8:11], v1, s[4:7], s94 offen offset:0 sc1
  s_waitcnt vmcnt(13)
  v_mfma_f32_32x32x16_bf16 v[40:55], v[192:195], a[88:91], v[40:55]
  v_mfma_f32_32x32x16_bf16 v[24:39], v[188:191], a[88:91], v[24:39]
  buffer_load_dwordx4 a[12:15], v1, s[4:7], s95 offen offset:0 sc1
  s_waitcnt vmcnt(13)
  v_mfma_f32_32x32x16_bf16 v[40:55], v[200:203], a[92:95], v[40:55]
  v_mfma_f32_32x32x16_bf16 v[24:39], v[196:199], a[92:95], v[24:39]
  buffer_load_dwordx4 a[16:19], v1, s[4:7], s92 offen offset:1024 sc1
  s_waitcnt vmcnt(13)
  v_mfma_f32_32x32x16_bf16 v[40:55], v[208:211], a[96:99], v[40:55]
  v_mfma_f32_32x32x16_bf16 v[24:39], v[204:207], a[96:99], v[24:39]
  buffer_load_dwordx4 a[20:23], v1, s[4:7], s93 offen offset:1024 sc1
  s_waitcnt vmcnt(13)
  v_mfma_f32_32x32x16_bf16 v[40:55], v[216:219], a[100:103], v[40:55]
  v_mfma_f32_32x32x16_bf16 v[24:39], v[212:215], a[100:103], v[24:39]
  buffer_load_dword v23, v13, s[4:7], 0 offen sc1
  buffer_load_dwordx4 a[24:27], v1, s[4:7], s94 offen offset:1024 sc1
  s_waitcnt vmcnt(13)
  v_mfma_f32_32x32x16_bf16 v[40:55], v[224:227], a[104:107], v[40:55]
  v_mfma_f32_32x32x16_bf16 v[24:39], v[220:223], a[104:107], v[24:39]
  buffer_load_dwordx4 a[28:31], v1, s[4:7], s95 offen offset:1024 sc1
  s_waitcnt vmcnt(13)
  v_mfma_f32_32x32x16_bf16 v[40:55], v[232:235], a[108:111], v[40:55]
  v_mfma_f32_32x32x16_bf16 v[24:39], v[228:231], a[108:111], v[24:39]
  buffer_load_dwordx4 a[32:35], v1, s[4:7], s88 offen offset:0 sc1
  s_waitcnt vmcnt(13)
  v_mfma_f32_32x32x16_bf16 v[40:55], v[240:243], a[112:115], v[40:55]
  v_mfma_f32_32x32x16_bf16 v[24:39], v[236:239], a[112:115], v[24:39]
  buffer_load_dwordx4 a[36:39], v1, s[4:7], s89 offen offset:0 sc1
  s_waitcnt vmcnt(13)
  v_mfma_f32_32x32x16_bf16 v[40:55], v[248:251], a[116:119], v[40:55]
  v_mfma_f32_32x32x16_bf16 v[24:39], v[244:247], a[116:119], v[24:39]
  buffer_load_dwordx4 a[40:43], v1, s[4:7], s90 offen offset:0 sc1
  s_waitcnt vmcnt(13)
  v_mfma_f32_32x32x16_bf16 v[40:55], a[128:131], a[120:123], v[40:55]
  v_mfma_f32_32x32x16_bf16 v[24:39], v[252:255], a[120:123], v[24:39]
  buffer_load_dwordx4 a[44:47], v1, s[4:7], s91 offen offset:0 sc1
  s_waitcnt vmcnt(13)
  v_mfma_f32_32x32x16_bf16 v[40:55], a[136:139], a[124:127], v[40:55]
  v_mfma_f32_32x32x16_bf16 v[24:39], a[132:135], a[124:127], v[24:39]
  s_waitcnt vmcnt(6)
  v_cmp_gt_u32 vcc, 6, v23
  s_cbranch_vccnz L_slow_37
L_back_38:
  buffer_load_dwordx4 a[48:51], v1, s[4:7], s92 offen offset:2048 sc1
  s_waitcnt vmcnt(13)
  v_mfma_f32_32x32x16_bf16 v[56:71], a[140:143], a[0:3], v[56:71]
  v_mfma_f32_32x32x16_bf16 v[72:87], a[144:147], a[0:3], v[72:87]
  buffer_load_dwordx4 a[52:55], v1, s[4:7], s93 offen offset:2048 sc1
  s_waitcnt vmcnt(13)
  v_mfma_f32_32x32x16_bf16 v[56:71], a[148:151], a[4:7], v[56:71]
  v_mfma_f32_32x32x16_bf16 v[72:87], a[152:155], a[4:7], v[72:87]
  buffer_load_dwordx4 a[56:59], v1, s[4:7], s94 offen offset:2048 sc1
  s_waitcnt vmcnt(13)
  v_mfma_f32_32x32x16_bf16 v[56:71], a[156:159], a[8:11], v[56:71]
  v_mfma_f32_32x32x16_bf16 v[72:87], a[160:163], a[8:11], v[72:87]
  buffer_load_dwordx4 a[60:63], v1, s[4:7], s95 offen offset:2048 sc1
  s_waitcnt vmcnt(13)
  v_mfma_f32_32x32x16_bf16 v[56:71], a[164:167], a[12:15], v[56:71]
  v_mfma_f32_32x32x16_bf16 v[72:87], a[168:171], a[12:15], v[72:87]
  buffer_load_dwordx4 a[64:67], v1, s[4:7], s88 offen offset:1024 sc1
  s_waitcnt vmcnt(13)
  v_mfma_f32_32x32x16_bf16 v[56:71], a[172:175], a[16:19], v[56:71]
  v_mfma_f32_32x32x16_bf16 v[72:87], a[176:179], a[16:19], v[72:87]
  buffer_load_dwordx4 a[68:71], v1, s[4:7], s89 offen offset:1024 sc1
  s_waitcnt vmcnt(13)
  v_mfma_f32_32x32x16_bf16 v[56:71], a[180:183], a[20:23], v[56:71]
  v_mfma_f32_32x32x16_bf16 v[72:87], a[184:187], a[20:23], v[72:87]
  buffer_load_dwordx4 a[72:75], v1, s[4:7], s90 offen offset:1024 sc1
  s_waitcnt vmcnt(12)
  v_mfma_f32_32x32x16_bf16 v[56:71], a[188:191], a[24:27], v[56:71]
  v_mfma_f32_32x32x16_bf16 v[72:87], a[192:195], a[24:27], v[72:87]
  buffer_load_dwordx4 a[76:79], v1, s[4:7], s91 offen offset:1024 sc1
  s_waitcnt vmcnt(12)
  v_mfma_f32_32x32x16_bf16 v[56:71], a[196:199], a[28:31], v[56:71]
  v_mfma_f32_32x32x16_bf16 v[72:87], a[200:203], a[28:31], v[72:87]
  buffer_load_dwordx4 a[80:83], v1, s[4:7], s88 offen offset:2048 sc1
  s_waitcnt vmcnt(8)
  v_mfma_f32_32x32x16_bf16 v[56:71], a[204:207], a[48:51], v[56:71]
  v_mfma_f32_32x32x16_bf16 v[72:87], a[208:211], a[48:51], v[72:87]
  buffer_load_dwordx4 a[84:87], v1, s[4:7], s89 offen offset:2048 sc1
  s_waitcnt vmcnt(8)
  v_mfma_f32_32x32x16_bf16 v[56:71], a[212:215], a[52:55], v[56:71]
  v_mfma_f32_32x32x16_bf16 v[72:87], a[216:219], a[52:55], v[72:87]
  buffer_load_dwordx4 a[88:91], v1, s[4:7], s90 offen offset:2048 sc1
  s_waitcnt vmcnt(8)
  v_mfma_f32_32x32x16_bf16 v[56:71], a[220:223], a[56:59], v[56:71]
  v_mfma_f32_32x32x16_bf16 v[72:87], a[224:227], a[56:59], v[72:87]
  buffer_load_dwordx4 a[92:95], v1, s[4:7], s91 offen offset:2048 sc1
  s_waitcnt vmcnt(8)
  v_mfma_f32_32x32x16_bf16 v[56:71], a[228:231], a[60:63], v[56:71]
  v_mfma_f32_32x32x16_bf16 v[72:87], a[232:235], a[60:63], v[72:87]
  s_lshl_b32 s44, s18, 2
  s_add_u32 s44, s44, s16
  s_mul_i32 s44, s44, 512
  s_add_u32 s44, s44, L_p1-interleave_layers__mha_block__glu_gated_swiglu__prompt_kernel
  v_min_u32 v128, 3, v0
  v_lshl_add_u32 v128, v128, 7, s44
  v_min_u32 v128, L_last-interleave_layers__mha_block__glu_gated_swiglu__prompt_kernel, v128
  global_load_dword v128, v128, s[74:75]
  s_waitcnt vmcnt(16)
  v_mfma_f32_32x32x16_bf16 v[40:55], a[144:147], a[32:35], v[40:55]
  s_waitcnt vmcnt(15)
  v_mfma_f32_32x32x16_bf16 v[40:55], a[152:155], a[36:39], v[40:55]
  s_add_u32 m0, s85, 101376
  s_nop 0
  buffer_load_dwordx4 v1, s[4:7], s84 offen offset:0 lds
  s_waitcnt vmcnt(15)
  v_mfma_f32_32x32x16_bf16 v[40:55], a[160:163], a[40:43], v[40:55]
  ds_write_b128 v90, v[56:59] offset:0
  s_waitcnt vmcnt(14)
  v_mfma_f32_32x32x16_bf16 v[40:55], a[168:171], a[44:47], v[40:55]
  buffer_load_dwordx4 v1, s[4:7], s84 offen offset:1024 lds
  ds_write_b128 v90, v[60:63] offset:1024
  s_waitcnt vmcnt(10)
  v_mfma_f32_32x32x16_bf16 v[40:55], a[176:179], a[64:67], v[40:55]
  ds_write_b128 v90, v[64:67] offset:2048
  s_waitcnt vmcnt(9)
  v_mfma_f32_32x32x16_bf16 v[40:55], a[184:187], a[68:71], v[40:55]
  buffer_load_dwordx4 v1, s[4:7], s84 offen offset:2048 lds
  ds_write_b128 v90, v[68:71] offset:3072
  s_waitcnt vmcnt(9)
  v_mfma_f32_32x32x16_bf16 v[40:55], a[192:195], a[72:75], v[40:55]
  ds_write_b128 v91, v[72:75] offset:0
  s_waitcnt vmcnt(8)
  v_mfma_f32_32x32x16_bf16 v[40:55], a[200:203], a[76:79], v[40:55]
  buffer_load_dwordx4 v1, s[4:7], s84 offen offset:3072 lds
  s_add_u32 s84, s84, 4096
  ds_write_b128 v91, v[76:79] offset:1024
  s_waitcnt vmcnt(8)
  v_mfma_f32_32x32x16_bf16 v[40:55], a[208:211], a[80:83], v[40:55]
  ds_write_b128 v91, v[80:83] offset:2048
  v_mfma_f32_32x32x16_bf16 v[24:39], a[140:143], a[32:35], v[24:39]
  s_add_u32 m0, s85, 105472
  s_nop 0
  buffer_load_dwordx4 v1, s[4:7], s84 offen offset:0 lds
  ds_write_b128 v91, v[84:87] offset:3072
  s_waitcnt vmcnt(8)
  v_mfma_f32_32x32x16_bf16 v[40:55], a[216:219], a[84:87], v[40:55]
  s_waitcnt lgkmcnt(0)
  s_barrier
  v_mfma_f32_32x32x16_bf16 v[24:39], a[148:151], a[36:39], v[24:39]
  buffer_load_dwordx4 v1, s[4:7], s84 offen offset:1024 lds
  ds_read_b128 v[96:99], v92 offset:0
  ds_read_b128 v[100:103], v92 offset:1024
  s_waitcnt vmcnt(8)
  v_mfma_f32_32x32x16_bf16 v[40:55], a[224:227], a[88:91], v[40:55]
  ds_read_b128 v[104:107], v92 offset:2048
  ds_read_b128 v[108:111], v92 offset:3072
  v_mfma_f32_32x32x16_bf16 v[24:39], a[156:159], a[40:43], v[24:39]
  buffer_load_dwordx4 v1, s[4:7], s84 offen offset:2048 lds
  ds_read_b128 v[112:115], v92 offset:4096
  ds_read_b128 v[116:119], v92 offset:5120
  s_waitcnt vmcnt(8)
  v_mfma_f32_32x32x16_bf16 v[40:55], a[232:235], a[92:95], v[40:55]
  ds_read_b128 v[120:123], v92 offset:6144
  v_mfma_f32_32x32x16_bf16 v[24:39], a[164:167], a[44:47], v[24:39]
  buffer_load_dwordx4 v1, s[4:7], s84 offen offset:3072 lds
  s_add_u32 s84, s84, 4096
  ds_read_b128 v[124:127], v92 offset:7168
  v_mfma_f32_32x32x16_bf16 v[24:39], a[172:175], a[64:67], v[24:39]
  s_nop 5
  ds_write_b128 v89, v[40:43] offset:0
  v_mfma_f32_32x32x16_bf16 v[24:39], a[180:183], a[68:71], v[24:39]
  s_add_u32 m0, s85, 109568
  s_nop 0
  buffer_load_dwordx4 v1, s[4:7], s84 offen offset:0 lds
  s_add_u32 s84, s84, 25600
  ds_write_b128 v89, v[44:47] offset:1024
  v_mfma_f32_32x32x16_bf16 v[24:39], a[188:191], a[72:75], v[24:39]
  ds_write_b128 v89, v[48:51] offset:2048
  v_mfma_f32_32x32x16_bf16 v[24:39], a[196:199], a[76:79], v[24:39]
  s_add_u32 m0, s85, 0
  s_nop 0
  buffer_load_dwordx4 v1, s[4:7], s84 offen offset:0 lds
  ds_write_b128 v89, v[52:55] offset:3072
  s_waitcnt lgkmcnt(0)
  s_barrier
  ds_read_b128 v[56:59], v88 offset:0
  ds_read_b128 v[60:63], v88 offset:1024
  ds_read_b128 v[64:67], v88 offset:2048
  ds_read_b128 v[68:71], v88 offset:3072
  v_mfma_f32_32x32x16_bf16 v[24:39], a[204:207], a[80:83], v[24:39]
  v_add_f32 v96, v96, v112
  v_add_f32 v97, v97, v113
  v_add_f32 v98, v98, v114
  v_add_f32 v99, v99, v115
  v_mfma_f32_32x32x16_bf16 v[24:39], a[212:215], a[84:87], v[24:39]
  buffer_load_dwordx4 v1, s[4:7], s84 offen offset:1024 lds
  v_add_f32 v100, v100, v116
  v_add_f32 v101, v101, v117
  v_add_f32 v102, v102, v118
  v_add_f32 v103, v103, v119
  v_mfma_f32_32x32x16_bf16 v[24:39], a[220:223], a[88:91], v[24:39]
  v_add_f32 v104, v104, v120
  v_add_f32 v105, v105, v121
  v_add_f32 v106, v106, v122
  v_add_f32 v107, v107, v123
  v_mfma_f32_32x32x16_bf16 v[24:39], a[228:231], a[92:95], v[24:39]
  buffer_load_dwordx4 v1, s[4:7], s84 offen offset:2048 lds
  v_add_f32 v108, v108, v124
  v_add_f32 v109, v109, v125
  v_add_f32 v110, v110, v126
  v_add_f32 v111, v111, v127
  s_waitcnt lgkmcnt(0)
  v_pk_add_f32 v[96:97], v[96:97], v[56:57]
  v_pk_add_f32 v[98:99], v[98:99], v[58:59]
  v_pk_add_f32 v[100:101], v[100:101], v[60:61]
  v_pk_add_f32 v[102:103], v[102:103], v[62:63]
  v_pk_add_f32 v[104:105], v[104:105], v[64:65]
  v_pk_add_f32 v[106:107], v[106:107], v[66:67]
  v_pk_add_f32 v[108:109], v[108:109], v[68:69]
  v_pk_add_f32 v[110:111], v[110:111], v[70:71]
  v_pk_add_f32 v[24:25], v[24:25], v[96:97]
  v_pk_add_f32 v[26:27], v[26:27], v[98:99]
  v_pk_add_f32 v[28:29], v[28:29], v[100:101]
  v_pk_add_f32 v[30:31], v[30:31], v[102:103]
  v_pk_add_f32 v[32:33], v[32:33], v[104:105]
  v_pk_add_f32 v[34:35], v[34:35], v[106:107]
  v_pk_add_f32 v[36:37], v[36:37], v[108:109]
  v_pk_add_f32 v[38:39], v[38:39], v[110:111]
  v_cvt_pk_bf16_f32 v44, v24, v25
  v_cvt_pk_bf16_f32 v45, v26, v27
  v_cvt_pk_bf16_f32 v46, v28, v29
  v_cvt_pk_bf16_f32 v47, v30, v31
  s_cmp_eq_u32 s79, 0
  s_cbranch_scc1 L_far_39
  buffer_store_dwordx4 v[44:47], v1, s[4:7], s52 offen offset:0
L_back_40:
  v_cvt_pk_bf16_f32 v48, v32, v33
  v_cvt_pk_bf16_f32 v49, v34, v35
  v_cvt_pk_bf16_f32 v50, v36, v37
  v_cvt_pk_bf16_f32 v51, v38, v39
  s_cmp_eq_u32 s79, 0
  s_cbranch_scc1 L_far_41
  buffer_store_dwordx4 v[48:51], v1, s[4:7], s52 offen offset:1024
L_back_42:
  v_pk_add_f32 v[40:41], v[24:25], v[26:27]
  v_pk_mul_f32 v[42:43], v[24:25], v[24:25]
  v_pk_fma_f32 v[42:43], v[26:27], v[26:27], v[42:43]
  v_pk_fma_f32 v[42:43], v[28:29], v[28:29], v[42:43]
  v_pk_add_f32 v[40:41], v[40:41], v[28:29]
  v_pk_fma_f32 v[42:43], v[30:31], v[30:31], v[42:43]
  v_pk_add_f32 v[40:41], v[40:41], v[30:31]
  v_pk_fma_f32 v[42:43], v[32:33], v[32:33], v[42:43]
  v_pk_add_f32 v[40:41], v[40:41], v[32:33]
  v_pk_fma_f32 v[42:43], v[34:35], v[34:35], v[42:43]
  v_pk_add_f32 v[40:41], v[40:41], v[34:35]
  v_pk_fma_f32 v[42:43], v[36:37], v[36:37], v[42:43]
  v_pk_add_f32 v[40:41], v[40:41], v[36:37]
  v_pk_fma_f32 v[42:43], v[38:39], v[38:39], v[42:43]
  v_pk_add_f32 v[40:41], v[40:41], v[38:39]
  v_add_f32 v40, v40, v41
  v_add_f32 v41, v42, v43
  s_nop 1
  v_permlane32_swap_b32 v40, v41
  v_add_f32 v40, v40, v41
  s_cmp_eq_u32 s79, 0
  s_cbranch_scc1 L_far_43
  buffer_store_dword v40, v19, s[4:7], s53 offen offset:0
L_back_44:
  s_waitcnt vmcnt(0) lgkmcnt(0)
  s_barrier
  v_mov_b32 v22, 7
  s_cmp_lg_u32 s16, 0
  s_cbranch_scc1 L_sig_45
  s_mov_b64 exec, 1
  s_cmp_eq_u32 s79, 0
  s_cbranch_scc1 L_far_46
  buffer_store_dword v22, off, s[4:7], s77
  s_mov_b64 exec, -1
L_sig_45:
  buffer_load_dwordx4 v1, s[4:7], s84 offen offset:3072 lds
  s_add_u32 s84, s84, 4096
  s_add_u32 m0, s85, 4096
  s_nop 0
  buffer_load_dwordx4 v1, s[4:7], s84 offen offset:0 lds
  buffer_load_dwordx4 v1, s[4:7], s84 offen offset:1024 lds
  buffer_load_dwordx4 v1, s[4:7], s84 offen offset:2048 lds
  buffer_load_dwordx4 v1, s[4:7], s84 offen offset:3072 lds
  s_add_u32 s84, s84, 4096
  s_add_u32 m0, s85, 8192
  s_nop 0
  buffer_load_dwordx4 v1, s[4:7], s84 offen offset:0 lds
  s_add_u32 s84, s84, 25600
L_p1:
  s_lshl_b32 s31, s27, 15
  s_add_u32 s31, s31, 0x1600000
  s_lshl_b32 s32, s27, 12
  s_add_u32 s32, s32, 0x80000
L_poll_47:
  buffer_load_dword v22, v13, s[4:7], 0 offen sc1
  s_waitcnt vmcnt(0)
  v_cmp_gt_u32 vcc, 7, v22
  s_cbranch_vccz L_pdone_48
  s_sub_u32 s20, s20, 1
  s_cbranch_scc0 L_poll_47
  s_mov_b32 s20, 0
L_pdone_48:
  buffer_load_dwordx4 a[0:3], v1, s[4:7], s31 offen offset:0 sc1
  buffer_load_dwordx4 a[4:7], v1, s[4:7], s31 offen offset:1024 sc1
  buffer_load_dwordx4 a[8:11], v1, s[4:7], s31 offen offset:2048 sc1
  buffer_load_dwordx4 a[12:15], v1, s[4:7], s31 offen offset:3072 sc1
  s_add_u32 s31, s31, 4096
  buffer_load_dwordx4 a[16:19], v1, s[4:7], s31 offen offset:0 sc1
  buffer_load_dwordx4 a[20:23], v1, s[4:7], s31 offen offset:1024 sc1
  buffer_load_dwordx4 a[24:27], v1, s[4:7], s31 offen offset:2048 sc1
  buffer_load_dwordx4 a[28:31], v1, s[4:7], s31 offen offset:3072 sc1
  s_add_u32 s31, s31, 4096
  buffer_load_dwordx4 a[32:35], v1, s[4:7], s31 offen offset:0 sc1
  buffer_load_dwordx4 a[36:39], v1, s[4:7], s31 offen offset:1024 sc1
  s_waitcnt vmcnt(9)
  s_barrier
  ds_read_b128 v[104:107], v17 offset:36864
  ds_read_b128 v[108:111], v17 offset:37888
  ds_read_b128 v[112:115], v17 offset:35840
  ds_read_b128 v[116:119], v17 offset:39936
  ds_read_b128 v[120:123], v17 offset:40960
  ds_read_b128 v[124:127], v17 offset:38912
  ds_read_b128 v[128:131], v17 offset:43008
  ds_read_b128 v[132:135], v17 offset:44032
  s_waitcnt vmcnt(9) lgkmcnt(7)
  v_mfma_f32_32x32x16_bf16 v[56:71], v[104:107], a[0:3], 0
  ds_read_b128 v[136:139], v17 offset:41984
  buffer_load_dwordx4 a[40:43], v1, s[4:7], s31 offen offset:2048 sc1
  s_waitcnt lgkmcnt(7)
  v_mfma_f32_32x32x16_bf16 v[72:87], a[0:3], v[108:111], 0
  ds_read_b128 v[104:107], v17 offset:46080
  s_waitcnt lgkmcnt(7)
  v_mfma_f32_32x32x16_bf16 v[40:55], v[112:115], a[0:3], 0
  ds_read_b128 v[108:111], v17 offset:47104
  buffer_load_dwordx4 a[44:47], v1, s[4:7], s31 offen offset:3072 sc1
  s_add_u32 s31, s31, 4096
  s_waitcnt vmcnt(10) lgkmcnt(7)
  v_mfma_f32_32x32x16_bf16 v[56:71], v[116:119], a[4:7], v[56:71]
  ds_read_b128 v[112:115], v17 offset:45056
  s_waitcnt lgkmcnt(7)
  v_mfma_f32_32x32x16_bf16 v[72:87], a[4:7], v[120:123], v[72:87]
  ds_read_b128 v[116:119], v17 offset:49152
  s_add_u32 m0, s85, 33792
  s_nop 0
  buffer_load_dwordx4 v1, s[4:7], s84 offen offset:0 lds
  s_waitcnt lgkmcnt(7)
  v_mfma_f32_32x32x16_bf16 v[40:55], v[124:127], a[4:7], v[40:55]
  ds_read_b128 v[120:123], v17 offset:50176
  s_waitcnt vmcnt(10) lgkmcnt(7)
  v_mfma_f32_32x32x16_bf16 v[56:71], v[128:131], a[8:11], v[56:71]
  ds_read_b128 v[124:127], v17 offset:48128
  buffer_load_dwordx4 a[48:51], v1, s[4:7], s31 offen offset:0 sc1
  s_waitcnt lgkmcnt(7)
  v_mfma_f32_32x32x16_bf16 v[72:87], a[8:11], v[132:135], v[72:87]
  ds_read_b128 v[128:131], v17 offset:52224
  s_waitcnt lgkmcnt(7)
  v_mfma_f32_32x32x16_bf16 v[40:55], v[136:139], a[8:11], v[40:55]
  ds_read_b128 v[132:135], v17 offset:53248
  buffer_load_dwordx4 v1, s[4:7], s84 offen offset:1024 lds
  s_waitcnt vmcnt(11) lgkmcnt(7)
  v_mfma_f32_32x32x16_bf16 v[56:71], v[104:107], a[12:15], v[56:71]
  ds_read_b128 v[136:139], v17 offset:51200
  s_waitcnt lgkmcnt(7)
  v_mfma_f32_32x32x16_bf16 v[72:87], a[12:15], v[108:111], v[72:87]
  ds_read_b128 v[104:107], v17 offset:55296
  buffer_load_dwordx4 a[52:55], v1, s[4:7], s31 offen offset:1024 sc1
  s_waitcnt lgkmcnt(7)
  v_mfma_f32_32x32x16_bf16 v[40:55], v[112:115], a[12:15], v[40:55]
  ds_read_b128 v[108:111], v17 offset:56320
  s_waitcnt vmcnt(11) lgkmcnt(7)
  v_mfma_f32_32x32x16_bf16 v[56:71], v[116:119], a[16:19], v[56:71]
  ds_read_b128 v[112:115], v17 offset:54272
  buffer_load_dwordx4 v1, s[4:7], s84 offen offset:2048 lds
  s_and_b32 s61, s16, 1
  s_lshl_b32 s52, s24, 1
  s_add_u32 s52, s52, s61
  s_waitcnt lgkmcnt(7)
  v_mfma_f32_32x32x16_bf16 v[72:87], a[16:19], v[120:123], v[72:87]
  ds_read_b128 v[116:119], v17 offset:58368
  s_lshl_b32 s61, s61, 10
  s_add_u32 s61, s61, 135168
  v_add_u32 v143, s61, v1
  s_waitcnt lgkmcnt(7)
  v_mfma_f32_32x32x16_bf16 v[40:55], v[124:127], a[16:19], v[40:55]
  ds_read_b128 v[120:123], v17 offset:59392
  buffer_load_dwordx4 a[56:59], v1, s[4:7], s31 offen offset:2048 sc1
  s_and_b32 s62, s16, 2
  s_mul_i32 s54, s62, 6144
  v_add_u32 v163, s54, v143
  s_waitcnt vmcnt(12) lgkmcnt(7)
  v_mfma_f32_32x32x16_bf16 v[56:71], v[128:131], a[20:23], v[56:71]
  ds_read_b128 v[124:127], v17 offset:57344
  s_add_u32 s61, s61, s54
  v_add_u32 v145, s61, v2
  s_sub_u32 s54, 12288, s54
  s_waitcnt lgkmcnt(7)
  v_mfma_f32_32x32x16_bf16 v[72:87], a[20:23], v[132:135], v[72:87]
  ds_read_b128 v[128:131], v17 offset:61440
  buffer_load_dwordx4 v1, s[4:7], s84 offen offset:3072 lds
  s_add_u32 s84, s84, 4096
  v_add_u32 v141, s54, v143
  s_lshl_b32 s53, s23, 2
  s_add_u32 s53, s53, s62
  s_waitcnt lgkmcnt(7)
  v_mfma_f32_32x32x16_bf16 v[40:55], v[136:139], a[20:23], v[40:55]
  ds_read_b128 v[132:135], v17 offset:62464
  s_lshl_b32 s62, s62, 11
  s_xor_b32 s54, s23, 1
  s_lshl_b32 s54, s54, 13
  s_waitcnt vmcnt(12) lgkmcnt(7)
  v_mfma_f32_32x32x16_bf16 v[56:71], v[104:107], a[24:27], v[56:71]
  ds_read_b128 v[136:139], v17 offset:60416
  buffer_load_dwordx4 a[60:63], v1, s[4:7], s31 offen offset:3072 sc1
  s_add_u32 s31, s31, 4096
  s_add_u32 s54, s54, s62
  s_and_b32 s59, s23, 14
  s_add_u32 s59, s59, 2
  s_waitcnt lgkmcnt(7)
  v_mfma_f32_32x32x16_bf16 v[72:87], a[24:27], v[108:111], v[72:87]
  ds_read_b128 v[104:107], v17 offset:64512
  s_and_b32 s59, s59, 15
  s_lshl_b32 s59, s59, 13
  s_add_u32 s59, s59, s62
  s_waitcnt lgkmcnt(7)
  v_mfma_f32_32x32x16_bf16 v[40:55], v[112:115], a[24:27], v[40:55]
  ds_read_b128 v[108:111], v18 offset:0
  s_add_u32 m0, s85, 37888
  s_nop 0
  buffer_load_dwordx4 v1, s[4:7], s84 offen offset:0 lds
  s_xor_b32 s60, s77, 256
  s_lshl_b32 s61, s52, 17
  s_add_u32 s61, s61, 0x1e00000
  s_waitcnt vmcnt(13) lgkmcnt(7)
  v_mfma_f32_32x32x16_bf16 v[56:71], v[116:119], a[28:31], v[56:71]
  ds_read_b128 v[112:115], v17 offset:63488
  s_mov_b32 s58, 0
  s_mul_i32 s55, s24, 7
  s_add_u32 s57, s55, 4
  s_waitcnt lgkmcnt(7)
  v_mfma_f32_32x32x16_bf16 v[72:87], a[28:31], v[120:123], v[72:87]
  ds_read_b128 v[116:119], v18 offset:2048
  buffer_load_dwordx4 a[64:67], v1, s[4:7], s31 offen offset:0 sc1
  s_add_u32 s55, s55, s16
  s_mul_i32 s55, s55, 33792
  s_add_u32 s55, s55, 0x5d0000
  s_waitcnt lgkmcnt(7)
  v_mfma_f32_32x32x16_bf16 v[40:55], v[124:127], a[28:31], v[40:55]
  ds_read_b128 v[120:123], v18 offset:3072
  s_mul_i32 s57, s57, 33792
  s_lshl_b32 s62, s16, 13
  s_add_u32 s57, s57, s62
  s_waitcnt vmcnt(13) lgkmcnt(7)
  v_mfma_f32_32x32x16_bf16 v[56:71], v[128:131], a[32:35], v[56:71]
  ds_read_b128 v[124:127], v18 offset:1024
  buffer_load_dwordx4 v1, s[4:7], s84 offen offset:1024 lds
  s_add_u32 s57, s57, 0x5d0000
  s_lshl_b32 s56, s22, 15
  s_add_u32 s56, s56, 0x390000
  s_waitcnt lgkmcnt(7)
  v_mfma_f32_32x32x16_bf16 v[72:87], a[32:35], v[132:135], v[72:87]
  ds_read_b128 v[128:131], v1 offset:1024
  s_lshl_b32 s86, s21, 15
  s_lshl_b32 s62, s22, 11
  s_add_u32 s86, s86, s62
  s_waitcnt lgkmcnt(7)
  v_mfma_f32_32x32x16_bf16 v[40:55], v[136:139], a[32:35], v[40:55]
  ds_read_b128 v[132:135], v1 offset:2048
  buffer_load_dwordx4 a[68:71], v1, s[4:7], s31 offen offset:1024 sc1
  s_add_u32 s86, s86, 0x1600000
  v_and_b32 v176, 27, v0
  v_mov_b32 v177, 0x3f803f80
  s_waitcnt vmcnt(14) lgkmcnt(7)
  v_mfma_f32_32x32x16_bf16 v[56:71], v[104:107], a[36:39], v[56:71]
  ds_read_b128 v[136:139], v1 offset:0
  v_cmp_eq_u32 s[64:65], 16, v176
  s_nop 1
  v_cndmask_b32 v176, 0, v177, s[64:65]
  v_mov_b32 v177, v176
  s_waitcnt lgkmcnt(7)
  v_mfma_f32_32x32x16_bf16 v[72:87], a[36:39], v[108:111], v[72:87]
  ds_read_b128 v[104:107], v1 offset:4096
  buffer_load_dwordx4 v1, s[4:7], s84 offen offset:2048 lds
  v_mov_b64 v[178:179], v[176:177]
  v_mov_b64 v[180:181], v[176:177]
  v_mov_b64 v[182:183], v[176:177]
  s_waitcnt lgkmcnt(7)
  v_mfma_f32_32x32x16_bf16 v[40:55], v[112:115], a[36:39], v[40:55]
  ds_read_b128 v[108:111], v1 offset:5120
  v_mov_b64 v[184:185], v[176:177]
  v_mov_b64 v[186:187], v[176:177]
  v_mov_b64 v[188:189], v[176:177]
  s_waitcnt vmcnt(14) lgkmcnt(7)
  v_mfma_f32_32x32x16_bf16 v[56:71], v[116:119], a[40:43], v[56:71]
  ds_read_b128 v[112:115], v1 offset:3072
  buffer_load_dwordx4 a[72:75], v1, s[4:7], s31 offen offset:2048 sc1
  v_mov_b64 v[190:191], v[176:177]
  v_mov_b64 v[192:193], 0
  v_mov_b64 v[194:195], 0
  s_waitcnt lgkmcnt(7)
  v_mfma_f32_32x32x16_bf16 v[72:87], a[40:43], v[120:123], v[72:87]
  ds_read_b128 v[116:119], v1 offset:7168
  v_mov_b64 v[196:197], 0
  v_mov_b64 v[198:199], 0
  v_mov_b64 v[200:201], 0
  s_waitcnt lgkmcnt(7)
  v_mfma_f32_32x32x16_bf16 v[40:55], v[124:127], a[40:43], v[40:55]
  ds_read_b128 v[120:123], v1 offset:8192
  buffer_load_dwordx4 v1, s[4:7], s84 offen offset:3072 lds
  s_add_u32 s84, s84, 4096
  v_mov_b64 v[202:203], 0
  v_mov_b64 v[204:205], 0
  v_mov_b64 v[206:207], 0
  s_waitcnt vmcnt(15) lgkmcnt(7)
  v_mfma_f32_32x32x16_bf16 v[56:71], v[128:131], a[44:47], v[56:71]
  ds_read_b128 v[124:127], v1 offset:6144
  v_mov_b64 v[208:209], 0
  v_mov_b64 v[210:211], 0
  v_mov_b64 v[212:213], 0
  s_waitcnt lgkmcnt(7)
  v_mfma_f32_32x32x16_bf16 v[72:87], a[44:47], v[132:135], v[72:87]
  ds_read_b128 v[128:131], v1 offset:10240
  buffer_load_dwordx4 a[76:79], v1, s[4:7], s31 offen offset:3072 sc1
  s_add_u32 s31, s31, 4096
  v_mov_b64 v[214:215], 0
  v_mov_b64 v[216:217], 0
  v_mov_b64 v[218:219], 0
  s_waitcnt lgkmcnt(7)
  v_mfma_f32_32x32x16_bf16 v[40:55], v[136:139], a[44:47], v[40:55]
  ds_read_b128 v[132:135], v1 offset:11264
  v_mov_b64 v[220:221], 0
  v_mov_b64 v[222:223], 0
  v_mov_b64 v[224:225], 0
  s_waitcnt vmcnt(14) lgkmcnt(7)
  v_mfma_f32_32x32x16_bf16 v[56:71], v[104:107], a[48:51], v[56:71]
  ds_read_b128 v[136:139], v1 offset:9216
  s_add_u32 m0, s85, 41984
  s_nop 0
  buffer_load_dwordx4 v1, s[4:7], s84 offen offset:0 lds
  s_add_u32 s84, s84, 25600
  v_mov_b64 v[226:227], 0
  v_mov_b64 v[228:229], 0
  v_mov_b64 v[230:231], 0
  s_waitcnt lgkmcnt(7)
  v_mfma_f32_32x32x16_bf16 v[72:87], a[48:51], v[108:111], v[72:87]
  ds_read_b128 v[104:107], v1 offset:13312
  v_mov_b64 v[232:233], 0
  v_mov_b64 v[234:235], 0
  v_mov_b64 v[236:237], 0
  s_waitcnt lgkmcnt(7)
  v_mfma_f32_32x32x16_bf16 v[40:55], v[112:115], a[48:51], v[40:55]
  ds_read_b128 v[108:111], v1 offset:14336
  buffer_load_dwordx4 a[80:83], v1, s[4:7], s31 offen offset:0 sc1
  v_mov_b64 v[238:239], 0
  v_mov_b64 v[240:241], 0
  v_mov_b64 v[242:243], 0
  s_waitcnt vmcnt(14) lgkmcnt(7)
  v_mfma_f32_32x32x16_bf16 v[56:71], v[116:119], a[52:55], v[56:71]
  ds_read_b128 v[112:115], v1 offset:12288
  v_mov_b64 v[244:245], 0
  v_mov_b64 v[246:247], 0
  v_mov_b64 v[248:249], 0
  s_waitcnt lgkmcnt(7)
  v_mfma_f32_32x32x16_bf16 v[72:87], a[52:55], v[120:123], v[72:87]
  ds_read_b128 v[116:119], v1 offset:16384
  buffer_load_dwordx4 a[84:87], v1, s[4:7], s31 offen offset:1024 sc1
  v_mov_b64 v[250:251], 0
  v_mov_b64 v[252:253], 0
  v_mov_b64 v[254:255], 0
  s_waitcnt lgkmcnt(7)
  v_mfma_f32_32x32x16_bf16 v[40:55], v[124:127], a[52:55], v[40:55]
  ds_read_b128 v[120:123], v1 offset:17408
  s_add_u32 s8, s4, s61
  s_addc_u32 s9, s5, 0
  s_mov_b32 s10, 0x20000
  s_mov_b32 s11, 0x20000
  s_waitcnt vmcnt(13) lgkmcnt(7)
  v_mfma_f32_32x32x16_bf16 v[56:71], v[128:131], a[56:59], v[56:71]
  ds_read_b128 v[124:127], v1 offset:15360
  buffer_load_dwordx4 v[24:27], v1, s[4:7], s32 offen offset:0 sc1
  s_mul_i32 s63, s16, 28672
  s_add_u32 s63, s63, 0x410000
  s_xor_b32 s66, s25, 0
  s_waitcnt lgkmcnt(7)
  v_mfma_f32_32x32x16_bf16 v[72:87], a[56:59], v[132:135], v[72:87]
  ds_read_b128 v[128:131], v1 offset:19456
  s_mul_i32 s66, s66, 114688
  s_add_u32 s66, s66, s63
  s_add_u32 s67, s66, 7168
  s_waitcnt lgkmcnt(7)
  v_mfma_f32_32x32x16_bf16 v[40:55], v[136:139], a[56:59], v[40:55]
  ds_read_b128 v[132:135], v1 offset:20480
  buffer_load_dwordx4 v[28:31], v1, s[4:7], s32 offen offset:1024 sc1
  s_add_u32 s68, s66, 14336
  s_add_u32 s69, s66, 21504
  s_xor_b32 s70, s25, 1
  s_waitcnt vmcnt(13) lgkmcnt(7)
  v_mfma_f32_32x32x16_bf16 v[56:71], v[104:107], a[60:63], v[56:71]
  ds_read_b128 v[136:139], v1 offset:18432
  s_mul_i32 s70, s70, 114688
  s_add_u32 s70, s70, s63
  s_add_u32 s71, s70, 7168
  s_waitcnt lgkmcnt(7)
  v_mfma_f32_32x32x16_bf16 v[72:87], a[60:63], v[108:111], v[72:87]
  ds_read_b128 v[104:107], v1 offset:22528
  buffer_load_dwordx4 v[32:35], v1, s[4:7], s32 offen offset:2048 sc1
  s_add_u32 s72, s70, 14336
  s_add_u32 s73, s70, 21504
  s_waitcnt lgkmcnt(7)
  v_mfma_f32_32x32x16_bf16 v[40:55], v[112:115], a[60:63], v[40:55]
  ds_read_b128 v[108:111], v1 offset:23552
  s_waitcnt vmcnt(12) lgkmcnt(7)
  v_mfma_f32_32x32x16_bf16 v[56:71], v[116:119], a[64:67], v[56:71]
  ds_read_b128 v[112:115], v1 offset:21504
  buffer_load_dwordx4 v[36:39], v1, s[4:7], s32 offen offset:3072 sc1
  s_waitcnt lgkmcnt(7)
  v_mfma_f32_32x32x16_bf16 v[72:87], a[64:67], v[120:123], v[72:87]
  ds_read_b128 v[116:119], v1 offset:25600
  s_waitcnt lgkmcnt(7)
  v_mfma_f32_32x32x16_bf16 v[40:55], v[124:127], a[64:67], v[40:55]
  ds_read_b128 v[120:123], v1 offset:26624
  buffer_load_dwordx4 a[88:91], v1, s[4:7], s31 offen offset:2048 sc1
  s_waitcnt vmcnt(12) lgkmcnt(7)
  v_mfma_f32_32x32x16_bf16 v[56:71], v[128:131], a[68:71], v[56:71]
  ds_read_b128 v[124:127], v1 offset:24576
  s_waitcnt lgkmcnt(7)
  v_mfma_f32_32x32x16_bf16 v[72:87], a[68:71], v[132:135], v[72:87]
  ds_read_b128 v[128:131], v1 offset:28672
  buffer_load_dwordx4 a[92:95], v1, s[4:7], s31 offen offset:3072 sc1
  s_add_u32 s31, s31, 4096
  s_waitcnt lgkmcnt(7)
  v_mfma_f32_32x32x16_bf16 v[40:55], v[136:139], a[68:71], v[40:55]
  ds_read_b128 v[132:135], v1 offset:29696
  s_waitcnt vmcnt(11) lgkmcnt(7)
  v_mfma_f32_32x32x16_bf16 v[56:71], v[104:107], a[72:75], v[56:71]
  ds_read_b128 v[136:139], v1 offset:27648
  buffer_load_dwordx4 a[96:99], v1, s[4:7], s31 offen offset:0 sc1
  s_waitcnt lgkmcnt(7)
  v_mfma_f32_32x32x16_bf16 v[72:87], a[72:75], v[108:111], v[72:87]
  ds_read_b128 v[104:107], v1 offset:31744
  s_waitcnt lgkmcnt(7)
  v_mfma_f32_32x32x16_bf16 v[40:55], v[112:115], a[72:75], v[40:55]
  ds_read_b128 v[108:111], v1 offset:32768
  buffer_load_dwordx4 a[100:103], v1, s[4:7], s31 offen offset:1024 sc1
  s_waitcnt vmcnt(11) lgkmcnt(7)
  v_mfma_f32_32x32x16_bf16 v[56:71], v[116:119], a[76:79], v[56:71]
  ds_read_b128 v[112:115], v1 offset:30720
  s_waitcnt lgkmcnt(7)
  v_mfma_f32_32x32x16_bf16 v[72:87], a[76:79], v[120:123], v[72:87]
  s_waitcnt vmcnt(10)
  s_barrier
  ds_read_b128 v[116:119], v1 offset:34816
  buffer_load_dwordx4 a[104:107], v1, s[4:7], s31 offen offset:2048 sc1
  s_waitcnt lgkmcnt(7)
  v_mfma_f32_32x32x16_bf16 v[40:55], v[124:127], a[76:79], v[40:55]
  ds_read_b128 v[120:123], v1 offset:35840
  s_waitcnt vmcnt(10) lgkmcnt(7)
  v_mfma_f32_32x32x16_bf16 v[56:71], v[128:131], a[80:83], v[56:71]
  ds_read_b128 v[124:127], v1 offset:33792
  buffer_load_dwordx4 a[108:111], v1, s[4:7], s31 offen offset:3072 sc1
  s_add_u32 s31, s31, 4096
  s_waitcnt lgkmcnt(7)
  v_mfma_f32_32x32x16_bf16 v[72:87], a[80:83], v[132:135], v[72:87]
  ds_read_b128 v[128:131], v1 offset:37888
  s_waitcnt lgkmcnt(7)
  v_mfma_f32_32x32x16_bf16 v[40:55], v[136:139], a[80:83], v[40:55]
  ds_read_b128 v[132:135], v1 offset:38912
  buffer_load_dwordx4 a[112:115], v1, s[4:7], s31 offen offset:0 sc1
  s_waitcnt vmcnt(11) lgkmcnt(7)
  v_mfma_f32_32x32x16_bf16 v[56:71], v[104:107], a[84:87], v[56:71]
  ds_read_b128 v[136:139], v1 offset:36864
  s_waitcnt lgkmcnt(7)
  v_mfma_f32_32x32x16_bf16 v[72:87], a[84:87], v[108:111], v[72:87]
  ds_read_b128 v[104:107], v1 offset:40960
  buffer_load_dwordx4 a[116:119], v1, s[4:7], s31 offen offset:1024 sc1
  s_waitcnt lgkmcnt(7)
  v_mfma_f32_32x32x16_bf16 v[40:55], v[112:115], a[84:87], v[40:55]
  ds_read_b128 v[108:111], v1 offset:41984
  s_waitcnt vmcnt(7) lgkmcnt(7)
  v_mfma_f32_32x32x16_bf16 v[56:71], v[116:119], a[88:91], v[56:71]
  ds_read_b128 v[112:115], v1 offset:39936
  buffer_load_dwordx4 a[120:123], v1, s[4:7], s31 offen offset:2048 sc1
  s_waitcnt lgkmcnt(7)
  v_mfma_f32_32x32x16_bf16 v[72:87], a[88:91], v[120:123], v[72:87]
  ds_read_b128 v[116:119], v1 offset:44032
  s_waitcnt lgkmcnt(7)
  v_mfma_f32_32x32x16_bf16 v[40:55], v[124:127], a[88:91], v[40:55]
  ds_read_b128 v[120:123], v1 offset:45056
  buffer_load_dwordx4 a[124:127], v1, s[4:7], s31 offen offset:3072 sc1
  s_waitcnt vmcnt(10)
  s_waitcnt vmcnt(8) lgkmcnt(7)
  v_mfma_f32_32x32x16_bf16 v[56:71], v[128:131], a[92:95], v[56:71]
  ds_read_b128 v[124:127], v1 offset:43008
  v_add_f32 v24, v24, v32
  v_add_f32 v25, v25, v33
  v_add_f32 v26, v26, v34
  s_waitcnt lgkmcnt(7)
  v_mfma_f32_32x32x16_bf16 v[72:87], a[92:95], v[132:135], v[72:87]
  ds_read_b128 v[128:131], v1 offset:47104
  v_add_f32 v27, v27, v35
  v_add_f32 v28, v28, v36
  v_add_f32 v29, v29, v37
  s_waitcnt lgkmcnt(7)
  v_mfma_f32_32x32x16_bf16 v[40:55], v[136:139], a[92:95], v[40:55]
  ds_read_b128 v[132:135], v1 offset:48128
  v_add_f32 v30, v30, v38
  v_add_f32 v31, v31, v39
  v_add_f32 v24, v24, v28
  s_waitcnt vmcnt(7) lgkmcnt(7)
  v_mfma_f32_32x32x16_bf16 v[56:71], v[104:107], a[96:99], v[56:71]
  ds_read_b128 v[136:139], v1 offset:46080
  v_add_f32 v25, v25, v29
  v_add_f32 v26, v26, v30
  v_add_f32 v27, v27, v31
  s_waitcnt lgkmcnt(7)
  v_mfma_f32_32x32x16_bf16 v[72:87], a[96:99], v[108:111], v[72:87]
  ds_read_b128 v[104:107], v1 offset:50176
  v_and_b32 v28, 1, v0
  v_bfe_u32 v29, v0, 1, 1
  v_permlane32_swap_b32 v24, v25
  s_waitcnt lgkmcnt(7)
  v_mfma_f32_32x32x16_bf16 v[40:55], v[112:115], a[96:99], v[40:55]
  ds_read_b128 v[108:111], v1 offset:51200
  v_permlane32_swap_b32 v26, v27
  v_lshl_or_b32 v28, v28, 1, v29
  v_and_b32 v29, 28, v0
  s_waitcnt vmcnt(6) lgkmcnt(7)
  v_mfma_f32_32x32x16_bf16 v[56:71], v[116:119], a[100:103], v[56:71]
  ds_read_b128 v[112:115], v1 offset:49152
  v_add_f32 v24, v24, v25
  v_add_f32 v26, v26, v27
  v_lshl_or_b32 v28, v28, 6, v29
  s_waitcnt lgkmcnt(7)
  v_mfma_f32_32x32x16_bf16 v[72:87], a[100:103], v[120:123], v[72:87]
  ds_read_b128 v[116:119], v1 offset:53248
  v_permlane16_swap_b32 v24, v26
  v_add_f32 v24, v24, v26
  ds_bpermute_b32 v26, v28, v24
  s_waitcnt lgkmcnt(8)
  v_mfma_f32_32x32x16_bf16 v[40:55], v[124:127], a[100:103], v[40:55]
  ds_read_b128 v[120:123], v1 offset:54272
  ds_bpermute_b32 v25, v28, v24 offset:32
  s_waitcnt vmcnt(5) lgkmcnt(9)
  v_mfma_f32_32x32x16_bf16 v[56:71], v[128:131], a[104:107], v[56:71]
  ds_read_b128 v[124:127], v1 offset:52224
  s_waitcnt lgkmcnt(9)
  v_mfma_f32_32x32x16_bf16 v[72:87], a[104:107], v[132:135], v[72:87]
  ds_read_b128 v[128:131], v1 offset:56320
  s_waitcnt lgkmcnt(2)
  v_mul_f32 v140, 0x3b000000, v26
  v_mul_f32 v25, 0x3b000000, v25
  s_waitcnt lgkmcnt(9)
  v_mfma_f32_32x32x16_bf16 v[40:55], v[136:139], a[104:107], v[40:55]
  ds_read_b128 v[132:135], v1 offset:57344
  v_fma_f32 v25, -v140, v140, v25
  v_max_f32 v25, 0, v25
  v_add_f32 v25, 0x3727c5ac, v25
  s_waitcnt vmcnt(4) lgkmcnt(9)
  v_mfma_f32_32x32x16_bf16 v[56:71], v[104:107], a[108:111], v[56:71]
  ds_read_b128 v[136:139], v1 offset:55296
  v_rsq_f32 v142, v25
  v_cvt_pk_bf16_f32 v148, -v140, -v140
  v_cvt_pk_bf16_f32 v149, -v140, -v140
  s_waitcnt lgkmcnt(9)
  v_mfma_f32_32x32x16_bf16 v[72:87], a[108:111], v[108:111], v[72:87]
  ds_read_b128 v[104:107], v1 offset:59392
  v_cvt_pk_bf16_f32 v150, -v140, -v140
  v_cvt_pk_bf16_f32 v151, -v140, -v140
  v_mul_f32 v144, 0x3eb8aa3b, v142
  s_waitcnt lgkmcnt(9)
  v_mfma_f32_32x32x16_bf16 v[40:55], v[112:115], a[108:111], v[40:55]
  ds_read_b128 v[108:111], v1 offset:60416
  v_and_b32 v24, 0xffff0000, v142
  v_sub_f32 v25, v142, v24
  v_and_b32 v26, 0xffff0000, v25
  s_waitcnt vmcnt(3) lgkmcnt(9)
  v_mfma_f32_32x32x16_bf16 v[56:71], v[116:119], a[112:115], v[56:71]
  ds_read_b128 v[112:115], v1 offset:58368
  v_sub_f32 v25, v25, v26
  v_cvt_pk_bf16_f32 v152, v24, v26
  v_cvt_pk_bf16_f32 v153, v25, 0
  s_waitcnt lgkmcnt(8)
  v_mfma_f32_32x32x16_bf16 v[72:87], a[112:115], v[120:123], v[72:87]
  ds_read_b128 v[116:119], v1 offset:62464
  v_mov_b32 v154, 0
  v_mov_b32 v155, 0
  v_mov_b32 v156, 0x3f003f00
  s_waitcnt lgkmcnt(7)
  v_mfma_f32_32x32x16_bf16 v[40:55], v[124:127], a[112:115], v[40:55]
  ds_read_b128 v[120:123], v1 offset:63488
  v_mov_b32 v157, 0x3f003f00
  v_mov_b32 v158, 0
  v_mov_b32 v159, 0
  s_waitcnt vmcnt(2) lgkmcnt(7)
  v_mfma_f32_32x32x16_bf16 v[56:71], v[128:131], a[116:119], v[56:71]
  ds_read_b128 v[124:127], v1 offset:61440
  s_lshl_b32 s33, s24, 7
  s_add_u32 s33, s33, s27
  s_lshl_b32 s33, s33, 11
  s_add_u32 s33, s33, 0x1e00000
  s_add_u32 s35, s33, 0x20000
  s_mul_i32 s34, s16, 6144
  s_waitcnt lgkmcnt(7)
  v_mfma_f32_32x32x16_bf16 v[72:87], a[116:119], v[132:135], v[72:87]
  ds_read_b128 v[128:131], v17 offset:0
  s_add_u32 s34, s34, 135168
  v_add_u32 v160, s34, v20
  v_lshrrev_b32 v161, 7, v21
  v_and_b32 v161, 0x400, v161
  v_add3_u32 v161, v161, v2, s34
  v_add_u32 v162, s34, v1
  s_waitcnt lgkmcnt(7)
  v_mfma_f32_32x32x16_bf16 v[40:55], v[136:139], a[116:119], v[40:55]
  ds_read_b128 v[132:135], v17 offset:1024
  s_waitcnt vmcnt(1) lgkmcnt(7)
  v_mfma_f32_32x32x16_bf16 v[56:71], v[104:107], a[120:123], v[56:71]
  ds_read_b128 v[136:139], v1 offset:64512
  s_waitcnt lgkmcnt(7)
  v_mfma_f32_32x32x16_bf16 v[72:87], a[120:123], v[108:111], v[72:87]
  s_waitcnt lgkmcnt(6)
  v_mfma_f32_32x32x16_bf16 v[40:55], v[112:115], a[120:123], v[40:55]
  s_waitcnt vmcnt(0) lgkmcnt(5)
  v_mfma_f32_32x32x16_bf16 v[56:71], v[116:119], a[124:127], v[56:71]
  s_waitcnt lgkmcnt(4)
  v_mfma_f32_32x32x16_bf16 v[72:87], a[124:127], v[120:123], v[72:87]
  s_waitcnt lgkmcnt(3)
  v_mfma_f32_32x32x16_bf16 v[40:55], v[124:127], a[124:127], v[40:55]
  v_mfma_f32_32x32x16_bf16 v[88:103], v[152:155], v[156:159], 0
  s_waitcnt lgkmcnt(2)
  v_mfma_f32_32x32x16_bf16 v[56:71], v[128:131], v[148:151], v[56:71]
  s_waitcnt lgkmcnt(1)
  v_mfma_f32_32x32x16_bf16 v[72:87], v[148:151], v[132:135], v[72:87]
  s_waitcnt lgkmcnt(0)
  v_mfma_f32_32x32x16_bf16 v[40:55], v[136:139], v[148:151], v[40:55]
  s_nop 7
  v_pk_mul_f32 v[56:57], v[56:57], v[142:143] op_sel_hi:[1,0]
  v_pk_mul_f32 v[58:59], v[58:59], v[142:143] op_sel_hi:[1,0]
  v_pk_mul_f32 v[60:61], v[60:61], v[142:143] op_sel_hi:[1,0]
  v_pk_mul_f32 v[62:63], v[62:63], v[142:143] op_sel_hi:[1,0]
  v_pk_mul_f32 v[64:65], v[64:65], v[142:143] op_sel_hi:[1,0]
  v_pk_mul_f32 v[66:67], v[66:67], v[142:143] op_sel_hi:[1,0]
  v_pk_mul_f32 v[68:69], v[68:69], v[142:143] op_sel_hi:[1,0]
  v_pk_mul_f32 v[70:71], v[70:71], v[142:143] op_sel_hi:[1,0]
  v_cvt_pk_bf16_f32 v104, v56, v57
  v_cvt_pk_bf16_f32 v105, v58, v59
  v_cvt_pk_bf16_f32 v106, v60, v61
  v_cvt_pk_bf16_f32 v107, v62, v63
  v_cvt_pk_bf16_f32 v108, v64, v65
  v_cvt_pk_bf16_f32 v109, v66, v67
  v_cvt_pk_bf16_f32 v110, v68, v69
  v_cvt_pk_bf16_f32 v111, v70, v71
  buffer_store_dwordx4 v[104:107], v20, s[4:7], s33 offen sc1
  buffer_store_dwordx4 v[108:111], v20, s[4:7], s35 offen sc1
  ds_write_b128 v160, v[104:107]
  ds_write_b128 v160, v[108:111] offset:1024
  v_pk_mul_f32 v[72:73], v[72:73], v[88:89]
  v_pk_mul_f32 v[74:75], v[74:75], v[90:91]
  v_pk_mul_f32 v[76:77], v[76:77], v[92:93]
  v_pk_mul_f32 v[78:79], v[78:79], v[94:95]
  v_pk_mul_f32 v[80:81], v[80:81], v[96:97]
  v_pk_mul_f32 v[82:83], v[82:83], v[98:99]
  v_pk_mul_f32 v[84:85], v[84:85], v[100:101]
  v_pk_mul_f32 v[86:87], v[86:87], v[102:103]
  v_cvt_pk_bf16_f32 v112, v72, v73
  v_cvt_pk_bf16_f32 v113, v74, v75
  v_cvt_pk_bf16_f32 v114, v76, v77
  v_cvt_pk_bf16_f32 v115, v78, v79
  v_cvt_pk_bf16_f32 v116, v80, v81
  v_cvt_pk_bf16_f32 v117, v82, v83
  v_cvt_pk_bf16_f32 v118, v84, v85
  v_cvt_pk_bf16_f32 v119, v86, v87
  buffer_store_dwordx4 v[112:115], v21, s[4:7], s33 offen offset:1024 sc1
  buffer_store_dwordx4 v[116:119], v21, s[4:7], s33 offen offset:1536 sc1
  ds_write_b128 v161, v[112:115] offset:2048
  ds_write_b128 v161, v[116:119] offset:2560
  v_pk_mul_f32 v[40:41], v[40:41], v[144:145] op_sel_hi:[1,0]
  v_pk_mul_f32 v[42:43], v[42:43], v[144:145] op_sel_hi:[1,0]
  v_pk_mul_f32 v[44:45], v[44:45], v[144:145] op_sel_hi:[1,0]
  v_pk_mul_f32 v[46:47], v[46:47], v[144:145] op_sel_hi:[1,0]
  v_pk_mul_f32 v[48:49], v[48:49], v[144:145] op_sel_hi:[1,0]
  v_pk_mul_f32 v[50:51], v[50:51], v[144:145] op_sel_hi:[1,0]
  v_pk_mul_f32 v[52:53], v[52:53], v[144:145] op_sel_hi:[1,0]
  v_pk_mul_f32 v[54:55], v[54:55], v[144:145] op_sel_hi:[1,0]
  v_cvt_pk_bf16_f32 v120, v40, v41
  v_cvt_pk_bf16_f32 v121, v42, v43
  v_cvt_pk_bf16_f32 v122, v44, v45
  v_cvt_pk_bf16_f32 v123, v46, v47
  v_cvt_pk_bf16_f32 v124, v48, v49
  v_cvt_pk_bf16_f32 v125, v50, v51
  v_cvt_pk_bf16_f32 v126, v52, v53
  v_cvt_pk_bf16_f32 v127, v54, v55
  ds_write_b128 v162, v[120:123] offset:4096
  ds_write_b128 v162, v[124:127] offset:5120
  s_waitcnt lgkmcnt(0)
  s_barrier
  ds_read_b128 v[128:131], v143
  ds_read_b128 a[248:251], v141 offset:4096
  ds_read_b128 a[252:255], v141 offset:10240
  ds_read_b128 a[240:243], v163 offset:4096
  ds_read_b128 a[244:247], v163 offset:10240
  ds_read_b128 v[120:123], v163 offset:0
  ds_read_b128 v[124:127], v163 offset:6144
  s_mov_b64 exec, s[28:29]
  ds_read_b128 v[176:179], v145 offset:2048
  ds_read_b128 v[180:183], v145 offset:2560
  ds_read_b128 v[184:187], v145 offset:8192
  ds_read_b128 v[188:191], v145 offset:8704
  s_mov_b64 exec, -1
  s_waitcnt lgkmcnt(9)
  v_mfma_f32_32x32x16_bf16 v[88:103], v[128:131], a[248:251], 0
  s_waitcnt lgkmcnt(8)
  v_mfma_f32_32x32x16_bf16 v[104:119], v[128:131], a[252:255], 0
  s_waitcnt lgkmcnt(7)
  v_mfma_f32_32x32x16_bf16 v[56:71], v[128:131], a[240:243], 0
  s_waitcnt lgkmcnt(6)
  v_mfma_f32_32x32x16_bf16 v[72:87], v[128:131], a[244:247], 0
  s_nop 5
  v_max3_f32 v40, v88, v89, v88
  v_max3_f32 v40, v90, v91, v40
  v_max3_f32 v40, v92, v93, v40
  v_max3_f32 v40, v94, v95, v40
  v_max3_f32 v40, v96, v97, v40
  v_max3_f32 v40, v98, v99, v40
  v_max3_f32 v40, v100, v101, v40
  v_max3_f32 v40, v102, v103, v40
  v_mov_b32 v41, v40
  s_nop 1
  v_permlane32_swap_b32 v40, v41
  v_max_f32 v40, v40, v41
  v_sub_f32 v88, 0, v40
  v_sub_f32 v89, 0, v40
  v_mov_b64 v[90:91], v[88:89]
  v_mov_b64 v[92:93], v[88:89]
  v_mov_b64 v[94:95], v[88:89]
  v_mov_b64 v[96:97], v[88:89]
  v_mov_b64 v[98:99], v[88:89]
  v_mov_b64 v[100:101], v[88:89]
  v_mov_b64 v[102:103], v[88:89]
  s_waitcnt lgkmcnt(0)
  s_nop 0
  v_mfma_f32_32x32x16_bf16 v[24:39], v[120:123], a[248:251], v[88:103]
  v_max3_f32 v40, v104, v105, v104
  v_max3_f32 v40, v106, v107, v40
  v_max3_f32 v40, v108, v109, v40
  v_max3_f32 v40, v110, v111, v40
  v_max3_f32 v40, v112, v113, v40
  v_max3_f32 v40, v114, v115, v40
  v_max3_f32 v40, v116, v117, v40
  v_max3_f32 v40, v118, v119, v40
  v_mov_b32 v41, v40
  s_nop 1
  v_permlane32_swap_b32 v40, v41
  v_max_f32 v40, v40, v41
  v_sub_f32 v104, 0, v40
  v_sub_f32 v105, 0, v40
  v_mov_b64 v[106:107], v[104:105]
  v_mov_b64 v[108:109], v[104:105]
  v_mov_b64 v[110:111], v[104:105]
  v_mov_b64 v[112:113], v[104:105]
  v_mov_b64 v[114:115], v[104:105]
  v_mov_b64 v[116:117], v[104:105]
  v_mov_b64 v[118:119], v[104:105]
  v_max3_f32 v40, v56, v57, v56
  v_max3_f32 v40, v58, v59, v40
  v_max3_f32 v40, v60, v61, v40
  v_max3_f32 v40, v62, v63, v40
  v_max3_f32 v40, v64, v65, v40
  v_max3_f32 v40, v66, v67, v40
  v_max3_f32 v40, v68, v69, v40
  v_max3_f32 v40, v70, v71, v40
  v_mov_b32 v41, v40
  s_nop 1
  v_permlane32_swap_b32 v40, v41
  v_max_f32 v40, v40, v41
  v_sub_f32 v56, 0, v40
  v_sub_f32 v57, 0, v40
  v_mov_b64 v[58:59], v[56:57]
  v_mov_b64 v[60:61], v[56:57]
  v_mov_b64 v[62:63], v[56:57]
  v_mov_b64 v[64:65], v[56:57]
  v_mov_b64 v[66:67], v[56:57]
  v_mov_b64 v[68:69], v[56:57]
  v_mov_b64 v[70:71], v[56:57]
  v_max3_f32 v40, v72, v73, v72
  v_max3_f32 v40, v74, v75, v40
  v_max3_f32 v40, v76, v77, v40
  v_max3_f32 v40, v78, v79, v40
  v_max3_f32 v40, v80, v81, v40
  v_max3_f32 v40, v82, v83, v40
  v_max3_f32 v40, v84, v85, v40
  v_max3_f32 v40, v86, v87, v40
  v_mov_b32 v41, v40
  s_nop 1
  v_permlane32_swap_b32 v40, v41
  v_max_f32 v40, v40, v41
  v_sub_f32 v72, 0, v40
  v_sub_f32 v73, 0, v40
  v_mov_b64 v[74:75], v[72:73]
  v_mov_b64 v[76:77], v[72:73]
  v_mov_b64 v[78:79], v[72:73]
  v_mov_b64 v[80:81], v[72:73]
  v_mov_b64 v[82:83], v[72:73]
  v_mov_b64 v[84:85], v[72:73]
  v_mov_b64 v[86:87], v[72:73]
  v_mov_b32 v175, s60
  s_mul_i32 s38, s16, 33792
  s_mov_b32 m0, s38
  v_exp_f32 v24, v24
  v_exp_f32 v25, v25
  v_exp_f32 v26, v26
  v_exp_f32 v27, v27
  v_exp_f32 v28, v28
  v_exp_f32 v29, v29
  v_exp_f32 v30, v30
  v_exp_f32 v31, v31
  v_mfma_f32_32x32x16_bf16 v[40:55], v[120:123], a[252:255], v[104:119]
  v_mov_b64 v[136:137], v[176:177]
  v_mov_b64 v[138:139], v[176:177]
  v_mov_b64 v[140:141], v[176:177]
  v_mov_b64 v[142:143], v[176:177]
  v_exp_f32 v32, v32
  v_exp_f32 v33, v33
  v_exp_f32 v34, v34
  v_exp_f32 v35, v35
  v_smfmac_f32_32x32x32_bf16 v[224:239], v[176:179], v[24:31], v3
  v_mov_b64 v[144:145], v[176:177]
  v_mov_b64 v[146:147], v[176:177]
  v_mov_b64 v[148:149], v[176:177]
  v_mov_b64 v[150:151], v[176:177]
  v_exp_f32 v36, v36
  v_exp_f32 v37, v37
  v_exp_f32 v38, v38
  v_exp_f32 v39, v39
  v_exp_f32 v40, v40
  v_exp_f32 v41, v41
  v_exp_f32 v42, v42
  v_smfmac_f32_32x32x32_bf16 v[224:239], v[180:183], v[32:39], v3
  v_exp_f32 v43, v43
  v_exp_f32 v44, v44
  v_exp_f32 v45, v45
  v_exp_f32 v46, v46
  v_exp_f32 v47, v47
  v_mfma_f32_32x32x16_bf16 v[24:39], v[120:123], a[240:243], v[56:71]
  v_exp_f32 v48, v48
  v_exp_f32 v49, v49
  v_exp_f32 v50, v50
  v_exp_f32 v51, v51
  v_smfmac_f32_32x32x32_bf16 v[240:255], v[176:179], v[40:47], v3
  v_exp_f32 v52, v52
  v_exp_f32 v53, v53
  v_exp_f32 v54, v54
  v_exp_f32 v55, v55
  s_waitcnt vmcnt(0)
  s_barrier
  v_mov_b32 v22, 3
  s_cmp_lg_u32 s16, 0
  s_cbranch_scc1 L_sig_49
  s_mov_b64 exec, 1
  v_mov_b32 v23, s78
  buffer_store_dwordx2 v[22:23], off, s[4:7], s30 sc1
  s_mov_b64 exec, -1
L_sig_49:
  v_mov_b32 v22, 8
  s_cmp_lg_u32 s16, 0
  s_cbranch_scc1 L_sig_50
  s_mov_b64 exec, 1
  s_cmp_eq_u32 s79, 0
  s_cbranch_scc1 L_far_51
  buffer_store_dword v22, off, s[4:7], s77
  s_mov_b64 exec, -1
L_sig_50:
  v_exp_f32 v24, v24
  v_exp_f32 v25, v25
  v_exp_f32 v26, v26
  v_smfmac_f32_32x32x32_bf16 v[240:255], v[180:183], v[48:55], v3
  v_exp_f32 v27, v27
  v_exp_f32 v28, v28
  v_exp_f32 v29, v29
  v_exp_f32 v30, v30
  v_exp_f32 v31, v31
  v_mfma_f32_32x32x16_bf16 v[40:55], v[120:123], a[244:247], v[72:87]
  v_exp_f32 v32, v32
  v_exp_f32 v33, v33
  v_exp_f32 v34, v34
  v_exp_f32 v35, v35
  v_smfmac_f32_32x32x32_bf16 v[192:207], v[176:179], v[24:31], v3
  v_exp_f32 v36, v36
  v_exp_f32 v37, v37
  v_exp_f32 v38, v38
  v_exp_f32 v39, v39
  v_exp_f32 v40, v40
  v_exp_f32 v41, v41
  v_exp_f32 v42, v42
  v_smfmac_f32_32x32x32_bf16 v[192:207], v[180:183], v[32:39], v3
  v_exp_f32 v43, v43
  v_exp_f32 v44, v44
  v_exp_f32 v45, v45
  v_exp_f32 v46, v46
  v_exp_f32 v47, v47
  v_mfma_f32_32x32x16_bf16 v[24:39], v[124:127], a[248:251], v[88:103]
  v_exp_f32 v48, v48
  v_exp_f32 v49, v49
  v_exp_f32 v50, v50
  v_exp_f32 v51, v51
  v_smfmac_f32_32x32x32_bf16 v[208:223], v[176:179], v[40:47], v3
  buffer_load_dword v23, v175, s[4:7], 0 offen sc1
  v_exp_f32 v52, v52
  v_exp_f32 v53, v53
  v_exp_f32 v54, v54
  v_exp_f32 v55, v55
  s_waitcnt vmcnt(0)
  v_cmp_gt_u32 vcc, 8, v23
  s_cbranch_vccnz L_slow_52
L_back_53:
  s_mov_b64 exec, s[28:29]
  buffer_load_dwordx4 v[136:139], v2, s[8:11], s54 offen offset:1024
  buffer_load_dwordx4 v[140:143], v2, s[8:11], s54 offen offset:1536
  s_mov_b64 exec, -1
  buffer_load_dwordx4 v[128:131], v1, s[8:11], s54 offen offset:0
  s_mov_b64 exec, s[28:29]
  buffer_load_dwordx4 v[144:147], v2, s[8:11], s54 offen offset:3072
  buffer_load_dwordx4 v[148:151], v2, s[8:11], s54 offen offset:3584
  s_mov_b64 exec, -1
  buffer_load_dwordx4 v[132:135], v1, s[8:11], s54 offen offset:2048
  s_mov_b32 s54, s59
  v_exp_f32 v24, v24
  v_exp_f32 v25, v25
  v_exp_f32 v26, v26
  v_smfmac_f32_32x32x32_bf16 v[208:223], v[180:183], v[48:55], v3
  v_exp_f32 v27, v27
  v_exp_f32 v28, v28
  v_exp_f32 v29, v29
  v_exp_f32 v30, v30
  v_exp_f32 v31, v31
  v_mfma_f32_32x32x16_bf16 v[40:55], v[124:127], a[252:255], v[104:119]
  v_exp_f32 v32, v32
  v_exp_f32 v33, v33
  v_exp_f32 v34, v34
  v_exp_f32 v35, v35
  v_smfmac_f32_32x32x32_bf16 v[224:239], v[184:187], v[24:31], v3
  v_exp_f32 v36, v36
  v_exp_f32 v37, v37
  v_exp_f32 v38, v38
  v_exp_f32 v39, v39
  v_exp_f32 v40, v40
  v_exp_f32 v41, v41
  v_exp_f32 v42, v42
  v_smfmac_f32_32x32x32_bf16 v[224:239], v[188:191], v[32:39], v3
  v_exp_f32 v43, v43
  v_exp_f32 v44, v44
  v_exp_f32 v45, v45
  v_exp_f32 v46, v46
  v_exp_f32 v47, v47
  v_mfma_f32_32x32x16_bf16 v[24:39], v[124:127], a[240:243], v[56:71]
  v_exp_f32 v48, v48
  v_exp_f32 v49, v49
  v_exp_f32 v50, v50
  v_exp_f32 v51, v51
  v_smfmac_f32_32x32x32_bf16 v[240:255], v[184:187], v[40:47], v3
  v_exp_f32 v52, v52
  v_exp_f32 v53, v53
  v_exp_f32 v54, v54
  v_exp_f32 v55, v55
  v_exp_f32 v24, v24
  v_exp_f32 v25, v25
  v_exp_f32 v26, v26
  v_smfmac_f32_32x32x32_bf16 v[240:255], v[188:191], v[48:55], v3
  v_exp_f32 v27, v27
  v_exp_f32 v28, v28
  v_exp_f32 v29, v29
  v_exp_f32 v30, v30
  v_exp_f32 v31, v31
  v_mfma_f32_32x32x16_bf16 v[40:55], v[124:127], a[244:247], v[72:87]
  v_exp_f32 v32, v32
  v_exp_f32 v33, v33
  v_exp_f32 v34, v34
  v_exp_f32 v35, v35
  v_smfmac_f32_32x32x32_bf16 v[192:207], v[184:187], v[24:31], v3
  v_exp_f32 v36, v36
  v_exp_f32 v37, v37
  v_exp_f32 v38, v38
  v_exp_f32 v39, v39
  v_exp_f32 v40, v40
  v_exp_f32 v41, v41
  v_exp_f32 v42, v42
  v_smfmac_f32_32x32x32_bf16 v[192:207], v[188:191], v[32:39], v3
  s_waitcnt vmcnt(3)
  v_exp_f32 v43, v43
  v_exp_f32 v44, v44
  v_exp_f32 v45, v45
  v_exp_f32 v46, v46
  v_exp_f32 v47, v47
  v_mfma_f32_32x32x16_bf16 v[24:39], v[128:131], a[248:251], v[88:103]
  v_exp_f32 v48, v48
  v_exp_f32 v49, v49
  v_exp_f32 v50, v50
  v_exp_f32 v51, v51
  v_smfmac_f32_32x32x32_bf16 v[208:223], v[184:187], v[40:47], v3
  v_exp_f32 v52, v52
  v_exp_f32 v53, v53
  v_exp_f32 v54, v54
  v_exp_f32 v55, v55
  v_exp_f32 v24, v24
  v_exp_f32 v25, v25
  v_exp_f32 v26, v26
  v_smfmac_f32_32x32x32_bf16 v[208:223], v[188:191], v[48:55], v3
  v_exp_f32 v27, v27
  v_exp_f32 v28, v28
  v_exp_f32 v29, v29
  v_exp_f32 v30, v30
  v_exp_f32 v31, v31
  v_mfma_f32_32x32x16_bf16 v[40:55], v[128:131], a[252:255], v[104:119]
  v_exp_f32 v32, v32
  v_exp_f32 v33, v33
  v_exp_f32 v34, v34
  v_exp_f32 v35, v35
  v_smfmac_f32_32x32x32_bf16 v[224:239], v[136:139], v[24:31], v3
  v_exp_f32 v36, v36
  v_exp_f32 v37, v37
  v_exp_f32 v38, v38
  v_exp_f32 v39, v39
  v_exp_f32 v40, v40
  v_exp_f32 v41, v41
  v_exp_f32 v42, v42
  v_smfmac_f32_32x32x32_bf16 v[224:239], v[140:143], v[32:39], v3
  v_exp_f32 v43, v43
  v_exp_f32 v44, v44
  v_exp_f32 v45, v45
  v_exp_f32 v46, v46
  v_exp_f32 v47, v47
  v_mfma_f32_32x32x16_bf16 v[24:39], v[128:131], a[240:243], v[56:71]
  v_exp_f32 v48, v48
  v_exp_f32 v49, v49
  v_exp_f32 v50, v50
  v_exp_f32 v51, v51
  v_smfmac_f32_32x32x32_bf16 v[240:255], v[136:139], v[40:47], v3
  buffer_load_dword v23, v12, s[4:7], 0 offen sc1
  v_exp_f32 v52, v52
  v_exp_f32 v53, v53
  v_exp_f32 v54, v54
  v_exp_f32 v55, v55
  s_waitcnt vmcnt(0)
  v_cmp_gt_u32 vcc, 3, v23
  s_cbranch_vccnz L_slow_54
L_back_55:
  s_mov_b64 exec, s[28:29]
  buffer_load_dwordx4 v[176:179], v2, s[8:11], s54 offen offset:1024
  buffer_load_dwordx4 v[180:183], v2, s[8:11], s54 offen offset:1536
  s_mov_b64 exec, -1
  buffer_load_dwordx4 v[120:123], v1, s[8:11], s54 offen offset:0
  s_mov_b64 exec, s[28:29]
  buffer_load_dwordx4 v[184:187], v2, s[8:11], s54 offen offset:3072
  buffer_load_dwordx4 v[188:191], v2, s[8:11], s54 offen offset:3584
  s_mov_b64 exec, -1
  buffer_load_dwordx4 v[124:127], v1, s[8:11], s54 offen offset:2048
  s_add_u32 s54, s54, 8192
  s_and_b32 s54, s54, 0x1ffff
  v_exp_f32 v24, v24
  v_exp_f32 v25, v25
  v_exp_f32 v26, v26
  v_smfmac_f32_32x32x32_bf16 v[240:255], v[140:143], v[48:55], v3
  v_exp_f32 v27, v27
  v_exp_f32 v28, v28
  v_exp_f32 v29, v29
  v_exp_f32 v30, v30
  v_exp_f32 v31, v31
  v_mfma_f32_32x32x16_bf16 v[40:55], v[128:131], a[244:247], v[72:87]
  v_exp_f32 v32, v32
  v_exp_f32 v33, v33
  v_exp_f32 v34, v34
  v_exp_f32 v35, v35
  v_smfmac_f32_32x32x32_bf16 v[192:207], v[136:139], v[24:31], v3
  v_exp_f32 v36, v36
  v_exp_f32 v37, v37
  v_exp_f32 v38, v38
  v_exp_f32 v39, v39
  v_exp_f32 v40, v40
  v_exp_f32 v41, v41
  v_exp_f32 v42, v42
  v_smfmac_f32_32x32x32_bf16 v[192:207], v[140:143], v[32:39], v3
  s_waitcnt vmcnt(7)
  v_exp_f32 v43, v43
  v_exp_f32 v44, v44
  v_exp_f32 v45, v45
  v_exp_f32 v46, v46
  v_exp_f32 v47, v47
  v_mfma_f32_32x32x16_bf16 v[24:39], v[132:135], a[248:251], v[88:103]
  v_exp_f32 v48, v48
  v_exp_f32 v49, v49
  v_exp_f32 v50, v50
  v_exp_f32 v51, v51
  v_smfmac_f32_32x32x32_bf16 v[208:223], v[136:139], v[40:47], v3
  v_exp_f32 v52, v52
  v_exp_f32 v53, v53
  v_exp_f32 v54, v54
  v_exp_f32 v55, v55
  v_exp_f32 v24, v24
  v_exp_f32 v25, v25
  v_exp_f32 v26, v26
  v_smfmac_f32_32x32x32_bf16 v[208:223], v[140:143], v[48:55], v3
  s_mov_b64 exec, s[28:29]
  buffer_load_dwordx4 v[136:139], v2, s[8:11], s54 offen offset:1024
  buffer_load_dwordx4 v[140:143], v2, s[8:11], s54 offen offset:1536
  s_mov_b64 exec, -1
  v_exp_f32 v27, v27
  v_exp_f32 v28, v28
  v_exp_f32 v29, v29
  v_exp_f32 v30, v30
  v_exp_f32 v31, v31
  v_mfma_f32_32x32x16_bf16 v[40:55], v[132:135], a[252:255], v[104:119]
  buffer_load_dwordx4 v[128:131], v1, s[8:11], s54 offen offset:0
  v_exp_f32 v32, v32
  v_exp_f32 v33, v33
  v_exp_f32 v34, v34
  v_exp_f32 v35, v35
  v_smfmac_f32_32x32x32_bf16 v[224:239], v[144:147], v[24:31], v3
  v_exp_f32 v36, v36
  v_exp_f32 v37, v37
  v_exp_f32 v38, v38
  v_exp_f32 v39, v39
  v_exp_f32 v40, v40
  v_exp_f32 v41, v41
  v_exp_f32 v42, v42
  v_smfmac_f32_32x32x32_bf16 v[224:239], v[148:151], v[32:39], v3
  v_exp_f32 v43, v43
  v_exp_f32 v44, v44
  v_exp_f32 v45, v45
  v_exp_f32 v46, v46
  v_exp_f32 v47, v47
  v_mfma_f32_32x32x16_bf16 v[24:39], v[132:135], a[240:243], v[56:71]
  buffer_load_dwordx4 a[0:3], v1, s[4:7], s56 offen offset:0
  v_exp_f32 v48, v48
  v_exp_f32 v49, v49
  v_exp_f32 v50, v50
  v_exp_f32 v51, v51
  v_smfmac_f32_32x32x32_bf16 v[240:255], v[144:147], v[40:47], v3
  buffer_load_dwordx4 v1, s[4:7], s55 offen offset:0 lds
  v_exp_f32 v52, v52
  v_exp_f32 v53, v53
  v_exp_f32 v54, v54
  v_exp_f32 v55, v55
  v_exp_f32 v24, v24
  v_exp_f32 v25, v25
  v_exp_f32 v26, v26
  v_smfmac_f32_32x32x32_bf16 v[240:255], v[148:151], v[48:55], v3
  v_exp_f32 v27, v27
  v_exp_f32 v28, v28
  v_exp_f32 v29, v29
  v_exp_f32 v30, v30
  v_exp_f32 v31, v31
  v_mfma_f32_32x32x16_bf16 v[40:55], v[132:135], a[244:247], v[72:87]
  v_exp_f32 v32, v32
  v_exp_f32 v33, v33
  v_exp_f32 v34, v34
  v_exp_f32 v35, v35
  v_smfmac_f32_32x32x32_bf16 v[192:207], v[144:147], v[24:31], v3
  buffer_load_dwordx4 a[128:131], v1, s[4:7], s57 offen offset:0
  v_exp_f32 v36, v36
  v_exp_f32 v37, v37
  v_exp_f32 v38, v38
  v_exp_f32 v39, v39
  v_exp_f32 v40, v40
  v_exp_f32 v41, v41
  v_exp_f32 v42, v42
  v_smfmac_f32_32x32x32_bf16 v[192:207], v[148:151], v[32:39], v3
  s_waitcnt vmcnt(9)
  v_exp_f32 v43, v43
  v_exp_f32 v44, v44
  v_exp_f32 v45, v45
  v_exp_f32 v46, v46
  v_exp_f32 v47, v47
  v_mfma_f32_32x32x16_bf16 v[24:39], v[120:123], a[248:251], v[88:103]
  v_exp_f32 v48, v48
  v_exp_f32 v49, v49
  v_exp_f32 v50, v50
  v_exp_f32 v51, v51
  v_smfmac_f32_32x32x32_bf16 v[208:223], v[144:147], v[40:47], v3
  v_exp_f32 v52, v52
  v_exp_f32 v53, v53
  v_exp_f32 v54, v54
  v_exp_f32 v55, v55
  v_exp_f32 v24, v24
  v_exp_f32 v25, v25
  v_exp_f32 v26, v26
  v_smfmac_f32_32x32x32_bf16 v[208:223], v[148:151], v[48:55], v3
  s_mov_b64 exec, s[28:29]
  buffer_load_dwordx4 v[144:147], v2, s[8:11], s54 offen offset:3072
  buffer_load_dwordx4 v[148:151], v2, s[8:11], s54 offen offset:3584
  s_mov_b64 exec, -1
  v_exp_f32 v27, v27
  v_exp_f32 v28, v28
  v_exp_f32 v29, v29
  v_exp_f32 v30, v30
  v_exp_f32 v31, v31
  v_mfma_f32_32x32x16_bf16 v[40:55], v[120:123], a[252:255], v[104:119]
  buffer_load_dwordx4 v[132:135], v1, s[8:11], s54 offen offset:2048
  v_exp_f32 v32, v32
  v_exp_f32 v33, v33
  v_exp_f32 v34, v34
  v_exp_f32 v35, v35
  v_smfmac_f32_32x32x32_bf16 v[224:239], v[176:179], v[24:31], v3
  s_add_u32 s54, s54, 8192
  s_and_b32 s54, s54, 0x1ffff
  v_exp_f32 v36, v36
  v_exp_f32 v37, v37
  v_exp_f32 v38, v38
  v_exp_f32 v39, v39
  v_exp_f32 v40, v40
  v_exp_f32 v41, v41
  v_exp_f32 v42, v42
  v_smfmac_f32_32x32x32_bf16 v[224:239], v[180:183], v[32:39], v3
  v_exp_f32 v43, v43
  v_exp_f32 v44, v44
  v_exp_f32 v45, v45
  v_exp_f32 v46, v46
  v_exp_f32 v47, v47
  v_mfma_f32_32x32x16_bf16 v[24:39], v[120:123], a[240:243], v[56:71]
  buffer_load_dwordx4 a[4:7], v1, s[4:7], s56 offen offset:1024
  v_exp_f32 v48, v48
  v_exp_f32 v49, v49
  v_exp_f32 v50, v50
  v_exp_f32 v51, v51
  v_smfmac_f32_32x32x32_bf16 v[240:255], v[176:179], v[40:47], v3
  buffer_load_dwordx4 v1, s[4:7], s55 offen offset:1024 lds
  v_exp_f32 v52, v52
  v_exp_f32 v53, v53
  v_exp_f32 v54, v54
  v_exp_f32 v55, v55
  v_exp_f32 v24, v24
  v_exp_f32 v25, v25
  v_exp_f32 v26, v26
  v_smfmac_f32_32x32x32_bf16 v[240:255], v[180:183], v[48:55], v3
  v_exp_f32 v27, v27
  v_exp_f32 v28, v28
  v_exp_f32 v29, v29
  v_exp_f32 v30, v30
  v_exp_f32 v31, v31
  v_mfma_f32_32x32x16_bf16 v[40:55], v[120:123], a[244:247], v[72:87]
  v_exp_f32 v32, v32
  v_exp_f32 v33, v33
  v_exp_f32 v34, v34
  v_exp_f32 v35, v35
  v_smfmac_f32_32x32x32_bf16 v[192:207], v[176:179], v[24:31], v3
  buffer_load_dwordx4 a[132:135], v1, s[4:7], s57 offen offset:1024
  v_exp_f32 v36, v36
  v_exp_f32 v37, v37
  v_exp_f32 v38, v38
  v_exp_f32 v39, v39
  v_exp_f32 v40, v40
  v_exp_f32 v41, v41
  v_exp_f32 v42, v42
  v_smfmac_f32_32x32x32_bf16 v[192:207], v[180:183], v[32:39], v3
  s_waitcnt vmcnt(12)
  v_exp_f32 v43, v43
  v_exp_f32 v44, v44
  v_exp_f32 v45, v45
  v_exp_f32 v46, v46
  v_exp_f32 v47, v47
  v_mfma_f32_32x32x16_bf16 v[24:39], v[124:127], a[248:251], v[88:103]
  v_exp_f32 v48, v48
  v_exp_f32 v49, v49
  v_exp_f32 v50, v50
  v_exp_f32 v51, v51
  v_smfmac_f32_32x32x32_bf16 v[208:223], v[176:179], v[40:47], v3
  buffer_load_dwordx4 a[8:11], v1, s[4:7], s56 offen offset:2048
  v_exp_f32 v52, v52
  v_exp_f32 v53, v53
  v_exp_f32 v54, v54
  v_exp_f32 v55, v55
  v_exp_f32 v24, v24
  v_exp_f32 v25, v25
  v_exp_f32 v26, v26
  v_smfmac_f32_32x32x32_bf16 v[208:223], v[180:183], v[48:55], v3
  s_mov_b64 exec, s[28:29]
  buffer_load_dwordx4 v[176:179], v2, s[8:11], s54 offen offset:1024
  buffer_load_dwordx4 v[180:183], v2, s[8:11], s54 offen offset:1536
  s_mov_b64 exec, -1
  v_exp_f32 v27, v27
  v_exp_f32 v28, v28
  v_exp_f32 v29, v29
  v_exp_f32 v30, v30
  v_exp_f32 v31, v31
  v_mfma_f32_32x32x16_bf16 v[40:55], v[124:127], a[252:255], v[104:119]
  buffer_load_dwordx4 v[120:123], v1, s[8:11], s54 offen offset:0
  v_exp_f32 v32, v32
  v_exp_f32 v33, v33
  v_exp_f32 v34, v34
  v_exp_f32 v35, v35
  v_smfmac_f32_32x32x32_bf16 v[224:239], v[184:187], v[24:31], v3
  v_exp_f32 v36, v36
  v_exp_f32 v37, v37
  v_exp_f32 v38, v38
  v_exp_f32 v39, v39
  v_exp_f32 v40, v40
  v_exp_f32 v41, v41
  v_exp_f32 v42, v42
  v_smfmac_f32_32x32x32_bf16 v[224:239], v[188:191], v[32:39], v3
  v_exp_f32 v43, v43
  v_exp_f32 v44, v44
  v_exp_f32 v45, v45
  v_exp_f32 v46, v46
  v_exp_f32 v47, v47
  v_mfma_f32_32x32x16_bf16 v[24:39], v[124:127], a[240:243], v[56:71]
  buffer_load_dwordx4 v1, s[4:7], s55 offen offset:2048 lds
  v_exp_f32 v48, v48
  v_exp_f32 v49, v49
  v_exp_f32 v50, v50
  v_exp_f32 v51, v51
  v_smfmac_f32_32x32x32_bf16 v[240:255], v[184:187], v[40:47], v3
  buffer_load_dwordx4 a[136:139], v1, s[4:7], s57 offen offset:2048
  v_exp_f32 v52, v52
  v_exp_f32 v53, v53
  v_exp_f32 v54, v54
  v_exp_f32 v55, v55
  v_exp_f32 v24, v24
  v_exp_f32 v25, v25
  v_exp_f32 v26, v26
  v_smfmac_f32_32x32x32_bf16 v[240:255], v[188:191], v[48:55], v3
  v_exp_f32 v27, v27
  v_exp_f32 v28, v28
  v_exp_f32 v29, v29
  v_exp_f32 v30, v30
  v_exp_f32 v31, v31
  v_mfma_f32_32x32x16_bf16 v[40:55], v[124:127], a[244:247], v[72:87]
  v_exp_f32 v32, v32
  v_exp_f32 v33, v33
  v_exp_f32 v34, v34
  v_exp_f32 v35, v35
  v_smfmac_f32_32x32x32_bf16 v[192:207], v[184:187], v[24:31], v3
  buffer_load_dwordx4 a[12:15], v1, s[4:7], s56 offen offset:3072
  s_add_u32 s56, s56, 4096
  v_exp_f32 v36, v36
  v_exp_f32 v37, v37
  v_exp_f32 v38, v38
  v_exp_f32 v39, v39
  v_exp_f32 v40, v40
  v_exp_f32 v41, v41
  v_exp_f32 v42, v42
  v_smfmac_f32_32x32x32_bf16 v[192:207], v[188:191], v[32:39], v3
  s_waitcnt vmcnt(16)
  v_exp_f32 v43, v43
  v_exp_f32 v44, v44
  v_exp_f32 v45, v45
  v_exp_f32 v46, v46
  v_exp_f32 v47, v47
  v_mfma_f32_32x32x16_bf16 v[24:39], v[128:131], a[248:251], v[88:103]
  v_exp_f32 v48, v48
  v_exp_f32 v49, v49
  v_exp_f32 v50, v50
  v_exp_f32 v51, v51
  v_smfmac_f32_32x32x32_bf16 v[208:223], v[184:187], v[40:47], v3
  v_exp_f32 v52, v52
  v_exp_f32 v53, v53
  v_exp_f32 v54, v54
  v_exp_f32 v55, v55
  v_exp_f32 v24, v24
  v_exp_f32 v25, v25
  v_exp_f32 v26, v26
  v_smfmac_f32_32x32x32_bf16 v[208:223], v[188:191], v[48:55], v3
  s_mov_b64 exec, s[28:29]
  buffer_load_dwordx4 v[184:187], v2, s[8:11], s54 offen offset:3072
  buffer_load_dwordx4 v[188:191], v2, s[8:11], s54 offen offset:3584
  s_mov_b64 exec, -1
  v_exp_f32 v27, v27
  v_exp_f32 v28, v28
  v_exp_f32 v29, v29
  v_exp_f32 v30, v30
  v_exp_f32 v31, v31
  v_mfma_f32_32x32x16_bf16 v[40:55], v[128:131], a[252:255], v[104:119]
  buffer_load_dwordx4 v[124:127], v1, s[8:11], s54 offen offset:2048
  v_exp_f32 v32, v32
  v_exp_f32 v33, v33
  v_exp_f32 v34, v34
  v_exp_f32 v35, v35
  v_smfmac_f32_32x32x32_bf16 v[224:239], v[136:139], v[24:31], v3
  s_add_u32 s54, s54, 8192
  s_and_b32 s54, s54, 0x1ffff
  v_exp_f32 v36, v36
  v_exp_f32 v37, v37
  v_exp_f32 v38, v38
  v_exp_f32 v39, v39
  v_exp_f32 v40, v40
  v_exp_f32 v41, v41
  v_exp_f32 v42, v42
  v_smfmac_f32_32x32x32_bf16 v[224:239], v[140:143], v[32:39], v3
  v_exp_f32 v43, v43
  v_exp_f32 v44, v44
  v_exp_f32 v45, v45
  v_exp_f32 v46, v46
  v_exp_f32 v47, v47
  v_mfma_f32_32x32x16_bf16 v[24:39], v[128:131], a[240:243], v[56:71]
  buffer_load_dwordx4 v1, s[4:7], s55 offen offset:3072 lds
  s_add_u32 m0, m0, 4096
  s_add_u32 s55, s55, 4096
  v_exp_f32 v48, v48
  v_exp_f32 v49, v49
  v_exp_f32 v50, v50
  v_exp_f32 v51, v51
  v_smfmac_f32_32x32x32_bf16 v[240:255], v[136:139], v[40:47], v3
  buffer_load_dwordx4 a[140:143], v1, s[4:7], s57 offen offset:3072
  s_add_u32 s57, s57, 4096
  v_exp_f32 v52, v52
  v_exp_f32 v53, v53
  v_exp_f32 v54, v54
  v_exp_f32 v55, v55
  v_exp_f32 v24, v24
  v_exp_f32 v25, v25
  v_exp_f32 v26, v26
  v_smfmac_f32_32x32x32_bf16 v[240:255], v[140:143], v[48:55], v3
  v_exp_f32 v27, v27
  v_exp_f32 v28, v28
  v_exp_f32 v29, v29
  v_exp_f32 v30, v30
  v_exp_f32 v31, v31
  v_mfma_f32_32x32x16_bf16 v[40:55], v[128:131], a[244:247], v[72:87]
  v_exp_f32 v32, v32
  v_exp_f32 v33, v33
  v_exp_f32 v34, v34
  v_exp_f32 v35, v35
  v_smfmac_f32_32x32x32_bf16 v[192:207], v[136:139], v[24:31], v3
  buffer_load_dwordx4 a[16:19], v1, s[4:7], s56 offen offset:0
  v_exp_f32 v36, v36
  v_exp_f32 v37, v37
  v_exp_f32 v38, v38
  v_exp_f32 v39, v39
  v_exp_f32 v40, v40
  v_exp_f32 v41, v41
  v_exp_f32 v42, v42
  v_smfmac_f32_32x32x32_bf16 v[192:207], v[140:143], v[32:39], v3
  s_waitcnt vmcnt(16)
  v_exp_f32 v43, v43
  v_exp_f32 v44, v44
  v_exp_f32 v45, v45
  v_exp_f32 v46, v46
  v_exp_f32 v47, v47
  v_mfma_f32_32x32x16_bf16 v[24:39], v[132:135], a[248:251], v[88:103]
  v_exp_f32 v48, v48
  v_exp_f32 v49, v49
  v_exp_f32 v50, v50
  v_exp_f32 v51, v51
  v_smfmac_f32_32x32x32_bf16 v[208:223], v[136:139], v[40:47], v3
  buffer_load_dwordx4 v1, s[4:7], s55 offen offset:0 lds
  v_exp_f32 v52, v52
  v_exp_f32 v53, v53
  v_exp_f32 v54, v54
  v_exp_f32 v55, v55
  v_exp_f32 v24, v24
  v_exp_f32 v25, v25
  v_exp_f32 v26, v26
  v_smfmac_f32_32x32x32_bf16 v[208:223], v[140:143], v[48:55], v3
  s_mov_b64 exec, s[28:29]
  buffer_load_dwordx4 v[136:139], v2, s[8:11], s54 offen offset:1024
  buffer_load_dwordx4 v[140:143], v2, s[8:11], s54 offen offset:1536
  s_mov_b64 exec, -1
  v_exp_f32 v27, v27
  v_exp_f32 v28, v28
  v_exp_f32 v29, v29
  v_exp_f32 v30, v30
  v_exp_f32 v31, v31
  v_mfma_f32_32x32x16_bf16 v[40:55], v[132:135], a[252:255], v[104:119]
  buffer_load_dwordx4 v[128:131], v1, s[8:11], s54 offen offset:0
  v_exp_f32 v32, v32
  v_exp_f32 v33, v33
  v_exp_f32 v34, v34
  v_exp_f32 v35, v35
  v_smfmac_f32_32x32x32_bf16 v[224:239], v[144:147], v[24:31], v3
  v_exp_f32 v36, v36
  v_exp_f32 v37, v37
  v_exp_f32 v38, v38
  v_exp_f32 v39, v39
  v_exp_f32 v40, v40
  v_exp_f32 v41, v41
  v_exp_f32 v42, v42
  v_smfmac_f32_32x32x32_bf16 v[224:239], v[148:151], v[32:39], v3
  v_exp_f32 v43, v43
  v_exp_f32 v44, v44
  v_exp_f32 v45, v45
  v_exp_f32 v46, v46
  v_exp_f32 v47, v47
  v_mfma_f32_32x32x16_bf16 v[24:39], v[132:135], a[240:243], v[56:71]
  buffer_load_dwordx4 a[20:23], v1, s[4:7], s56 offen offset:1024
  v_exp_f32 v48, v48
  v_exp_f32 v49, v49
  v_exp_f32 v50, v50
  v_exp_f32 v51, v51
  v_smfmac_f32_32x32x32_bf16 v[240:255], v[144:147], v[40:47], v3
  buffer_load_dwordx4 v1, s[4:7], s55 offen offset:1024 lds
  v_exp_f32 v52, v52
  v_exp_f32 v53, v53
  v_exp_f32 v54, v54
  v_exp_f32 v55, v55
  v_exp_f32 v24, v24
  v_exp_f32 v25, v25
  v_exp_f32 v26, v26
  v_smfmac_f32_32x32x32_bf16 v[240:255], v[148:151], v[48:55], v3
  v_exp_f32 v27, v27
  v_exp_f32 v28, v28
  v_exp_f32 v29, v29
  v_exp_f32 v30, v30
  v_exp_f32 v31, v31
  v_mfma_f32_32x32x16_bf16 v[40:55], v[132:135], a[244:247], v[72:87]
  v_exp_f32 v32, v32
  v_exp_f32 v33, v33
  v_exp_f32 v34, v34
  v_exp_f32 v35, v35
  v_smfmac_f32_32x32x32_bf16 v[192:207], v[144:147], v[24:31], v3
  buffer_load_dwordx4 a[144:147], v1, s[4:7], s57 offen offset:0
  v_exp_f32 v36, v36
  v_exp_f32 v37, v37
  v_exp_f32 v38, v38
  v_exp_f32 v39, v39
  v_exp_f32 v40, v40
  v_exp_f32 v41, v41
  v_exp_f32 v42, v42
  v_smfmac_f32_32x32x32_bf16 v[192:207], v[148:151], v[32:39], v3
  s_waitcnt vmcnt(16)
  v_exp_f32 v43, v43
  v_exp_f32 v44, v44
  v_exp_f32 v45, v45
  v_exp_f32 v46, v46
  v_exp_f32 v47, v47
  v_mfma_f32_32x32x16_bf16 v[24:39], v[120:123], a[248:251], v[88:103]
  v_exp_f32 v48, v48
  v_exp_f32 v49, v49
  v_exp_f32 v50, v50
  v_exp_f32 v51, v51
  v_smfmac_f32_32x32x32_bf16 v[208:223], v[144:147], v[40:47], v3
  v_exp_f32 v52, v52
  v_exp_f32 v53, v53
  v_exp_f32 v54, v54
  v_exp_f32 v55, v55
  v_exp_f32 v24, v24
  v_exp_f32 v25, v25
  v_exp_f32 v26, v26
  v_smfmac_f32_32x32x32_bf16 v[208:223], v[148:151], v[48:55], v3
  s_mov_b64 exec, s[28:29]
  buffer_load_dwordx4 v[144:147], v2, s[8:11], s54 offen offset:3072
  buffer_load_dwordx4 v[148:151], v2, s[8:11], s54 offen offset:3584
  s_mov_b64 exec, -1
  v_exp_f32 v27, v27
  v_exp_f32 v28, v28
  v_exp_f32 v29, v29
  v_exp_f32 v30, v30
  v_exp_f32 v31, v31
  v_mfma_f32_32x32x16_bf16 v[40:55], v[120:123], a[252:255], v[104:119]
  buffer_load_dwordx4 v[132:135], v1, s[8:11], s54 offen offset:2048
  v_exp_f32 v32, v32
  v_exp_f32 v33, v33
  v_exp_f32 v34, v34
  v_exp_f32 v35, v35
  v_smfmac_f32_32x32x32_bf16 v[224:239], v[176:179], v[24:31], v3
  s_add_u32 s54, s54, 8192
  s_and_b32 s54, s54, 0x1ffff
  v_exp_f32 v36, v36
  v_exp_f32 v37, v37
  v_exp_f32 v38, v38
  v_exp_f32 v39, v39
  v_exp_f32 v40, v40
  v_exp_f32 v41, v41
  v_exp_f32 v42, v42
  v_smfmac_f32_32x32x32_bf16 v[224:239], v[180:183], v[32:39], v3
  v_exp_f32 v43, v43
  v_exp_f32 v44, v44
  v_exp_f32 v45, v45
  v_exp_f32 v46, v46
  v_exp_f32 v47, v47
  v_mfma_f32_32x32x16_bf16 v[24:39], v[120:123], a[240:243], v[56:71]
  buffer_load_dwordx4 a[24:27], v1, s[4:7], s56 offen offset:2048
  v_exp_f32 v48, v48
  v_exp_f32 v49, v49
  v_exp_f32 v50, v50
  v_exp_f32 v51, v51
  v_smfmac_f32_32x32x32_bf16 v[240:255], v[176:179], v[40:47], v3
  buffer_load_dwordx4 v1, s[4:7], s55 offen offset:2048 lds
  v_exp_f32 v52, v52
  v_exp_f32 v53, v53
  v_exp_f32 v54, v54
  v_exp_f32 v55, v55
  v_exp_f32 v24, v24
  v_exp_f32 v25, v25
  v_exp_f32 v26, v26
  v_smfmac_f32_32x32x32_bf16 v[240:255], v[180:183], v[48:55], v3
  v_exp_f32 v27, v27
  v_exp_f32 v28, v28
  v_exp_f32 v29, v29
  v_exp_f32 v30, v30
  v_exp_f32 v31, v31
  v_mfma_f32_32x32x16_bf16 v[40:55], v[120:123], a[244:247], v[72:87]
  v_exp_f32 v32, v32
  v_exp_f32 v33, v33
  v_exp_f32 v34, v34
  v_exp_f32 v35, v35
  v_smfmac_f32_32x32x32_bf16 v[192:207], v[176:179], v[24:31], v3
  buffer_load_dwordx4 a[148:151], v1, s[4:7], s57 offen offset:1024
  v_exp_f32 v36, v36
  v_exp_f32 v37, v37
  v_exp_f32 v38, v38
  v_exp_f32 v39, v39
  v_exp_f32 v40, v40
  v_exp_f32 v41, v41
  v_exp_f32 v42, v42
  v_smfmac_f32_32x32x32_bf16 v[192:207], v[180:183], v[32:39], v3
  s_waitcnt vmcnt(16)
  v_exp_f32 v43, v43
  v_exp_f32 v44, v44
  v_exp_f32 v45, v45
  v_exp_f32 v46, v46
  v_exp_f32 v47, v47
  v_mfma_f32_32x32x16_bf16 v[24:39], v[124:127], a[248:251], v[88:103]
  v_exp_f32 v48, v48
  v_exp_f32 v49, v49
  v_exp_f32 v50, v50
  v_exp_f32 v51, v51
  v_smfmac_f32_32x32x32_bf16 v[208:223], v[176:179], v[40:47], v3
  buffer_load_dwordx4 a[28:31], v1, s[4:7], s56 offen offset:3072
  s_add_u32 s56, s56, 4096
  v_exp_f32 v52, v52
  v_exp_f32 v53, v53
  v_exp_f32 v54, v54
  v_exp_f32 v55, v55
  v_exp_f32 v24, v24
  v_exp_f32 v25, v25
  v_exp_f32 v26, v26
  v_smfmac_f32_32x32x32_bf16 v[208:223], v[180:183], v[48:55], v3
  s_mov_b64 exec, s[28:29]
  buffer_load_dwordx4 v[176:179], v2, s[8:11], s54 offen offset:1024
  buffer_load_dwordx4 v[180:183], v2, s[8:11], s54 offen offset:1536
  s_mov_b64 exec, -1
  v_exp_f32 v27, v27
  v_exp_f32 v28, v28
  v_exp_f32 v29, v29
  v_exp_f32 v30, v30
  v_exp_f32 v31, v31
  v_mfma_f32_32x32x16_bf16 v[40:55], v[124:127], a[252:255], v[104:119]
  buffer_load_dwordx4 v[120:123], v1, s[8:11], s54 offen offset:0
  v_exp_f32 v32, v32
  v_exp_f32 v33, v33
  v_exp_f32 v34, v34
  v_exp_f32 v35, v35
  v_smfmac_f32_32x32x32_bf16 v[224:239], v[184:187], v[24:31], v3
  v_exp_f32 v36, v36
  v_exp_f32 v37, v37
  v_exp_f32 v38, v38
  v_exp_f32 v39, v39
  v_exp_f32 v40, v40
  v_exp_f32 v41, v41
  v_exp_f32 v42, v42
  v_smfmac_f32_32x32x32_bf16 v[224:239], v[188:191], v[32:39], v3
  v_exp_f32 v43, v43
  v_exp_f32 v44, v44
  v_exp_f32 v45, v45
  v_exp_f32 v46, v46
  v_exp_f32 v47, v47
  v_mfma_f32_32x32x16_bf16 v[24:39], v[124:127], a[240:243], v[56:71]
  buffer_load_dwordx4 v1, s[4:7], s55 offen offset:3072 lds
  s_add_u32 m0, m0, 4096
  s_add_u32 s55, s55, 4096
  v_exp_f32 v48, v48
  v_exp_f32 v49, v49
  v_exp_f32 v50, v50
  v_exp_f32 v51, v51
  v_smfmac_f32_32x32x32_bf16 v[240:255], v[184:187], v[40:47], v3
  buffer_load_dwordx4 a[152:155], v1, s[4:7], s57 offen offset:2048
  v_exp_f32 v52, v52
  v_exp_f32 v53, v53
  v_exp_f32 v54, v54
  v_exp_f32 v55, v55
  v_exp_f32 v24, v24
  v_exp_f32 v25, v25
  v_exp_f32 v26, v26
  v_smfmac_f32_32x32x32_bf16 v[240:255], v[188:191], v[48:55], v3
  v_exp_f32 v27, v27
  v_exp_f32 v28, v28
  v_exp_f32 v29, v29
  v_exp_f32 v30, v30
  v_exp_f32 v31, v31
  v_mfma_f32_32x32x16_bf16 v[40:55], v[124:127], a[244:247], v[72:87]
  v_exp_f32 v32, v32
  v_exp_f32 v33, v33
  v_exp_f32 v34, v34
  v_exp_f32 v35, v35
  v_smfmac_f32_32x32x32_bf16 v[192:207], v[184:187], v[24:31], v3
  buffer_load_dwordx4 a[32:35], v1, s[4:7], s56 offen offset:0
  v_exp_f32 v36, v36
  v_exp_f32 v37, v37
  v_exp_f32 v38, v38
  v_exp_f32 v39, v39
  v_exp_f32 v40, v40
  v_exp_f32 v41, v41
  v_exp_f32 v42, v42
  v_smfmac_f32_32x32x32_bf16 v[192:207], v[188:191], v[32:39], v3
  s_waitcnt vmcnt(16)
  v_exp_f32 v43, v43
  v_exp_f32 v44, v44
  v_exp_f32 v45, v45
  v_exp_f32 v46, v46
  v_exp_f32 v47, v47
  v_mfma_f32_32x32x16_bf16 v[24:39], v[128:131], a[248:251], v[88:103]
  v_exp_f32 v48, v48
  v_exp_f32 v49, v49
  v_exp_f32 v50, v50
  v_exp_f32 v51, v51
  v_smfmac_f32_32x32x32_bf16 v[208:223], v[184:187], v[40:47], v3
  v_exp_f32 v52, v52
  v_exp_f32 v53, v53
  v_exp_f32 v54, v54
  v_exp_f32 v55, v55
  v_exp_f32 v24, v24
  v_exp_f32 v25, v25
  v_exp_f32 v26, v26
  v_smfmac_f32_32x32x32_bf16 v[208:223], v[188:191], v[48:55], v3
  s_mov_b64 exec, s[28:29]
  buffer_load_dwordx4 v[184:187], v2, s[8:11], s54 offen offset:3072
  buffer_load_dwordx4 v[188:191], v2, s[8:11], s54 offen offset:3584
  s_mov_b64 exec, -1
  v_exp_f32 v27, v27
  v_exp_f32 v28, v28
  v_exp_f32 v29, v29
  v_exp_f32 v30, v30
  v_exp_f32 v31, v31
  v_mfma_f32_32x32x16_bf16 v[40:55], v[128:131], a[252:255], v[104:119]
  buffer_load_dwordx4 v[124:127], v1, s[8:11], s54 offen offset:2048
  v_exp_f32 v32, v32
  v_exp_f32 v33, v33
  v_exp_f32 v34, v34
  v_exp_f32 v35, v35
  v_smfmac_f32_32x32x32_bf16 v[224:239], v[136:139], v[24:31], v3
  s_add_u32 s54, s54, 8192
  s_and_b32 s54, s54, 0x1ffff
  v_exp_f32 v36, v36
  v_exp_f32 v37, v37
  v_exp_f32 v38, v38
  v_exp_f32 v39, v39
  v_exp_f32 v40, v40
  v_exp_f32 v41, v41
  v_exp_f32 v42, v42
  v_smfmac_f32_32x32x32_bf16 v[224:239], v[140:143], v[32:39], v3
  v_exp_f32 v43, v43
  v_exp_f32 v44, v44
  v_exp_f32 v45, v45
  v_exp_f32 v46, v46
  v_exp_f32 v47, v47
  v_mfma_f32_32x32x16_bf16 v[24:39], v[128:131], a[240:243], v[56:71]
  buffer_load_dwordx4 v1, s[4:7], s55 offen offset:0 lds
  v_exp_f32 v48, v48
  v_exp_f32 v49, v49
  v_exp_f32 v50, v50
  v_exp_f32 v51, v51
  v_smfmac_f32_32x32x32_bf16 v[240:255], v[136:139], v[40:47], v3
  buffer_load_dwordx4 a[156:159], v1, s[4:7], s57 offen offset:3072
  s_add_u32 s57, s57, 4096
  v_exp_f32 v52, v52
  v_exp_f32 v53, v53
  v_exp_f32 v54, v54
  v_exp_f32 v55, v55
  v_exp_f32 v24, v24
  v_exp_f32 v25, v25
  v_exp_f32 v26, v26
  v_smfmac_f32_32x32x32_bf16 v[240:255], v[140:143], v[48:55], v3
  v_exp_f32 v27, v27
  v_exp_f32 v28, v28
  v_exp_f32 v29, v29
  v_exp_f32 v30, v30
  v_exp_f32 v31, v31
  v_mfma_f32_32x32x16_bf16 v[40:55], v[128:131], a[244:247], v[72:87]
  v_exp_f32 v32, v32
  v_exp_f32 v33, v33
  v_exp_f32 v34, v34
  v_exp_f32 v35, v35
  v_smfmac_f32_32x32x32_bf16 v[192:207], v[136:139], v[24:31], v3
  buffer_load_dwordx4 a[36:39], v1, s[4:7], s56 offen offset:1024
  v_exp_f32 v36, v36
  v_exp_f32 v37, v37
  v_exp_f32 v38, v38
  v_exp_f32 v39, v39
  v_exp_f32 v40, v40
  v_exp_f32 v41, v41
  v_exp_f32 v42, v42
  v_smfmac_f32_32x32x32_bf16 v[192:207], v[140:143], v[32:39], v3
  s_waitcnt vmcnt(16)
  v_exp_f32 v43, v43
  v_exp_f32 v44, v44
  v_exp_f32 v45, v45
  v_exp_f32 v46, v46
  v_exp_f32 v47, v47
  v_mfma_f32_32x32x16_bf16 v[24:39], v[132:135], a[248:251], v[88:103]
  v_exp_f32 v48, v48
  v_exp_f32 v49, v49
  v_exp_f32 v50, v50
  v_exp_f32 v51, v51
  v_smfmac_f32_32x32x32_bf16 v[208:223], v[136:139], v[40:47], v3
  buffer_load_dwordx4 v1, s[4:7], s55 offen offset:1024 lds
  v_exp_f32 v52, v52
  v_exp_f32 v53, v53
  v_exp_f32 v54, v54
  v_exp_f32 v55, v55
  v_exp_f32 v24, v24
  v_exp_f32 v25, v25
  v_exp_f32 v26, v26
  v_smfmac_f32_32x32x32_bf16 v[208:223], v[140:143], v[48:55], v3
  s_mov_b64 exec, s[28:29]
  buffer_load_dwordx4 v[136:139], v2, s[8:11], s54 offen offset:1024
  buffer_load_dwordx4 v[140:143], v2, s[8:11], s54 offen offset:1536
  s_mov_b64 exec, -1
  v_exp_f32 v27, v27
  v_exp_f32 v28, v28
  v_exp_f32 v29, v29
  v_exp_f32 v30, v30
  v_exp_f32 v31, v31
  v_mfma_f32_32x32x16_bf16 v[40:55], v[132:135], a[252:255], v[104:119]
  buffer_load_dwordx4 v[128:131], v1, s[8:11], s54 offen offset:0
  v_exp_f32 v32, v32
  v_exp_f32 v33, v33
  v_exp_f32 v34, v34
  v_exp_f32 v35, v35
  v_smfmac_f32_32x32x32_bf16 v[224:239], v[144:147], v[24:31], v3
  v_exp_f32 v36, v36
  v_exp_f32 v37, v37
  v_exp_f32 v38, v38
  v_exp_f32 v39, v39
  v_exp_f32 v40, v40
  v_exp_f32 v41, v41
  v_exp_f32 v42, v42
  v_smfmac_f32_32x32x32_bf16 v[224:239], v[148:151], v[32:39], v3
  v_exp_f32 v43, v43
  v_exp_f32 v44, v44
  v_exp_f32 v45, v45
  v_exp_f32 v46, v46
  v_exp_f32 v47, v47
  v_mfma_f32_32x32x16_bf16 v[24:39], v[132:135], a[240:243], v[56:71]
  buffer_load_dwordx4 a[40:43], v1, s[4:7], s56 offen offset:2048
  v_exp_f32 v48, v48
  v_exp_f32 v49, v49
  v_exp_f32 v50, v50
  v_exp_f32 v51, v51
  v_smfmac_f32_32x32x32_bf16 v[240:255], v[144:147], v[40:47], v3
  buffer_load_dwordx4 a[160:163], v1, s[4:7], s57 offen offset:0
  s_add_u32 s57, s57, 25600
  v_exp_f32 v52, v52
  v_exp_f32 v53, v53
  v_exp_f32 v54, v54
  v_exp_f32 v55, v55
  v_exp_f32 v24, v24
  v_exp_f32 v25, v25
  v_exp_f32 v26, v26
  v_smfmac_f32_32x32x32_bf16 v[240:255], v[148:151], v[48:55], v3
  v_exp_f32 v27, v27
  v_exp_f32 v28, v28
  v_exp_f32 v29, v29
  v_exp_f32 v30, v30
  v_exp_f32 v31, v31
  v_mfma_f32_32x32x16_bf16 v[40:55], v[132:135], a[244:247], v[72:87]
  v_exp_f32 v32, v32
  v_exp_f32 v33, v33
  v_exp_f32 v34, v34
  v_exp_f32 v35, v35
  v_smfmac_f32_32x32x32_bf16 v[192:207], v[144:147], v[24:31], v3
  buffer_load_dwordx4 v1, s[4:7], s55 offen offset:2048 lds
  v_exp_f32 v36, v36
  v_exp_f32 v37, v37
  v_exp_f32 v38, v38
  v_exp_f32 v39, v39
  v_exp_f32 v40, v40
  v_exp_f32 v41, v41
  v_exp_f32 v42, v42
  v_smfmac_f32_32x32x32_bf16 v[192:207], v[148:151], v[32:39], v3
  s_waitcnt vmcnt(16)
  v_exp_f32 v43, v43
  v_exp_f32 v44, v44
  v_exp_f32 v45, v45
  v_exp_f32 v46, v46
  v_exp_f32 v47, v47
  v_mfma_f32_32x32x16_bf16 v[24:39], v[120:123], a[248:251], v[88:103]
  v_exp_f32 v48, v48
  v_exp_f32 v49, v49
  v_exp_f32 v50, v50
  v_exp_f32 v51, v51
  v_smfmac_f32_32x32x32_bf16 v[208:223], v[144:147], v[40:47], v3
  v_exp_f32 v52, v52
  v_exp_f32 v53, v53
  v_exp_f32 v54, v54
  v_exp_f32 v55, v55
  v_exp_f32 v24, v24
  v_exp_f32 v25, v25
  v_exp_f32 v26, v26
  v_smfmac_f32_32x32x32_bf16 v[208:223], v[148:151], v[48:55], v3
  s_mov_b64 exec, s[28:29]
  buffer_load_dwordx4 v[144:147], v2, s[8:11], s54 offen offset:3072
  buffer_load_dwordx4 v[148:151], v2, s[8:11], s54 offen offset:3584
  s_mov_b64 exec, -1
  v_exp_f32 v27, v27
  v_exp_f32 v28, v28
  v_exp_f32 v29, v29
  v_exp_f32 v30, v30
  v_exp_f32 v31, v31
  v_mfma_f32_32x32x16_bf16 v[40:55], v[120:123], a[252:255], v[104:119]
  buffer_load_dwordx4 v[132:135], v1, s[8:11], s54 offen offset:2048
  v_exp_f32 v32, v32
  v_exp_f32 v33, v33
  v_exp_f32 v34, v34
  v_exp_f32 v35, v35
  v_smfmac_f32_32x32x32_bf16 v[224:239], v[176:179], v[24:31], v3
  s_add_u32 s54, s54, 8192
  s_and_b32 s54, s54, 0x1ffff
  v_exp_f32 v36, v36
  v_exp_f32 v37, v37
  v_exp_f32 v38, v38
  v_exp_f32 v39, v39
  v_exp_f32 v40, v40
  v_exp_f32 v41, v41
  v_exp_f32 v42, v42
  v_smfmac_f32_32x32x32_bf16 v[224:239], v[180:183], v[32:39], v3
  v_exp_f32 v43, v43
  v_exp_f32 v44, v44
  v_exp_f32 v45, v45
  v_exp_f32 v46, v46
  v_exp_f32 v47, v47
  v_mfma_f32_32x32x16_bf16 v[24:39], v[120:123], a[240:243], v[56:71]
  buffer_load_dwordx4 a[44:47], v1, s[4:7], s56 offen offset:3072
  s_add_u32 s56, s56, 4096
  v_exp_f32 v48, v48
  v_exp_f32 v49, v49
  v_exp_f32 v50, v50
  v_exp_f32 v51, v51
  v_smfmac_f32_32x32x32_bf16 v[240:255], v[176:179], v[40:47], v3
  buffer_load_dwordx4 v1, s[4:7], s55 offen offset:3072 lds
  s_add_u32 m0, m0, 4096
  s_add_u32 s55, s55, 4096
  v_exp_f32 v52, v52
  v_exp_f32 v53, v53
  v_exp_f32 v54, v54
  v_exp_f32 v55, v55
  v_exp_f32 v24, v24
  v_exp_f32 v25, v25
  v_exp_f32 v26, v26
  v_smfmac_f32_32x32x32_bf16 v[240:255], v[180:183], v[48:55], v3
  v_exp_f32 v27, v27
  v_exp_f32 v28, v28
  v_exp_f32 v29, v29
  v_exp_f32 v30, v30
  v_exp_f32 v31, v31
  v_mfma_f32_32x32x16_bf16 v[40:55], v[120:123], a[244:247], v[72:87]
  v_exp_f32 v32, v32
  v_exp_f32 v33, v33
  v_exp_f32 v34, v34
  v_exp_f32 v35, v35
  v_smfmac_f32_32x32x32_bf16 v[192:207], v[176:179], v[24:31], v3
  buffer_load_dwordx4 a[164:167], v1, s[4:7], s57 offen offset:0
  v_exp_f32 v36, v36
  v_exp_f32 v37, v37
  v_exp_f32 v38, v38
  v_exp_f32 v39, v39
  v_exp_f32 v40, v40
  v_exp_f32 v41, v41
  v_exp_f32 v42, v42
  v_smfmac_f32_32x32x32_bf16 v[192:207], v[180:183], v[32:39], v3
  s_waitcnt vmcnt(16)
  v_exp_f32 v43, v43
  v_exp_f32 v44, v44
  v_exp_f32 v45, v45
  v_exp_f32 v46, v46
  v_exp_f32 v47, v47
  v_mfma_f32_32x32x16_bf16 v[24:39], v[124:127], a[248:251], v[88:103]
  v_exp_f32 v48, v48
  v_exp_f32 v49, v49
  v_exp_f32 v50, v50
  v_exp_f32 v51, v51
  v_smfmac_f32_32x32x32_bf16 v[208:223], v[176:179], v[40:47], v3
  buffer_load_dwordx4 a[48:51], v1, s[4:7], s56 offen offset:0
  v_exp_f32 v52, v52
  v_exp_f32 v53, v53
  v_exp_f32 v54, v54
  v_exp_f32 v55, v55
  v_exp_f32 v24, v24
  v_exp_f32 v25, v25
  v_exp_f32 v26, v26
  v_smfmac_f32_32x32x32_bf16 v[208:223], v[180:183], v[48:55], v3
  s_mov_b64 exec, s[28:29]
  buffer_load_dwordx4 v[176:179], v2, s[8:11], s54 offen offset:1024
  buffer_load_dwordx4 v[180:183], v2, s[8:11], s54 offen offset:1536
  s_mov_b64 exec, -1
  v_exp_f32 v27, v27
  v_exp_f32 v28, v28
  v_exp_f32 v29, v29
  v_exp_f32 v30, v30
  v_exp_f32 v31, v31
  v_mfma_f32_32x32x16_bf16 v[40:55], v[124:127], a[252:255], v[104:119]
  buffer_load_dwordx4 v[120:123], v1, s[8:11], s54 offen offset:0
  v_exp_f32 v32, v32
  v_exp_f32 v33, v33
  v_exp_f32 v34, v34
  v_exp_f32 v35, v35
  v_smfmac_f32_32x32x32_bf16 v[224:239], v[184:187], v[24:31], v3
  v_exp_f32 v36, v36
  v_exp_f32 v37, v37
  v_exp_f32 v38, v38
  v_exp_f32 v39, v39
  v_exp_f32 v40, v40
  v_exp_f32 v41, v41
  v_exp_f32 v42, v42
  v_smfmac_f32_32x32x32_bf16 v[224:239], v[188:191], v[32:39], v3
  v_exp_f32 v43, v43
  v_exp_f32 v44, v44
  v_exp_f32 v45, v45
  v_exp_f32 v46, v46
  v_exp_f32 v47, v47
  v_mfma_f32_32x32x16_bf16 v[24:39], v[124:127], a[240:243], v[56:71]
  buffer_load_dwordx4 v1, s[4:7], s55 offen offset:0 lds
  v_exp_f32 v48, v48
  v_exp_f32 v49, v49
  v_exp_f32 v50, v50
  v_exp_f32 v51, v51
  v_smfmac_f32_32x32x32_bf16 v[240:255], v[184:187], v[40:47], v3
  buffer_load_dwordx4 a[168:171], v1, s[4:7], s57 offen offset:1024
  v_exp_f32 v52, v52
  v_exp_f32 v53, v53
  v_exp_f32 v54, v54
  v_exp_f32 v55, v55
  v_exp_f32 v24, v24
  v_exp_f32 v25, v25
  v_exp_f32 v26, v26
  v_smfmac_f32_32x32x32_bf16 v[240:255], v[188:191], v[48:55], v3
  v_exp_f32 v27, v27
  v_exp_f32 v28, v28
  v_exp_f32 v29, v29
  v_exp_f32 v30, v30
  v_exp_f32 v31, v31
  v_mfma_f32_32x32x16_bf16 v[40:55], v[124:127], a[244:247], v[72:87]
  v_exp_f32 v32, v32
  v_exp_f32 v33, v33
  v_exp_f32 v34, v34
  v_exp_f32 v35, v35
  v_smfmac_f32_32x32x32_bf16 v[192:207], v[184:187], v[24:31], v3
  buffer_load_dwordx4 a[52:55], v1, s[4:7], s56 offen offset:1024
  v_exp_f32 v36, v36
  v_exp_f32 v37, v37
  v_exp_f32 v38, v38
  v_exp_f32 v39, v39
  v_exp_f32 v40, v40
  v_exp_f32 v41, v41
  v_exp_f32 v42, v42
  v_smfmac_f32_32x32x32_bf16 v[192:207], v[188:191], v[32:39], v3
  s_waitcnt vmcnt(16)
  v_exp_f32 v43, v43
  v_exp_f32 v44, v44
  v_exp_f32 v45, v45
  v_exp_f32 v46, v46
  v_exp_f32 v47, v47
  v_mfma_f32_32x32x16_bf16 v[24:39], v[128:131], a[248:251], v[88:103]
  v_exp_f32 v48, v48
  v_exp_f32 v49, v49
  v_exp_f32 v50, v50
  v_exp_f32 v51, v51
  v_smfmac_f32_32x32x32_bf16 v[208:223], v[184:187], v[40:47], v3
  v_exp_f32 v52, v52
  v_exp_f32 v53, v53
  v_exp_f32 v54, v54
  v_exp_f32 v55, v55
  v_exp_f32 v24, v24
  v_exp_f32 v25, v25
  v_exp_f32 v26, v26
  v_smfmac_f32_32x32x32_bf16 v[208:223], v[188:191], v[48:55], v3
  s_mov_b64 exec, s[28:29]
  buffer_load_dwordx4 v[184:187], v2, s[8:11], s54 offen offset:3072
  buffer_load_dwordx4 v[188:191], v2, s[8:11], s54 offen offset:3584
  s_mov_b64 exec, -1
  v_exp_f32 v27, v27
  v_exp_f32 v28, v28
  v_exp_f32 v29, v29
  v_exp_f32 v30, v30
  v_exp_f32 v31, v31
  v_mfma_f32_32x32x16_bf16 v[40:55], v[128:131], a[252:255], v[104:119]
  buffer_load_dwordx4 v[124:127], v1, s[8:11], s54 offen offset:2048
  v_exp_f32 v32, v32
  v_exp_f32 v33, v33
  v_exp_f32 v34, v34
  v_exp_f32 v35, v35
  v_smfmac_f32_32x32x32_bf16 v[224:239], v[136:139], v[24:31], v3
  s_add_u32 s54, s54, 8192
  s_and_b32 s54, s54, 0x1ffff
  v_exp_f32 v36, v36
  v_exp_f32 v37, v37
  v_exp_f32 v38, v38
  v_exp_f32 v39, v39
  v_exp_f32 v40, v40
  v_exp_f32 v41, v41
  v_exp_f32 v42, v42
  v_smfmac_f32_32x32x32_bf16 v[224:239], v[140:143], v[32:39], v3
  v_exp_f32 v43, v43
  v_exp_f32 v44, v44
  v_exp_f32 v45, v45
  v_exp_f32 v46, v46
  v_exp_f32 v47, v47
  v_mfma_f32_32x32x16_bf16 v[24:39], v[128:131], a[240:243], v[56:71]
  buffer_load_dwordx4 v1, s[4:7], s55 offen offset:1024 lds
  v_exp_f32 v48, v48
  v_exp_f32 v49, v49
  v_exp_f32 v50, v50
  v_exp_f32 v51, v51
  v_smfmac_f32_32x32x32_bf16 v[240:255], v[136:139], v[40:47], v3
  buffer_load_dwordx4 a[172:175], v1, s[4:7], s57 offen offset:2048
  v_exp_f32 v52, v52
  v_exp_f32 v53, v53
  v_exp_f32 v54, v54
  v_exp_f32 v55, v55
  v_exp_f32 v24, v24
  v_exp_f32 v25, v25
  v_exp_f32 v26, v26
  v_smfmac_f32_32x32x32_bf16 v[240:255], v[140:143], v[48:55], v3
  v_exp_f32 v27, v27
  v_exp_f32 v28, v28
  v_exp_f32 v29, v29
  v_exp_f32 v30, v30
  v_exp_f32 v31, v31
  v_mfma_f32_32x32x16_bf16 v[40:55], v[128:131], a[244:247], v[72:87]
  v_exp_f32 v32, v32
  v_exp_f32 v33, v33
  v_exp_f32 v34, v34
  v_exp_f32 v35, v35
  v_smfmac_f32_32x32x32_bf16 v[192:207], v[136:139], v[24:31], v3
  buffer_load_dwordx4 a[56:59], v1, s[4:7], s56 offen offset:2048
  v_exp_f32 v36, v36
  v_exp_f32 v37, v37
  v_exp_f32 v38, v38
  v_exp_f32 v39, v39
  v_exp_f32 v40, v40
  v_exp_f32 v41, v41
  v_exp_f32 v42, v42
  v_smfmac_f32_32x32x32_bf16 v[192:207], v[140:143], v[32:39], v3
  s_waitcnt vmcnt(16)
  v_exp_f32 v43, v43
  v_exp_f32 v44, v44
  v_exp_f32 v45, v45
  v_exp_f32 v46, v46
  v_exp_f32 v47, v47
  v_mfma_f32_32x32x16_bf16 v[24:39], v[132:135], a[248:251], v[88:103]
  v_exp_f32 v48, v48
  v_exp_f32 v49, v49
  v_exp_f32 v50, v50
  v_exp_f32 v51, v51
  v_smfmac_f32_32x32x32_bf16 v[208:223], v[136:139], v[40:47], v3
  buffer_load_dwordx4 v1, s[4:7], s55 offen offset:2048 lds
  v_exp_f32 v52, v52
  v_exp_f32 v53, v53
  v_exp_f32 v54, v54
  v_exp_f32 v55, v55
  v_exp_f32 v24, v24
  v_exp_f32 v25, v25
  v_exp_f32 v26, v26
  v_smfmac_f32_32x32x32_bf16 v[208:223], v[140:143], v[48:55], v3
  s_mov_b64 exec, s[28:29]
  buffer_load_dwordx4 v[136:139], v2, s[8:11], s54 offen offset:1024
  buffer_load_dwordx4 v[140:143], v2, s[8:11], s54 offen offset:1536
  s_mov_b64 exec, -1
  v_exp_f32 v27, v27
  v_exp_f32 v28, v28
  v_exp_f32 v29, v29
  v_exp_f32 v30, v30
  v_exp_f32 v31, v31
  v_mfma_f32_32x32x16_bf16 v[40:55], v[132:135], a[252:255], v[104:119]
  buffer_load_dwordx4 v[128:131], v1, s[8:11], s54 offen offset:0
  v_exp_f32 v32, v32
  v_exp_f32 v33, v33
  v_exp_f32 v34, v34
  v_exp_f32 v35, v35
  v_smfmac_f32_32x32x32_bf16 v[224:239], v[144:147], v[24:31], v3
  v_exp_f32 v36, v36
  v_exp_f32 v37, v37
  v_exp_f32 v38, v38
  v_exp_f32 v39, v39
  v_exp_f32 v40, v40
  v_exp_f32 v41, v41
  v_exp_f32 v42, v42
  v_smfmac_f32_32x32x32_bf16 v[224:239], v[148:151], v[32:39], v3
  v_exp_f32 v43, v43
  v_exp_f32 v44, v44
  v_exp_f32 v45, v45
  v_exp_f32 v46, v46
  v_exp_f32 v47, v47
  v_mfma_f32_32x32x16_bf16 v[24:39], v[132:135], a[240:243], v[56:71]
  buffer_load_dwordx4 a[60:63], v1, s[4:7], s56 offen offset:3072
  s_add_u32 s56, s56, 4096
  v_exp_f32 v48, v48
  v_exp_f32 v49, v49
  v_exp_f32 v50, v50
  v_exp_f32 v51, v51
  v_smfmac_f32_32x32x32_bf16 v[240:255], v[144:147], v[40:47], v3
  buffer_load_dwordx4 a[176:179], v1, s[4:7], s57 offen offset:3072
  s_add_u32 s57, s57, 4096
  v_exp_f32 v52, v52
  v_exp_f32 v53, v53
  v_exp_f32 v54, v54
  v_exp_f32 v55, v55
  v_exp_f32 v24, v24
  v_exp_f32 v25, v25
  v_exp_f32 v26, v26
  v_smfmac_f32_32x32x32_bf16 v[240:255], v[148:151], v[48:55], v3
  v_exp_f32 v27, v27
  v_exp_f32 v28, v28
  v_exp_f32 v29, v29
  v_exp_f32 v30, v30
  v_exp_f32 v31, v31
  v_mfma_f32_32x32x16_bf16 v[40:55], v[132:135], a[244:247], v[72:87]
  v_exp_f32 v32, v32
  v_exp_f32 v33, v33
  v_exp_f32 v34, v34
  v_exp_f32 v35, v35
  v_smfmac_f32_32x32x32_bf16 v[192:207], v[144:147], v[24:31], v3
  buffer_load_dwordx4 v1, s[4:7], s55 offen offset:3072 lds
  s_add_u32 m0, m0, 4096
  s_add_u32 s55, s55, 4096
  v_exp_f32 v36, v36
  v_exp_f32 v37, v37
  v_exp_f32 v38, v38
  v_exp_f32 v39, v39
  v_exp_f32 v40, v40
  v_exp_f32 v41, v41
  v_exp_f32 v42, v42
  v_smfmac_f32_32x32x32_bf16 v[192:207], v[148:151], v[32:39], v3
  s_waitcnt vmcnt(16)
  v_exp_f32 v43, v43
  v_exp_f32 v44, v44
  v_exp_f32 v45, v45
  v_exp_f32 v46, v46
  v_exp_f32 v47, v47
  v_mfma_f32_32x32x16_bf16 v[24:39], v[120:123], a[248:251], v[88:103]
  v_exp_f32 v48, v48
  v_exp_f32 v49, v49
  v_exp_f32 v50, v50
  v_exp_f32 v51, v51
  v_smfmac_f32_32x32x32_bf16 v[208:223], v[144:147], v[40:47], v3
  v_exp_f32 v52, v52
  v_exp_f32 v53, v53
  v_exp_f32 v54, v54
  v_exp_f32 v55, v55
  v_exp_f32 v24, v24
  v_exp_f32 v25, v25
  v_exp_f32 v26, v26
  v_smfmac_f32_32x32x32_bf16 v[208:223], v[148:151], v[48:55], v3
  s_mov_b64 exec, s[28:29]
  buffer_load_dwordx4 v[144:147], v2, s[8:11], s54 offen offset:3072
  buffer_load_dwordx4 v[148:151], v2, s[8:11], s54 offen offset:3584
  s_mov_b64 exec, -1
  v_exp_f32 v27, v27
  v_exp_f32 v28, v28
  v_exp_f32 v29, v29
  v_exp_f32 v30, v30
  v_exp_f32 v31, v31
  v_mfma_f32_32x32x16_bf16 v[40:55], v[120:123], a[252:255], v[104:119]
  buffer_load_dwordx4 v[132:135], v1, s[8:11], s54 offen offset:2048
  v_exp_f32 v32, v32
  v_exp_f32 v33, v33
  v_exp_f32 v34, v34
  v_exp_f32 v35, v35
  v_smfmac_f32_32x32x32_bf16 v[224:239], v[176:179], v[24:31], v3
  s_add_u32 s54, s54, 8192
  s_and_b32 s54, s54, 0x1ffff
  v_exp_f32 v36, v36
  v_exp_f32 v37, v37
  v_exp_f32 v38, v38
  v_exp_f32 v39, v39
  v_exp_f32 v40, v40
  v_exp_f32 v41, v41
  v_exp_f32 v42, v42
  v_smfmac_f32_32x32x32_bf16 v[224:239], v[180:183], v[32:39], v3
  v_exp_f32 v43, v43
  v_exp_f32 v44, v44
  v_exp_f32 v45, v45
  v_exp_f32 v46, v46
  v_exp_f32 v47, v47
  v_mfma_f32_32x32x16_bf16 v[24:39], v[120:123], a[240:243], v[56:71]
  buffer_load_dwordx4 a[64:67], v1, s[4:7], s56 offen offset:0
  v_exp_f32 v48, v48
  v_exp_f32 v49, v49
  v_exp_f32 v50, v50
  v_exp_f32 v51, v51
  v_smfmac_f32_32x32x32_bf16 v[240:255], v[176:179], v[40:47], v3
  buffer_load_dwordx4 v1, s[4:7], s55 offen offset:0 lds
  v_exp_f32 v52, v52
  v_exp_f32 v53, v53
  v_exp_f32 v54, v54
  v_exp_f32 v55, v55
  v_exp_f32 v24, v24
  v_exp_f32 v25, v25
  v_exp_f32 v26, v26
  v_smfmac_f32_32x32x32_bf16 v[240:255], v[180:183], v[48:55], v3
  v_exp_f32 v27, v27
  v_exp_f32 v28, v28
  v_exp_f32 v29, v29
  v_exp_f32 v30, v30
  v_exp_f32 v31, v31
  v_mfma_f32_32x32x16_bf16 v[40:55], v[120:123], a[244:247], v[72:87]
  v_exp_f32 v32, v32
  v_exp_f32 v33, v33
  v_exp_f32 v34, v34
  v_exp_f32 v35, v35
  v_smfmac_f32_32x32x32_bf16 v[192:207], v[176:179], v[24:31], v3
  buffer_load_dwordx4 a[180:183], v1, s[4:7], s57 offen offset:0
  v_exp_f32 v36, v36
  v_exp_f32 v37, v37
  v_exp_f32 v38, v38
  v_exp_f32 v39, v39
  v_exp_f32 v40, v40
  v_exp_f32 v41, v41
  v_exp_f32 v42, v42
  v_smfmac_f32_32x32x32_bf16 v[192:207], v[180:183], v[32:39], v3
  s_waitcnt vmcnt(16)
  v_exp_f32 v43, v43
  v_exp_f32 v44, v44
  v_exp_f32 v45, v45
  v_exp_f32 v46, v46
  v_exp_f32 v47, v47
  v_mfma_f32_32x32x16_bf16 v[24:39], v[124:127], a[248:251], v[88:103]
  v_exp_f32 v48, v48
  v_exp_f32 v49, v49
  v_exp_f32 v50, v50
  v_exp_f32 v51, v51
  v_smfmac_f32_32x32x32_bf16 v[208:223], v[176:179], v[40:47], v3
  buffer_load_dwordx4 a[68:71], v1, s[4:7], s56 offen offset:1024
  v_exp_f32 v52, v52
  v_exp_f32 v53, v53
  v_exp_f32 v54, v54
  v_exp_f32 v55, v55
  v_exp_f32 v24, v24
  v_exp_f32 v25, v25
  v_exp_f32 v26, v26
  v_smfmac_f32_32x32x32_bf16 v[208:223], v[180:183], v[48:55], v3
  s_mov_b64 exec, s[28:29]
  buffer_load_dwordx4 v[176:179], v2, s[8:11], s54 offen offset:1024
  buffer_load_dwordx4 v[180:183], v2, s[8:11], s54 offen offset:1536
  s_mov_b64 exec, -1
  v_exp_f32 v27, v27
  v_exp_f32 v28, v28
  v_exp_f32 v29, v29
  v_exp_f32 v30, v30
  v_exp_f32 v31, v31
  v_mfma_f32_32x32x16_bf16 v[40:55], v[124:127], a[252:255], v[104:119]
  buffer_load_dwordx4 v[120:123], v1, s[8:11], s54 offen offset:0
  v_exp_f32 v32, v32
  v_exp_f32 v33, v33
  v_exp_f32 v34, v34
  v_exp_f32 v35, v35
  v_smfmac_f32_32x32x32_bf16 v[224:239], v[184:187], v[24:31], v3
  v_exp_f32 v36, v36
  v_exp_f32 v37, v37
  v_exp_f32 v38, v38
  v_exp_f32 v39, v39
  v_exp_f32 v40, v40
  v_exp_f32 v41, v41
  v_exp_f32 v42, v42
  v_smfmac_f32_32x32x32_bf16 v[224:239], v[188:191], v[32:39], v3
  v_exp_f32 v43, v43
  v_exp_f32 v44, v44
  v_exp_f32 v45, v45
  v_exp_f32 v46, v46
  v_exp_f32 v47, v47
  v_mfma_f32_32x32x16_bf16 v[24:39], v[124:127], a[240:243], v[56:71]
  buffer_load_dwordx4 v1, s[4:7], s55 offen offset:1024 lds
  v_exp_f32 v48, v48
  v_exp_f32 v49, v49
  v_exp_f32 v50, v50
  v_exp_f32 v51, v51
  v_smfmac_f32_32x32x32_bf16 v[240:255], v[184:187], v[40:47], v3
  buffer_load_dwordx4 a[184:187], v1, s[4:7], s57 offen offset:1024
  v_exp_f32 v52, v52
  v_exp_f32 v53, v53
  v_exp_f32 v54, v54
  v_exp_f32 v55, v55
  v_exp_f32 v24, v24
  v_exp_f32 v25, v25
  v_exp_f32 v26, v26
  v_smfmac_f32_32x32x32_bf16 v[240:255], v[188:191], v[48:55], v3
  v_exp_f32 v27, v27
  v_exp_f32 v28, v28
  v_exp_f32 v29, v29
  v_exp_f32 v30, v30
  v_exp_f32 v31, v31
  v_mfma_f32_32x32x16_bf16 v[40:55], v[124:127], a[244:247], v[72:87]
  v_exp_f32 v32, v32
  v_exp_f32 v33, v33
  v_exp_f32 v34, v34
  v_exp_f32 v35, v35
  v_smfmac_f32_32x32x32_bf16 v[192:207], v[184:187], v[24:31], v3
  v_exp_f32 v36, v36
  v_exp_f32 v37, v37
  v_exp_f32 v38, v38
  v_exp_f32 v39, v39
  v_exp_f32 v40, v40
  v_exp_f32 v41, v41
  v_exp_f32 v42, v42
  v_smfmac_f32_32x32x32_bf16 v[192:207], v[188:191], v[32:39], v3
  s_waitcnt vmcnt(15)
  v_exp_f32 v43, v43
  v_exp_f32 v44, v44
  v_exp_f32 v45, v45
  v_exp_f32 v46, v46
  v_exp_f32 v47, v47
  v_mfma_f32_32x32x16_bf16 v[24:39], v[128:131], a[248:251], v[88:103]
  v_exp_f32 v48, v48
  v_exp_f32 v49, v49
  v_exp_f32 v50, v50
  v_exp_f32 v51, v51
  v_smfmac_f32_32x32x32_bf16 v[208:223], v[184:187], v[40:47], v3
  buffer_load_dwordx4 a[72:75], v1, s[4:7], s56 offen offset:2048
  v_exp_f32 v52, v52
  v_exp_f32 v53, v53
  v_exp_f32 v54, v54
  v_exp_f32 v55, v55
  v_exp_f32 v24, v24
  v_exp_f32 v25, v25
  v_exp_f32 v26, v26
  v_smfmac_f32_32x32x32_bf16 v[208:223], v[188:191], v[48:55], v3
  s_mov_b64 exec, s[28:29]
  buffer_load_dwordx4 v[184:187], v2, s[8:11], s54 offen offset:3072
  buffer_load_dwordx4 v[188:191], v2, s[8:11], s54 offen offset:3584
  s_mov_b64 exec, -1
  v_exp_f32 v27, v27
  v_exp_f32 v28, v28
  v_exp_f32 v29, v29
  v_exp_f32 v30, v30
  v_exp_f32 v31, v31
  v_mfma_f32_32x32x16_bf16 v[40:55], v[128:131], a[252:255], v[104:119]
  buffer_load_dwordx4 v[124:127], v1, s[8:11], s54 offen offset:2048
  v_exp_f32 v32, v32
  v_exp_f32 v33, v33
  v_exp_f32 v34, v34
  v_exp_f32 v35, v35
  v_smfmac_f32_32x32x32_bf16 v[224:239], v[136:139], v[24:31], v3
  s_add_u32 s54, s54, 8192
  s_and_b32 s54, s54, 0x1ffff
  v_exp_f32 v36, v36
  v_exp_f32 v37, v37
  v_exp_f32 v38, v38
  v_exp_f32 v39, v39
  v_exp_f32 v40, v40
  v_exp_f32 v41, v41
  v_exp_f32 v42, v42
  v_smfmac_f32_32x32x32_bf16 v[224:239], v[140:143], v[32:39], v3
  v_exp_f32 v43, v43
  v_exp_f32 v44, v44
  v_exp_f32 v45, v45
  v_exp_f32 v46, v46
  v_exp_f32 v47, v47
  v_mfma_f32_32x32x16_bf16 v[24:39], v[128:131], a[240:243], v[56:71]
  buffer_load_dwordx4 v1, s[4:7], s55 offen offset:2048 lds
  v_exp_f32 v48, v48
  v_exp_f32 v49, v49
  v_exp_f32 v50, v50
  v_exp_f32 v51, v51
  v_smfmac_f32_32x32x32_bf16 v[240:255], v[136:139], v[40:47], v3
  buffer_load_dwordx4 a[76:79], v1, s[4:7], s56 offen offset:3072
  s_add_u32 s56, s56, 4096
  v_exp_f32 v52, v52
  v_exp_f32 v53, v53
  v_exp_f32 v54, v54
  v_exp_f32 v55, v55
  v_exp_f32 v24, v24
  v_exp_f32 v25, v25
  v_exp_f32 v26, v26
  v_smfmac_f32_32x32x32_bf16 v[240:255], v[140:143], v[48:55], v3
  v_exp_f32 v27, v27
  v_exp_f32 v28, v28
  v_exp_f32 v29, v29
  v_exp_f32 v30, v30
  v_exp_f32 v31, v31
  v_mfma_f32_32x32x16_bf16 v[40:55], v[128:131], a[244:247], v[72:87]
  v_exp_f32 v32, v32
  v_exp_f32 v33, v33
  v_exp_f32 v34, v34
  v_exp_f32 v35, v35
  v_smfmac_f32_32x32x32_bf16 v[192:207], v[136:139], v[24:31], v3
  buffer_load_dwordx4 a[188:191], v1, s[4:7], s57 offen offset:2048
  v_exp_f32 v36, v36
  v_exp_f32 v37, v37
  v_exp_f32 v38, v38
  v_exp_f32 v39, v39
  v_exp_f32 v40, v40
  v_exp_f32 v41, v41
  v_exp_f32 v42, v42
  v_smfmac_f32_32x32x32_bf16 v[192:207], v[140:143], v[32:39], v3
  s_waitcnt vmcnt(16)
  v_exp_f32 v43, v43
  v_exp_f32 v44, v44
  v_exp_f32 v45, v45
  v_exp_f32 v46, v46
  v_exp_f32 v47, v47
  v_mfma_f32_32x32x16_bf16 v[24:39], v[132:135], a[248:251], v[88:103]
  v_exp_f32 v48, v48
  v_exp_f32 v49, v49
  v_exp_f32 v50, v50
  v_exp_f32 v51, v51
  v_smfmac_f32_32x32x32_bf16 v[208:223], v[136:139], v[40:47], v3
  buffer_load_dwordx4 v1, s[4:7], s55 offen offset:3072 lds
  s_add_u32 m0, m0, 4096
  s_add_u32 s55, s55, 4096
  v_exp_f32 v52, v52
  v_exp_f32 v53, v53
  v_exp_f32 v54, v54
  v_exp_f32 v55, v55
  v_exp_f32 v24, v24
  v_exp_f32 v25, v25
  v_exp_f32 v26, v26
  v_smfmac_f32_32x32x32_bf16 v[208:223], v[140:143], v[48:55], v3
  s_mov_b64 exec, s[28:29]
  buffer_load_dwordx4 v[136:139], v2, s[8:11], s54 offen offset:1024
  buffer_load_dwordx4 v[140:143], v2, s[8:11], s54 offen offset:1536
  s_mov_b64 exec, -1
  v_exp_f32 v27, v27
  v_exp_f32 v28, v28
  v_exp_f32 v29, v29
  v_exp_f32 v30, v30
  v_exp_f32 v31, v31
  v_mfma_f32_32x32x16_bf16 v[40:55], v[132:135], a[252:255], v[104:119]
  buffer_load_dwordx4 v[128:131], v1, s[8:11], s54 offen offset:0
  v_exp_f32 v32, v32
  v_exp_f32 v33, v33
  v_exp_f32 v34, v34
  v_exp_f32 v35, v35
  v_smfmac_f32_32x32x32_bf16 v[224:239], v[144:147], v[24:31], v3
  v_exp_f32 v36, v36
  v_exp_f32 v37, v37
  v_exp_f32 v38, v38
  v_exp_f32 v39, v39
  v_exp_f32 v40, v40
  v_exp_f32 v41, v41
  v_exp_f32 v42, v42
  v_smfmac_f32_32x32x32_bf16 v[224:239], v[148:151], v[32:39], v3
  v_exp_f32 v43, v43
  v_exp_f32 v44, v44
  v_exp_f32 v45, v45
  v_exp_f32 v46, v46
  v_exp_f32 v47, v47
  v_mfma_f32_32x32x16_bf16 v[24:39], v[132:135], a[240:243], v[56:71]
  buffer_load_dwordx4 a[80:83], v1, s[4:7], s56 offen offset:0
  v_exp_f32 v48, v48
  v_exp_f32 v49, v49
  v_exp_f32 v50, v50
  v_exp_f32 v51, v51
  v_smfmac_f32_32x32x32_bf16 v[240:255], v[144:147], v[40:47], v3
  buffer_load_dwordx4 a[192:195], v1, s[4:7], s57 offen offset:3072
  s_add_u32 s57, s57, 4096
  v_exp_f32 v52, v52
  v_exp_f32 v53, v53
  v_exp_f32 v54, v54
  v_exp_f32 v55, v55
  v_exp_f32 v24, v24
  v_exp_f32 v25, v25
  v_exp_f32 v26, v26
  v_smfmac_f32_32x32x32_bf16 v[240:255], v[148:151], v[48:55], v3
  v_exp_f32 v27, v27
  v_exp_f32 v28, v28
  v_exp_f32 v29, v29
  v_exp_f32 v30, v30
  v_exp_f32 v31, v31
  v_mfma_f32_32x32x16_bf16 v[40:55], v[132:135], a[244:247], v[72:87]
  v_exp_f32 v32, v32
  v_exp_f32 v33, v33
  v_exp_f32 v34, v34
  v_exp_f32 v35, v35
  v_smfmac_f32_32x32x32_bf16 v[192:207], v[144:147], v[24:31], v3
  v_exp_f32 v36, v36
  v_exp_f32 v37, v37
  v_exp_f32 v38, v38
  v_exp_f32 v39, v39
  v_exp_f32 v40, v40
  v_exp_f32 v41, v41
  v_exp_f32 v42, v42
  v_smfmac_f32_32x32x32_bf16 v[192:207], v[148:151], v[32:39], v3
  s_waitcnt vmcnt(15)
  v_exp_f32 v43, v43
  v_exp_f32 v44, v44
  v_exp_f32 v45, v45
  v_exp_f32 v46, v46
  v_exp_f32 v47, v47
  v_mfma_f32_32x32x16_bf16 v[24:39], v[120:123], a[248:251], v[88:103]
  v_exp_f32 v48, v48
  v_exp_f32 v49, v49
  v_exp_f32 v50, v50
  v_exp_f32 v51, v51
  v_smfmac_f32_32x32x32_bf16 v[208:223], v[144:147], v[40:47], v3
  buffer_load_dwordx4 v1, s[4:7], s55 offen offset:0 lds
  v_exp_f32 v52, v52
  v_exp_f32 v53, v53
  v_exp_f32 v54, v54
  v_exp_f32 v55, v55
  v_exp_f32 v24, v24
  v_exp_f32 v25, v25
  v_exp_f32 v26, v26
  v_smfmac_f32_32x32x32_bf16 v[208:223], v[148:151], v[48:55], v3
  s_mov_b64 exec, s[28:29]
  buffer_load_dwordx4 v[144:147], v2, s[8:11], s54 offen offset:3072
  buffer_load_dwordx4 v[148:151], v2, s[8:11], s54 offen offset:3584
  s_mov_b64 exec, -1
  v_exp_f32 v27, v27
  v_exp_f32 v28, v28
  v_exp_f32 v29, v29
  v_exp_f32 v30, v30
  v_exp_f32 v31, v31
  v_mfma_f32_32x32x16_bf16 v[40:55], v[120:123], a[252:255], v[104:119]
  buffer_load_dwordx4 v[132:135], v1, s[8:11], s54 offen offset:2048
  v_exp_f32 v32, v32
  v_exp_f32 v33, v33
  v_exp_f32 v34, v34
  v_exp_f32 v35, v35
  v_smfmac_f32_32x32x32_bf16 v[224:239], v[176:179], v[24:31], v3
  s_add_u32 s54, s54, 8192
  s_and_b32 s54, s54, 0x1ffff
  v_exp_f32 v36, v36
  v_exp_f32 v37, v37
  v_exp_f32 v38, v38
  v_exp_f32 v39, v39
  v_exp_f32 v40, v40
  v_exp_f32 v41, v41
  v_exp_f32 v42, v42
  v_smfmac_f32_32x32x32_bf16 v[224:239], v[180:183], v[32:39], v3
  v_exp_f32 v43, v43
  v_exp_f32 v44, v44
  v_exp_f32 v45, v45
  v_exp_f32 v46, v46
  v_exp_f32 v47, v47
  v_mfma_f32_32x32x16_bf16 v[24:39], v[120:123], a[240:243], v[56:71]
  buffer_load_dwordx4 a[84:87], v1, s[4:7], s56 offen offset:1024
  v_exp_f32 v48, v48
  v_exp_f32 v49, v49
  v_exp_f32 v50, v50
  v_exp_f32 v51, v51
  v_smfmac_f32_32x32x32_bf16 v[240:255], v[176:179], v[40:47], v3
  buffer_load_dwordx4 a[196:199], v1, s[4:7], s57 offen offset:0
  s_add_u32 s57, s57, 25600
  v_exp_f32 v52, v52
  v_exp_f32 v53, v53
  v_exp_f32 v54, v54
  v_exp_f32 v55, v55
  v_exp_f32 v24, v24
  v_exp_f32 v25, v25
  v_exp_f32 v26, v26
  v_smfmac_f32_32x32x32_bf16 v[240:255], v[180:183], v[48:55], v3
  v_exp_f32 v27, v27
  v_exp_f32 v28, v28
  v_exp_f32 v29, v29
  v_exp_f32 v30, v30
  v_exp_f32 v31, v31
  v_mfma_f32_32x32x16_bf16 v[40:55], v[120:123], a[244:247], v[72:87]
  v_exp_f32 v32, v32
  v_exp_f32 v33, v33
  v_exp_f32 v34, v34
  v_exp_f32 v35, v35
  v_smfmac_f32_32x32x32_bf16 v[192:207], v[176:179], v[24:31], v3
  buffer_load_dwordx4 v1, s[4:7], s55 offen offset:1024 lds
  v_exp_f32 v36, v36
  v_exp_f32 v37, v37
  v_exp_f32 v38, v38
  v_exp_f32 v39, v39
  v_exp_f32 v40, v40
  v_exp_f32 v41, v41
  v_exp_f32 v42, v42
  v_smfmac_f32_32x32x32_bf16 v[192:207], v[180:183], v[32:39], v3
  s_waitcnt vmcnt(16)
  v_exp_f32 v43, v43
  v_exp_f32 v44, v44
  v_exp_f32 v45, v45
  v_exp_f32 v46, v46
  v_exp_f32 v47, v47
  v_mfma_f32_32x32x16_bf16 v[24:39], v[124:127], a[248:251], v[88:103]
  v_exp_f32 v48, v48
  v_exp_f32 v49, v49
  v_exp_f32 v50, v50
  v_exp_f32 v51, v51
  v_smfmac_f32_32x32x32_bf16 v[208:223], v[176:179], v[40:47], v3
  buffer_load_dwordx4 a[88:91], v1, s[4:7], s56 offen offset:2048
  v_exp_f32 v52, v52
  v_exp_f32 v53, v53
  v_exp_f32 v54, v54
  v_exp_f32 v55, v55
  v_exp_f32 v24, v24
  v_exp_f32 v25, v25
  v_exp_f32 v26, v26
  v_smfmac_f32_32x32x32_bf16 v[208:223], v[180:183], v[48:55], v3
  s_mov_b64 exec, s[28:29]
  buffer_load_dwordx4 v[176:179], v2, s[8:11], s54 offen offset:1024
  buffer_load_dwordx4 v[180:183], v2, s[8:11], s54 offen offset:1536
  s_mov_b64 exec, -1
  v_exp_f32 v27, v27
  v_exp_f32 v28, v28
  v_exp_f32 v29, v29
  v_exp_f32 v30, v30
  v_exp_f32 v31, v31
  v_mfma_f32_32x32x16_bf16 v[40:55], v[124:127], a[252:255], v[104:119]
  buffer_load_dwordx4 v[120:123], v1, s[8:11], s54 offen offset:0
  v_exp_f32 v32, v32
  v_exp_f32 v33, v33
  v_exp_f32 v34, v34
  v_exp_f32 v35, v35
  v_smfmac_f32_32x32x32_bf16 v[224:239], v[184:187], v[24:31], v3
  v_exp_f32 v36, v36
  v_exp_f32 v37, v37
  v_exp_f32 v38, v38
  v_exp_f32 v39, v39
  v_exp_f32 v40, v40
  v_exp_f32 v41, v41
  v_exp_f32 v42, v42
  v_smfmac_f32_32x32x32_bf16 v[224:239], v[188:191], v[32:39], v3
  v_exp_f32 v43, v43
  v_exp_f32 v44, v44
  v_exp_f32 v45, v45
  v_exp_f32 v46, v46
  v_exp_f32 v47, v47
  v_mfma_f32_32x32x16_bf16 v[24:39], v[124:127], a[240:243], v[56:71]
  buffer_load_dwordx4 v1, s[4:7], s55 offen offset:2048 lds
  v_exp_f32 v48, v48
  v_exp_f32 v49, v49
  v_exp_f32 v50, v50
  v_exp_f32 v51, v51
  v_smfmac_f32_32x32x32_bf16 v[240:255], v[184:187], v[40:47], v3
  buffer_load_dwordx4 a[200:203], v1, s[4:7], s57 offen offset:0
  v_exp_f32 v52, v52
  v_exp_f32 v53, v53
  v_exp_f32 v54, v54
  v_exp_f32 v55, v55
  v_exp_f32 v24, v24
  v_exp_f32 v25, v25
  v_exp_f32 v26, v26
  v_smfmac_f32_32x32x32_bf16 v[240:255], v[188:191], v[48:55], v3
  v_exp_f32 v27, v27
  v_exp_f32 v28, v28
  v_exp_f32 v29, v29
  v_exp_f32 v30, v30
  v_exp_f32 v31, v31
  v_mfma_f32_32x32x16_bf16 v[40:55], v[124:127], a[244:247], v[72:87]
  v_exp_f32 v32, v32
  v_exp_f32 v33, v33
  v_exp_f32 v34, v34
  v_exp_f32 v35, v35
  v_smfmac_f32_32x32x32_bf16 v[192:207], v[184:187], v[24:31], v3
  v_exp_f32 v36, v36
  v_exp_f32 v37, v37
  v_exp_f32 v38, v38
  v_exp_f32 v39, v39
  v_exp_f32 v40, v40
  v_exp_f32 v41, v41
  v_exp_f32 v42, v42
  v_smfmac_f32_32x32x32_bf16 v[192:207], v[188:191], v[32:39], v3
  s_waitcnt vmcnt(15)
  v_exp_f32 v43, v43
  v_exp_f32 v44, v44
  v_exp_f32 v45, v45
  v_exp_f32 v46, v46
  v_exp_f32 v47, v47
  v_mfma_f32_32x32x16_bf16 v[24:39], v[128:131], a[248:251], v[88:103]
  v_exp_f32 v48, v48
  v_exp_f32 v49, v49
  v_exp_f32 v50, v50
  v_exp_f32 v51, v51
  v_smfmac_f32_32x32x32_bf16 v[208:223], v[184:187], v[40:47], v3
  buffer_load_dwordx4 a[92:95], v1, s[4:7], s56 offen offset:3072
  s_add_u32 s56, s56, 4096
  v_exp_f32 v52, v52
  v_exp_f32 v53, v53
  v_exp_f32 v54, v54
  v_exp_f32 v55, v55
  v_exp_f32 v24, v24
  v_exp_f32 v25, v25
  v_exp_f32 v26, v26
  v_smfmac_f32_32x32x32_bf16 v[208:223], v[188:191], v[48:55], v3
  s_mov_b64 exec, s[28:29]
  buffer_load_dwordx4 v[184:187], v2, s[8:11], s54 offen offset:3072
  buffer_load_dwordx4 v[188:191], v2, s[8:11], s54 offen offset:3584
  s_mov_b64 exec, -1
  v_exp_f32 v27, v27
  v_exp_f32 v28, v28
  v_exp_f32 v29, v29
  v_exp_f32 v30, v30
  v_exp_f32 v31, v31
  v_mfma_f32_32x32x16_bf16 v[40:55], v[128:131], a[252:255], v[104:119]
  buffer_load_dwordx4 v[124:127], v1, s[8:11], s54 offen offset:2048
  v_exp_f32 v32, v32
  v_exp_f32 v33, v33
  v_exp_f32 v34, v34
  v_exp_f32 v35, v35
  v_smfmac_f32_32x32x32_bf16 v[224:239], v[136:139], v[24:31], v3
  s_add_u32 s54, s54, 8192
  s_and_b32 s54, s54, 0x1ffff
  v_exp_f32 v36, v36
  v_exp_f32 v37, v37
  v_exp_f32 v38, v38
  v_exp_f32 v39, v39
  v_exp_f32 v40, v40
  v_exp_f32 v41, v41
  v_exp_f32 v42, v42
  v_smfmac_f32_32x32x32_bf16 v[224:239], v[140:143], v[32:39], v3
  v_exp_f32 v43, v43
  v_exp_f32 v44, v44
  v_exp_f32 v45, v45
  v_exp_f32 v46, v46
  v_exp_f32 v47, v47
  v_mfma_f32_32x32x16_bf16 v[24:39], v[128:131], a[240:243], v[56:71]
  buffer_load_dwordx4 v1, s[4:7], s55 offen offset:3072 lds
  s_add_u32 m0, m0, 4096
  s_add_u32 s55, s55, 4096
  v_exp_f32 v48, v48
  v_exp_f32 v49, v49
  v_exp_f32 v50, v50
  v_exp_f32 v51, v51
  v_smfmac_f32_32x32x32_bf16 v[240:255], v[136:139], v[40:47], v3
  buffer_load_dwordx4 a[96:99], v1, s[4:7], s56 offen offset:0
  v_exp_f32 v52, v52
  v_exp_f32 v53, v53
  v_exp_f32 v54, v54
  v_exp_f32 v55, v55
  v_exp_f32 v24, v24
  v_exp_f32 v25, v25
  v_exp_f32 v26, v26
  v_smfmac_f32_32x32x32_bf16 v[240:255], v[140:143], v[48:55], v3
  v_exp_f32 v27, v27
  v_exp_f32 v28, v28
  v_exp_f32 v29, v29
  v_exp_f32 v30, v30
  v_exp_f32 v31, v31
  v_mfma_f32_32x32x16_bf16 v[40:55], v[128:131], a[244:247], v[72:87]
  v_exp_f32 v32, v32
  v_exp_f32 v33, v33
  v_exp_f32 v34, v34
  v_exp_f32 v35, v35
  v_smfmac_f32_32x32x32_bf16 v[192:207], v[136:139], v[24:31], v3
  buffer_load_dwordx4 a[204:207], v1, s[4:7], s57 offen offset:1024
  v_exp_f32 v36, v36
  v_exp_f32 v37, v37
  v_exp_f32 v38, v38
  v_exp_f32 v39, v39
  v_exp_f32 v40, v40
  v_exp_f32 v41, v41
  v_exp_f32 v42, v42
  v_smfmac_f32_32x32x32_bf16 v[192:207], v[140:143], v[32:39], v3
  s_waitcnt vmcnt(16)
  v_exp_f32 v43, v43
  v_exp_f32 v44, v44
  v_exp_f32 v45, v45
  v_exp_f32 v46, v46
  v_exp_f32 v47, v47
  v_mfma_f32_32x32x16_bf16 v[24:39], v[132:135], a[248:251], v[88:103]
  v_exp_f32 v48, v48
  v_exp_f32 v49, v49
  v_exp_f32 v50, v50
  v_exp_f32 v51, v51
  v_smfmac_f32_32x32x32_bf16 v[208:223], v[136:139], v[40:47], v3
  buffer_load_dwordx4 v1, s[4:7], s55 offen offset:0 lds
  v_exp_f32 v52, v52
  v_exp_f32 v53, v53
  v_exp_f32 v54, v54
  v_exp_f32 v55, v55
  v_exp_f32 v24, v24
  v_exp_f32 v25, v25
  v_exp_f32 v26, v26
  v_smfmac_f32_32x32x32_bf16 v[208:223], v[140:143], v[48:55], v3
  s_mov_b64 exec, s[28:29]
  buffer_load_dwordx4 v[136:139], v2, s[8:11], s54 offen offset:1024
  buffer_load_dwordx4 v[140:143], v2, s[8:11], s54 offen offset:1536
  s_mov_b64 exec, -1
  v_exp_f32 v27, v27
  v_exp_f32 v28, v28
  v_exp_f32 v29, v29
  v_exp_f32 v30, v30
  v_exp_f32 v31, v31
  v_mfma_f32_32x32x16_bf16 v[40:55], v[132:135], a[252:255], v[104:119]
  buffer_load_dwordx4 v[128:131], v1, s[8:11], s54 offen offset:0
  v_exp_f32 v32, v32
  v_exp_f32 v33, v33
  v_exp_f32 v34, v34
  v_exp_f32 v35, v35
  v_smfmac_f32_32x32x32_bf16 v[224:239], v[144:147], v[24:31], v3
  v_exp_f32 v36, v36
  v_exp_f32 v37, v37
  v_exp_f32 v38, v38
  v_exp_f32 v39, v39
  v_exp_f32 v40, v40
  v_exp_f32 v41, v41
  v_exp_f32 v42, v42
  v_smfmac_f32_32x32x32_bf16 v[224:239], v[148:151], v[32:39], v3
  v_exp_f32 v43, v43
  v_exp_f32 v44, v44
  v_exp_f32 v45, v45
  v_exp_f32 v46, v46
  v_exp_f32 v47, v47
  v_mfma_f32_32x32x16_bf16 v[24:39], v[132:135], a[240:243], v[56:71]
  buffer_load_dwordx4 a[100:103], v1, s[4:7], s56 offen offset:1024
  v_exp_f32 v48, v48
  v_exp_f32 v49, v49
  v_exp_f32 v50, v50
  v_exp_f32 v51, v51
  v_smfmac_f32_32x32x32_bf16 v[240:255], v[144:147], v[40:47], v3
  buffer_load_dwordx4 a[208:211], v1, s[4:7], s57 offen offset:2048
  v_exp_f32 v52, v52
  v_exp_f32 v53, v53
  v_exp_f32 v54, v54
  v_exp_f32 v55, v55
  v_exp_f32 v24, v24
  v_exp_f32 v25, v25
  v_exp_f32 v26, v26
  v_smfmac_f32_32x32x32_bf16 v[240:255], v[148:151], v[48:55], v3
  v_exp_f32 v27, v27
  v_exp_f32 v28, v28
  v_exp_f32 v29, v29
  v_exp_f32 v30, v30
  v_exp_f32 v31, v31
  v_mfma_f32_32x32x16_bf16 v[40:55], v[132:135], a[244:247], v[72:87]
  v_exp_f32 v32, v32
  v_exp_f32 v33, v33
  v_exp_f32 v34, v34
  v_exp_f32 v35, v35
  v_smfmac_f32_32x32x32_bf16 v[192:207], v[144:147], v[24:31], v3
  v_exp_f32 v36, v36
  v_exp_f32 v37, v37
  v_exp_f32 v38, v38
  v_exp_f32 v39, v39
  v_exp_f32 v40, v40
  v_exp_f32 v41, v41
  v_exp_f32 v42, v42
  v_smfmac_f32_32x32x32_bf16 v[192:207], v[148:151], v[32:39], v3
  s_waitcnt vmcnt(15)
  v_exp_f32 v43, v43
  v_exp_f32 v44, v44
  v_exp_f32 v45, v45
  v_exp_f32 v46, v46
  v_exp_f32 v47, v47
  v_mfma_f32_32x32x16_bf16 v[24:39], v[120:123], a[248:251], v[88:103]
  v_exp_f32 v48, v48
  v_exp_f32 v49, v49
  v_exp_f32 v50, v50
  v_exp_f32 v51, v51
  v_smfmac_f32_32x32x32_bf16 v[208:223], v[144:147], v[40:47], v3
  buffer_load_dwordx4 v1, s[4:7], s55 offen offset:1024 lds
  v_exp_f32 v52, v52
  v_exp_f32 v53, v53
  v_exp_f32 v54, v54
  v_exp_f32 v55, v55
  v_exp_f32 v24, v24
  v_exp_f32 v25, v25
  v_exp_f32 v26, v26
  v_smfmac_f32_32x32x32_bf16 v[208:223], v[148:151], v[48:55], v3
  s_mov_b64 exec, s[28:29]
  buffer_load_dwordx4 v[144:147], v2, s[8:11], s54 offen offset:3072
  buffer_load_dwordx4 v[148:151], v2, s[8:11], s54 offen offset:3584
  s_mov_b64 exec, -1
  v_exp_f32 v27, v27
  v_exp_f32 v28, v28
  v_exp_f32 v29, v29
  v_exp_f32 v30, v30
  v_exp_f32 v31, v31
  v_mfma_f32_32x32x16_bf16 v[40:55], v[120:123], a[252:255], v[104:119]
  buffer_load_dwordx4 v[132:135], v1, s[8:11], s54 offen offset:2048
  v_exp_f32 v32, v32
  v_exp_f32 v33, v33
  v_exp_f32 v34, v34
  v_exp_f32 v35, v35
  v_smfmac_f32_32x32x32_bf16 v[224:239], v[176:179], v[24:31], v3
  s_add_u32 s54, s54, 8192
  s_and_b32 s54, s54, 0x1ffff
  v_exp_f32 v36, v36
  v_exp_f32 v37, v37
  v_exp_f32 v38, v38
  v_exp_f32 v39, v39
  v_exp_f32 v40, v40
  v_exp_f32 v41, v41
  v_exp_f32 v42, v42
  v_smfmac_f32_32x32x32_bf16 v[224:239], v[180:183], v[32:39], v3
  v_exp_f32 v43, v43
  v_exp_f32 v44, v44
  v_exp_f32 v45, v45
  v_exp_f32 v46, v46
  v_exp_f32 v47, v47
  v_mfma_f32_32x32x16_bf16 v[24:39], v[120:123], a[240:243], v[56:71]
  buffer_load_dwordx4 a[104:107], v1, s[4:7], s56 offen offset:2048
  v_exp_f32 v48, v48
  v_exp_f32 v49, v49
  v_exp_f32 v50, v50
  v_exp_f32 v51, v51
  v_smfmac_f32_32x32x32_bf16 v[240:255], v[176:179], v[40:47], v3
  buffer_load_dwordx4 a[212:215], v1, s[4:7], s57 offen offset:3072
  s_add_u32 s57, s57, 4096
  v_exp_f32 v52, v52
  v_exp_f32 v53, v53
  v_exp_f32 v54, v54
  v_exp_f32 v55, v55
  v_exp_f32 v24, v24
  v_exp_f32 v25, v25
  v_exp_f32 v26, v26
  v_smfmac_f32_32x32x32_bf16 v[240:255], v[180:183], v[48:55], v3
  v_exp_f32 v27, v27
  v_exp_f32 v28, v28
  v_exp_f32 v29, v29
  v_exp_f32 v30, v30
  v_exp_f32 v31, v31
  v_mfma_f32_32x32x16_bf16 v[40:55], v[120:123], a[244:247], v[72:87]
  v_exp_f32 v32, v32
  v_exp_f32 v33, v33
  v_exp_f32 v34, v34
  v_exp_f32 v35, v35
  v_smfmac_f32_32x32x32_bf16 v[192:207], v[176:179], v[24:31], v3
  s_lshl_b32 s44, s18, 2
  s_add_u32 s44, s44, s16
  s_mul_i32 s44, s44, 512
  s_add_u32 s44, s44, L_p3_1-interleave_layers__mha_block__glu_gated_swiglu__prompt_kernel
  v_min_u32 v174, 3, v0
  v_lshl_add_u32 v174, v174, 7, s44
  v_min_u32 v174, L_last-interleave_layers__mha_block__glu_gated_swiglu__prompt_kernel, v174
  global_load_dword v174, v174, s[74:75]
  v_exp_f32 v36, v36
  v_exp_f32 v37, v37
  v_exp_f32 v38, v38
  v_exp_f32 v39, v39
  v_exp_f32 v40, v40
  v_exp_f32 v41, v41
  v_exp_f32 v42, v42
  v_smfmac_f32_32x32x32_bf16 v[192:207], v[180:183], v[32:39], v3
  s_waitcnt vmcnt(16)
  v_exp_f32 v43, v43
  v_exp_f32 v44, v44
  v_exp_f32 v45, v45
  v_exp_f32 v46, v46
  v_exp_f32 v47, v47
  v_mfma_f32_32x32x16_bf16 v[24:39], v[124:127], a[248:251], v[88:103]
  v_exp_f32 v48, v48
  v_exp_f32 v49, v49
  v_exp_f32 v50, v50
  v_exp_f32 v51, v51
  v_smfmac_f32_32x32x32_bf16 v[208:223], v[176:179], v[40:47], v3
  buffer_load_dwordx4 v1, s[4:7], s55 offen offset:2048 lds
  v_exp_f32 v52, v52
  v_exp_f32 v53, v53
  v_exp_f32 v54, v54
  v_exp_f32 v55, v55
  v_exp_f32 v24, v24
  v_exp_f32 v25, v25
  v_exp_f32 v26, v26
  v_smfmac_f32_32x32x32_bf16 v[208:223], v[180:183], v[48:55], v3
  s_mov_b64 exec, s[28:29]
  buffer_load_dwordx4 v[176:179], v2, s[8:11], s54 offen offset:1024
  buffer_load_dwordx4 v[180:183], v2, s[8:11], s54 offen offset:1536
  s_mov_b64 exec, -1
  v_exp_f32 v27, v27
  v_exp_f32 v28, v28
  v_exp_f32 v29, v29
  v_exp_f32 v30, v30
  v_exp_f32 v31, v31
  v_mfma_f32_32x32x16_bf16 v[40:55], v[124:127], a[252:255], v[104:119]
  buffer_load_dwordx4 v[120:123], v1, s[8:11], s54 offen offset:0
  v_exp_f32 v32, v32
  v_exp_f32 v33, v33
  v_exp_f32 v34, v34
  v_exp_f32 v35, v35
  v_smfmac_f32_32x32x32_bf16 v[224:239], v[184:187], v[24:31], v3
  v_exp_f32 v36, v36
  v_exp_f32 v37, v37
  v_exp_f32 v38, v38
  v_exp_f32 v39, v39
  v_exp_f32 v40, v40
  v_exp_f32 v41, v41
  v_exp_f32 v42, v42
  v_smfmac_f32_32x32x32_bf16 v[224:239], v[188:191], v[32:39], v3
  v_exp_f32 v43, v43
  v_exp_f32 v44, v44
  v_exp_f32 v45, v45
  v_exp_f32 v46, v46
  v_exp_f32 v47, v47
  v_mfma_f32_32x32x16_bf16 v[24:39], v[124:127], a[240:243], v[56:71]
  buffer_load_dwordx4 a[108:111], v1, s[4:7], s56 offen offset:3072
  s_add_u32 s56, s56, 4096
  v_exp_f32 v48, v48
  v_exp_f32 v49, v49
  v_exp_f32 v50, v50
  v_exp_f32 v51, v51
  v_smfmac_f32_32x32x32_bf16 v[240:255], v[184:187], v[40:47], v3
  buffer_load_dwordx4 v1, s[4:7], s55 offen offset:3072 lds
  s_add_u32 m0, m0, 4096
  s_add_u32 s55, s55, 4096
  v_exp_f32 v52, v52
  v_exp_f32 v53, v53
  v_exp_f32 v54, v54
  v_exp_f32 v55, v55
  v_exp_f32 v24, v24
  v_exp_f32 v25, v25
  v_exp_f32 v26, v26
  v_smfmac_f32_32x32x32_bf16 v[240:255], v[188:191], v[48:55], v3
  v_exp_f32 v27, v27
  v_exp_f32 v28, v28
  v_exp_f32 v29, v29
  v_exp_f32 v30, v30
  v_exp_f32 v31, v31
  v_mfma_f32_32x32x16_bf16 v[40:55], v[124:127], a[244:247], v[72:87]
  v_exp_f32 v32, v32
  v_exp_f32 v33, v33
  v_exp_f32 v34, v34
  v_exp_f32 v35, v35
  v_smfmac_f32_32x32x32_bf16 v[192:207], v[184:187], v[24:31], v3
  v_exp_f32 v36, v36
  v_exp_f32 v37, v37
  v_exp_f32 v38, v38
  v_exp_f32 v39, v39
  v_exp_f32 v40, v40
  v_exp_f32 v41, v41
  v_exp_f32 v42, v42
  v_smfmac_f32_32x32x32_bf16 v[192:207], v[188:191], v[32:39], v3
  s_waitcnt vmcnt(15)
  v_exp_f32 v43, v43
  v_exp_f32 v44, v44
  v_exp_f32 v45, v45
  v_exp_f32 v46, v46
  v_exp_f32 v47, v47
  v_mfma_f32_32x32x16_bf16 v[24:39], v[128:131], a[248:251], v[88:103]
  v_exp_f32 v48, v48
  v_exp_f32 v49, v49
  v_exp_f32 v50, v50
  v_exp_f32 v51, v51
  v_smfmac_f32_32x32x32_bf16 v[208:223], v[184:187], v[40:47], v3
  buffer_load_dwordx4 a[216:219], v1, s[4:7], s57 offen offset:0
  v_exp_f32 v52, v52
  v_exp_f32 v53, v53
  v_exp_f32 v54, v54
  v_exp_f32 v55, v55
  v_exp_f32 v24, v24
  v_exp_f32 v25, v25
  v_exp_f32 v26, v26
  v_smfmac_f32_32x32x32_bf16 v[208:223], v[188:191], v[48:55], v3
  s_mov_b64 exec, s[28:29]
  buffer_load_dwordx4 v[184:187], v2, s[8:11], s54 offen offset:3072
  buffer_load_dwordx4 v[188:191], v2, s[8:11], s54 offen offset:3584
  s_mov_b64 exec, -1
  v_exp_f32 v27, v27
  v_exp_f32 v28, v28
  v_exp_f32 v29, v29
  v_exp_f32 v30, v30
  v_exp_f32 v31, v31
  v_mfma_f32_32x32x16_bf16 v[40:55], v[128:131], a[252:255], v[104:119]
  buffer_load_dwordx4 v[124:127], v1, s[8:11], s54 offen offset:2048
  v_exp_f32 v32, v32
  v_exp_f32 v33, v33
  v_exp_f32 v34, v34
  v_exp_f32 v35, v35
  v_smfmac_f32_32x32x32_bf16 v[224:239], v[136:139], v[24:31], v3
  s_add_u32 s54, s54, 8192
  s_and_b32 s54, s54, 0x1ffff
  v_exp_f32 v36, v36
  v_exp_f32 v37, v37
  v_exp_f32 v38, v38
  v_exp_f32 v39, v39
  v_exp_f32 v40, v40
  v_exp_f32 v41, v41
  v_exp_f32 v42, v42
  v_smfmac_f32_32x32x32_bf16 v[224:239], v[140:143], v[32:39], v3
  v_exp_f32 v43, v43
  v_exp_f32 v44, v44
  v_exp_f32 v45, v45
  v_exp_f32 v46, v46
  v_exp_f32 v47, v47
  v_mfma_f32_32x32x16_bf16 v[24:39], v[128:131], a[240:243], v[56:71]
  buffer_load_dwordx4 a[112:115], v1, s[4:7], s56 offen offset:0
  v_exp_f32 v48, v48
  v_exp_f32 v49, v49
  v_exp_f32 v50, v50
  v_exp_f32 v51, v51
  v_smfmac_f32_32x32x32_bf16 v[240:255], v[136:139], v[40:47], v3
  s_lshl_b32 s43, s53, 5
  s_add_u32 s43, s43, s52
  s_lshl_b32 s43, s43, 10
  s_add_u32 s43, s43, 0xa00000
  v_subrev_u32 v173, 0, v0
  v_min_u32 v173, 7, v173
  v_lshl_add_u32 v172, v173, 7, s43
  s_add_u32 s43, s43, 0x8000
  v_subrev_u32 v173, 8, v0
  v_min_u32 v173, 7, v173
  v_lshl_add_u32 v173, v173, 7, s43
  v_cmp_le_u32 vcc, 8, v0
  s_nop 1
  v_cndmask_b32 v172, v172, v173, vcc
  s_lshl_b32 s43, s21, 12
  s_lshl_b32 s44, s22, 8
  s_add_u32 s43, s43, s44
  s_add_u32 s43, s43, 0xc0000
  v_subrev_u32 v173, 16, v0
  v_min_u32 v173, 1, v173
  v_lshl_add_u32 v173, v173, 7, s43
  v_cmp_le_u32 vcc, 16, v0
  s_nop 1
  v_cndmask_b32 v172, v172, v173, vcc
  buffer_load_dword v173, v172, s[4:7], 0 offen sc1
  v_exp_f32 v52, v52
  v_exp_f32 v53, v53
  v_exp_f32 v54, v54
  v_exp_f32 v55, v55
  v_exp_f32 v24, v24
  v_exp_f32 v25, v25
  v_exp_f32 v26, v26
  v_smfmac_f32_32x32x32_bf16 v[240:255], v[140:143], v[48:55], v3
  v_exp_f32 v27, v27
  v_exp_f32 v28, v28
  v_exp_f32 v29, v29
  v_exp_f32 v30, v30
  v_exp_f32 v31, v31
  v_mfma_f32_32x32x16_bf16 v[40:55], v[128:131], a[244:247], v[72:87]
  v_exp_f32 v32, v32
  v_exp_f32 v33, v33
  v_exp_f32 v34, v34
  v_exp_f32 v35, v35
  v_smfmac_f32_32x32x32_bf16 v[192:207], v[136:139], v[24:31], v3
  buffer_load_dwordx4 v1, s[4:7], s55 offen offset:0 lds
  v_exp_f32 v36, v36
  v_exp_f32 v37, v37
  v_exp_f32 v38, v38
  v_exp_f32 v39, v39
  v_exp_f32 v40, v40
  v_exp_f32 v41, v41
  v_exp_f32 v42, v42
  v_smfmac_f32_32x32x32_bf16 v[192:207], v[140:143], v[32:39], v3
  s_waitcnt vmcnt(16)
  v_exp_f32 v43, v43
  v_exp_f32 v44, v44
  v_exp_f32 v45, v45
  v_exp_f32 v46, v46
  v_exp_f32 v47, v47
  v_mfma_f32_32x32x16_bf16 v[24:39], v[132:135], a[248:251], v[88:103]
  v_exp_f32 v48, v48
  v_exp_f32 v49, v49
  v_exp_f32 v50, v50
  v_exp_f32 v51, v51
  v_smfmac_f32_32x32x32_bf16 v[208:223], v[136:139], v[40:47], v3
  buffer_load_dwordx4 a[116:119], v1, s[4:7], s56 offen offset:1024
  v_exp_f32 v52, v52
  v_exp_f32 v53, v53
  v_exp_f32 v54, v54
  v_exp_f32 v55, v55
  v_exp_f32 v24, v24
  v_exp_f32 v25, v25
  v_exp_f32 v26, v26
  v_smfmac_f32_32x32x32_bf16 v[208:223], v[140:143], v[48:55], v3
  s_mov_b64 exec, s[28:29]
  buffer_load_dwordx4 v[136:139], v2, s[8:11], s54 offen offset:1024
  buffer_load_dwordx4 v[140:143], v2, s[8:11], s54 offen offset:1536
  s_mov_b64 exec, -1
  v_exp_f32 v27, v27
  v_exp_f32 v28, v28
  v_exp_f32 v29, v29
  v_exp_f32 v30, v30
  v_exp_f32 v31, v31
  v_mfma_f32_32x32x16_bf16 v[40:55], v[132:135], a[252:255], v[104:119]
  buffer_load_dwordx4 v[128:131], v1, s[8:11], s54 offen offset:0
  v_exp_f32 v32, v32
  v_exp_f32 v33, v33
  v_exp_f32 v34, v34
  v_exp_f32 v35, v35
  v_smfmac_f32_32x32x32_bf16 v[224:239], v[144:147], v[24:31], v3
  v_exp_f32 v36, v36
  v_exp_f32 v37, v37
  v_exp_f32 v38, v38
  v_exp_f32 v39, v39
  v_exp_f32 v40, v40
  v_exp_f32 v41, v41
  v_exp_f32 v42, v42
  v_smfmac_f32_32x32x32_bf16 v[224:239], v[148:151], v[32:39], v3
  v_exp_f32 v43, v43
  v_exp_f32 v44, v44
  v_exp_f32 v45, v45
  v_exp_f32 v46, v46
  v_exp_f32 v47, v47
  v_mfma_f32_32x32x16_bf16 v[24:39], v[132:135], a[240:243], v[56:71]
  buffer_load_dwordx4 a[220:223], v1, s[4:7], s57 offen offset:1024
  v_exp_f32 v48, v48
  v_exp_f32 v49, v49
  v_exp_f32 v50, v50
  v_exp_f32 v51, v51
  v_smfmac_f32_32x32x32_bf16 v[240:255], v[144:147], v[40:47], v3
  buffer_load_dwordx4 v1, s[4:7], s55 offen offset:1024 lds
  v_exp_f32 v52, v52
  v_exp_f32 v53, v53
  v_exp_f32 v54, v54
  v_exp_f32 v55, v55
  v_exp_f32 v24, v24
  v_exp_f32 v25, v25
  v_exp_f32 v26, v26
  v_smfmac_f32_32x32x32_bf16 v[240:255], v[148:151], v[48:55], v3
  v_exp_f32 v27, v27
  v_exp_f32 v28, v28
  v_exp_f32 v29, v29
  v_exp_f32 v30, v30
  v_exp_f32 v31, v31
  v_mfma_f32_32x32x16_bf16 v[40:55], v[132:135], a[244:247], v[72:87]
  v_exp_f32 v32, v32
  v_exp_f32 v33, v33
  v_exp_f32 v34, v34
  v_exp_f32 v35, v35
  v_smfmac_f32_32x32x32_bf16 v[192:207], v[144:147], v[24:31], v3
  v_exp_f32 v36, v36
  v_exp_f32 v37, v37
  v_exp_f32 v38, v38
  v_exp_f32 v39, v39
  v_exp_f32 v40, v40
  v_exp_f32 v41, v41
  v_exp_f32 v42, v42
  v_smfmac_f32_32x32x32_bf16 v[192:207], v[148:151], v[32:39], v3
  s_waitcnt vmcnt(15)
  v_exp_f32 v43, v43
  v_exp_f32 v44, v44
  v_exp_f32 v45, v45
  v_exp_f32 v46, v46
  v_exp_f32 v47, v47
  v_mfma_f32_32x32x16_bf16 v[24:39], v[120:123], a[248:251], v[88:103]
  v_exp_f32 v48, v48
  v_exp_f32 v49, v49
  v_exp_f32 v50, v50
  v_exp_f32 v51, v51
  v_smfmac_f32_32x32x32_bf16 v[208:223], v[144:147], v[40:47], v3
  buffer_load_dwordx4 a[120:123], v1, s[4:7], s56 offen offset:2048
  v_exp_f32 v52, v52
  v_exp_f32 v53, v53
  v_exp_f32 v54, v54
  v_exp_f32 v55, v55
  v_exp_f32 v24, v24
  v_exp_f32 v25, v25
  v_exp_f32 v26, v26
  v_smfmac_f32_32x32x32_bf16 v[208:223], v[148:151], v[48:55], v3
  s_mov_b64 exec, s[28:29]
  buffer_load_dwordx4 v[144:147], v2, s[8:11], s54 offen offset:3072
  buffer_load_dwordx4 v[148:151], v2, s[8:11], s54 offen offset:3584
  s_mov_b64 exec, -1
  v_exp_f32 v27, v27
  v_exp_f32 v28, v28
  v_exp_f32 v29, v29
  v_exp_f32 v30, v30
  v_exp_f32 v31, v31
  v_mfma_f32_32x32x16_bf16 v[40:55], v[120:123], a[252:255], v[104:119]
  buffer_load_dwordx4 v[132:135], v1, s[8:11], s54 offen offset:2048
  v_exp_f32 v32, v32
  v_exp_f32 v33, v33
  v_exp_f32 v34, v34
  v_exp_f32 v35, v35
  v_smfmac_f32_32x32x32_bf16 v[224:239], v[176:179], v[24:31], v3
  v_exp_f32 v36, v36
  v_exp_f32 v37, v37
  v_exp_f32 v38, v38
  v_exp_f32 v39, v39
  v_exp_f32 v40, v40
  v_exp_f32 v41, v41
  v_exp_f32 v42, v42
  v_smfmac_f32_32x32x32_bf16 v[224:239], v[180:183], v[32:39], v3
  v_exp_f32 v43, v43
  v_exp_f32 v44, v44
  v_exp_f32 v45, v45
  v_exp_f32 v46, v46
  v_exp_f32 v47, v47
  v_mfma_f32_32x32x16_bf16 v[24:39], v[120:123], a[240:243], v[56:71]
  buffer_load_dwordx4 a[224:227], v1, s[4:7], s57 offen offset:2048
  v_exp_f32 v48, v48
  v_exp_f32 v49, v49
  v_exp_f32 v50, v50
  v_exp_f32 v51, v51
  v_smfmac_f32_32x32x32_bf16 v[240:255], v[176:179], v[40:47], v3
  buffer_load_dwordx4 v1, s[4:7], s55 offen offset:2048 lds
  v_exp_f32 v52, v52
  v_exp_f32 v53, v53
  v_exp_f32 v54, v54
  v_exp_f32 v55, v55
  v_exp_f32 v24, v24
  v_exp_f32 v25, v25
  v_exp_f32 v26, v26
  v_smfmac_f32_32x32x32_bf16 v[240:255], v[180:183], v[48:55], v3
  v_exp_f32 v27, v27
  v_exp_f32 v28, v28
  v_exp_f32 v29, v29
  v_exp_f32 v30, v30
  v_exp_f32 v31, v31
  v_mfma_f32_32x32x16_bf16 v[40:55], v[120:123], a[244:247], v[72:87]
  v_exp_f32 v32, v32
  v_exp_f32 v33, v33
  v_exp_f32 v34, v34
  v_exp_f32 v35, v35
  v_smfmac_f32_32x32x32_bf16 v[192:207], v[176:179], v[24:31], v3
  buffer_load_dwordx4 a[124:127], v1, s[4:7], s56 offen offset:3072
  v_exp_f32 v36, v36
  v_exp_f32 v37, v37
  v_exp_f32 v38, v38
  v_exp_f32 v39, v39
  v_exp_f32 v40, v40
  v_exp_f32 v41, v41
  v_exp_f32 v42, v42
  v_smfmac_f32_32x32x32_bf16 v[192:207], v[180:183], v[32:39], v3
  s_waitcnt vmcnt(16)
  v_exp_f32 v43, v43
  v_exp_f32 v44, v44
  v_exp_f32 v45, v45
  v_exp_f32 v46, v46
  v_exp_f32 v47, v47
  v_mfma_f32_32x32x16_bf16 v[24:39], v[124:127], a[248:251], v[88:103]
  v_exp_f32 v48, v48
  v_exp_f32 v49, v49
  v_exp_f32 v50, v50
  v_exp_f32 v51, v51
  v_smfmac_f32_32x32x32_bf16 v[208:223], v[176:179], v[40:47], v3
  buffer_load_dwordx4 a[228:231], v1, s[4:7], s57 offen offset:3072
  s_add_u32 s57, s57, 4096
  v_exp_f32 v52, v52
  v_exp_f32 v53, v53
  v_exp_f32 v54, v54
  v_exp_f32 v55, v55
  v_exp_f32 v24, v24
  v_exp_f32 v25, v25
  v_exp_f32 v26, v26
  v_smfmac_f32_32x32x32_bf16 v[208:223], v[180:183], v[48:55], v3
  v_exp_f32 v27, v27
  v_exp_f32 v28, v28
  v_exp_f32 v29, v29
  v_exp_f32 v30, v30
  v_exp_f32 v31, v31
  v_mfma_f32_32x32x16_bf16 v[40:55], v[124:127], a[252:255], v[104:119]
  v_exp_f32 v32, v32
  v_exp_f32 v33, v33
  v_exp_f32 v34, v34
  v_exp_f32 v35, v35
  v_smfmac_f32_32x32x32_bf16 v[224:239], v[184:187], v[24:31], v3
  v_exp_f32 v36, v36
  v_exp_f32 v37, v37
  v_exp_f32 v38, v38
  v_exp_f32 v39, v39
  v_exp_f32 v40, v40
  v_exp_f32 v41, v41
  v_exp_f32 v42, v42
  v_smfmac_f32_32x32x32_bf16 v[224:239], v[188:191], v[32:39], v3
  v_exp_f32 v43, v43
  v_exp_f32 v44, v44
  v_exp_f32 v45, v45
  v_exp_f32 v46, v46
  v_exp_f32 v47, v47
  v_mfma_f32_32x32x16_bf16 v[24:39], v[124:127], a[240:243], v[56:71]
  buffer_load_dwordx4 v1, s[4:7], s55 offen offset:3072 lds
  s_add_u32 m0, m0, 4096
  s_add_u32 s55, s55, 4096
  v_exp_f32 v48, v48
  v_exp_f32 v49, v49
  v_exp_f32 v50, v50
  v_exp_f32 v51, v51
  v_smfmac_f32_32x32x32_bf16 v[240:255], v[184:187], v[40:47], v3
  buffer_load_dwordx4 v[4:7], v1, s[4:7], s86 offen offset:0 sc1
  v_exp_f32 v52, v52
  v_exp_f32 v53, v53
  v_exp_f32 v54, v54
  v_exp_f32 v55, v55
  v_exp_f32 v24, v24
  v_exp_f32 v25, v25
  v_exp_f32 v26, v26
  v_smfmac_f32_32x32x32_bf16 v[240:255], v[188:191], v[48:55], v3
  v_exp_f32 v27, v27
  v_exp_f32 v28, v28
  v_exp_f32 v29, v29
  v_exp_f32 v30, v30
  v_exp_f32 v31, v31
  v_mfma_f32_32x32x16_bf16 v[40:55], v[124:127], a[244:247], v[72:87]
  v_exp_f32 v32, v32
  v_exp_f32 v33, v33
  v_exp_f32 v34, v34
  v_exp_f32 v35, v35
  v_smfmac_f32_32x32x32_bf16 v[192:207], v[184:187], v[24:31], v3
  v_exp_f32 v36, v36
  v_exp_f32 v37, v37
  v_exp_f32 v38, v38
  v_exp_f32 v39, v39
  v_exp_f32 v40, v40
  v_exp_f32 v41, v41
  v_exp_f32 v42, v42
  v_smfmac_f32_32x32x32_bf16 v[192:207], v[188:191], v[32:39], v3
  s_waitcnt vmcnt(12)
  v_exp_f32 v43, v43
  v_exp_f32 v44, v44
  v_exp_f32 v45, v45
  v_exp_f32 v46, v46
  v_exp_f32 v47, v47
  v_mfma_f32_32x32x16_bf16 v[24:39], v[128:131], a[248:251], v[88:103]
  v_exp_f32 v48, v48
  v_exp_f32 v49, v49
  v_exp_f32 v50, v50
  v_exp_f32 v51, v51
  v_smfmac_f32_32x32x32_bf16 v[208:223], v[184:187], v[40:47], v3
  buffer_load_dwordx4 a[232:235], v1, s[4:7], s57 offen offset:0
  v_exp_f32 v52, v52
  v_exp_f32 v53, v53
  v_exp_f32 v54, v54
  v_exp_f32 v55, v55
  v_exp_f32 v24, v24
  v_exp_f32 v25, v25
  v_exp_f32 v26, v26
  v_smfmac_f32_32x32x32_bf16 v[208:223], v[188:191], v[48:55], v3
  v_exp_f32 v27, v27
  v_exp_f32 v28, v28
  v_exp_f32 v29, v29
  v_exp_f32 v30, v30
  v_exp_f32 v31, v31
  v_mfma_f32_32x32x16_bf16 v[40:55], v[128:131], a[252:255], v[104:119]
  s_xor_b32 s38, s16, 2
  s_mul_i32 s38, s38, 6144
  s_add_u32 s38, s38, 135168
  v_add_u32 v164, s38, v1
  v_exp_f32 v32, v32
  v_exp_f32 v33, v33
  v_exp_f32 v34, v34
  v_exp_f32 v35, v35
  v_smfmac_f32_32x32x32_bf16 v[224:239], v[136:139], v[24:31], v3
  s_mul_i32 s38, s16, 6144
  s_add_u32 s38, s38, 135168
  v_add_u32 v165, s38, v1
  v_exp_f32 v36, v36
  v_exp_f32 v37, v37
  v_exp_f32 v38, v38
  v_exp_f32 v39, v39
  v_exp_f32 v40, v40
  v_exp_f32 v41, v41
  v_exp_f32 v42, v42
  v_smfmac_f32_32x32x32_bf16 v[224:239], v[140:143], v[32:39], v3
  v_exp_f32 v43, v43
  v_exp_f32 v44, v44
  v_exp_f32 v45, v45
  v_exp_f32 v46, v46
  v_exp_f32 v47, v47
  v_mfma_f32_32x32x16_bf16 v[24:39], v[128:131], a[240:243], v[56:71]
  buffer_load_dwordx4 v1, s[4:7], s55 offen offset:0 lds
  v_exp_f32 v48, v48
  v_exp_f32 v49, v49
  v_exp_f32 v50, v50
  v_exp_f32 v51, v51
  v_smfmac_f32_32x32x32_bf16 v[240:255], v[136:139], v[40:47], v3
  buffer_load_dwordx4 v[8:11], v1, s[4:7], s86 offen offset:1024 sc1
  v_exp_f32 v52, v52
  v_exp_f32 v53, v53
  v_exp_f32 v54, v54
  v_exp_f32 v55, v55
  v_exp_f32 v24, v24
  v_exp_f32 v25, v25
  v_exp_f32 v26, v26
  v_smfmac_f32_32x32x32_bf16 v[240:255], v[140:143], v[48:55], v3
  v_exp_f32 v27, v27
  v_exp_f32 v28, v28
  v_exp_f32 v29, v29
  v_exp_f32 v30, v30
  v_exp_f32 v31, v31
  v_mfma_f32_32x32x16_bf16 v[40:55], v[128:131], a[244:247], v[72:87]
  v_exp_f32 v32, v32
  v_exp_f32 v33, v33
  v_exp_f32 v34, v34
  v_exp_f32 v35, v35
  v_smfmac_f32_32x32x32_bf16 v[192:207], v[136:139], v[24:31], v3
  v_exp_f32 v36, v36
  v_exp_f32 v37, v37
  v_exp_f32 v38, v38
  v_exp_f32 v39, v39
  v_exp_f32 v40, v40
  v_exp_f32 v41, v41
  v_exp_f32 v42, v42
  v_smfmac_f32_32x32x32_bf16 v[192:207], v[140:143], v[32:39], v3
  s_waitcnt vmcnt(9)
  v_exp_f32 v43, v43
  v_exp_f32 v44, v44
  v_exp_f32 v45, v45
  v_exp_f32 v46, v46
  v_exp_f32 v47, v47
  v_mfma_f32_32x32x16_bf16 v[24:39], v[132:135], a[248:251], v[88:103]
  v_exp_f32 v48, v48
  v_exp_f32 v49, v49
  v_exp_f32 v50, v50
  v_exp_f32 v51, v51
  v_smfmac_f32_32x32x32_bf16 v[208:223], v[136:139], v[40:47], v3
  v_exp_f32 v52, v52
  v_exp_f32 v53, v53
  v_exp_f32 v54, v54
  v_exp_f32 v55, v55
  v_exp_f32 v24, v24
  v_exp_f32 v25, v25
  v_exp_f32 v26, v26
  v_smfmac_f32_32x32x32_bf16 v[208:223], v[140:143], v[48:55], v3
  v_exp_f32 v27, v27
  v_exp_f32 v28, v28
  v_exp_f32 v29, v29
  v_exp_f32 v30, v30
  v_exp_f32 v31, v31
  v_mfma_f32_32x32x16_bf16 v[40:55], v[132:135], a[252:255], v[104:119]
  v_exp_f32 v32, v32
  v_exp_f32 v33, v33
  v_exp_f32 v34, v34
  v_exp_f32 v35, v35
  v_smfmac_f32_32x32x32_bf16 v[224:239], v[144:147], v[24:31], v3
  v_exp_f32 v36, v36
  v_exp_f32 v37, v37
  v_exp_f32 v38, v38
  v_exp_f32 v39, v39
  v_exp_f32 v40, v40
  v_exp_f32 v41, v41
  v_exp_f32 v42, v42
  v_smfmac_f32_32x32x32_bf16 v[224:239], v[148:151], v[32:39], v3
  v_exp_f32 v43, v43
  v_exp_f32 v44, v44
  v_exp_f32 v45, v45
  v_exp_f32 v46, v46
  v_exp_f32 v47, v47
  v_mfma_f32_32x32x16_bf16 v[24:39], v[132:135], a[240:243], v[56:71]
  v_exp_f32 v48, v48
  v_exp_f32 v49, v49
  v_exp_f32 v50, v50
  v_exp_f32 v51, v51
  v_smfmac_f32_32x32x32_bf16 v[240:255], v[144:147], v[40:47], v3
  v_exp_f32 v52, v52
  v_exp_f32 v53, v53
  v_exp_f32 v54, v54
  v_exp_f32 v55, v55
  v_exp_f32 v24, v24
  v_exp_f32 v25, v25
  v_exp_f32 v26, v26
  v_smfmac_f32_32x32x32_bf16 v[240:255], v[148:151], v[48:55], v3
  ds_write_b128 v164, v[224:227] offset:0
  v_exp_f32 v27, v27
  v_exp_f32 v28, v28
  v_exp_f32 v29, v29
  v_exp_f32 v30, v30
  v_exp_f32 v31, v31
  v_mfma_f32_32x32x16_bf16 v[40:55], v[132:135], a[244:247], v[72:87]
  ds_write_b128 v164, v[228:231] offset:1024
  v_exp_f32 v32, v32
  v_exp_f32 v33, v33
  v_exp_f32 v34, v34
  v_exp_f32 v35, v35
  v_smfmac_f32_32x32x32_bf16 v[192:207], v[144:147], v[24:31], v3
  ds_write_b128 v164, v[232:235] offset:2048
  v_exp_f32 v36, v36
  v_exp_f32 v37, v37
  v_exp_f32 v38, v38
  v_exp_f32 v39, v39
  v_exp_f32 v40, v40
  v_exp_f32 v41, v41
  v_exp_f32 v42, v42
  v_smfmac_f32_32x32x32_bf16 v[192:207], v[148:151], v[32:39], v3
  ds_write_b128 v164, v[240:243] offset:3072
  ds_write_b128 v164, v[244:247] offset:4096
  v_exp_f32 v43, v43
  v_exp_f32 v44, v44
  v_exp_f32 v45, v45
  v_exp_f32 v46, v46
  v_exp_f32 v47, v47
  ds_write_b128 v164, v[248:251] offset:5120
  v_exp_f32 v48, v48
  v_exp_f32 v49, v49
  v_exp_f32 v50, v50
  v_exp_f32 v51, v51
  v_smfmac_f32_32x32x32_bf16 v[208:223], v[144:147], v[40:47], v3
  s_waitcnt lgkmcnt(0)
  s_barrier
  ds_read_b128 v[224:227], v165 offset:0
  ds_read_b128 v[228:231], v165 offset:1024
  ds_read_b128 v[232:235], v165 offset:2048
  ds_read_b128 v[240:243], v165 offset:3072
  ds_read_b128 v[244:247], v165 offset:4096
  ds_read_b128 v[248:251], v165 offset:5120
  v_exp_f32 v52, v52
  v_exp_f32 v53, v53
  v_exp_f32 v54, v54
  v_exp_f32 v55, v55
  s_nop 1
  v_smfmac_f32_32x32x32_bf16 v[208:223], v[148:151], v[48:55], v3
  s_lshl_b32 s38, s53, 5
  s_add_u32 s38, s38, s52
  s_lshl_b32 s38, s38, 10
  s_add_u32 s38, s38, 0xa00000
  s_add_u32 s39, s38, 0x8000
  s_mov_b32 s40, 0x4e800000
  s_waitcnt lgkmcnt(0)
  v_pk_add_f32 v[192:193], v[192:193], v[224:225]
  v_pk_add_f32 v[194:195], v[194:195], v[226:227]
  v_pk_add_f32 v[196:197], v[196:197], v[228:229]
  v_pk_add_f32 v[198:199], v[198:199], v[230:231]
  v_pk_add_f32 v[200:201], v[200:201], v[232:233]
  v_pk_add_f32 v[208:209], v[208:209], v[240:241]
  v_pk_add_f32 v[210:211], v[210:211], v[242:243]
  v_pk_add_f32 v[212:213], v[212:213], v[244:245]
  v_pk_add_f32 v[214:215], v[214:215], v[246:247]
  v_pk_add_f32 v[216:217], v[216:217], v[248:249]
L_attepi_56:
  v_rcp_f32 v202, v200
  v_add_f32 v28, v200, v216
  v_rcp_f32 v218, v216
  v_cmp_nge_f32 vcc, s40, v28
  s_cbranch_vccnz L_attfb_58
L_attok_57:
  v_pk_mul_f32 v[192:193], v[192:193], v[202:203] op_sel_hi:[1,0]
  v_pk_mul_f32 v[194:195], v[194:195], v[202:203] op_sel_hi:[1,0]
  v_pk_mul_f32 v[196:197], v[196:197], v[202:203] op_sel_hi:[1,0]
  v_pk_mul_f32 v[198:199], v[198:199], v[202:203] op_sel_hi:[1,0]
  v_cvt_pk_bf16_f32 v24, v192, v193
  v_cvt_pk_bf16_f32 v25, v194, v195
  v_cvt_pk_bf16_f32 v26, v196, v197
  v_cvt_pk_bf16_f32 v27, v198, v199
  s_cmp_eq_u32 s79, 0
  s_cbranch_scc1 L_far_59
  buffer_store_dwordx4 v[24:27], v1, s[4:7], s38 offen
L_back_60:
  v_pk_mul_f32 v[208:209], v[208:209], v[218:219] op_sel_hi:[1,0]
  v_pk_mul_f32 v[210:211], v[210:211], v[218:219] op_sel_hi:[1,0]
  v_pk_mul_f32 v[212:213], v[212:213], v[218:219] op_sel_hi:[1,0]
  v_pk_mul_f32 v[214:215], v[214:215], v[218:219] op_sel_hi:[1,0]
  v_cvt_pk_bf16_f32 v40, v208, v209
  v_cvt_pk_bf16_f32 v41, v210, v211
  v_cvt_pk_bf16_f32 v42, v212, v213
  v_cvt_pk_bf16_f32 v43, v214, v215
  s_cmp_eq_u32 s79, 0
  s_cbranch_scc1 L_far_61
  buffer_store_dwordx4 v[40:43], v1, s[4:7], s39 offen
L_back_62:
  s_waitcnt vmcnt(0)
  s_waitcnt lgkmcnt(0)
  s_barrier
  v_mov_b32 v22, 9
  s_cmp_lg_u32 s16, 0
  s_cbranch_scc1 L_sig_63
  s_mov_b64 exec, 1
  s_cmp_eq_u32 s79, 0
  s_cbranch_scc1 L_far_64
  buffer_store_dword v22, off, s[4:7], s77
  s_mov_b64 exec, -1
L_sig_63:
L_p3_1:
  s_lshl_b32 s31, s21, 15
  s_add_u32 s31, s31, 0xa00000
  v_lshlrev_b32 v24, 16, v4
  v_and_b32 v25, 0xffff0000, v4
  v_lshlrev_b32 v26, 16, v5
  v_and_b32 v27, 0xffff0000, v5
  v_lshlrev_b32 v28, 16, v6
  v_and_b32 v29, 0xffff0000, v6
  v_lshlrev_b32 v30, 16, v7
  v_and_b32 v31, 0xffff0000, v7
  v_lshlrev_b32 v32, 16, v8
  v_and_b32 v33, 0xffff0000, v8
  v_lshlrev_b32 v34, 16, v9
  v_and_b32 v35, 0xffff0000, v9
  v_lshlrev_b32 v36, 16, v10
  v_and_b32 v37, 0xffff0000, v10
  v_lshlrev_b32 v38, 16, v11
  v_and_b32 v39, 0xffff0000, v11
  s_lshl_b32 s52, s21, 15
  s_lshl_b32 s54, s22, 11
  s_add_u32 s52, s52, s54
  s_add_u32 s52, s52, 0x1600000
  s_lshl_b32 s53, s21, 12
  s_lshl_b32 s54, s22, 8
  s_add_u32 s53, s53, s54
  s_add_u32 s53, s53, 0xc0000
  s_add_u32 s32, s31, 28672
  s_mul_i32 s33, s16, 7168
  s_add_u32 s31, s31, s33
  s_add_u32 m0, s33, 135168
L_poll_65:
  buffer_load_dword v22, v13, s[4:7], 0 offen sc1
  s_waitcnt vmcnt(0)
  v_cmp_gt_u32 vcc, 9, v22
  s_cbranch_vccz L_pdone_66
  s_sub_u32 s20, s20, 1
  s_cbranch_scc0 L_poll_65
  s_mov_b32 s20, 0
L_pdone_66:
  buffer_load_dwordx4 v1, s[4:7], s31 offen offset:0 sc1 lds
  buffer_load_dwordx4 v1, s[4:7], s31 offen offset:1024 sc1 lds
  buffer_load_dwordx4 v1, s[4:7], s31 offen offset:2048 sc1 lds
  buffer_load_dwordx4 v1, s[4:7], s31 offen offset:3072 sc1 lds
  s_add_u32 m0, m0, 4096
  s_add_u32 s31, s31, 4096
  buffer_load_dwordx4 v1, s[4:7], s31 offen offset:0 sc1 lds
  buffer_load_dwordx4 v1, s[4:7], s31 offen offset:1024 sc1 lds
  buffer_load_dwordx4 v1, s[4:7], s31 offen offset:2048 sc1 lds
  s_waitcnt vmcnt(3)
  s_barrier
  ds_read_b128 v[72:75], v18 offset:4096
  ds_read_b128 v[76:79], v18 offset:11264
  ds_read_b128 v[80:83], v18 offset:18432
  ds_read_b128 v[84:87], v18 offset:25600
  ds_read_b128 v[88:91], v18 offset:5120
  ds_read_b128 v[92:95], v18 offset:12288
  ds_read_b128 v[96:99], v18 offset:19456
  s_waitcnt lgkmcnt(6)
  v_mfma_f32_32x32x16_bf16 v[24:39], a[0:3], v[72:75], v[24:39]
  buffer_load_dwordx4 v[56:59], v1, s[4:7], s32 offen offset:0 sc1
  ds_read_b128 v[100:103], v18 offset:26624
  s_waitcnt lgkmcnt(6)
  v_mfma_f32_32x32x16_bf16 v[24:39], a[28:31], v[76:79], v[24:39]
  buffer_load_dwordx4 v[60:63], v1, s[4:7], s32 offen offset:1024 sc1
  ds_read_b128 v[72:75], v18 offset:6144
  s_waitcnt lgkmcnt(6)
  v_mfma_f32_32x32x16_bf16 v[24:39], a[56:59], v[80:83], v[24:39]
  buffer_load_dwordx4 v[64:67], v1, s[4:7], s32 offen offset:2048 sc1
  ds_read_b128 v[76:79], v18 offset:13312
  s_waitcnt lgkmcnt(6)
  v_mfma_f32_32x32x16_bf16 v[24:39], a[84:87], v[84:87], v[24:39]
  buffer_load_dwordx4 v[68:71], v1, s[4:7], s32 offen offset:3072 sc1
  ds_read_b128 v[80:83], v18 offset:20480
  s_waitcnt lgkmcnt(6)
  v_mfma_f32_32x32x16_bf16 v[24:39], a[4:7], v[88:91], v[24:39]
  ds_read_b128 v[84:87], v18 offset:27648
  s_waitcnt lgkmcnt(6)
  v_mfma_f32_32x32x16_bf16 v[24:39], a[32:35], v[92:95], v[24:39]
  ds_read_b128 v[88:91], v18 offset:7168
  s_waitcnt lgkmcnt(6)
  v_mfma_f32_32x32x16_bf16 v[24:39], a[60:63], v[96:99], v[24:39]
  ds_read_b128 v[92:95], v18 offset:14336
  s_waitcnt lgkmcnt(6)
  v_mfma_f32_32x32x16_bf16 v[24:39], a[88:91], v[100:103], v[24:39]
  ds_read_b128 v[96:99], v18 offset:21504
  s_waitcnt lgkmcnt(6)
  v_mfma_f32_32x32x16_bf16 v[24:39], a[8:11], v[72:75], v[24:39]
  ds_read_b128 v[100:103], v18 offset:28672
  s_waitcnt lgkmcnt(6)
  v_mfma_f32_32x32x16_bf16 v[24:39], a[36:39], v[76:79], v[24:39]
  s_waitcnt vmcnt(4)
  s_barrier
  ds_read_b128 v[72:75], v18 offset:8192
  s_waitcnt lgkmcnt(6)
  v_mfma_f32_32x32x16_bf16 v[24:39], a[64:67], v[80:83], v[24:39]
  ds_read_b128 v[76:79], v18 offset:15360
  buffer_load_dwordx4 a[236:239], v1, s[4:7], s66 offen offset:0
  s_waitcnt lgkmcnt(6)
  v_mfma_f32_32x32x16_bf16 v[24:39], a[92:95], v[84:87], v[24:39]
  ds_read_b128 v[80:83], v18 offset:22528
  s_waitcnt lgkmcnt(6)
  v_mfma_f32_32x32x16_bf16 v[24:39], a[12:15], v[88:91], v[24:39]
  ds_read_b128 v[84:87], v18 offset:29696
  buffer_load_dwordx4 a[240:243], v1, s[4:7], s70 offen offset:0
  s_waitcnt lgkmcnt(6)
  v_mfma_f32_32x32x16_bf16 v[24:39], a[40:43], v[92:95], v[24:39]
  ds_read_b128 v[88:91], v18 offset:9216
  s_waitcnt lgkmcnt(6)
  v_mfma_f32_32x32x16_bf16 v[24:39], a[68:71], v[96:99], v[24:39]
  ds_read_b128 v[92:95], v18 offset:16384
  buffer_load_dwordx4 a[244:247], v1, s[4:7], s67 offen offset:0
  s_waitcnt lgkmcnt(6)
  v_mfma_f32_32x32x16_bf16 v[24:39], a[96:99], v[100:103], v[24:39]
  ds_read_b128 v[96:99], v18 offset:23552
  s_waitcnt lgkmcnt(6)
  v_mfma_f32_32x32x16_bf16 v[24:39], a[16:19], v[72:75], v[24:39]
  ds_read_b128 v[100:103], v18 offset:30720
  buffer_load_dwordx4 a[248:251], v1, s[4:7], s71 offen offset:0
  s_waitcnt lgkmcnt(6)
  v_mfma_f32_32x32x16_bf16 v[24:39], a[44:47], v[76:79], v[24:39]
  ds_read_b128 v[72:75], v18 offset:10240
  s_waitcnt lgkmcnt(6)
  v_mfma_f32_32x32x16_bf16 v[24:39], a[72:75], v[80:83], v[24:39]
  ds_read_b128 v[76:79], v18 offset:17408
  buffer_load_dwordx4 a[252:255], v1, s[4:7], s68 offen offset:0
  s_waitcnt lgkmcnt(6)
  v_mfma_f32_32x32x16_bf16 v[24:39], a[100:103], v[84:87], v[24:39]
  ds_read_b128 v[80:83], v18 offset:24576
  s_waitcnt lgkmcnt(6)
  v_mfma_f32_32x32x16_bf16 v[24:39], a[20:23], v[88:91], v[24:39]
  ds_read_b128 v[84:87], v18 offset:31744
  buffer_load_dwordx4 v[160:163], v1, s[4:7], s72 offen offset:0
  s_waitcnt lgkmcnt(6)
  v_mfma_f32_32x32x16_bf16 v[24:39], a[48:51], v[92:95], v[24:39]
  s_waitcnt lgkmcnt(5)
  v_mfma_f32_32x32x16_bf16 v[24:39], a[76:79], v[96:99], v[24:39]
  buffer_load_dwordx4 v[164:167], v1, s[4:7], s69 offen offset:0
  s_waitcnt lgkmcnt(4)
  v_mfma_f32_32x32x16_bf16 v[24:39], a[104:107], v[100:103], v[24:39]
  s_waitcnt lgkmcnt(3)
  v_mfma_f32_32x32x16_bf16 v[24:39], a[24:27], v[72:75], v[24:39]
  buffer_load_dwordx4 v[168:171], v1, s[4:7], s73 offen offset:0
  s_waitcnt lgkmcnt(2)
  v_mfma_f32_32x32x16_bf16 v[24:39], a[52:55], v[76:79], v[24:39]
  s_waitcnt lgkmcnt(1)
  v_mfma_f32_32x32x16_bf16 v[24:39], a[80:83], v[80:83], v[24:39]
  buffer_load_dwordx4 v[172:175], v1, s[4:7], s66 offen offset:1024
  s_waitcnt lgkmcnt(0)
  v_mfma_f32_32x32x16_bf16 v[24:39], a[108:111], v[84:87], v[24:39]
  s_waitcnt vmcnt(12)
  v_mfma_f32_32x32x16_bf16 v[24:39], a[112:115], v[56:59], v[24:39]
  s_waitcnt vmcnt(11)
  v_mfma_f32_32x32x16_bf16 v[24:39], a[116:119], v[60:63], v[24:39]
  s_waitcnt vmcnt(10)
  v_mfma_f32_32x32x16_bf16 v[24:39], a[120:123], v[64:67], v[24:39]
  s_waitcnt vmcnt(9)
  v_mfma_f32_32x32x16_bf16 v[24:39], a[124:127], v[68:71], v[24:39]
  s_nop 11
  v_cvt_pk_bf16_f32 v44, v24, v25
  v_cvt_pk_bf16_f32 v45, v26, v27
  v_cvt_pk_bf16_f32 v46, v28, v29
  v_cvt_pk_bf16_f32 v47, v30, v31
  s_cmp_eq_u32 s79, 0
  s_cbranch_scc1 L_far_67
  buffer_store_dwordx4 v[44:47], v1, s[4:7], s52 offen offset:0
L_back_68:
  v_cvt_pk_bf16_f32 v48, v32, v33
  v_cvt_pk_bf16_f32 v49, v34, v35
  v_cvt_pk_bf16_f32 v50, v36, v37
  v_cvt_pk_bf16_f32 v51, v38, v39
  s_cmp_eq_u32 s79, 0
  s_cbranch_scc1 L_far_69
  buffer_store_dwordx4 v[48:51], v1, s[4:7], s52 offen offset:1024
L_back_70:
  v_pk_add_f32 v[40:41], v[24:25], v[26:27]
  v_pk_mul_f32 v[42:43], v[24:25], v[24:25]
  v_pk_fma_f32 v[42:43], v[26:27], v[26:27], v[42:43]
  v_pk_fma_f32 v[42:43], v[28:29], v[28:29], v[42:43]
  v_pk_add_f32 v[40:41], v[40:41], v[28:29]
  v_pk_fma_f32 v[42:43], v[30:31], v[30:31], v[42:43]
  v_pk_add_f32 v[40:41], v[40:41], v[30:31]
  v_pk_fma_f32 v[42:43], v[32:33], v[32:33], v[42:43]
  v_pk_add_f32 v[40:41], v[40:41], v[32:33]
  v_pk_fma_f32 v[42:43], v[34:35], v[34:35], v[42:43]
  v_pk_add_f32 v[40:41], v[40:41], v[34:35]
  v_pk_fma_f32 v[42:43], v[36:37], v[36:37], v[42:43]
  v_pk_add_f32 v[40:41], v[40:41], v[36:37]
  v_pk_fma_f32 v[42:43], v[38:39], v[38:39], v[42:43]
  v_pk_add_f32 v[40:41], v[40:41], v[38:39]
  v_add_f32 v40, v40, v41
  v_add_f32 v41, v42, v43
  s_nop 1
  v_permlane32_swap_b32 v40, v41
  v_add_f32 v40, v40, v41
  s_cmp_eq_u32 s79, 0
  s_cbranch_scc1 L_far_71
  buffer_store_dword v40, v19, s[4:7], s53 offen offset:0
L_back_72:
  s_waitcnt vmcnt(0)
  s_waitcnt lgkmcnt(0)
  s_barrier
  v_mov_b32 v22, 10
  s_cmp_lg_u32 s16, 0
  s_cbranch_scc1 L_sig_73
  s_mov_b64 exec, 1
  s_cmp_eq_u32 s79, 0
  s_cbranch_scc1 L_far_74
  buffer_store_dword v22, off, s[4:7], s77
  s_mov_b64 exec, -1
L_sig_73:
  s_lshl_b32 s31, s27, 15
  s_add_u32 s31, s31, 0x1600000
  s_mul_i32 s34, s27, 112
  s_mul_i32 s33, s24, 7
  s_add_u32 s34, s34, s33
  s_lshl_b32 s34, s34, 10
  s_add_u32 s34, s34, 0x2900000
  s_lshl_b32 s38, s16, 13
  v_add_u32 v158, s38, v1
  v_add_u32 v159, s38, v17
  s_mul_i32 s44, s16, 28672
  s_add_u32 s44, s44, 0x2900000
  s_xor_b32 s88, s26, 0
  s_mul_i32 s88, s88, 114688
  s_add_u32 s88, s88, s44
  s_add_u32 s89, s88, 7168
  s_add_u32 s90, s88, 14336
  s_add_u32 s91, s88, 21504
  s_xor_b32 s92, s26, 1
  s_mul_i32 s92, s92, 114688
  s_add_u32 s92, s92, s44
  s_add_u32 s93, s92, 7168
  s_add_u32 s94, s92, 14336
  s_add_u32 s95, s92, 21504
  s_lshl_b32 s86, s26, 15
  s_lshl_b32 s39, s25, 11
  s_add_u32 s86, s86, s39
  s_add_u32 s86, s86, 0x1600000
  s_lshl_b32 s32, s27, 12
  s_add_u32 s32, s32, 0xc0000
  ds_read_b128 v[88:91], v1 offset:0
  ds_read_b128 v[92:95], v1 offset:33792
  ds_read_b128 v[96:99], v17 offset:2048
  ds_read_b128 v[100:103], v1 offset:1024
  ds_read_b128 v[104:107], v1 offset:34816
  ds_read_b128 v[108:111], v17 offset:3072
  ds_read_b128 v[112:115], v1 offset:2048
L_poll_75:
  buffer_load_dword v22, v13, s[4:7], 0 offen sc1
  s_waitcnt vmcnt(0)
  v_cmp_gt_u32 vcc, 10, v22
  s_cbranch_vccz L_pdone_76
  s_sub_u32 s20, s20, 1
  s_cbranch_scc0 L_poll_75
  s_mov_b32 s20, 0
L_pdone_76:
  buffer_load_dwordx4 a[0:3], v1, s[4:7], s31 offen offset:0 sc1
  buffer_load_dwordx4 a[4:7], v1, s[4:7], s31 offen offset:1024 sc1
  buffer_load_dwordx4 a[8:11], v1, s[4:7], s31 offen offset:2048 sc1
  buffer_load_dwordx4 a[12:15], v1, s[4:7], s31 offen offset:3072 sc1
  s_add_u32 s31, s31, 4096
  buffer_load_dwordx4 a[16:19], v1, s[4:7], s31 offen offset:0 sc1
  buffer_load_dwordx4 a[20:23], v1, s[4:7], s31 offen offset:1024 sc1
  buffer_load_dwordx4 a[24:27], v1, s[4:7], s31 offen offset:2048 sc1
  buffer_load_dwordx4 a[28:31], v1, s[4:7], s31 offen offset:3072 sc1
  s_add_u32 s31, s31, 4096
  buffer_load_dwordx4 a[32:35], v1, s[4:7], s31 offen offset:0 sc1
  buffer_load_dwordx4 a[36:39], v1, s[4:7], s31 offen offset:1024 sc1
  s_waitcnt vmcnt(9) lgkmcnt(5)
  v_mfma_f32_32x32x16_bf16 v[24:39], v[88:91], a[0:3], 0
  ds_read_b128 v[116:119], v1 offset:35840
  buffer_load_dwordx4 a[40:43], v1, s[4:7], s31 offen offset:2048 sc1
  v_mfma_f32_32x32x16_bf16 v[40:55], v[92:95], a[0:3], 0
  ds_read_b128 v[88:91], v17 offset:4096
  s_waitcnt lgkmcnt(5)
  v_mfma_f32_32x32x16_bf16 v[56:71], v[96:99], a[0:3], 0
  ds_read_b128 v[92:95], v1 offset:3072
  buffer_load_dwordx4 a[44:47], v1, s[4:7], s31 offen offset:3072 sc1
  s_add_u32 s31, s31, 4096
  s_waitcnt vmcnt(10)
  v_mfma_f32_32x32x16_bf16 v[24:39], v[100:103], a[4:7], v[24:39]
  ds_read_b128 v[96:99], v1 offset:36864
  s_waitcnt lgkmcnt(5)
  v_mfma_f32_32x32x16_bf16 v[40:55], v[104:107], a[4:7], v[40:55]
  ds_read_b128 v[100:103], v17 offset:5120
  buffer_load_dwordx4 a[48:51], v1, s[4:7], s31 offen offset:0 sc1
  v_mfma_f32_32x32x16_bf16 v[56:71], v[108:111], a[4:7], v[56:71]
  ds_read_b128 v[104:107], v1 offset:4096
  s_waitcnt vmcnt(10) lgkmcnt(5)
  v_mfma_f32_32x32x16_bf16 v[24:39], v[112:115], a[8:11], v[24:39]
  ds_read_b128 v[108:111], v1 offset:37888
  buffer_load_dwordx4 a[52:55], v1, s[4:7], s31 offen offset:1024 sc1
  v_mfma_f32_32x32x16_bf16 v[40:55], v[116:119], a[8:11], v[40:55]
  ds_read_b128 v[112:115], v17 offset:6144
  s_waitcnt lgkmcnt(5)
  v_mfma_f32_32x32x16_bf16 v[56:71], v[88:91], a[8:11], v[56:71]
  ds_read_b128 v[116:119], v1 offset:5120
  buffer_load_dwordx4 v[120:123], v1, s[4:7], s32 offen offset:0 sc1
  s_waitcnt vmcnt(11)
  v_mfma_f32_32x32x16_bf16 v[24:39], v[92:95], a[12:15], v[24:39]
  ds_read_b128 v[88:91], v1 offset:38912
  s_waitcnt lgkmcnt(5)
  v_mfma_f32_32x32x16_bf16 v[40:55], v[96:99], a[12:15], v[40:55]
  ds_read_b128 v[92:95], v17 offset:7168
  buffer_load_dwordx4 v[124:127], v1, s[4:7], s32 offen offset:1024 sc1
  v_mfma_f32_32x32x16_bf16 v[56:71], v[100:103], a[12:15], v[56:71]
  ds_read_b128 v[96:99], v1 offset:6144
  s_waitcnt vmcnt(11) lgkmcnt(5)
  v_mfma_f32_32x32x16_bf16 v[24:39], v[104:107], a[16:19], v[24:39]
  ds_read_b128 v[100:103], v1 offset:39936
  buffer_load_dwordx4 v[128:131], v1, s[4:7], s32 offen offset:2048 sc1
  v_mfma_f32_32x32x16_bf16 v[40:55], v[108:111], a[16:19], v[40:55]
  ds_read_b128 v[104:107], v17 offset:8192
  s_waitcnt lgkmcnt(5)
  v_mfma_f32_32x32x16_bf16 v[56:71], v[112:115], a[16:19], v[56:71]
  ds_read_b128 v[108:111], v1 offset:7168
  buffer_load_dwordx4 v[132:135], v1, s[4:7], s32 offen offset:3072 sc1
  s_waitcnt vmcnt(12)
  v_mfma_f32_32x32x16_bf16 v[24:39], v[116:119], a[20:23], v[24:39]
  ds_read_b128 v[112:115], v1 offset:40960
  s_waitcnt lgkmcnt(5)
  v_mfma_f32_32x32x16_bf16 v[40:55], v[88:91], a[20:23], v[40:55]
  ds_read_b128 v[116:119], v17 offset:9216
  buffer_load_dwordx4 a[56:59], v1, s[4:7], s31 offen offset:2048 sc1
  v_mfma_f32_32x32x16_bf16 v[56:71], v[92:95], a[20:23], v[56:71]
  ds_read_b128 v[88:91], v1 offset:8192
  s_waitcnt vmcnt(12) lgkmcnt(5)
  v_mfma_f32_32x32x16_bf16 v[24:39], v[96:99], a[24:27], v[24:39]
  ds_read_b128 v[92:95], v1 offset:41984
  buffer_load_dwordx4 a[60:63], v1, s[4:7], s31 offen offset:3072 sc1
  s_add_u32 s31, s31, 4096
  v_mfma_f32_32x32x16_bf16 v[40:55], v[100:103], a[24:27], v[40:55]
  ds_read_b128 v[96:99], v17 offset:10240
  s_waitcnt lgkmcnt(5)
  v_mfma_f32_32x32x16_bf16 v[56:71], v[104:107], a[24:27], v[56:71]
  ds_read_b128 v[100:103], v1 offset:9216
  buffer_load_dwordx4 a[64:67], v1, s[4:7], s31 offen offset:0 sc1
  s_waitcnt vmcnt(13)
  v_mfma_f32_32x32x16_bf16 v[24:39], v[108:111], a[28:31], v[24:39]
  ds_read_b128 v[104:107], v1 offset:43008
  s_waitcnt lgkmcnt(5)
  v_mfma_f32_32x32x16_bf16 v[40:55], v[112:115], a[28:31], v[40:55]
  ds_read_b128 v[108:111], v17 offset:11264
  buffer_load_dwordx4 a[68:71], v1, s[4:7], s31 offen offset:1024 sc1
  v_mfma_f32_32x32x16_bf16 v[56:71], v[116:119], a[28:31], v[56:71]
  ds_read_b128 v[112:115], v1 offset:10240
  s_waitcnt vmcnt(13) lgkmcnt(5)
  v_mfma_f32_32x32x16_bf16 v[24:39], v[88:91], a[32:35], v[24:39]
  ds_read_b128 v[116:119], v1 offset:44032
  buffer_load_dwordx4 a[72:75], v1, s[4:7], s31 offen offset:2048 sc1
  v_mfma_f32_32x32x16_bf16 v[40:55], v[92:95], a[32:35], v[40:55]
  ds_read_b128 v[88:91], v17 offset:12288
  s_waitcnt lgkmcnt(5)
  v_mfma_f32_32x32x16_bf16 v[56:71], v[96:99], a[32:35], v[56:71]
  ds_read_b128 v[92:95], v1 offset:11264
  buffer_load_dwordx4 a[76:79], v1, s[4:7], s31 offen offset:3072 sc1
  s_add_u32 s31, s31, 4096
  s_waitcnt vmcnt(14)
  v_mfma_f32_32x32x16_bf16 v[24:39], v[100:103], a[36:39], v[24:39]
  ds_read_b128 v[96:99], v1 offset:45056
  s_waitcnt lgkmcnt(5)
  v_mfma_f32_32x32x16_bf16 v[40:55], v[104:107], a[36:39], v[40:55]
  ds_read_b128 v[100:103], v17 offset:13312
  buffer_load_dwordx4 a[80:83], v1, s[4:7], s31 offen offset:0 sc1
  v_mfma_f32_32x32x16_bf16 v[56:71], v[108:111], a[36:39], v[56:71]
  ds_read_b128 v[104:107], v1 offset:12288
  s_waitcnt vmcnt(14) lgkmcnt(5)
  v_mfma_f32_32x32x16_bf16 v[24:39], v[112:115], a[40:43], v[24:39]
  ds_read_b128 v[108:111], v1 offset:46080
  buffer_load_dwordx4 a[84:87], v1, s[4:7], s31 offen offset:1024 sc1
  v_mfma_f32_32x32x16_bf16 v[40:55], v[116:119], a[40:43], v[40:55]
  ds_read_b128 v[112:115], v17 offset:14336
  s_waitcnt lgkmcnt(5)
  v_mfma_f32_32x32x16_bf16 v[56:71], v[88:91], a[40:43], v[56:71]
  ds_read_b128 v[116:119], v1 offset:13312
  buffer_load_dwordx4 a[88:91], v1, s[4:7], s31 offen offset:2048 sc1
  s_waitcnt vmcnt(15)
  v_mfma_f32_32x32x16_bf16 v[24:39], v[92:95], a[44:47], v[24:39]
  ds_read_b128 v[88:91], v1 offset:47104
  s_waitcnt lgkmcnt(5)
  v_mfma_f32_32x32x16_bf16 v[40:55], v[96:99], a[44:47], v[40:55]
  ds_read_b128 v[92:95], v17 offset:15360
  buffer_load_dwordx4 a[92:95], v1, s[4:7], s31 offen offset:3072 sc1
  s_add_u32 s31, s31, 4096
  v_mfma_f32_32x32x16_bf16 v[56:71], v[100:103], a[44:47], v[56:71]
  ds_read_b128 v[96:99], v1 offset:14336
  s_waitcnt vmcnt(15) lgkmcnt(5)
  v_mfma_f32_32x32x16_bf16 v[24:39], v[104:107], a[48:51], v[24:39]
  ds_read_b128 v[100:103], v1 offset:48128
  buffer_load_dwordx4 a[96:99], v1, s[4:7], s31 offen offset:0 sc1
  v_mfma_f32_32x32x16_bf16 v[40:55], v[108:111], a[48:51], v[40:55]
  ds_read_b128 v[104:107], v17 offset:16384
  s_waitcnt lgkmcnt(5)
  v_mfma_f32_32x32x16_bf16 v[56:71], v[112:115], a[48:51], v[56:71]
  ds_read_b128 v[108:111], v1 offset:15360
  buffer_load_dwordx4 a[100:103], v1, s[4:7], s31 offen offset:1024 sc1
  s_waitcnt vmcnt(16)
  v_mfma_f32_32x32x16_bf16 v[24:39], v[116:119], a[52:55], v[24:39]
  ds_read_b128 v[112:115], v1 offset:49152
  s_waitcnt lgkmcnt(5)
  v_mfma_f32_32x32x16_bf16 v[40:55], v[88:91], a[52:55], v[40:55]
  ds_read_b128 v[116:119], v17 offset:17408
  buffer_load_dwordx4 a[104:107], v1, s[4:7], s31 offen offset:2048 sc1
  v_mfma_f32_32x32x16_bf16 v[56:71], v[92:95], a[52:55], v[56:71]
  ds_read_b128 v[88:91], v1 offset:16384
  s_waitcnt vmcnt(12) lgkmcnt(5)
  v_mfma_f32_32x32x16_bf16 v[24:39], v[96:99], a[56:59], v[24:39]
  ds_read_b128 v[92:95], v1 offset:50176
  buffer_load_dwordx4 a[108:111], v1, s[4:7], s31 offen offset:3072 sc1
  s_add_u32 s31, s31, 4096
  v_mfma_f32_32x32x16_bf16 v[40:55], v[100:103], a[56:59], v[40:55]
  ds_read_b128 v[96:99], v17 offset:18432
  s_waitcnt lgkmcnt(5)
  v_mfma_f32_32x32x16_bf16 v[56:71], v[104:107], a[56:59], v[56:71]
  ds_read_b128 v[100:103], v1 offset:17408
  buffer_load_dwordx4 a[112:115], v1, s[4:7], s31 offen offset:0 sc1
  s_waitcnt vmcnt(13)
  v_mfma_f32_32x32x16_bf16 v[24:39], v[108:111], a[60:63], v[24:39]
  ds_read_b128 v[104:107], v1 offset:51200
  s_waitcnt lgkmcnt(5)
  v_mfma_f32_32x32x16_bf16 v[40:55], v[112:115], a[60:63], v[40:55]
  ds_read_b128 v[108:111], v17 offset:19456
  buffer_load_dwordx4 a[116:119], v1, s[4:7], s31 offen offset:1024 sc1
  v_mfma_f32_32x32x16_bf16 v[56:71], v[116:119], a[60:63], v[56:71]
  ds_read_b128 v[112:115], v1 offset:18432
  s_waitcnt vmcnt(13) lgkmcnt(5)
  v_mfma_f32_32x32x16_bf16 v[24:39], v[88:91], a[64:67], v[24:39]
  ds_read_b128 v[116:119], v1 offset:52224
  buffer_load_dwordx4 a[120:123], v1, s[4:7], s31 offen offset:2048 sc1
  v_mfma_f32_32x32x16_bf16 v[40:55], v[92:95], a[64:67], v[40:55]
  ds_read_b128 v[88:91], v17 offset:20480
  s_waitcnt lgkmcnt(5)
  v_mfma_f32_32x32x16_bf16 v[56:71], v[96:99], a[64:67], v[56:71]
  ds_read_b128 v[92:95], v1 offset:19456
  buffer_load_dwordx4 a[124:127], v1, s[4:7], s31 offen offset:3072 sc1
  s_waitcnt vmcnt(14)
  v_mfma_f32_32x32x16_bf16 v[24:39], v[100:103], a[68:71], v[24:39]
  ds_read_b128 v[96:99], v1 offset:53248
  s_waitcnt lgkmcnt(5)
  v_mfma_f32_32x32x16_bf16 v[40:55], v[104:107], a[68:71], v[40:55]
  ds_read_b128 v[100:103], v17 offset:21504
  buffer_load_dwordx4 v[4:7], v1, s[4:7], s86 offen offset:0 sc1
  v_mfma_f32_32x32x16_bf16 v[56:71], v[108:111], a[68:71], v[56:71]
  ds_read_b128 v[104:107], v1 offset:20480
  s_waitcnt vmcnt(19)
  s_waitcnt vmcnt(14) lgkmcnt(5)
  v_mfma_f32_32x32x16_bf16 v[24:39], v[112:115], a[72:75], v[24:39]
  ds_read_b128 v[108:111], v1 offset:54272
  buffer_load_dwordx4 v[8:11], v1, s[4:7], s86 offen offset:1024 sc1
  v_add_f32 v120, v120, v128
  v_add_f32 v121, v121, v129
  v_add_f32 v122, v122, v130
  v_add_f32 v123, v123, v131
  v_add_f32 v124, v124, v132
  v_add_f32 v125, v125, v133
  v_mfma_f32_32x32x16_bf16 v[40:55], v[116:119], a[72:75], v[40:55]
  ds_read_b128 v[112:115], v17 offset:22528
  v_add_f32 v126, v126, v134
  v_add_f32 v127, v127, v135
  v_add_f32 v120, v120, v124
  v_add_f32 v121, v121, v125
  v_add_f32 v122, v122, v126
  v_add_f32 v123, v123, v127
  v_and_b32 v124, 1, v0
  v_bfe_u32 v125, v0, 1, 1
  s_waitcnt lgkmcnt(5)
  v_mfma_f32_32x32x16_bf16 v[56:71], v[88:91], a[72:75], v[56:71]
  ds_read_b128 v[116:119], v1 offset:21504
  buffer_load_dwordx4 v[176:179], v1, s[4:7], s70 offen offset:1024
  v_permlane32_swap_b32 v120, v121
  v_permlane32_swap_b32 v122, v123
  v_lshl_or_b32 v124, v124, 1, v125
  v_and_b32 v125, 28, v0
  s_waitcnt vmcnt(15)
  v_mfma_f32_32x32x16_bf16 v[24:39], v[92:95], a[76:79], v[24:39]
  ds_read_b128 v[88:91], v1 offset:55296
  v_add_f32 v120, v120, v121
  v_add_f32 v122, v122, v123
  v_lshl_or_b32 v124, v124, 6, v125
  s_nop 0
  v_permlane16_swap_b32 v120, v122
  v_add_f32 v120, v120, v122
  ds_bpermute_b32 v122, v124, v120
  s_waitcnt lgkmcnt(6)
  v_mfma_f32_32x32x16_bf16 v[40:55], v[96:99], a[76:79], v[40:55]
  ds_read_b128 v[92:95], v17 offset:23552
  buffer_load_dwordx4 v[180:183], v1, s[4:7], s67 offen offset:1024
  ds_bpermute_b32 v121, v124, v120 offset:32
  v_mfma_f32_32x32x16_bf16 v[56:71], v[100:103], a[76:79], v[56:71]
  ds_read_b128 v[96:99], v1 offset:22528
  s_waitcnt vmcnt(15) lgkmcnt(7)
  v_mfma_f32_32x32x16_bf16 v[24:39], v[104:107], a[80:83], v[24:39]
  ds_read_b128 v[100:103], v1 offset:56320
  buffer_load_dwordx4 v[184:187], v1, s[4:7], s71 offen offset:1024
  s_waitcnt lgkmcnt(2)
  v_mul_f32 v136, 0x3b000000, v122
  v_mul_f32 v121, 0x3b000000, v121
  v_fma_f32 v121, -v136, v136, v121
  v_max_f32 v121, 0, v121
  v_add_f32 v121, 0x3727c5ac, v121
  v_mfma_f32_32x32x16_bf16 v[40:55], v[108:111], a[80:83], v[40:55]
  ds_read_b128 v[104:107], v17 offset:24576
  v_rsq_f32 v137, v121
  v_cvt_pk_bf16_f32 v140, -v136, -v136
  v_cvt_pk_bf16_f32 v141, -v136, -v136
  v_cvt_pk_bf16_f32 v142, -v136, -v136
  v_cvt_pk_bf16_f32 v143, -v136, -v136
  v_mul_f32 v138, 0xbfb8aa3b, v137
  s_waitcnt lgkmcnt(7)
  v_mfma_f32_32x32x16_bf16 v[56:71], v[112:115], a[80:83], v[56:71]
  ds_read_b128 v[108:111], v1 offset:23552
  buffer_load_dwordx4 v[188:191], v1, s[4:7], s68 offen offset:1024
  v_rcp_f32 v139, v137
  s_nop 0
  v_mul_f32 v139, 0xbfb8aa3b, v139
  s_waitcnt vmcnt(16)
  v_mfma_f32_32x32x16_bf16 v[24:39], v[116:119], a[84:87], v[24:39]
  ds_read_b128 v[112:115], v1 offset:57344
  s_waitcnt lgkmcnt(6)
  v_mfma_f32_32x32x16_bf16 v[40:55], v[88:91], a[84:87], v[40:55]
  ds_read_b128 v[116:119], v17 offset:25600
  buffer_load_dwordx4 v[192:195], v1, s[4:7], s72 offen offset:1024
  v_mfma_f32_32x32x16_bf16 v[56:71], v[92:95], a[84:87], v[56:71]
  ds_read_b128 v[88:91], v1 offset:24576
  s_waitcnt vmcnt(16) lgkmcnt(5)
  v_mfma_f32_32x32x16_bf16 v[24:39], v[96:99], a[88:91], v[24:39]
  ds_read_b128 v[92:95], v1 offset:58368
  buffer_load_dwordx4 v[196:199], v1, s[4:7], s69 offen offset:1024
  v_mfma_f32_32x32x16_bf16 v[40:55], v[100:103], a[88:91], v[40:55]
  ds_read_b128 v[96:99], v17 offset:26624
  s_waitcnt lgkmcnt(5)
  v_mfma_f32_32x32x16_bf16 v[56:71], v[104:107], a[88:91], v[56:71]
  ds_read_b128 v[100:103], v1 offset:25600
  buffer_load_dwordx4 v[200:203], v1, s[4:7], s73 offen offset:1024
  s_waitcnt vmcnt(17)
  v_mfma_f32_32x32x16_bf16 v[24:39], v[108:111], a[92:95], v[24:39]
  ds_read_b128 v[104:107], v1 offset:59392
  s_waitcnt lgkmcnt(5)
  v_mfma_f32_32x32x16_bf16 v[40:55], v[112:115], a[92:95], v[40:55]
  ds_read_b128 v[108:111], v17 offset:27648
  buffer_load_dwordx4 v[204:207], v1, s[4:7], s66 offen offset:2048
  v_mfma_f32_32x32x16_bf16 v[56:71], v[116:119], a[92:95], v[56:71]
  ds_read_b128 v[112:115], v1 offset:26624
  s_waitcnt vmcnt(17) lgkmcnt(5)
  v_mfma_f32_32x32x16_bf16 v[24:39], v[88:91], a[96:99], v[24:39]
  ds_read_b128 v[116:119], v1 offset:60416
  buffer_load_dwordx4 v[208:211], v1, s[4:7], s70 offen offset:2048
  v_mfma_f32_32x32x16_bf16 v[40:55], v[92:95], a[96:99], v[40:55]
  ds_read_b128 v[88:91], v17 offset:28672
  s_waitcnt lgkmcnt(5)
  v_mfma_f32_32x32x16_bf16 v[56:71], v[96:99], a[96:99], v[56:71]
  ds_read_b128 v[92:95], v1 offset:27648
  buffer_load_dwordx4 v[212:215], v1, s[4:7], s67 offen offset:2048
  s_waitcnt vmcnt(18)
  v_mfma_f32_32x32x16_bf16 v[24:39], v[100:103], a[100:103], v[24:39]
  ds_read_b128 v[96:99], v1 offset:61440
  s_waitcnt lgkmcnt(5)
  v_mfma_f32_32x32x16_bf16 v[40:55], v[104:107], a[100:103], v[40:55]
  ds_read_b128 v[100:103], v17 offset:29696
  buffer_load_dwordx4 v[216:219], v1, s[4:7], s71 offen offset:2048
  v_mfma_f32_32x32x16_bf16 v[56:71], v[108:111], a[100:103], v[56:71]
  ds_read_b128 v[104:107], v1 offset:28672
  s_waitcnt vmcnt(18) lgkmcnt(5)
  v_mfma_f32_32x32x16_bf16 v[24:39], v[112:115], a[104:107], v[24:39]
  ds_read_b128 v[108:111], v1 offset:62464
  buffer_load_dwordx4 v[220:223], v1, s[4:7], s68 offen offset:2048
  v_mfma_f32_32x32x16_bf16 v[40:55], v[116:119], a[104:107], v[40:55]
  ds_read_b128 v[112:115], v17 offset:30720
  s_waitcnt lgkmcnt(5)
  v_mfma_f32_32x32x16_bf16 v[56:71], v[88:91], a[104:107], v[56:71]
  ds_read_b128 v[116:119], v1 offset:29696
  buffer_load_dwordx4 v[224:227], v1, s[4:7], s72 offen offset:2048
  s_waitcnt vmcnt(19)
  v_mfma_f32_32x32x16_bf16 v[24:39], v[92:95], a[108:111], v[24:39]
  ds_read_b128 v[88:91], v1 offset:63488
  s_waitcnt lgkmcnt(5)
  v_mfma_f32_32x32x16_bf16 v[40:55], v[96:99], a[108:111], v[40:55]
  ds_read_b128 v[92:95], v17 offset:31744
  buffer_load_dwordx4 v[228:231], v1, s[4:7], s69 offen offset:2048
  v_mfma_f32_32x32x16_bf16 v[56:71], v[100:103], a[108:111], v[56:71]
  ds_read_b128 v[96:99], v1 offset:30720
  s_waitcnt vmcnt(19) lgkmcnt(5)
  v_mfma_f32_32x32x16_bf16 v[24:39], v[104:107], a[112:115], v[24:39]
  ds_read_b128 v[100:103], v1 offset:64512
  buffer_load_dwordx4 v[232:235], v1, s[4:7], s73 offen offset:2048
  v_mfma_f32_32x32x16_bf16 v[40:55], v[108:111], a[112:115], v[40:55]
  ds_read_b128 v[104:107], v17 offset:32768
  s_waitcnt lgkmcnt(5)
  v_mfma_f32_32x32x16_bf16 v[56:71], v[112:115], a[112:115], v[56:71]
  ds_read_b128 v[108:111], v1 offset:31744
  buffer_load_dwordx4 v[236:239], v1, s[4:7], s66 offen offset:3072
  s_add_u32 s66, s66, 4096
  s_waitcnt vmcnt(20)
  v_mfma_f32_32x32x16_bf16 v[24:39], v[116:119], a[116:119], v[24:39]
  ds_read_b128 v[112:115], v17 offset:0
  s_waitcnt lgkmcnt(5)
  v_mfma_f32_32x32x16_bf16 v[40:55], v[88:91], a[116:119], v[40:55]
  ds_read_b128 v[116:119], v17 offset:33792
  buffer_load_dwordx4 v[240:243], v1, s[4:7], s70 offen offset:3072
  s_add_u32 s70, s70, 4096
  v_mfma_f32_32x32x16_bf16 v[56:71], v[92:95], a[116:119], v[56:71]
  ds_read_b128 v[88:91], v1 offset:32768
  s_waitcnt vmcnt(20) lgkmcnt(5)
  v_mfma_f32_32x32x16_bf16 v[24:39], v[96:99], a[120:123], v[24:39]
  ds_read_b128 v[92:95], v17 offset:1024
  buffer_load_dwordx4 v[244:247], v1, s[4:7], s67 offen offset:3072
  s_add_u32 s67, s67, 4096
  v_mfma_f32_32x32x16_bf16 v[40:55], v[100:103], a[120:123], v[40:55]
  ds_read_b128 v[96:99], v17 offset:34816
  s_waitcnt lgkmcnt(5)
  v_mfma_f32_32x32x16_bf16 v[56:71], v[104:107], a[120:123], v[56:71]
  ds_read_b128 v[100:103], v17 offset:35840
  buffer_load_dwordx4 v[248:251], v1, s[4:7], s71 offen offset:3072
  s_add_u32 s71, s71, 4096
  s_waitcnt vmcnt(21)
  v_mfma_f32_32x32x16_bf16 v[24:39], v[108:111], a[124:127], v[24:39]
  ds_read_b128 v[104:107], v17 offset:36864
  s_waitcnt lgkmcnt(5)
  v_mfma_f32_32x32x16_bf16 v[40:55], v[112:115], a[124:127], v[40:55]
  ds_read_b128 v[108:111], v17 offset:37888
  buffer_load_dwordx4 v[252:255], v1, s[4:7], s68 offen offset:3072
  s_add_u32 s68, s68, 4096
  v_mfma_f32_32x32x16_bf16 v[56:71], v[116:119], a[124:127], v[56:71]
  ds_read_b128 v[112:115], v17 offset:38912
  s_waitcnt lgkmcnt(5)
  v_mfma_f32_32x32x16_bf16 v[24:39], v[88:91], v[140:143], v[24:39]
  ds_read_b128 v[116:119], v17 offset:39936
  v_mfma_f32_32x32x16_bf16 v[40:55], v[92:95], v[140:143], v[40:55]
  ds_read_b128 v[88:91], v17 offset:40960
  s_waitcnt lgkmcnt(5)
  v_mfma_f32_32x32x16_bf16 v[56:71], v[96:99], v[140:143], v[56:71]
  s_barrier
  ds_read_b128 v[92:95], v17 offset:41984
  ds_write_b128 v158, a[128:131] offset:0
  v_mfma_f32_32x32x16_bf16 v[72:87], v[100:103], a[0:3], 0
  ds_read_b128 v[96:99], v17 offset:43008
  s_nop 1
  v_mul_f32 v24, v138, v24
  v_mul_f32 v25, v138, v25
  v_mul_f32 v26, v138, v26
  v_mul_f32 v27, v138, v27
  v_mul_f32 v28, v138, v28
  v_mul_f32 v29, v138, v29
  v_mul_f32 v30, v138, v30
  v_mul_f32 v31, v138, v31
  s_waitcnt lgkmcnt(6)
  v_mfma_f32_32x32x16_bf16 v[72:87], v[104:107], a[4:7], v[72:87]
  ds_read_b128 v[100:103], v17 offset:44032
  v_exp_f32 v144, v24
  v_mul_f32 v32, v24, v32
  v_exp_f32 v145, v25
  v_mul_f32 v33, v25, v33
  v_mfma_f32_32x32x16_bf16 v[72:87], v[108:111], a[8:11], v[72:87]
  ds_read_b128 v[104:107], v17 offset:45056
  ds_write_b128 v158, a[132:135] offset:1024
  s_waitcnt lgkmcnt(7)
  v_mfma_f32_32x32x16_bf16 v[72:87], v[112:115], a[12:15], v[72:87]
  ds_read_b128 v[108:111], v17 offset:46080
  v_exp_f32 v146, v26
  v_mul_f32 v34, v26, v34
  v_exp_f32 v147, v27
  v_mul_f32 v35, v27, v35
  v_mfma_f32_32x32x16_bf16 v[72:87], v[116:119], a[16:19], v[72:87]
  ds_read_b128 v[112:115], v17 offset:47104
  v_exp_f32 v148, v28
  v_mul_f32 v36, v28, v36
  v_exp_f32 v149, v29
  v_mul_f32 v37, v29, v37
  v_exp_f32 v150, v30
  s_waitcnt lgkmcnt(7)
  v_mfma_f32_32x32x16_bf16 v[72:87], v[88:91], a[20:23], v[72:87]
  ds_read_b128 v[116:119], v17 offset:48128
  ds_write_b128 v158, a[136:139] offset:2048
  v_mfma_f32_32x32x16_bf16 v[72:87], v[92:95], a[24:27], v[72:87]
  ds_read_b128 v[88:91], v17 offset:49152
  v_mul_f32 v38, v30, v38
  v_exp_f32 v151, v31
  v_mul_f32 v39, v31, v39
  v_fma_f32 v144, v144, v139, v139
  v_fma_f32 v145, v145, v139, v139
  v_fma_f32 v146, v146, v139, v139
  v_fma_f32 v147, v147, v139, v139
  s_waitcnt lgkmcnt(7)
  v_mfma_f32_32x32x16_bf16 v[72:87], v[96:99], a[28:31], v[72:87]
  ds_read_b128 v[92:95], v17 offset:50176
  v_fma_f32 v148, v148, v139, v139
  v_fma_f32 v149, v149, v139, v139
  v_fma_f32 v150, v150, v139, v139
  v_fma_f32 v151, v151, v139, v139
  v_rcp_f32 v144, v144
  v_mfma_f32_32x32x16_bf16 v[72:87], v[100:103], a[32:35], v[72:87]
  ds_read_b128 v[96:99], v17 offset:51200
  ds_write_b128 v158, a[140:143] offset:3072
  s_waitcnt lgkmcnt(7)
  v_mfma_f32_32x32x16_bf16 v[72:87], v[104:107], a[36:39], v[72:87]
  ds_read_b128 v[100:103], v17 offset:52224
  v_rcp_f32 v145, v145
  v_rcp_f32 v146, v146
  v_rcp_f32 v147, v147
  v_mfma_f32_32x32x16_bf16 v[72:87], v[108:111], a[40:43], v[72:87]
  ds_read_b128 v[104:107], v17 offset:53248
  v_rcp_f32 v148, v148
  v_rcp_f32 v149, v149
  v_rcp_f32 v150, v150
  v_rcp_f32 v151, v151
  s_waitcnt lgkmcnt(7)
  v_mfma_f32_32x32x16_bf16 v[72:87], v[112:115], a[44:47], v[72:87]
  ds_read_b128 v[108:111], v17 offset:54272
  ds_write_b128 v158, a[144:147] offset:4096
  v_mfma_f32_32x32x16_bf16 v[72:87], v[116:119], a[48:51], v[72:87]
  ds_read_b128 v[112:115], v17 offset:55296
  v_mul_f32 v32, v32, v144
  v_mul_f32 v33, v33, v145
  v_mul_f32 v34, v34, v146
  v_mul_f32 v35, v35, v147
  v_mul_f32 v36, v36, v148
  v_mul_f32 v37, v37, v149
  v_mul_f32 v38, v38, v150
  v_mul_f32 v39, v39, v151
  s_waitcnt lgkmcnt(7)
  v_mfma_f32_32x32x16_bf16 v[72:87], v[88:91], a[52:55], v[72:87]
  ds_read_b128 v[116:119], v17 offset:56320
  v_cvt_pk_bf16_f32 v152, v32, v33
  v_cvt_pk_bf16_f32 v153, v34, v35
  v_cvt_pk_bf16_f32 v154, v36, v37
  v_cvt_pk_bf16_f32 v155, v38, v39
  buffer_store_dwordx4 v[152:155], v1, s[4:7], s34 offen offset:0 sc1
  v_mul_f32 v40, v138, v40
  v_mul_f32 v41, v138, v41
  v_mfma_f32_32x32x16_bf16 v[72:87], v[92:95], a[56:59], v[72:87]
  ds_read_b128 v[88:91], v17 offset:57344
  ds_write_b128 v158, a[148:151] offset:5120
  v_mul_f32 v42, v138, v42
  s_waitcnt lgkmcnt(7)
  v_mfma_f32_32x32x16_bf16 v[72:87], v[96:99], a[60:63], v[72:87]
  ds_read_b128 v[92:95], v17 offset:58368
  v_mul_f32 v43, v138, v43
  v_mul_f32 v44, v138, v44
  v_mul_f32 v45, v138, v45
  v_mul_f32 v46, v138, v46
  v_mul_f32 v47, v138, v47
  v_exp_f32 v144, v40
  v_mfma_f32_32x32x16_bf16 v[72:87], v[100:103], a[64:67], v[72:87]
  ds_read_b128 v[96:99], v17 offset:59392
  v_mul_f32 v48, v40, v48
  v_exp_f32 v145, v41
  v_mul_f32 v49, v41, v49
  v_exp_f32 v146, v42
  v_mul_f32 v50, v42, v50
  s_waitcnt lgkmcnt(7)
  v_mfma_f32_32x32x16_bf16 v[72:87], v[104:107], a[68:71], v[72:87]
  ds_read_b128 v[100:103], v17 offset:60416
  ds_write_b128 v158, a[152:155] offset:6144
  v_mfma_f32_32x32x16_bf16 v[72:87], v[108:111], a[72:75], v[72:87]
  ds_read_b128 v[104:107], v17 offset:61440
  v_exp_f32 v147, v43
  v_mul_f32 v51, v43, v51
  v_exp_f32 v148, v44
  v_mul_f32 v52, v44, v52
  v_exp_f32 v149, v45
  s_waitcnt lgkmcnt(7)
  v_mfma_f32_32x32x16_bf16 v[72:87], v[112:115], a[76:79], v[72:87]
  ds_read_b128 v[108:111], v17 offset:62464
  v_mul_f32 v53, v45, v53
  v_exp_f32 v150, v46
  v_mul_f32 v54, v46, v54
  v_exp_f32 v151, v47
  v_mul_f32 v55, v47, v55
  v_mfma_f32_32x32x16_bf16 v[72:87], v[116:119], a[80:83], v[72:87]
  ds_read_b128 v[112:115], v17 offset:63488
  ds_write_b128 v158, a[156:159] offset:7168
  v_fma_f32 v144, v144, v139, v139
  s_waitcnt lgkmcnt(7)
  v_mfma_f32_32x32x16_bf16 v[72:87], v[88:91], a[84:87], v[72:87]
  ds_read_b128 v[116:119], v17 offset:64512
  v_fma_f32 v145, v145, v139, v139
  v_fma_f32 v146, v146, v139, v139
  v_fma_f32 v147, v147, v139, v139
  v_fma_f32 v148, v148, v139, v139
  v_fma_f32 v149, v149, v139, v139
  v_fma_f32 v150, v150, v139, v139
  v_fma_f32 v151, v151, v139, v139
  v_mfma_f32_32x32x16_bf16 v[72:87], v[92:95], a[88:91], v[72:87]
  ds_read_b128 v[88:91], v18 offset:0
  v_rcp_f32 v144, v144
  v_rcp_f32 v145, v145
  v_rcp_f32 v146, v146
  v_rcp_f32 v147, v147
  s_waitcnt lgkmcnt(7)
  v_mfma_f32_32x32x16_bf16 v[72:87], v[96:99], a[92:95], v[72:87]
  ds_read_b128 v[92:95], v18 offset:1024
  ds_write_b128 v158, a[160:163] offset:8192
  v_mfma_f32_32x32x16_bf16 v[72:87], v[100:103], a[96:99], v[72:87]
  ds_read_b128 v[96:99], v18 offset:2048
  v_rcp_f32 v148, v148
  v_rcp_f32 v149, v149
  v_rcp_f32 v150, v150
  v_rcp_f32 v151, v151
  s_waitcnt lgkmcnt(7)
  v_mfma_f32_32x32x16_bf16 v[72:87], v[104:107], a[100:103], v[72:87]
  ds_read_b128 v[100:103], v18 offset:3072
  v_mul_f32 v48, v48, v144
  v_mul_f32 v49, v49, v145
  v_mul_f32 v50, v50, v146
  v_mul_f32 v51, v51, v147
  v_mul_f32 v52, v52, v148
  v_mul_f32 v53, v53, v149
  v_mul_f32 v54, v54, v150
  v_mfma_f32_32x32x16_bf16 v[72:87], v[108:111], a[104:107], v[72:87]
  s_waitcnt lgkmcnt(2)
  s_barrier
  ds_read_b128 v[104:107], v1 offset:0
  ds_write_b128 v158, a[164:167] offset:33792
  v_mul_f32 v55, v55, v151
  s_waitcnt lgkmcnt(7)
  v_mfma_f32_32x32x16_bf16 v[72:87], v[112:115], a[108:111], v[72:87]
  ds_read_b128 v[108:111], v1 offset:1024
  v_cvt_pk_bf16_f32 v152, v48, v49
  v_cvt_pk_bf16_f32 v153, v50, v51
  v_cvt_pk_bf16_f32 v154, v52, v53
  v_cvt_pk_bf16_f32 v155, v54, v55
  buffer_store_dwordx4 v[152:155], v1, s[4:7], s34 offen offset:1024 sc1
  v_mul_f32 v56, v138, v56
  v_mul_f32 v57, v138, v57
  v_mfma_f32_32x32x16_bf16 v[72:87], v[116:119], a[112:115], v[72:87]
  ds_read_b128 v[112:115], v1 offset:2048
  v_mul_f32 v58, v138, v58
  v_mul_f32 v59, v138, v59
  v_mul_f32 v60, v138, v60
  v_mul_f32 v61, v138, v61
  v_mul_f32 v62, v138, v62
  v_mul_f32 v63, v138, v63
  v_exp_f32 v144, v56
  s_waitcnt lgkmcnt(7)
  v_mfma_f32_32x32x16_bf16 v[72:87], v[88:91], a[116:119], v[72:87]
  ds_read_b128 v[116:119], v1 offset:3072
  ds_write_b128 v158, a[168:171] offset:34816
  v_mfma_f32_32x32x16_bf16 v[72:87], v[92:95], a[120:123], v[72:87]
  ds_read_b128 v[88:91], v1 offset:4096
  v_mul_f32 v64, v56, v64
  v_exp_f32 v145, v57
  v_mul_f32 v65, v57, v65
  v_exp_f32 v146, v58
  v_mul_f32 v66, v58, v66
  s_waitcnt lgkmcnt(7)
  v_mfma_f32_32x32x16_bf16 v[72:87], v[96:99], a[124:127], v[72:87]
  ds_read_b128 v[92:95], v1 offset:5120
  v_exp_f32 v147, v59
  v_mul_f32 v67, v59, v67
  v_exp_f32 v148, v60
  v_mul_f32 v68, v60, v68
  v_mfma_f32_32x32x16_bf16 v[72:87], v[100:103], v[140:143], v[72:87]
  ds_read_b128 v[96:99], v1 offset:6144
  buffer_load_dwordx4 a[128:131], v1, s[4:7], s72 offen offset:3072
  s_add_u32 s72, s72, 4096
  v_exp_f32 v149, v61
  v_mul_f32 v69, v61, v69
  v_exp_f32 v150, v62
  v_mul_f32 v70, v62, v70
  s_waitcnt lgkmcnt(6)
  v_mfma_f32_32x32x16_bf16 v[24:39], v[104:107], a[0:3], 0
  ds_read_b128 v[100:103], v1 offset:7168
  ds_write_b128 v158, a[172:175] offset:35840
  v_mfma_f32_32x32x16_bf16 v[24:39], v[108:111], a[4:7], v[24:39]
  ds_read_b128 v[104:107], v1 offset:8192
  buffer_load_dwordx4 a[132:135], v1, s[4:7], s69 offen offset:3072
  s_add_u32 s69, s69, 4096
  v_exp_f32 v151, v63
  v_mul_f32 v71, v63, v71
  v_fma_f32 v144, v144, v139, v139
  v_fma_f32 v145, v145, v139, v139
  v_fma_f32 v146, v146, v139, v139
  s_waitcnt lgkmcnt(7)
  v_mfma_f32_32x32x16_bf16 v[24:39], v[112:115], a[8:11], v[24:39]
  ds_read_b128 v[108:111], v1 offset:9216
  v_fma_f32 v147, v147, v139, v139
  v_fma_f32 v148, v148, v139, v139
  v_fma_f32 v149, v149, v139, v139
  v_fma_f32 v150, v150, v139, v139
  v_fma_f32 v151, v151, v139, v139
  v_rcp_f32 v144, v144
  v_mfma_f32_32x32x16_bf16 v[24:39], v[116:119], a[12:15], v[24:39]
  ds_read_b128 v[112:115], v1 offset:10240
  buffer_load_dwordx4 a[136:139], v1, s[4:7], s73 offen offset:3072
  s_add_u32 s73, s73, 4096
  v_rcp_f32 v145, v145
  v_rcp_f32 v146, v146
  v_rcp_f32 v147, v147
  s_waitcnt lgkmcnt(6)
  v_mfma_f32_32x32x16_bf16 v[24:39], v[88:91], a[16:19], v[24:39]
  ds_read_b128 v[116:119], v1 offset:11264
  ds_write_b128 v158, a[176:179] offset:36864
  v_mfma_f32_32x32x16_bf16 v[24:39], v[92:95], a[20:23], v[24:39]
  ds_read_b128 v[88:91], v1 offset:12288
  buffer_load_dwordx4 a[140:143], v1, s[4:7], s66 offen offset:0
  v_rcp_f32 v148, v148
  v_rcp_f32 v149, v149
  v_rcp_f32 v150, v150
  s_waitcnt lgkmcnt(7)
  v_mfma_f32_32x32x16_bf16 v[24:39], v[96:99], a[24:27], v[24:39]
  ds_read_b128 v[92:95], v1 offset:13312
  v_rcp_f32 v151, v151
  v_mul_f32 v64, v64, v144
  v_mul_f32 v65, v65, v145
  v_mul_f32 v66, v66, v146
  v_mul_f32 v67, v67, v147
  v_mul_f32 v68, v68, v148
  v_mfma_f32_32x32x16_bf16 v[24:39], v[100:103], a[28:31], v[24:39]
  ds_read_b128 v[96:99], v1 offset:14336
  buffer_load_dwordx4 a[144:147], v1, s[4:7], s70 offen offset:0
  v_mul_f32 v69, v69, v149
  v_mul_f32 v70, v70, v150
  v_mul_f32 v71, v71, v151
  v_cvt_pk_bf16_f32 v152, v64, v65
  v_cvt_pk_bf16_f32 v153, v66, v67
  v_cvt_pk_bf16_f32 v154, v68, v69
  v_cvt_pk_bf16_f32 v155, v70, v71
  s_waitcnt lgkmcnt(6)
  v_mfma_f32_32x32x16_bf16 v[24:39], v[104:107], a[32:35], v[24:39]
  ds_read_b128 v[100:103], v1 offset:15360
  ds_write_b128 v158, a[180:183] offset:37888
  v_mfma_f32_32x32x16_bf16 v[24:39], v[108:111], a[36:39], v[24:39]
  ds_read_b128 v[104:107], v1 offset:16384
  buffer_load_dwordx4 a[148:151], v1, s[4:7], s67 offen offset:0
  buffer_store_dwordx4 v[152:155], v1, s[4:7], s34 offen offset:2048 sc1
  v_mul_f32 v72, v138, v72
  v_mul_f32 v73, v138, v73
  v_mul_f32 v74, v138, v74
  v_mul_f32 v75, v138, v75
  v_mul_f32 v76, v138, v76
  v_mul_f32 v77, v138, v77
  s_waitcnt lgkmcnt(7)
  v_mfma_f32_32x32x16_bf16 v[24:39], v[112:115], a[40:43], v[24:39]
  ds_read_b128 v[108:111], v1 offset:17408
  v_mul_f32 v78, v138, v78
  v_mul_f32 v79, v138, v79
  v_exp_f32 v144, v72
  v_mul_f32 v80, v72, v80
  v_exp_f32 v145, v73
  v_mfma_f32_32x32x16_bf16 v[24:39], v[116:119], a[44:47], v[24:39]
  ds_read_b128 v[112:115], v1 offset:18432
  buffer_load_dwordx4 a[152:155], v1, s[4:7], s71 offen offset:0
  v_mul_f32 v81, v73, v81
  v_exp_f32 v146, v74
  v_mul_f32 v82, v74, v82
  v_exp_f32 v147, v75
  v_mul_f32 v83, v75, v83
  s_waitcnt lgkmcnt(6)
  v_mfma_f32_32x32x16_bf16 v[24:39], v[88:91], a[48:51], v[24:39]
  ds_read_b128 v[116:119], v1 offset:19456
  ds_write_b128 v158, a[184:187] offset:38912
  v_mfma_f32_32x32x16_bf16 v[24:39], v[92:95], a[52:55], v[24:39]
  ds_read_b128 v[88:91], v1 offset:20480
  buffer_load_dwordx4 a[156:159], v1, s[4:7], s68 offen offset:0
  v_exp_f32 v148, v76
  v_mul_f32 v84, v76, v84
  v_exp_f32 v149, v77
  v_mul_f32 v85, v77, v85
  s_waitcnt lgkmcnt(7)
  v_mfma_f32_32x32x16_bf16 v[24:39], v[96:99], a[56:59], v[24:39]
  ds_read_b128 v[92:95], v1 offset:21504
  v_exp_f32 v150, v78
  v_mul_f32 v86, v78, v86
  v_exp_f32 v151, v79
  v_mul_f32 v87, v79, v87
  v_fma_f32 v144, v144, v139, v139
  v_mfma_f32_32x32x16_bf16 v[24:39], v[100:103], a[60:63], v[24:39]
  ds_read_b128 v[96:99], v1 offset:22528
  buffer_load_dwordx4 a[160:163], v1, s[4:7], s72 offen offset:0
  v_fma_f32 v145, v145, v139, v139
  v_fma_f32 v146, v146, v139, v139
  v_fma_f32 v147, v147, v139, v139
  v_fma_f32 v148, v148, v139, v139
  v_fma_f32 v149, v149, v139, v139
  v_fma_f32 v150, v150, v139, v139
  v_fma_f32 v151, v151, v139, v139
  s_waitcnt lgkmcnt(6)
  v_mfma_f32_32x32x16_bf16 v[24:39], v[104:107], a[64:67], v[24:39]
  ds_read_b128 v[100:103], v1 offset:23552
  ds_write_b128 v158, a[188:191] offset:39936
  v_mfma_f32_32x32x16_bf16 v[24:39], v[108:111], a[68:71], v[24:39]
  ds_read_b128 v[104:107], v1 offset:24576
  v_rcp_f32 v144, v144
  v_rcp_f32 v145, v145
  v_rcp_f32 v146, v146
  v_rcp_f32 v147, v147
  s_waitcnt lgkmcnt(7)
  v_mfma_f32_32x32x16_bf16 v[24:39], v[112:115], a[72:75], v[24:39]
  ds_read_b128 v[108:111], v1 offset:25600
  v_rcp_f32 v148, v148
  v_rcp_f32 v149, v149
  v_rcp_f32 v150, v150
  v_mfma_f32_32x32x16_bf16 v[24:39], v[116:119], a[76:79], v[24:39]
  ds_read_b128 v[112:115], v1 offset:26624
  ds_write_b128 v158, a[192:195] offset:40960
  s_waitcnt lgkmcnt(7)
  v_mfma_f32_32x32x16_bf16 v[24:39], v[88:91], a[80:83], v[24:39]
  ds_read_b128 v[116:119], v1 offset:27648
  v_rcp_f32 v151, v151
  v_mul_f32 v80, v80, v144
  v_mul_f32 v81, v81, v145
  v_mul_f32 v82, v82, v146
  v_mul_f32 v83, v83, v147
  v_mul_f32 v84, v84, v148
  v_mfma_f32_32x32x16_bf16 v[24:39], v[92:95], a[84:87], v[24:39]
  ds_read_b128 v[88:91], v1 offset:28672
  v_mul_f32 v85, v85, v149
  v_mul_f32 v86, v86, v150
  v_mul_f32 v87, v87, v151
  v_cvt_pk_bf16_f32 v152, v80, v81
  v_cvt_pk_bf16_f32 v153, v82, v83
  v_cvt_pk_bf16_f32 v154, v84, v85
  v_cvt_pk_bf16_f32 v155, v86, v87
  buffer_store_dwordx4 v[152:155], v1, s[4:7], s34 offen offset:3072 sc1
  s_waitcnt lgkmcnt(7)
  v_mfma_f32_32x32x16_bf16 v[24:39], v[96:99], a[88:91], v[24:39]
  ds_read_b128 v[92:95], v1 offset:29696
  ds_write_b128 v158, a[196:199] offset:41984
  v_mfma_f32_32x32x16_bf16 v[24:39], v[100:103], a[92:95], v[24:39]
  ds_read_b128 v[96:99], v1 offset:30720
  s_waitcnt lgkmcnt(7)
  v_mfma_f32_32x32x16_bf16 v[24:39], v[104:107], a[96:99], v[24:39]
  ds_read_b128 v[100:103], v1 offset:31744
  v_mfma_f32_32x32x16_bf16 v[24:39], v[108:111], a[100:103], v[24:39]
  ds_read_b128 v[104:107], v1 offset:32768
  ds_write_b128 v159, a[200:203] offset:2048
  s_waitcnt lgkmcnt(7)
  v_mfma_f32_32x32x16_bf16 v[24:39], v[112:115], a[104:107], v[24:39]
  s_waitcnt lgkmcnt(4)
  s_barrier
  ds_read_b128 v[108:111], v1 offset:33792
  v_mfma_f32_32x32x16_bf16 v[24:39], v[116:119], a[108:111], v[24:39]
  ds_read_b128 v[112:115], v1 offset:34816
  s_waitcnt lgkmcnt(7)
  v_mfma_f32_32x32x16_bf16 v[24:39], v[88:91], a[112:115], v[24:39]
  ds_read_b128 v[116:119], v1 offset:35840
  ds_write_b128 v159, a[204:207] offset:3072
  v_mfma_f32_32x32x16_bf16 v[24:39], v[92:95], a[116:119], v[24:39]
  ds_read_b128 v[88:91], v1 offset:36864
  s_waitcnt lgkmcnt(7)
  v_mfma_f32_32x32x16_bf16 v[24:39], v[96:99], a[120:123], v[24:39]
  ds_read_b128 v[92:95], v1 offset:37888
  v_mfma_f32_32x32x16_bf16 v[24:39], v[100:103], a[124:127], v[24:39]
  ds_read_b128 v[96:99], v1 offset:38912
  buffer_load_dwordx4 a[164:167], v1, s[4:7], s69 offen offset:0
  s_waitcnt lgkmcnt(6)
  v_mfma_f32_32x32x16_bf16 v[24:39], v[104:107], v[140:143], v[24:39]
  ds_read_b128 v[100:103], v1 offset:39936
  ds_write_b128 v159, a[208:211] offset:4096
  v_mfma_f32_32x32x16_bf16 v[40:55], v[108:111], a[0:3], 0
  ds_read_b128 v[104:107], v1 offset:40960
  buffer_load_dwordx4 a[168:171], v1, s[4:7], s73 offen offset:0
  s_waitcnt lgkmcnt(7)
  v_mfma_f32_32x32x16_bf16 v[40:55], v[112:115], a[4:7], v[40:55]
  ds_read_b128 v[108:111], v1 offset:41984
  v_mfma_f32_32x32x16_bf16 v[40:55], v[116:119], a[8:11], v[40:55]
  ds_read_b128 v[112:115], v1 offset:43008
  buffer_load_dwordx4 a[172:175], v1, s[4:7], s66 offen offset:1024
  s_nop 0
  v_mul_f32 v24, v138, v24
  v_mul_f32 v25, v138, v25
  v_mul_f32 v26, v138, v26
  v_mul_f32 v27, v138, v27
  v_mul_f32 v28, v138, v28
  v_mul_f32 v29, v138, v29
  v_mul_f32 v30, v138, v30
  s_waitcnt lgkmcnt(6)
  v_mfma_f32_32x32x16_bf16 v[40:55], v[88:91], a[12:15], v[40:55]
  ds_read_b128 v[116:119], v1 offset:44032
  ds_write_b128 v159, a[212:215] offset:5120
  v_mfma_f32_32x32x16_bf16 v[40:55], v[92:95], a[16:19], v[40:55]
  ds_read_b128 v[88:91], v1 offset:45056
  buffer_load_dwordx4 a[176:179], v1, s[4:7], s70 offen offset:1024
  v_mul_f32 v31, v138, v31
  v_exp_f32 v144, v24
  v_mul_f32 v32, v24, v32
  v_exp_f32 v145, v25
  v_mul_f32 v33, v25, v33
  s_waitcnt lgkmcnt(7)
  v_mfma_f32_32x32x16_bf16 v[40:55], v[96:99], a[20:23], v[40:55]
  ds_read_b128 v[92:95], v1 offset:46080
  v_exp_f32 v146, v26
  v_mul_f32 v34, v26, v34
  v_exp_f32 v147, v27
  v_mul_f32 v35, v27, v35
  v_mfma_f32_32x32x16_bf16 v[40:55], v[100:103], a[24:27], v[40:55]
  ds_read_b128 v[96:99], v1 offset:47104
  buffer_load_dwordx4 a[180:183], v1, s[4:7], s67 offen offset:1024
  v_exp_f32 v148, v28
  v_mul_f32 v36, v28, v36
  v_exp_f32 v149, v29
  v_mul_f32 v37, v29, v37
  s_waitcnt lgkmcnt(6)
  v_mfma_f32_32x32x16_bf16 v[40:55], v[104:107], a[28:31], v[40:55]
  ds_read_b128 v[100:103], v1 offset:48128
  ds_write_b128 v159, a[216:219] offset:6144
  v_mfma_f32_32x32x16_bf16 v[40:55], v[108:111], a[32:35], v[40:55]
  ds_read_b128 v[104:107], v1 offset:49152
  buffer_load_dwordx4 a[184:187], v1, s[4:7], s71 offen offset:1024
  v_exp_f32 v150, v30
  v_mul_f32 v38, v30, v38
  v_exp_f32 v151, v31
  v_mul_f32 v39, v31, v39
  v_fma_f32 v144, v144, v139, v139
  s_waitcnt lgkmcnt(7)
  v_mfma_f32_32x32x16_bf16 v[40:55], v[112:115], a[36:39], v[40:55]
  ds_read_b128 v[108:111], v1 offset:50176
  v_fma_f32 v145, v145, v139, v139
  v_fma_f32 v146, v146, v139, v139
  v_fma_f32 v147, v147, v139, v139
  v_fma_f32 v148, v148, v139, v139
  v_fma_f32 v149, v149, v139, v139
  v_fma_f32 v150, v150, v139, v139
  v_fma_f32 v151, v151, v139, v139
  v_mfma_f32_32x32x16_bf16 v[40:55], v[116:119], a[40:43], v[40:55]
  ds_read_b128 v[112:115], v1 offset:51200
  buffer_load_dwordx4 a[188:191], v1, s[4:7], s68 offen offset:1024
  v_rcp_f32 v144, v144
  v_rcp_f32 v145, v145
  v_rcp_f32 v146, v146
  s_waitcnt lgkmcnt(6)
  v_mfma_f32_32x32x16_bf16 v[40:55], v[88:91], a[44:47], v[40:55]
  ds_read_b128 v[116:119], v1 offset:52224
  ds_write_b128 v159, a[220:223] offset:7168
  v_mfma_f32_32x32x16_bf16 v[40:55], v[92:95], a[48:51], v[40:55]
  ds_read_b128 v[88:91], v1 offset:53248
  buffer_load_dwordx4 a[192:195], v1, s[4:7], s72 offen offset:1024
  v_rcp_f32 v147, v147
  v_rcp_f32 v148, v148
  v_rcp_f32 v149, v149
  s_waitcnt lgkmcnt(7)
  v_mfma_f32_32x32x16_bf16 v[40:55], v[96:99], a[52:55], v[40:55]
  s_waitcnt vmcnt(8)
  s_barrier
  v_mov_b32 v22, 11
  s_cmp_lg_u32 s16, 0
  s_cbranch_scc1 L_sig_77
  s_mov_b64 exec, 1
  s_cmp_eq_u32 s79, 0
  s_cbranch_scc1 L_far_78
  buffer_store_dword v22, off, s[4:7], s77
  s_mov_b64 exec, -1
L_sig_77:
  ds_read_b128 v[92:95], v1 offset:54272
  v_rcp_f32 v150, v150
  v_rcp_f32 v151, v151
  v_mul_f32 v32, v32, v144
  v_mul_f32 v33, v33, v145
  v_mul_f32 v34, v34, v146
  v_mfma_f32_32x32x16_bf16 v[40:55], v[100:103], a[56:59], v[40:55]
  ds_read_b128 v[96:99], v1 offset:55296
  buffer_load_dwordx4 a[196:199], v1, s[4:7], s69 offen offset:1024
  v_mul_f32 v35, v35, v147
  v_mul_f32 v36, v36, v148
  v_mul_f32 v37, v37, v149
  v_mul_f32 v38, v38, v150
  v_mul_f32 v39, v39, v151
  v_cvt_pk_bf16_f32 v152, v32, v33
  v_cvt_pk_bf16_f32 v153, v34, v35
  s_waitcnt lgkmcnt(6)
  v_mfma_f32_32x32x16_bf16 v[40:55], v[104:107], a[60:63], v[40:55]
  ds_read_b128 v[100:103], v1 offset:56320
  ds_write_b128 v159, a[224:227] offset:8192
  v_mfma_f32_32x32x16_bf16 v[40:55], v[108:111], a[64:67], v[40:55]
  ds_read_b128 v[104:107], v1 offset:57344
  v_cvt_pk_bf16_f32 v154, v36, v37
  v_cvt_pk_bf16_f32 v155, v38, v39
  s_add_u32 s34, s34, 4096
  buffer_store_dwordx4 v[152:155], v1, s[4:7], s34 offen offset:0 sc1
  s_waitcnt lgkmcnt(7)
  v_mfma_f32_32x32x16_bf16 v[40:55], v[112:115], a[68:71], v[40:55]
  ds_read_b128 v[108:111], v1 offset:58368
  v_mfma_f32_32x32x16_bf16 v[40:55], v[116:119], a[72:75], v[40:55]
  ds_read_b128 v[112:115], v1 offset:59392
  ds_write_b128 v159, a[228:231] offset:9216
  s_waitcnt lgkmcnt(7)
  v_mfma_f32_32x32x16_bf16 v[40:55], v[88:91], a[76:79], v[40:55]
  ds_read_b128 v[116:119], v1 offset:60416
  v_mfma_f32_32x32x16_bf16 v[40:55], v[92:95], a[80:83], v[40:55]
  ds_read_b128 v[88:91], v1 offset:61440
  s_waitcnt lgkmcnt(7)
  v_mfma_f32_32x32x16_bf16 v[40:55], v[96:99], a[84:87], v[40:55]
  ds_read_b128 v[92:95], v1 offset:62464
  ds_write_b128 v159, a[232:235] offset:10240
  v_mfma_f32_32x32x16_bf16 v[40:55], v[100:103], a[88:91], v[40:55]
  ds_read_b128 v[96:99], v1 offset:63488
  s_waitcnt lgkmcnt(7)
  v_mfma_f32_32x32x16_bf16 v[40:55], v[104:107], a[92:95], v[40:55]
  ds_read_b128 v[100:103], v1 offset:64512
  v_mfma_f32_32x32x16_bf16 v[40:55], v[108:111], a[96:99], v[40:55]
  ds_read_b128 v[104:107], v17 offset:0
  s_waitcnt lgkmcnt(6)
  v_mfma_f32_32x32x16_bf16 v[40:55], v[112:115], a[100:103], v[40:55]
  buffer_load_dword v23, v13, s[4:7], 0 offen sc1
  ds_read_b128 v[108:111], v17 offset:1024
  v_mfma_f32_32x32x16_bf16 v[40:55], v[116:119], a[104:107], v[40:55]
  s_waitcnt lgkmcnt(4)
  s_barrier
  ds_read_b128 v[112:115], v17 offset:2048
  s_waitcnt lgkmcnt(6)
  v_mfma_f32_32x32x16_bf16 v[40:55], v[88:91], a[108:111], v[40:55]
  ds_read_b128 v[116:119], v17 offset:3072
  v_mfma_f32_32x32x16_bf16 v[40:55], v[92:95], a[112:115], v[40:55]
  ds_read_b128 v[88:91], v17 offset:4096
  s_waitcnt lgkmcnt(5)
  v_mfma_f32_32x32x16_bf16 v[40:55], v[96:99], a[116:119], v[40:55]
  ds_read_b128 v[92:95], v17 offset:5120
  v_mfma_f32_32x32x16_bf16 v[40:55], v[100:103], a[120:123], v[40:55]
  ds_read_b128 v[96:99], v17 offset:6144
  buffer_load_dwordx4 a[200:203], v1, s[4:7], s73 offen offset:1024
  s_waitcnt lgkmcnt(5)
  v_mfma_f32_32x32x16_bf16 v[40:55], v[104:107], a[124:127], v[40:55]
  ds_read_b128 v[100:103], v17 offset:7168
  v_mfma_f32_32x32x16_bf16 v[40:55], v[108:111], v[140:143], v[40:55]
  ds_read_b128 v[104:107], v17 offset:8192
  buffer_load_dwordx4 a[204:207], v1, s[4:7], s66 offen offset:2048
  s_waitcnt lgkmcnt(5)
  v_mfma_f32_32x32x16_bf16 v[56:71], v[112:115], a[0:3], 0
  ds_read_b128 v[108:111], v17 offset:9216
  v_mfma_f32_32x32x16_bf16 v[56:71], v[116:119], a[4:7], v[56:71]
  ds_read_b128 v[112:115], v17 offset:10240
  buffer_load_dwordx4 a[208:211], v1, s[4:7], s70 offen offset:2048
  s_waitcnt lgkmcnt(5)
  v_mfma_f32_32x32x16_bf16 v[56:71], v[88:91], a[8:11], v[56:71]
  s_waitcnt vmcnt(3)
  v_cmp_gt_u32 vcc, 11, v23
  s_cbranch_vccnz L_slow_79
L_back_80:
  ds_read_b128 v[116:119], v17 offset:11264
  v_mul_f32 v40, v138, v40
  v_mul_f32 v41, v138, v41
  v_mul_f32 v42, v138, v42
  v_mul_f32 v43, v138, v43
  v_mul_f32 v44, v138, v44
  v_mul_f32 v45, v138, v45
  v_mul_f32 v46, v138, v46
  v_mfma_f32_32x32x16_bf16 v[56:71], v[92:95], a[12:15], v[56:71]
  ds_read_b128 v[88:91], v17 offset:12288
  buffer_load_dwordx4 a[212:215], v1, s[4:7], s67 offen offset:2048
  v_mul_f32 v47, v138, v47
  v_exp_f32 v144, v40
  v_mul_f32 v48, v40, v48
  v_exp_f32 v145, v41
  v_mul_f32 v49, v41, v49
  s_waitcnt lgkmcnt(5)
  v_mfma_f32_32x32x16_bf16 v[56:71], v[96:99], a[16:19], v[56:71]
  ds_read_b128 v[92:95], v17 offset:13312
  v_exp_f32 v146, v42
  v_mul_f32 v50, v42, v50
  v_exp_f32 v147, v43
  v_mul_f32 v51, v43, v51
  v_mfma_f32_32x32x16_bf16 v[56:71], v[100:103], a[20:23], v[56:71]
  ds_read_b128 v[96:99], v17 offset:14336
  buffer_load_dwordx4 a[216:219], v1, s[4:7], s71 offen offset:2048
  v_exp_f32 v148, v44
  v_mul_f32 v52, v44, v52
  v_exp_f32 v149, v45
  v_mul_f32 v53, v45, v53
  s_waitcnt lgkmcnt(5)
  v_mfma_f32_32x32x16_bf16 v[56:71], v[104:107], a[24:27], v[56:71]
  ds_read_b128 v[100:103], v17 offset:15360
  v_exp_f32 v150, v46
  v_mul_f32 v54, v46, v54
  v_exp_f32 v151, v47
  v_mul_f32 v55, v47, v55
  v_fma_f32 v144, v144, v139, v139
  v_mfma_f32_32x32x16_bf16 v[56:71], v[108:111], a[28:31], v[56:71]
  ds_read_b128 v[104:107], v17 offset:16384
  buffer_load_dwordx4 a[220:223], v1, s[4:7], s68 offen offset:2048
  v_fma_f32 v145, v145, v139, v139
  v_fma_f32 v146, v146, v139, v139
  v_fma_f32 v147, v147, v139, v139
  v_fma_f32 v148, v148, v139, v139
  v_fma_f32 v149, v149, v139, v139
  v_fma_f32 v150, v150, v139, v139
  v_fma_f32 v151, v151, v139, v139
  s_waitcnt lgkmcnt(5)
  v_mfma_f32_32x32x16_bf16 v[56:71], v[112:115], a[32:35], v[56:71]
  ds_read_b128 v[108:111], v17 offset:17408
  v_rcp_f32 v144, v144
  v_rcp_f32 v145, v145
  v_rcp_f32 v146, v146
  v_mfma_f32_32x32x16_bf16 v[56:71], v[116:119], a[36:39], v[56:71]
  ds_read_b128 v[112:115], v17 offset:18432
  buffer_load_dwordx4 a[224:227], v1, s[4:7], s72 offen offset:2048
  v_rcp_f32 v147, v147
  v_rcp_f32 v148, v148
  v_rcp_f32 v149, v149
  s_waitcnt lgkmcnt(5)
  v_mfma_f32_32x32x16_bf16 v[56:71], v[88:91], a[40:43], v[56:71]
  ds_read_b128 v[116:119], v17 offset:19456
  v_rcp_f32 v150, v150
  v_rcp_f32 v151, v151
  v_mul_f32 v48, v48, v144
  v_mul_f32 v49, v49, v145
  v_mul_f32 v50, v50, v146
  v_mfma_f32_32x32x16_bf16 v[56:71], v[92:95], a[44:47], v[56:71]
  ds_read_b128 v[88:91], v17 offset:20480
  buffer_load_dwordx4 a[228:231], v1, s[4:7], s69 offen offset:2048
  v_mul_f32 v51, v51, v147
  v_mul_f32 v52, v52, v148
  v_mul_f32 v53, v53, v149
  v_mul_f32 v54, v54, v150
  v_mul_f32 v55, v55, v151
  v_cvt_pk_bf16_f32 v152, v48, v49
  v_cvt_pk_bf16_f32 v153, v50, v51
  s_waitcnt lgkmcnt(5)
  v_mfma_f32_32x32x16_bf16 v[56:71], v[96:99], a[48:51], v[56:71]
  ds_read_b128 v[92:95], v17 offset:21504
  v_cvt_pk_bf16_f32 v154, v52, v53
  v_cvt_pk_bf16_f32 v155, v54, v55
  buffer_store_dwordx4 v[152:155], v1, s[4:7], s34 offen offset:1024 sc1
  v_mfma_f32_32x32x16_bf16 v[56:71], v[100:103], a[52:55], v[56:71]
  ds_read_b128 v[96:99], v17 offset:22528
  s_waitcnt lgkmcnt(5)
  v_mfma_f32_32x32x16_bf16 v[56:71], v[104:107], a[56:59], v[56:71]
  ds_read_b128 v[100:103], v17 offset:23552
  buffer_load_dwordx4 a[232:235], v1, s[4:7], s73 offen offset:2048
  v_mfma_f32_32x32x16_bf16 v[56:71], v[108:111], a[60:63], v[56:71]
  ds_read_b128 v[104:107], v17 offset:24576
  s_waitcnt lgkmcnt(5)
  v_mfma_f32_32x32x16_bf16 v[56:71], v[112:115], a[64:67], v[56:71]
  ds_read_b128 v[108:111], v17 offset:25600
  buffer_load_dwordx4 a[0:3], v1, s[4:7], s92 offen offset:0 sc1
  v_mfma_f32_32x32x16_bf16 v[56:71], v[116:119], a[68:71], v[56:71]
  ds_read_b128 v[112:115], v17 offset:26624
  s_waitcnt lgkmcnt(5)
  v_mfma_f32_32x32x16_bf16 v[56:71], v[88:91], a[72:75], v[56:71]
  ds_read_b128 v[116:119], v17 offset:27648
  buffer_load_dwordx4 a[4:7], v1, s[4:7], s93 offen offset:0 sc1
  v_mfma_f32_32x32x16_bf16 v[56:71], v[92:95], a[76:79], v[56:71]
  ds_read_b128 v[88:91], v17 offset:28672
  s_waitcnt lgkmcnt(5)
  v_mfma_f32_32x32x16_bf16 v[56:71], v[96:99], a[80:83], v[56:71]
  ds_read_b128 v[92:95], v17 offset:29696
  buffer_load_dwordx4 a[8:11], v1, s[4:7], s94 offen offset:0 sc1
  v_mfma_f32_32x32x16_bf16 v[56:71], v[100:103], a[84:87], v[56:71]
  ds_read_b128 v[96:99], v17 offset:30720
  s_waitcnt lgkmcnt(5)
  v_mfma_f32_32x32x16_bf16 v[56:71], v[104:107], a[88:91], v[56:71]
  ds_read_b128 v[100:103], v17 offset:31744
  buffer_load_dwordx4 a[12:15], v1, s[4:7], s95 offen offset:0 sc1
  v_mfma_f32_32x32x16_bf16 v[56:71], v[108:111], a[92:95], v[56:71]
  ds_read_b128 v[104:107], v17 offset:32768
  s_waitcnt lgkmcnt(5)
  v_mfma_f32_32x32x16_bf16 v[56:71], v[112:115], a[96:99], v[56:71]
  ds_read_b128 v[108:111], v17 offset:33792
  buffer_load_dwordx4 a[16:19], v1, s[4:7], s92 offen offset:1024 sc1
  v_mfma_f32_32x32x16_bf16 v[56:71], v[116:119], a[100:103], v[56:71]
  ds_read_b128 v[112:115], v17 offset:34816
  s_waitcnt lgkmcnt(5)
  v_mfma_f32_32x32x16_bf16 v[56:71], v[88:91], a[104:107], v[56:71]
  buffer_load_dwordx4 a[20:23], v1, s[4:7], s93 offen offset:1024 sc1
  v_mfma_f32_32x32x16_bf16 v[56:71], v[92:95], a[108:111], v[56:71]
  s_waitcnt lgkmcnt(3)
  v_mfma_f32_32x32x16_bf16 v[56:71], v[96:99], a[112:115], v[56:71]
  buffer_load_dwordx4 a[24:27], v1, s[4:7], s94 offen offset:1024 sc1
  v_mfma_f32_32x32x16_bf16 v[56:71], v[100:103], a[116:119], v[56:71]
  s_waitcnt lgkmcnt(1)
  v_mfma_f32_32x32x16_bf16 v[56:71], v[104:107], a[120:123], v[56:71]
  buffer_load_dwordx4 a[28:31], v1, s[4:7], s95 offen offset:1024 sc1
  v_mfma_f32_32x32x16_bf16 v[56:71], v[108:111], a[124:127], v[56:71]
  s_waitcnt lgkmcnt(0)
  v_mfma_f32_32x32x16_bf16 v[56:71], v[112:115], v[140:143], v[56:71]
  buffer_load_dwordx4 a[32:35], v1, s[4:7], s92 offen offset:2048 sc1
  s_nop 10
  v_mul_f32 v56, v138, v56
  v_mul_f32 v57, v138, v57
  v_mul_f32 v58, v138, v58
  v_mul_f32 v59, v138, v59
  v_mul_f32 v60, v138, v60
  v_mul_f32 v61, v138, v61
  buffer_load_dwordx4 a[36:39], v1, s[4:7], s93 offen offset:2048 sc1
  v_mul_f32 v62, v138, v62
  v_mul_f32 v63, v138, v63
  v_exp_f32 v144, v56
  v_mul_f32 v64, v56, v64
  v_exp_f32 v145, v57
  v_mul_f32 v65, v57, v65
  v_exp_f32 v146, v58
  v_mul_f32 v66, v58, v66
  v_exp_f32 v147, v59
  v_mul_f32 v67, v59, v67
  v_exp_f32 v148, v60
  v_mul_f32 v68, v60, v68
  buffer_load_dwordx4 a[40:43], v1, s[4:7], s94 offen offset:2048 sc1
  v_exp_f32 v149, v61
  v_mul_f32 v69, v61, v69
  v_exp_f32 v150, v62
  v_mul_f32 v70, v62, v70
  v_exp_f32 v151, v63
  v_mul_f32 v71, v63, v71
  v_fma_f32 v144, v144, v139, v139
  v_fma_f32 v145, v145, v139, v139
  v_fma_f32 v146, v146, v139, v139
  v_fma_f32 v147, v147, v139, v139
  v_fma_f32 v148, v148, v139, v139
  v_fma_f32 v149, v149, v139, v139
  buffer_load_dwordx4 a[44:47], v1, s[4:7], s95 offen offset:2048 sc1
  v_fma_f32 v150, v150, v139, v139
  v_fma_f32 v151, v151, v139, v139
  v_rcp_f32 v144, v144
  v_rcp_f32 v145, v145
  v_rcp_f32 v146, v146
  v_rcp_f32 v147, v147
  v_rcp_f32 v148, v148
  v_rcp_f32 v149, v149
  v_rcp_f32 v150, v150
  v_rcp_f32 v151, v151
  v_mul_f32 v64, v64, v144
  v_mul_f32 v65, v65, v145
  buffer_load_dwordx4 a[48:51], v1, s[4:7], s92 offen offset:3072 sc1
  s_add_u32 s92, s92, 4096
  v_mul_f32 v66, v66, v146
  v_mul_f32 v67, v67, v147
  v_mul_f32 v68, v68, v148
  v_mul_f32 v69, v69, v149
  v_mul_f32 v70, v70, v150
  v_mul_f32 v71, v71, v151
  v_cvt_pk_bf16_f32 v152, v64, v65
  v_cvt_pk_bf16_f32 v153, v66, v67
  v_cvt_pk_bf16_f32 v154, v68, v69
  v_cvt_pk_bf16_f32 v155, v70, v71
  s_waitcnt vmcnt(14)
  s_barrier
  v_mov_b32 v22, 12
  s_cmp_lg_u32 s16, 0
  s_cbranch_scc1 L_sig_81
  s_mov_b64 exec, 1
  s_cmp_eq_u32 s79, 0
  s_cbranch_scc1 L_far_82
  buffer_store_dword v22, off, s[4:7], s77
  s_mov_b64 exec, -1
L_sig_81:
  buffer_store_dwordx4 v[152:155], v1, s[4:7], s34 offen offset:2048 sc1
  s_waitcnt vmcnt(13)
  v_mfma_f32_32x32x16_bf16 v[56:71], a[236:239], a[0:3], 0
  v_lshlrev_b32 v24, 16, v4
  v_and_b32 v25, 0xffff0000, v4
  v_mfma_f32_32x32x16_bf16 v[72:87], a[240:243], a[0:3], 0
  buffer_load_dwordx4 a[52:55], v1, s[4:7], s93 offen offset:3072 sc1
  s_add_u32 s93, s93, 4096
  v_lshlrev_b32 v26, 16, v5
  v_and_b32 v27, 0xffff0000, v5
  s_waitcnt vmcnt(13)
  v_mfma_f32_32x32x16_bf16 v[56:71], a[244:247], a[4:7], v[56:71]
  v_lshlrev_b32 v28, 16, v6
  v_and_b32 v29, 0xffff0000, v6
  v_mfma_f32_32x32x16_bf16 v[72:87], a[248:251], a[4:7], v[72:87]
  buffer_load_dwordx4 a[56:59], v1, s[4:7], s94 offen offset:3072 sc1
  s_add_u32 s94, s94, 4096
  v_lshlrev_b32 v30, 16, v7
  v_and_b32 v31, 0xffff0000, v7
  s_waitcnt vmcnt(13)
  v_mfma_f32_32x32x16_bf16 v[56:71], a[252:255], a[8:11], v[56:71]
  v_lshlrev_b32 v32, 16, v8
  v_and_b32 v33, 0xffff0000, v8
  v_mfma_f32_32x32x16_bf16 v[72:87], v[160:163], a[8:11], v[72:87]
  buffer_load_dwordx4 a[60:63], v1, s[4:7], s95 offen offset:3072 sc1
  s_add_u32 s95, s95, 4096
  v_lshlrev_b32 v34, 16, v9
  v_and_b32 v35, 0xffff0000, v9
  s_waitcnt vmcnt(13)
  v_mfma_f32_32x32x16_bf16 v[56:71], v[164:167], a[12:15], v[56:71]
  v_lshlrev_b32 v36, 16, v10
  v_and_b32 v37, 0xffff0000, v10
  v_mfma_f32_32x32x16_bf16 v[72:87], v[168:171], a[12:15], v[72:87]
  buffer_load_dwordx4 a[64:67], v1, s[4:7], s88 offen offset:0 sc1
  v_lshlrev_b32 v38, 16, v11
  v_and_b32 v39, 0xffff0000, v11
  s_waitcnt vmcnt(13)
  v_mfma_f32_32x32x16_bf16 v[56:71], v[172:175], a[16:19], v[56:71]
  s_xor_b32 s34, s16, 2
  s_lshl_b32 s34, s34, 13
  s_add_u32 s34, s34, 67584
  v_add_u32 v90, s34, v1
  v_mfma_f32_32x32x16_bf16 v[72:87], v[176:179], a[16:19], v[72:87]
  buffer_load_dwordx4 a[68:71], v1, s[4:7], s89 offen offset:0 sc1
  s_xor_b32 s34, s16, 3
  s_lshl_b32 s34, s34, 13
  s_add_u32 s34, s34, 71680
  v_add_u32 v91, s34, v1
  s_waitcnt vmcnt(13)
  v_mfma_f32_32x32x16_bf16 v[56:71], v[180:183], a[20:23], v[56:71]
  s_xor_b32 s34, s16, 1
  s_lshl_b32 s34, s34, 12
  s_add_u32 s34, s34, 135168
  v_add_u32 v89, s34, v1
  v_mfma_f32_32x32x16_bf16 v[72:87], v[184:187], a[20:23], v[72:87]
  buffer_load_dwordx4 a[72:75], v1, s[4:7], s90 offen offset:0 sc1
  s_lshl_b32 s34, s16, 12
  s_add_u32 s34, s34, 135168
  v_add_u32 v88, s34, v1
  s_waitcnt vmcnt(13)
  v_mfma_f32_32x32x16_bf16 v[56:71], v[188:191], a[24:27], v[56:71]
  s_lshl_b32 s34, s16, 13
  s_add_u32 s34, s34, 67584
  v_add_u32 v92, s34, v1
  v_mfma_f32_32x32x16_bf16 v[72:87], v[192:195], a[24:27], v[72:87]
  buffer_load_dwordx4 a[76:79], v1, s[4:7], s91 offen offset:0 sc1
  s_mov_b32 s8, s48
  s_waitcnt vmcnt(13)
  v_mfma_f32_32x32x16_bf16 v[56:71], v[196:199], a[28:31], v[56:71]
  s_mov_b32 s9, s49
  v_mfma_f32_32x32x16_bf16 v[72:87], v[200:203], a[28:31], v[72:87]
  buffer_load_dwordx4 a[80:83], v1, s[4:7], s88 offen offset:1024 sc1
  s_mov_b32 s10, 2097152
  s_waitcnt vmcnt(13)
  v_mfma_f32_32x32x16_bf16 v[56:71], v[204:207], a[32:35], v[56:71]
  s_mov_b32 s11, 0x20000
  v_mfma_f32_32x32x16_bf16 v[72:87], v[208:211], a[32:35], v[72:87]
  buffer_load_dwordx4 a[84:87], v1, s[4:7], s89 offen offset:1024 sc1
  v_and_b32 v14, 31, v0
  v_lshrrev_b32 v16, 5, v0
  s_waitcnt vmcnt(13)
  v_mfma_f32_32x32x16_bf16 v[56:71], v[212:215], a[36:39], v[56:71]
  v_lshlrev_b32 v14, 10, v14
  v_lshl_or_b32 v14, v16, 4, v14
  v_mfma_f32_32x32x16_bf16 v[72:87], v[216:219], a[36:39], v[72:87]
  buffer_load_dwordx4 a[88:91], v1, s[4:7], s90 offen offset:1024 sc1
  s_lshl_b32 s52, s26, 15
  s_waitcnt vmcnt(13)
  s_waitcnt vmcnt(10)
  s_barrier
  v_mov_b32 v22, 13
  s_cmp_lg_u32 s16, 0
  s_cbranch_scc1 L_sig_83
  s_mov_b64 exec, 1
  s_cmp_eq_u32 s79, 0
  s_cbranch_scc1 L_far_84
  buffer_store_dword v22, off, s[4:7], s77
  s_mov_b64 exec, -1
L_sig_83:
  v_mfma_f32_32x32x16_bf16 v[56:71], v[220:223], a[40:43], v[56:71]
  s_lshl_b32 s54, s25, 6
  v_mfma_f32_32x32x16_bf16 v[72:87], v[224:227], a[40:43], v[72:87]
  buffer_load_dwordx4 a[92:95], v1, s[4:7], s91 offen offset:1024 sc1
  s_add_u32 s52, s52, s54
  s_waitcnt vmcnt(13)
  v_mfma_f32_32x32x16_bf16 v[56:71], v[228:231], a[44:47], v[56:71]
  v_mfma_f32_32x32x16_bf16 v[72:87], v[232:235], a[44:47], v[72:87]
  buffer_load_dwordx4 a[96:99], v1, s[4:7], s88 offen offset:2048 sc1
  s_waitcnt vmcnt(13)
  v_mfma_f32_32x32x16_bf16 v[56:71], v[236:239], a[48:51], v[56:71]
  v_mfma_f32_32x32x16_bf16 v[72:87], v[240:243], a[48:51], v[72:87]
  buffer_load_dwordx4 a[100:103], v1, s[4:7], s89 offen offset:2048 sc1
  s_waitcnt vmcnt(12)
  v_mfma_f32_32x32x16_bf16 v[56:71], v[244:247], a[52:55], v[56:71]
  v_mfma_f32_32x32x16_bf16 v[72:87], v[248:251], a[52:55], v[72:87]
  buffer_load_dword v23, v13, s[4:7], 0 offen sc1
  buffer_load_dwordx4 a[104:107], v1, s[4:7], s90 offen offset:2048 sc1
  s_waitcnt vmcnt(13)
  v_mfma_f32_32x32x16_bf16 v[56:71], v[252:255], a[56:59], v[56:71]
  v_mfma_f32_32x32x16_bf16 v[72:87], a[128:131], a[56:59], v[72:87]
  buffer_load_dwordx4 a[108:111], v1, s[4:7], s91 offen offset:2048 sc1
  s_waitcnt vmcnt(13)
  v_mfma_f32_32x32x16_bf16 v[56:71], a[132:135], a[60:63], v[56:71]
  v_mfma_f32_32x32x16_bf16 v[72:87], a[136:139], a[60:63], v[72:87]
  buffer_load_dwordx4 a[112:115], v1, s[4:7], s88 offen offset:3072 sc1
  s_add_u32 s88, s88, 4096
  s_waitcnt vmcnt(13)
  v_mfma_f32_32x32x16_bf16 v[40:55], a[240:243], a[64:67], 0
  v_mfma_f32_32x32x16_bf16 v[24:39], a[236:239], a[64:67], v[24:39]
  buffer_load_dwordx4 a[116:119], v1, s[4:7], s89 offen offset:3072 sc1
  s_add_u32 s89, s89, 4096
  s_waitcnt vmcnt(13)
  v_mfma_f32_32x32x16_bf16 v[40:55], a[248:251], a[68:71], v[40:55]
  v_mfma_f32_32x32x16_bf16 v[24:39], a[244:247], a[68:71], v[24:39]
  buffer_load_dwordx4 a[120:123], v1, s[4:7], s90 offen offset:3072 sc1
  s_add_u32 s90, s90, 4096
  s_waitcnt vmcnt(13)
  v_mfma_f32_32x32x16_bf16 v[40:55], v[160:163], a[72:75], v[40:55]
  v_mfma_f32_32x32x16_bf16 v[24:39], a[252:255], a[72:75], v[24:39]
  buffer_load_dwordx4 a[124:127], v1, s[4:7], s91 offen offset:3072 sc1
  s_add_u32 s91, s91, 4096
  s_waitcnt vmcnt(13)
  v_mfma_f32_32x32x16_bf16 v[40:55], v[168:171], a[76:79], v[40:55]
  v_mfma_f32_32x32x16_bf16 v[24:39], v[164:167], a[76:79], v[24:39]
  s_waitcnt vmcnt(6)
  v_cmp_gt_u32 vcc, 12, v23
  s_cbranch_vccnz L_slow_85
L_back_86:
  buffer_load_dwordx4 a[0:3], v1, s[4:7], s92 offen offset:0 sc1
  s_waitcnt vmcnt(13)
  v_mfma_f32_32x32x16_bf16 v[40:55], v[176:179], a[80:83], v[40:55]
  v_mfma_f32_32x32x16_bf16 v[24:39], v[172:175], a[80:83], v[24:39]
  buffer_load_dwordx4 a[4:7], v1, s[4:7], s93 offen offset:0 sc1
  s_waitcnt vmcnt(13)
  v_mfma_f32_32x32x16_bf16 v[40:55], v[184:187], a[84:87], v[40:55]
  v_mfma_f32_32x32x16_bf16 v[24:39], v[180:183], a[84:87], v[24:39]
  buffer_load_dwordx4 a[8:11], v1, s[4:7], s94 offen offset:0 sc1
  s_waitcnt vmcnt(13)
  v_mfma_f32_32x32x16_bf16 v[40:55], v[192:195], a[88:91], v[40:55]
  v_mfma_f32_32x32x16_bf16 v[24:39], v[188:191], a[88:91], v[24:39]
  buffer_load_dwordx4 a[12:15], v1, s[4:7], s95 offen offset:0 sc1
  s_waitcnt vmcnt(13)
  v_mfma_f32_32x32x16_bf16 v[40:55], v[200:203], a[92:95], v[40:55]
  v_mfma_f32_32x32x16_bf16 v[24:39], v[196:199], a[92:95], v[24:39]
  buffer_load_dwordx4 a[16:19], v1, s[4:7], s92 offen offset:1024 sc1
  s_waitcnt vmcnt(13)
  v_mfma_f32_32x32x16_bf16 v[40:55], v[208:211], a[96:99], v[40:55]
  v_mfma_f32_32x32x16_bf16 v[24:39], v[204:207], a[96:99], v[24:39]
  buffer_load_dwordx4 a[20:23], v1, s[4:7], s93 offen offset:1024 sc1
  s_waitcnt vmcnt(13)
  v_mfma_f32_32x32x16_bf16 v[40:55], v[216:219], a[100:103], v[40:55]
  v_mfma_f32_32x32x16_bf16 v[24:39], v[212:215], a[100:103], v[24:39]
  buffer_load_dword v23, v13, s[4:7], 0 offen sc1
  buffer_load_dwordx4 a[24:27], v1, s[4:7], s94 offen offset:1024 sc1
  s_waitcnt vmcnt(13)
  v_mfma_f32_32x32x16_bf16 v[40:55], v[224:227], a[104:107], v[40:55]
  v_mfma_f32_32x32x16_bf16 v[24:39], v[220:223], a[104:107], v[24:39]
  buffer_load_dwordx4 a[28:31], v1, s[4:7], s95 offen offset:1024 sc1
  s_waitcnt vmcnt(13)
  v_mfma_f32_32x32x16_bf16 v[40:55], v[232:235], a[108:111], v[40:55]
  v_mfma_f32_32x32x16_bf16 v[24:39], v[228:231], a[108:111], v[24:39]
  buffer_load_dwordx4 a[32:35], v1, s[4:7], s88 offen offset:0 sc1
  s_waitcnt vmcnt(13)
  v_mfma_f32_32x32x16_bf16 v[40:55], v[240:243], a[112:115], v[40:55]
  v_mfma_f32_32x32x16_bf16 v[24:39], v[236:239], a[112:115], v[24:39]
  buffer_load_dwordx4 a[36:39], v1, s[4:7], s89 offen offset:0 sc1
  s_waitcnt vmcnt(13)
  v_mfma_f32_32x32x16_bf16 v[40:55], v[248:251], a[116:119], v[40:55]
  v_mfma_f32_32x32x16_bf16 v[24:39], v[244:247], a[116:119], v[24:39]
  buffer_load_dwordx4 a[40:43], v1, s[4:7], s90 offen offset:0 sc1
  s_waitcnt vmcnt(13)
  v_mfma_f32_32x32x16_bf16 v[40:55], a[128:131], a[120:123], v[40:55]
  v_mfma_f32_32x32x16_bf16 v[24:39], v[252:255], a[120:123], v[24:39]
  buffer_load_dwordx4 a[44:47], v1, s[4:7], s91 offen offset:0 sc1
  s_waitcnt vmcnt(13)
  v_mfma_f32_32x32x16_bf16 v[40:55], a[136:139], a[124:127], v[40:55]
  v_mfma_f32_32x32x16_bf16 v[24:39], a[132:135], a[124:127], v[24:39]
  s_waitcnt vmcnt(6)
  v_cmp_gt_u32 vcc, 13, v23
  s_cbranch_vccnz L_slow_87
L_back_88:
  buffer_load_dwordx4 a[48:51], v1, s[4:7], s92 offen offset:2048 sc1
  s_waitcnt vmcnt(13)
  v_mfma_f32_32x32x16_bf16 v[56:71], a[140:143], a[0:3], v[56:71]
  v_mfma_f32_32x32x16_bf16 v[72:87], a[144:147], a[0:3], v[72:87]
  buffer_load_dwordx4 a[52:55], v1, s[4:7], s93 offen offset:2048 sc1
  s_waitcnt vmcnt(13)
  v_mfma_f32_32x32x16_bf16 v[56:71], a[148:151], a[4:7], v[56:71]
  v_mfma_f32_32x32x16_bf16 v[72:87], a[152:155], a[4:7], v[72:87]
  buffer_load_dwordx4 a[56:59], v1, s[4:7], s94 offen offset:2048 sc1
  s_waitcnt vmcnt(13)
  v_mfma_f32_32x32x16_bf16 v[56:71], a[156:159], a[8:11], v[56:71]
  v_mfma_f32_32x32x16_bf16 v[72:87], a[160:163], a[8:11], v[72:87]
  buffer_load_dwordx4 a[60:63], v1, s[4:7], s95 offen offset:2048 sc1
  s_waitcnt vmcnt(13)
  v_mfma_f32_32x32x16_bf16 v[56:71], a[164:167], a[12:15], v[56:71]
  v_mfma_f32_32x32x16_bf16 v[72:87], a[168:171], a[12:15], v[72:87]
  buffer_load_dwordx4 a[64:67], v1, s[4:7], s88 offen offset:1024 sc1
  s_waitcnt vmcnt(13)
  v_mfma_f32_32x32x16_bf16 v[56:71], a[172:175], a[16:19], v[56:71]
  v_mfma_f32_32x32x16_bf16 v[72:87], a[176:179], a[16:19], v[72:87]
  buffer_load_dwordx4 a[68:71], v1, s[4:7], s89 offen offset:1024 sc1
  s_waitcnt vmcnt(13)
  v_mfma_f32_32x32x16_bf16 v[56:71], a[180:183], a[20:23], v[56:71]
  v_mfma_f32_32x32x16_bf16 v[72:87], a[184:187], a[20:23], v[72:87]
  buffer_load_dwordx4 a[72:75], v1, s[4:7], s90 offen offset:1024 sc1
  s_waitcnt vmcnt(12)
  v_mfma_f32_32x32x16_bf16 v[56:71], a[188:191], a[24:27], v[56:71]
  v_mfma_f32_32x32x16_bf16 v[72:87], a[192:195], a[24:27], v[72:87]
  buffer_load_dwordx4 a[76:79], v1, s[4:7], s91 offen offset:1024 sc1
  s_waitcnt vmcnt(12)
  v_mfma_f32_32x32x16_bf16 v[56:71], a[196:199], a[28:31], v[56:71]
  v_mfma_f32_32x32x16_bf16 v[72:87], a[200:203], a[28:31], v[72:87]
  buffer_load_dwordx4 a[80:83], v1, s[4:7], s88 offen offset:2048 sc1
  s_waitcnt vmcnt(8)
  v_mfma_f32_32x32x16_bf16 v[56:71], a[204:207], a[48:51], v[56:71]
  v_mfma_f32_32x32x16_bf16 v[72:87], a[208:211], a[48:51], v[72:87]
  buffer_load_dwordx4 a[84:87], v1, s[4:7], s89 offen offset:2048 sc1
  s_waitcnt vmcnt(8)
  v_mfma_f32_32x32x16_bf16 v[56:71], a[212:215], a[52:55], v[56:71]
  v_mfma_f32_32x32x16_bf16 v[72:87], a[216:219], a[52:55], v[72:87]
  buffer_load_dwordx4 a[88:91], v1, s[4:7], s90 offen offset:2048 sc1
  s_waitcnt vmcnt(8)
  v_mfma_f32_32x32x16_bf16 v[56:71], a[220:223], a[56:59], v[56:71]
  v_mfma_f32_32x32x16_bf16 v[72:87], a[224:227], a[56:59], v[72:87]
  buffer_load_dwordx4 a[92:95], v1, s[4:7], s91 offen offset:2048 sc1
  s_waitcnt vmcnt(8)
  v_mfma_f32_32x32x16_bf16 v[56:71], a[228:231], a[60:63], v[56:71]
  v_mfma_f32_32x32x16_bf16 v[72:87], a[232:235], a[60:63], v[72:87]
  s_waitcnt vmcnt(15)
  v_mfma_f32_32x32x16_bf16 v[40:55], a[144:147], a[32:35], v[40:55]
  s_waitcnt vmcnt(14)
  v_mfma_f32_32x32x16_bf16 v[40:55], a[152:155], a[36:39], v[40:55]
  s_waitcnt vmcnt(13)
  v_mfma_f32_32x32x16_bf16 v[40:55], a[160:163], a[40:43], v[40:55]
  s_nop 4
  ds_write_b128 v90, v[56:59] offset:0
  s_waitcnt vmcnt(12)
  v_mfma_f32_32x32x16_bf16 v[40:55], a[168:171], a[44:47], v[40:55]
  ds_write_b128 v90, v[60:63] offset:1024
  s_waitcnt vmcnt(7)
  v_mfma_f32_32x32x16_bf16 v[40:55], a[176:179], a[64:67], v[40:55]
  ds_write_b128 v90, v[64:67] offset:2048
  s_waitcnt vmcnt(6)
  v_mfma_f32_32x32x16_bf16 v[40:55], a[184:187], a[68:71], v[40:55]
  ds_write_b128 v90, v[68:71] offset:3072
  s_waitcnt vmcnt(5)
  v_mfma_f32_32x32x16_bf16 v[40:55], a[192:195], a[72:75], v[40:55]
  ds_write_b128 v91, v[72:75] offset:0
  s_waitcnt vmcnt(4)
  v_mfma_f32_32x32x16_bf16 v[40:55], a[200:203], a[76:79], v[40:55]
  ds_write_b128 v91, v[76:79] offset:1024
  s_waitcnt vmcnt(3)
  v_mfma_f32_32x32x16_bf16 v[40:55], a[208:211], a[80:83], v[40:55]
  ds_write_b128 v91, v[80:83] offset:2048
  v_mfma_f32_32x32x16_bf16 v[24:39], a[140:143], a[32:35], v[24:39]
  ds_write_b128 v91, v[84:87] offset:3072
  s_waitcnt vmcnt(2)
  v_mfma_f32_32x32x16_bf16 v[40:55], a[216:219], a[84:87], v[40:55]
  s_waitcnt lgkmcnt(0)
  s_barrier
  v_mfma_f32_32x32x16_bf16 v[24:39], a[148:151], a[36:39], v[24:39]
  ds_read_b128 v[96:99], v92 offset:0
  ds_read_b128 v[100:103], v92 offset:1024
  s_waitcnt vmcnt(1)
  v_mfma_f32_32x32x16_bf16 v[40:55], a[224:227], a[88:91], v[40:55]
  ds_read_b128 v[104:107], v92 offset:2048
  ds_read_b128 v[108:111], v92 offset:3072
  v_mfma_f32_32x32x16_bf16 v[24:39], a[156:159], a[40:43], v[24:39]
  ds_read_b128 v[112:115], v92 offset:4096
  ds_read_b128 v[116:119], v92 offset:5120
  s_waitcnt vmcnt(0)
  v_mfma_f32_32x32x16_bf16 v[40:55], a[232:235], a[92:95], v[40:55]
  ds_read_b128 v[120:123], v92 offset:6144
  v_mfma_f32_32x32x16_bf16 v[24:39], a[164:167], a[44:47], v[24:39]
  ds_read_b128 v[124:127], v92 offset:7168
  v_mfma_f32_32x32x16_bf16 v[24:39], a[172:175], a[64:67], v[24:39]
  s_nop 7
  ds_write_b128 v89, v[40:43] offset:0
  v_mfma_f32_32x32x16_bf16 v[24:39], a[180:183], a[68:71], v[24:39]
  ds_write_b128 v89, v[44:47] offset:1024
  v_mfma_f32_32x32x16_bf16 v[24:39], a[188:191], a[72:75], v[24:39]
  ds_write_b128 v89, v[48:51] offset:2048
  v_mfma_f32_32x32x16_bf16 v[24:39], a[196:199], a[76:79], v[24:39]
  ds_write_b128 v89, v[52:55] offset:3072
  s_waitcnt lgkmcnt(0)
  s_barrier
  ds_read_b128 v[56:59], v88 offset:0
  ds_read_b128 v[60:63], v88 offset:1024
  ds_read_b128 v[64:67], v88 offset:2048
  ds_read_b128 v[68:71], v88 offset:3072
  v_mfma_f32_32x32x16_bf16 v[24:39], a[204:207], a[80:83], v[24:39]
  v_add_f32 v96, v96, v112
  v_add_f32 v97, v97, v113
  v_add_f32 v98, v98, v114
  v_add_f32 v99, v99, v115
  v_mfma_f32_32x32x16_bf16 v[24:39], a[212:215], a[84:87], v[24:39]
  v_add_f32 v100, v100, v116
  v_add_f32 v101, v101, v117
  v_add_f32 v102, v102, v118
  v_add_f32 v103, v103, v119
  v_mfma_f32_32x32x16_bf16 v[24:39], a[220:223], a[88:91], v[24:39]
  v_add_f32 v104, v104, v120
  v_add_f32 v105, v105, v121
  v_add_f32 v106, v106, v122
  v_add_f32 v107, v107, v123
  v_mfma_f32_32x32x16_bf16 v[24:39], a[228:231], a[92:95], v[24:39]
  v_add_f32 v108, v108, v124
  v_add_f32 v109, v109, v125
  v_add_f32 v110, v110, v126
  v_add_f32 v111, v111, v127
  s_waitcnt lgkmcnt(0)
  v_pk_add_f32 v[96:97], v[96:97], v[56:57]
  v_pk_add_f32 v[98:99], v[98:99], v[58:59]
  v_pk_add_f32 v[100:101], v[100:101], v[60:61]
  v_pk_add_f32 v[102:103], v[102:103], v[62:63]
  v_pk_add_f32 v[104:105], v[104:105], v[64:65]
  v_pk_add_f32 v[106:107], v[106:107], v[66:67]
  v_pk_add_f32 v[108:109], v[108:109], v[68:69]
  v_pk_add_f32 v[110:111], v[110:111], v[70:71]
  v_pk_add_f32 v[24:25], v[24:25], v[96:97]
  v_pk_add_f32 v[26:27], v[26:27], v[98:99]
  v_pk_add_f32 v[28:29], v[28:29], v[100:101]
  v_pk_add_f32 v[30:31], v[30:31], v[102:103]
  v_pk_add_f32 v[32:33], v[32:33], v[104:105]
  v_pk_add_f32 v[34:35], v[34:35], v[106:107]
  v_pk_add_f32 v[36:37], v[36:37], v[108:109]
  v_pk_add_f32 v[38:39], v[38:39], v[110:111]
  v_cvt_pk_bf16_f32 v44, v24, v25
  v_cvt_pk_bf16_f32 v45, v26, v27
  v_cvt_pk_bf16_f32 v46, v28, v29
  v_cvt_pk_bf16_f32 v47, v30, v31
  buffer_store_dwordx4 v[44:47], v14, s[8:11], s52 offen offset:0
  v_cvt_pk_bf16_f32 v48, v32, v33
  v_cvt_pk_bf16_f32 v49, v34, v35
  v_cvt_pk_bf16_f32 v50, v36, v37
  v_cvt_pk_bf16_f32 v51, v38, v39
  buffer_store_dwordx4 v[48:51], v14, s[8:11], s52 offen offset:32
L_end:
L_exit:
  s_endpgm
L_slow_1:
L_poll_89:
  buffer_load_dword v22, v174, s[96:99], 0 offen sc1
  s_waitcnt vmcnt(0)
  v_cmp_gt_u32 vcc, s34, v22
  s_cbranch_vccz L_pdone_90
  s_sub_u32 s20, s20, 1
  s_cbranch_scc0 L_poll_89
  s_mov_b32 s20, 0
L_pdone_90:
  s_branch L_back_2
L_slow_4:
L_poll_91:
  buffer_load_dwordx2 v[22:23], v175, s[4:7], 0 offen sc1
  s_waitcnt vmcnt(0)
  v_cmp_gt_u32 vcc, 1, v22
  s_cbranch_vccz L_pdone_92
  s_sub_u32 s20, s20, 1
  s_cbranch_scc0 L_poll_91
  s_mov_b32 s20, 0
L_pdone_92:
  s_branch L_back_5
L_far_8:
  buffer_store_dword v22, off, s[4:7], s77 sc1
  s_mov_b64 exec, -1
  s_branch L_sig_7
L_slow_9:
L_poll_93:
  buffer_load_dword v22, v175, s[4:7], 0 offen sc1
  s_waitcnt vmcnt(0)
  v_cmp_gt_u32 vcc, 1, v22
  s_cbranch_vccz L_pdone_94
  s_sub_u32 s20, s20, 1
  s_cbranch_scc0 L_poll_93
  s_mov_b32 s20, 0
L_pdone_94:
  s_branch L_back_10
L_slow_11:
L_poll_95:
  buffer_load_dword v22, v12, s[4:7], 0 offen sc1
  s_waitcnt vmcnt(0)
  v_cmp_gt_u32 vcc, 2, v22
  s_cbranch_vccz L_pdone_96
  s_sub_u32 s20, s20, 1
  s_cbranch_scc0 L_poll_95
  s_mov_b32 s20, 0
L_pdone_96:
  s_branch L_back_12
L_slow_14:
L_poll_97:
  buffer_load_dword v22, v16, s[4:7], 0 offen sc1
  s_waitcnt vmcnt(0)
  v_cmp_gt_u32 vcc, 1, v22
  s_cbranch_vccz L_pdone_98
  s_sub_u32 s20, s20, 1
  s_cbranch_scc0 L_poll_97
  s_mov_b32 s20, 0
L_pdone_98:
  s_branch L_back_15
L_far_20:
  buffer_store_dword v22, off, s[4:7], s77 sc1
  s_mov_b64 exec, -1
  s_branch L_sig_19
L_attfb_18:
  s_cmp_lg_u32 s58, 0
  s_cbranch_scc1 L_attok_17
  s_waitcnt vmcnt(0)
  s_mov_b32 s58, 1
  s_mov_b32 s54, 0
  v_mov_b32 v192, 0xff800000
  v_mov_b32 v208, 0xff800000
L_truemax_99:
  buffer_load_dwordx4 v[120:123], v1, s[8:11], s54 offen offset:0
  s_add_u32 s54, s54, 2048
  s_waitcnt vmcnt(0)
  v_mfma_f32_32x32x16_bf16 v[24:39], v[120:123], a[240:243], 0
  v_mfma_f32_32x32x16_bf16 v[40:55], v[120:123], a[244:247], 0
  s_nop 10
  v_max3_f32 v192, v24, v25, v192
  v_max3_f32 v192, v26, v27, v192
  v_max3_f32 v192, v28, v29, v192
  v_max3_f32 v192, v30, v31, v192
  v_max3_f32 v192, v32, v33, v192
  v_max3_f32 v192, v34, v35, v192
  v_max3_f32 v192, v36, v37, v192
  v_max3_f32 v192, v38, v39, v192
  v_max3_f32 v208, v40, v41, v208
  v_max3_f32 v208, v42, v43, v208
  v_max3_f32 v208, v44, v45, v208
  v_max3_f32 v208, v46, v47, v208
  v_max3_f32 v208, v48, v49, v208
  v_max3_f32 v208, v50, v51, v208
  v_max3_f32 v208, v52, v53, v208
  v_max3_f32 v208, v54, v55, v208
  s_cmp_lt_u32 s54, 0x20000
  s_cbranch_scc1 L_truemax_99
  v_mov_b32 v193, v192
  s_nop 1
  v_permlane32_swap_b32 v192, v193
  v_max_f32 v192, v192, v193
  v_sub_f32 v56, 0, v192
  v_sub_f32 v57, 0, v192
  v_mov_b64 v[58:59], v[56:57]
  v_mov_b64 v[60:61], v[56:57]
  v_mov_b64 v[62:63], v[56:57]
  v_mov_b64 v[64:65], v[56:57]
  v_mov_b64 v[66:67], v[56:57]
  v_mov_b64 v[68:69], v[56:57]
  v_mov_b64 v[70:71], v[56:57]
  v_mov_b32 v209, v208
  s_nop 1
  v_permlane32_swap_b32 v208, v209
  v_max_f32 v208, v208, v209
  v_sub_f32 v72, 0, v208
  v_sub_f32 v73, 0, v208
  v_mov_b64 v[74:75], v[72:73]
  v_mov_b64 v[76:77], v[72:73]
  v_mov_b64 v[78:79], v[72:73]
  v_mov_b64 v[80:81], v[72:73]
  v_mov_b64 v[82:83], v[72:73]
  v_mov_b64 v[84:85], v[72:73]
  v_mov_b64 v[86:87], v[72:73]
  v_mov_b32 v192, 0
  v_mov_b32 v208, 0
  v_mov_b32 v193, 0
  v_mov_b32 v209, 0
  v_mov_b32 v194, 0
  v_mov_b32 v210, 0
  v_mov_b32 v195, 0
  v_mov_b32 v211, 0
  v_mov_b32 v196, 0
  v_mov_b32 v212, 0
  v_mov_b32 v197, 0
  v_mov_b32 v213, 0
  v_mov_b32 v198, 0
  v_mov_b32 v214, 0
  v_mov_b32 v199, 0
  v_mov_b32 v215, 0
  v_mov_b32 v200, 0
  v_mov_b32 v216, 0
  v_mov_b32 v201, 0
  v_mov_b32 v217, 0
  v_mov_b32 v202, 0
  v_mov_b32 v218, 0
  v_mov_b32 v203, 0
  v_mov_b32 v219, 0
  v_mov_b32 v204, 0
  v_mov_b32 v220, 0
  v_mov_b32 v205, 0
  v_mov_b32 v221, 0
  v_mov_b32 v206, 0
  v_mov_b32 v222, 0
  v_mov_b32 v207, 0
  v_mov_b32 v223, 0
  s_mov_b32 s54, 0
L_redo_100:
  buffer_load_dwordx4 v[120:123], v1, s[8:11], s54 offen offset:0
  s_mov_b64 exec, s[28:29]
  buffer_load_dwordx4 v[176:179], v2, s[8:11], s54 offen offset:1024
  buffer_load_dwordx4 v[180:183], v2, s[8:11], s54 offen offset:1536
  s_mov_b64 exec, -1
  s_add_u32 s54, s54, 2048
  s_waitcnt vmcnt(0)
  v_mfma_f32_32x32x16_bf16 v[24:39], v[120:123], a[240:243], v[56:71]
  v_mfma_f32_32x32x16_bf16 v[40:55], v[120:123], a[244:247], v[72:87]
  s_nop 10
  v_exp_f32 v24, v24
  v_exp_f32 v25, v25
  v_exp_f32 v26, v26
  v_exp_f32 v27, v27
  v_exp_f32 v28, v28
  v_exp_f32 v29, v29
  v_exp_f32 v30, v30
  v_exp_f32 v31, v31
  v_exp_f32 v32, v32
  v_exp_f32 v33, v33
  v_exp_f32 v34, v34
  v_exp_f32 v35, v35
  v_exp_f32 v36, v36
  v_exp_f32 v37, v37
  v_exp_f32 v38, v38
  v_exp_f32 v39, v39
  v_exp_f32 v40, v40
  v_exp_f32 v41, v41
  v_exp_f32 v42, v42
  v_exp_f32 v43, v43
  v_exp_f32 v44, v44
  v_exp_f32 v45, v45
  v_exp_f32 v46, v46
  v_exp_f32 v47, v47
  v_exp_f32 v48, v48
  v_exp_f32 v49, v49
  v_exp_f32 v50, v50
  v_exp_f32 v51, v51
  v_exp_f32 v52, v52
  v_exp_f32 v53, v53
  v_exp_f32 v54, v54
  v_exp_f32 v55, v55
  v_smfmac_f32_32x32x32_bf16 v[192:207], v[176:179], v[24:31], v3
  v_smfmac_f32_32x32x32_bf16 v[192:207], v[180:183], v[32:39], v3
  v_smfmac_f32_32x32x32_bf16 v[208:223], v[176:179], v[40:47], v3
  v_smfmac_f32_32x32x32_bf16 v[208:223], v[180:183], v[48:55], v3
  s_nop 15
  s_cmp_lt_u32 s54, 0x20000
  s_cbranch_scc1 L_redo_100
  s_branch L_attepi_16
L_far_24:
  buffer_store_dword v22, off, s[4:7], s77 sc1
  s_mov_b64 exec, -1
  s_branch L_sig_23
L_far_28:
  buffer_store_dword v22, off, s[4:7], s77 sc1
  s_mov_b64 exec, -1
  s_branch L_sig_27
L_slow_29:
L_poll_101:
  buffer_load_dword v22, v13, s[4:7], 0 offen sc1
  s_waitcnt vmcnt(0)
  v_cmp_gt_u32 vcc, 4, v22
  s_cbranch_vccz L_pdone_102
  s_sub_u32 s20, s20, 1
  s_cbranch_scc0 L_poll_101
  s_mov_b32 s20, 0
L_pdone_102:
  s_branch L_back_30
L_far_32:
  buffer_store_dword v22, off, s[4:7], s77 sc1
  s_mov_b64 exec, -1
  s_branch L_sig_31
L_far_34:
  buffer_store_dword v22, off, s[4:7], s77 sc1
  s_mov_b64 exec, -1
  s_branch L_sig_33
L_slow_35:
L_poll_103:
  buffer_load_dword v22, v13, s[4:7], 0 offen sc1
  s_waitcnt vmcnt(0)
  v_cmp_gt_u32 vcc, 5, v22
  s_cbranch_vccz L_pdone_104
  s_sub_u32 s20, s20, 1
  s_cbranch_scc0 L_poll_103
  s_mov_b32 s20, 0
L_pdone_104:
  s_branch L_back_36
L_slow_37:
L_poll_105:
  buffer_load_dword v22, v13, s[4:7], 0 offen sc1
  s_waitcnt vmcnt(0)
  v_cmp_gt_u32 vcc, 6, v22
  s_cbranch_vccz L_pdone_106
  s_sub_u32 s20, s20, 1
  s_cbranch_scc0 L_poll_105
  s_mov_b32 s20, 0
L_pdone_106:
  s_branch L_back_38
L_far_39:
  buffer_store_dwordx4 v[44:47], v1, s[4:7], s52 offen offset:0 sc1
  s_branch L_back_40
L_far_41:
  buffer_store_dwordx4 v[48:51], v1, s[4:7], s52 offen offset:1024 sc1
  s_branch L_back_42
L_far_43:
  buffer_store_dword v40, v19, s[4:7], s53 offen offset:0 sc1
  s_branch L_back_44
L_far_46:
  buffer_store_dword v22, off, s[4:7], s77 sc1
  s_mov_b64 exec, -1
  s_branch L_sig_45
L_far_51:
  buffer_store_dword v22, off, s[4:7], s77 sc1
  s_mov_b64 exec, -1
  s_branch L_sig_50
L_slow_52:
L_poll_107:
  buffer_load_dword v22, v175, s[4:7], 0 offen sc1
  s_waitcnt vmcnt(0)
  v_cmp_gt_u32 vcc, 8, v22
  s_cbranch_vccz L_pdone_108
  s_sub_u32 s20, s20, 1
  s_cbranch_scc0 L_poll_107
  s_mov_b32 s20, 0
L_pdone_108:
  s_branch L_back_53
L_slow_54:
L_poll_109:
  buffer_load_dword v22, v12, s[4:7], 0 offen sc1
  s_waitcnt vmcnt(0)
  v_cmp_gt_u32 vcc, 3, v22
  s_cbranch_vccz L_pdone_110
  s_sub_u32 s20, s20, 1
  s_cbranch_scc0 L_poll_109
  s_mov_b32 s20, 0
L_pdone_110:
  s_branch L_back_55
L_far_59:
  buffer_store_dwordx4 v[24:27], v1, s[4:7], s38 offen sc1
  s_branch L_back_60
L_far_61:
  buffer_store_dwordx4 v[40:43], v1, s[4:7], s39 offen sc1
  s_branch L_back_62
L_far_64:
  buffer_store_dword v22, off, s[4:7], s77 sc1
  s_mov_b64 exec, -1
  s_branch L_sig_63
L_attfb_58:
  s_cmp_lg_u32 s58, 0
  s_cbranch_scc1 L_attok_57
  s_waitcnt vmcnt(0)
  s_mov_b32 s58, 1
  s_mov_b32 s54, 0
  v_mov_b32 v192, 0xff800000
  v_mov_b32 v208, 0xff800000
L_truemax_111:
  buffer_load_dwordx4 v[120:123], v1, s[8:11], s54 offen offset:0
  s_add_u32 s54, s54, 2048
  s_waitcnt vmcnt(0)
  v_mfma_f32_32x32x16_bf16 v[24:39], v[120:123], a[240:243], 0
  v_mfma_f32_32x32x16_bf16 v[40:55], v[120:123], a[244:247], 0
  s_nop 10
  v_max3_f32 v192, v24, v25, v192
  v_max3_f32 v192, v26, v27, v192
  v_max3_f32 v192, v28, v29, v192
  v_max3_f32 v192, v30, v31, v192
  v_max3_f32 v192, v32, v33, v192
  v_max3_f32 v192, v34, v35, v192
  v_max3_f32 v192, v36, v37, v192
  v_max3_f32 v192, v38, v39, v192
  v_max3_f32 v208, v40, v41, v208
  v_max3_f32 v208, v42, v43, v208
  v_max3_f32 v208, v44, v45, v208
  v_max3_f32 v208, v46, v47, v208
  v_max3_f32 v208, v48, v49, v208
  v_max3_f32 v208, v50, v51, v208
  v_max3_f32 v208, v52, v53, v208
  v_max3_f32 v208, v54, v55, v208
  s_cmp_lt_u32 s54, 0x20000
  s_cbranch_scc1 L_truemax_111
  v_mov_b32 v193, v192
  s_nop 1
  v_permlane32_swap_b32 v192, v193
  v_max_f32 v192, v192, v193
  v_sub_f32 v56, 0, v192
  v_sub_f32 v57, 0, v192
  v_mov_b64 v[58:59], v[56:57]
  v_mov_b64 v[60:61], v[56:57]
  v_mov_b64 v[62:63], v[56:57]
  v_mov_b64 v[64:65], v[56:57]
  v_mov_b64 v[66:67], v[56:57]
  v_mov_b64 v[68:69], v[56:57]
  v_mov_b64 v[70:71], v[56:57]
  v_mov_b32 v209, v208
  s_nop 1
  v_permlane32_swap_b32 v208, v209
  v_max_f32 v208, v208, v209
  v_sub_f32 v72, 0, v208
  v_sub_f32 v73, 0, v208
  v_mov_b64 v[74:75], v[72:73]
  v_mov_b64 v[76:77], v[72:73]
  v_mov_b64 v[78:79], v[72:73]
  v_mov_b64 v[80:81], v[72:73]
  v_mov_b64 v[82:83], v[72:73]
  v_mov_b64 v[84:85], v[72:73]
  v_mov_b64 v[86:87], v[72:73]
  v_mov_b32 v192, 0
  v_mov_b32 v208, 0
  v_mov_b32 v193, 0
  v_mov_b32 v209, 0
  v_mov_b32 v194, 0
  v_mov_b32 v210, 0
  v_mov_b32 v195, 0
  v_mov_b32 v211, 0
  v_mov_b32 v196, 0
  v_mov_b32 v212, 0
  v_mov_b32 v197, 0
  v_mov_b32 v213, 0
  v_mov_b32 v198, 0
  v_mov_b32 v214, 0
  v_mov_b32 v199, 0
  v_mov_b32 v215, 0
  v_mov_b32 v200, 0
  v_mov_b32 v216, 0
  v_mov_b32 v201, 0
  v_mov_b32 v217, 0
  v_mov_b32 v202, 0
  v_mov_b32 v218, 0
  v_mov_b32 v203, 0
  v_mov_b32 v219, 0
  v_mov_b32 v204, 0
  v_mov_b32 v220, 0
  v_mov_b32 v205, 0
  v_mov_b32 v221, 0
  v_mov_b32 v206, 0
  v_mov_b32 v222, 0
  v_mov_b32 v207, 0
  v_mov_b32 v223, 0
  s_mov_b32 s54, 0
L_redo_112:
  buffer_load_dwordx4 v[120:123], v1, s[8:11], s54 offen offset:0
  s_mov_b64 exec, s[28:29]
  buffer_load_dwordx4 v[176:179], v2, s[8:11], s54 offen offset:1024
  buffer_load_dwordx4 v[180:183], v2, s[8:11], s54 offen offset:1536
  s_mov_b64 exec, -1
  s_add_u32 s54, s54, 2048
  s_waitcnt vmcnt(0)
  v_mfma_f32_32x32x16_bf16 v[24:39], v[120:123], a[240:243], v[56:71]
  v_mfma_f32_32x32x16_bf16 v[40:55], v[120:123], a[244:247], v[72:87]
  s_nop 10
  v_exp_f32 v24, v24
  v_exp_f32 v25, v25
  v_exp_f32 v26, v26
  v_exp_f32 v27, v27
  v_exp_f32 v28, v28
  v_exp_f32 v29, v29
  v_exp_f32 v30, v30
  v_exp_f32 v31, v31
  v_exp_f32 v32, v32
  v_exp_f32 v33, v33
  v_exp_f32 v34, v34
  v_exp_f32 v35, v35
  v_exp_f32 v36, v36
  v_exp_f32 v37, v37
  v_exp_f32 v38, v38
  v_exp_f32 v39, v39
  v_exp_f32 v40, v40
  v_exp_f32 v41, v41
  v_exp_f32 v42, v42
  v_exp_f32 v43, v43
  v_exp_f32 v44, v44
  v_exp_f32 v45, v45
  v_exp_f32 v46, v46
  v_exp_f32 v47, v47
  v_exp_f32 v48, v48
  v_exp_f32 v49, v49
  v_exp_f32 v50, v50
  v_exp_f32 v51, v51
  v_exp_f32 v52, v52
  v_exp_f32 v53, v53
  v_exp_f32 v54, v54
  v_exp_f32 v55, v55
  v_smfmac_f32_32x32x32_bf16 v[192:207], v[176:179], v[24:31], v3
  v_smfmac_f32_32x32x32_bf16 v[192:207], v[180:183], v[32:39], v3
  v_smfmac_f32_32x32x32_bf16 v[208:223], v[176:179], v[40:47], v3
  v_smfmac_f32_32x32x32_bf16 v[208:223], v[180:183], v[48:55], v3
  s_nop 15
  s_cmp_lt_u32 s54, 0x20000
  s_cbranch_scc1 L_redo_112
  s_branch L_attepi_56
L_far_67:
  buffer_store_dwordx4 v[44:47], v1, s[4:7], s52 offen offset:0 sc1
  s_branch L_back_68
L_far_69:
  buffer_store_dwordx4 v[48:51], v1, s[4:7], s52 offen offset:1024 sc1
  s_branch L_back_70
L_far_71:
  buffer_store_dword v40, v19, s[4:7], s53 offen offset:0 sc1
  s_branch L_back_72
L_far_74:
  buffer_store_dword v22, off, s[4:7], s77 sc1
  s_mov_b64 exec, -1
  s_branch L_sig_73
L_far_78:
  buffer_store_dword v22, off, s[4:7], s77 sc1
  s_mov_b64 exec, -1
  s_branch L_sig_77
L_slow_79:
L_poll_113:
  buffer_load_dword v22, v13, s[4:7], 0 offen sc1
  s_waitcnt vmcnt(0)
  v_cmp_gt_u32 vcc, 11, v22
  s_cbranch_vccz L_pdone_114
  s_sub_u32 s20, s20, 1
  s_cbranch_scc0 L_poll_113
  s_mov_b32 s20, 0
L_pdone_114:
  s_branch L_back_80
L_far_82:
  buffer_store_dword v22, off, s[4:7], s77 sc1
  s_mov_b64 exec, -1
  s_branch L_sig_81
L_far_84:
  buffer_store_dword v22, off, s[4:7], s77 sc1
  s_mov_b64 exec, -1
  s_branch L_sig_83
L_slow_85:
L_poll_115:
  buffer_load_dword v22, v13, s[4:7], 0 offen sc1
  s_waitcnt vmcnt(0)
  v_cmp_gt_u32 vcc, 12, v22
  s_cbranch_vccz L_pdone_116
  s_sub_u32 s20, s20, 1
  s_cbranch_scc0 L_poll_115
  s_mov_b32 s20, 0
L_pdone_116:
  s_branch L_back_86
L_slow_87:
L_poll_117:
  buffer_load_dword v22, v13, s[4:7], 0 offen sc1
  s_waitcnt vmcnt(0)
  v_cmp_gt_u32 vcc, 13, v22
  s_cbranch_vccz L_pdone_118
  s_sub_u32 s20, s20, 1
  s_cbranch_scc0 L_poll_117
  s_mov_b32 s20, 0
L_pdone_118:
  s_branch L_back_88
L_last:
  s_endpgm

.section .rodata,"a"
.p2align 6
.amdhsa_kernel interleave_layers__mha_block__glu_gated_swiglu__prompt_kernel
  .amdhsa_next_free_vgpr 512
  .amdhsa_next_free_sgpr 102
  .amdhsa_accum_offset 256
  .amdhsa_group_segment_fixed_size 0
  .amdhsa_kernarg_size 80
  .amdhsa_user_sgpr_count 2
  .amdhsa_user_sgpr_kernarg_segment_ptr 1
  .amdhsa_system_sgpr_workgroup_id_x 1
.end_amdhsa_kernel
```
